```python
import torch

def _softmax(x, axis=-1):
    return torch.softmax(x, dim=axis)
def _gelu(x):
    return torch.nn.functional.gelu(x, approximate="tanh")
def _silu(x):
    return torch.nn.functional.silu(x)
def _sigmoid(x):
    return torch.sigmoid(x)
def _layernorm(x, axis=-1, eps=1e-5):
    m = x.mean(dim=axis, keepdim=True)
    v = x.var(dim=axis, keepdim=True, unbiased=False)
    return (x - m) / torch.sqrt(v + eps)
def _scatter_add(tgt, idx, src, axis=0):
    return tgt.clone().index_add_(axis, idx, src)
def _segment_sum(src, seg, n):
    out = torch.zeros((n,) + src.shape[1:], dtype=src.dtype)
    return out.index_add_(0, seg, src)
def _pad(x, pw):
    flat = tuple(v for pair in reversed(pw) for v in pair)
    return torch.nn.functional.pad(x, flat)

kernel_name = 'interleave_layers__sliding_local_dilated__linear_kernel_hedgehog__prompt'

def setup_inputs():

    _w = (lambda a: (lambda t: t.to(torch.bfloat16) if t.is_floating_point() else t)(torch.as_tensor(a)))
    def _A_setup():
        B, S, D = 1, 2048, 640
        return {
            "x": _w((lambda *s: torch.randn(*s, dtype=torch.bfloat16) * 0.05)(B, S, D)),
            "wqkv": _w((lambda *s: torch.randn(*s, dtype=torch.bfloat16) * 0.05)(D, 3 * D)),
            "wo": _w((lambda *s: torch.randn(*s, dtype=torch.bfloat16) * 0.05)(D, D)),
        }
    _A_in = _A_setup()

    def _B_setup():
        B, S, D, H = 1, 2048, 640, 32
        Dh = D // H
        return {
            "x": _w((lambda *s: torch.randn(*s, dtype=torch.bfloat16) * 0.05)(B, S, D)),
            "wqkv": _w((lambda *s: torch.randn(*s, dtype=torch.bfloat16) * 0.4)(D, 3 * D)),
            "w_phi": _w((lambda *s: torch.randn(*s, dtype=torch.bfloat16) * 0.4)(H, Dh, Dh) * (Dh ** -0.5)),
            "wo": _w((lambda *s: torch.randn(*s, dtype=torch.bfloat16) * 0.1)(D, D)),
        }
    _B_in = _B_setup()

    return {
        "A_x": _A_in["x"],
        "A_wqkv": _A_in["wqkv"],
        "A_wo": _A_in["wo"],
        "B_x": _B_in["x"],
        "B_wqkv": _B_in["wqkv"],
        "B_w_phi": _B_in["w_phi"],
        "B_wo": _B_in["wo"],
    }

def reference(A_x, A_wqkv, A_wo, B_x, B_wqkv, B_w_phi, B_wo):
    def _A_ref(x, wqkv, wo):
        B, S, D = x.shape
        H = 32; Dh = D // H
        W, dil = 8, 2
        qkv = (lambda x, *d: x.permute(*d))((x @ wqkv).reshape(B, S, 3, H, Dh), 2, 0, 3, 1, 4)
        q, k, v = qkv[0], qkv[1], qkv[2]
        scale = Dh ** -0.5
        pos = torch.arange(S)
        off = torch.arange(W) * dil
        idx = pos[:, None] - off[None, :]
        mask = idx >= 0
        idx_c = torch.where(mask, idx, 0).reshape(-1)
        kg = k[:, :, idx_c, :].reshape(B, H, S, W, Dh)
        vg = v[:, :, idx_c, :].reshape(B, H, S, W, Dh)
        logits = torch.einsum("bhsd,bhswd->bhsw", q, kg) * scale
        logits = torch.where(mask[None, None, :, :], logits, -1e9)
        attn = _softmax(logits, axis=-1)
        o = torch.einsum("bhsw,bhswd->bhsd", attn, vg)
        return (lambda x, *d: x.permute(*d))(o, 0, 2, 1, 3).reshape(B, S, D) @ wo

    def _B_ref(x, wqkv, w_phi, wo):
        B, S, D = x.shape
        H = 32; Dh = D // H
        qkv = (lambda x, *d: x.permute(*d))((x @ wqkv).reshape(B, S, 3, H, Dh), 2, 0, 3, 1, 4)
        q, k, v = qkv[0], qkv[1], qkv[2]
        pq = torch.einsum("bhsd,hdf->bhsf", q, w_phi)
        pk = torch.einsum("bhsd,hdf->bhsf", k, w_phi)
        phi_q = torch.concatenate([_softmax(pq, axis=-1), _softmax(-pq, axis=-1)], axis=-1)
        phi_k = torch.concatenate([_softmax(pk, axis=-1), _softmax(-pk, axis=-1)], axis=-1)
        kv = torch.einsum("bhsf,bhsd->bhfd", phi_k, v)
        z  = torch.einsum("bhsf->bhf", phi_k)
        num = torch.einsum("bhqf,bhfd->bhqd", phi_q, kv)
        den = torch.einsum("bhqf,bhf->bhq", phi_q, z)[..., None] + 1e-6
        o = num / den
        return (lambda x, *d: x.permute(*d))(o, 0, 2, 1, 3).reshape(B, S, D) @ wo

    x = A_x
    x = x + _A_ref(_layernorm(x, axis=-1), A_wqkv, A_wo)
    x = x + _B_ref(_layernorm(x, axis=-1), B_wqkv, B_w_phi, B_wo)
    x = x + _A_ref(_layernorm(x, axis=-1), A_wqkv, A_wo)
    x = x + _B_ref(_layernorm(x, axis=-1), B_wqkv, B_w_phi, B_wo)
    return x
```

```asm
; @launch grid=(256,1,1) block=(256,1,1) lds=163840
.amdgcn_target "amdgcn-amd-amdhsa--gfx950"
.text
.globl interleave_layers__sliding_local_dilated__linear_kernel_hedgehog__prompt_kernel
.p2align 8
.type interleave_layers__sliding_local_dilated__linear_kernel_hedgehog__prompt_kernel,@function
interleave_layers__sliding_local_dilated__linear_kernel_hedgehog__prompt_kernel:
L_start:
    s_getpc_b64 s[84:85]
    s_and_b32 s84, s84, 0xffffff00
    s_cmp_ge_u32 s2, 256
    s_cbranch_scc1 L_end
    s_load_dwordx16 s[64:79], s[0:1], 0
    s_load_dwordx4 s[80:83], s[0:1], 64
    v_lshrrev_b32 v1, 6, v0
    v_and_b32 v21, 63, v0
    v_readfirstlane_b32 s44, v1
    s_and_b32 s52, s2, 7
    s_lshr_b32 s53, s2, 3
    s_and_b32 s48, s52, 1
    s_lshr_b32 s52, s52, 1
    s_lshl_b32 s52, s52, 2
    s_lshr_b32 s54, s53, 3
    s_add_u32 s45, s52, s54
    s_and_b32 s47, s53, 7
    s_lshl_b32 s52, s48, 3
    s_add_u32 s46, s52, s47
    s_lshl_b32 s52, s45, 2
    s_add_u32 s49, s52, s44
    s_lshl_b32 s52, s45, 1
    s_add_u32 s52, s52, s48
    s_lshl_b32 s52, s52, 2
    s_add_u32 s50, s52, s44
    s_mov_b32 s51, 0
    v_lshlrev_b32 v1, 4, v21
    v_mov_b32 v22, 0x3f803f80
    s_lshr_b32 s52, s2, 3
    s_lshl_b32 s52, s52, 2
    s_add_u32 s52, s52, s44
    s_lshl_b32 s52, s52, 10
    s_min_u32 s52, s52, (L_end-L_start-1024)&0xfffffff0
    v_add_u32 v172, s52, v1
    global_load_dwordx4 a[252:255], v172, s[84:85]
    s_waitcnt lgkmcnt(0)
    s_mov_b32 s8, s82
    s_and_b32 s9, s83, 0xffff
    s_mov_b32 s10, 33554432
    s_mov_b32 s11, 0x00020000
    s_mov_b32 s12, s64
    s_and_b32 s13, s65, 0xffff
    s_mov_b32 s14, 2621440
    s_mov_b32 s15, 0x00020000
    s_mov_b32 s16, s66
    s_and_b32 s17, s67, 0xffff
    s_mov_b32 s18, 2457600
    s_mov_b32 s19, 0x00020000
    s_mov_b32 s20, s68
    s_and_b32 s21, s69, 0xffff
    s_mov_b32 s22, 819200
    s_mov_b32 s23, 0x00020000
    s_mov_b32 s24, s72
    s_and_b32 s25, s73, 0xffff
    s_mov_b32 s26, 2457600
    s_mov_b32 s27, 0x00020000
    s_mov_b32 s28, s74
    s_and_b32 s29, s75, 0xffff
    s_mov_b32 s30, 25600
    s_mov_b32 s31, 0x00020000
    s_mov_b32 s32, s76
    s_and_b32 s33, s77, 0xffff
    s_mov_b32 s34, 819200
    s_mov_b32 s35, 0x00020000
    s_mov_b32 s36, s78
    s_and_b32 s37, s79, 0xffff
    s_mov_b32 s38, 2621440
    s_mov_b32 s39, 0x00020000
    s_mov_b32 s40, s80
    s_and_b32 s41, s81, 0xffff
    s_mov_b32 s42, 256
    s_mov_b32 s43, 0x00020000
    s_mul_i32 s88, s46, 153600
    s_lshl_b32 s89, s44, 10
    s_add_u32 s88, s88, s89
    s_add_u32 s88, s88, 23461888
    s_movk_i32 s61, 1280
    v_lshrrev_b32 v164, 2, v21
    v_mul_u32_u24 v164, 1280, v164
    v_lshrrev_b32 v165, 4, v21
    v_xor_b32 v165, v165, v21
    v_and_b32 v165, 3, v165
    v_lshl_add_u32 v188, v165, 4, v164
    s_mul_i32 s86, s49, 40960
    s_add_u32 s87, s86, 20480
    s_mul_i32 s63, s47, 160
    s_mul_i32 s62, s46, 80
    s_lshl_b32 s97, s44, 10
    s_and_b32 s96, s45, 3
    s_mul_i32 s96, s96, 3
    s_add_u32 s96, s96, s47
    s_lshr_b32 s91, s47, 1
    s_sub_u32 s96, s96, s91
    s_add_u32 s74, s96, 0
    s_cmp_ge_u32 s74, 10
    s_cselect_b32 s91, 10, 0
    s_sub_u32 s74, s74, s91
    s_mov_b32 s96, s74
    s_add_u32 s75, s96, 1
    s_cmp_ge_u32 s75, 10
    s_cselect_b32 s91, 10, 0
    s_sub_u32 s75, s75, s91
    s_mov_b32 s96, s75
    s_lshl_b32 s90, s74, 7
    s_add_u32 s90, s90, s86
    buffer_load_dwordx4 a[0:3], v188, s[12:15], s90 offen offset:0
    s_lshl_b32 s90, s74, 7
    s_add_u32 s90, s90, s87
    buffer_load_dwordx4 a[4:7], v188, s[12:15], s90 offen offset:0
    s_lshl_b32 s90, s74, 7
    s_add_u32 s90, s90, s86
    buffer_load_dwordx4 a[8:11], v188, s[12:15], s90 offen offset:64
    s_lshl_b32 s90, s74, 7
    s_add_u32 s90, s90, s87
    buffer_load_dwordx4 a[12:15], v188, s[12:15], s90 offen offset:64
    s_add_u32 s58, s44, 0
    s_cmp_ge_u32 s58, 11
    s_cselect_b32 s57, 11, 0
    s_sub_u32 s58, s58, s57
    s_lshl_b32 s94, s58, 6
    v_add_u32 v164, s94, v21
    v_mul_u32_u24 v165, 5958, v164
    v_lshrrev_b32 v165, 16, v165
    v_mul_u32_u24 v166, 11, v165
    v_sub_u32 v164, v164, v166
    v_and_b32 v166, 3, v165
    v_lshlrev_b32 v166, 2, v166
    v_bfe_u32 v167, v165, 2, 2
    v_and_b32 v165, -16, v165
    v_or3_b32 v165, v165, v166, v167
    v_mul_u32_u24 v176, 3840, v165
    v_lshrrev_b32 v165, 2, v164
    v_add_u32 v165, 1, v165
    v_mul_u32_u24 v165, 80, v165
    v_and_b32 v166, 3, v164
    v_bfe_u32 v167, v164, 1, 1
    v_add3_u32 v165, v165, v166, v167
    v_mul_u32_u24 v166, 80, v164
    v_subrev_u32 v166, 638, v166
    v_cmp_gt_u32 vcc, 8, v164
    s_nop 1
    v_cndmask_b32 v165, v166, v165, vcc
    v_lshl_add_u32 v176, v165, 4, v176
    s_add_u32 s94, s97, 0
    s_mov_b32 m0, s94
    s_mul_i32 s95, s74, 245760
    s_add_u32 s95, s95, s62
    buffer_load_dwordx4 v176, s[16:19], s95 offen lds
    s_add_u32 s58, s44, 4
    s_cmp_ge_u32 s58, 11
    s_cselect_b32 s57, 11, 0
    s_sub_u32 s58, s58, s57
    s_lshl_b32 s94, s58, 6
    v_add_u32 v164, s94, v21
    v_mul_u32_u24 v165, 5958, v164
    v_lshrrev_b32 v165, 16, v165
    v_mul_u32_u24 v166, 11, v165
    v_sub_u32 v164, v164, v166
    v_and_b32 v166, 3, v165
    v_lshlrev_b32 v166, 2, v166
    v_bfe_u32 v167, v165, 2, 2
    v_and_b32 v165, -16, v165
    v_or3_b32 v165, v165, v166, v167
    v_mul_u32_u24 v177, 3840, v165
    v_lshrrev_b32 v165, 2, v164
    v_add_u32 v165, 1, v165
    v_mul_u32_u24 v165, 80, v165
    v_and_b32 v166, 3, v164
    v_bfe_u32 v167, v164, 1, 1
    v_add3_u32 v165, v165, v166, v167
    v_mul_u32_u24 v166, 80, v164
    v_subrev_u32 v166, 638, v166
    v_cmp_gt_u32 vcc, 8, v164
    s_nop 1
    v_cndmask_b32 v165, v166, v165, vcc
    v_lshl_add_u32 v177, v165, 4, v177
    s_add_u32 s94, s97, 4096
    s_mov_b32 m0, s94
    s_mul_i32 s95, s74, 245760
    s_add_u32 s95, s95, s62
    buffer_load_dwordx4 v177, s[16:19], s95 offen lds
    s_add_u32 s58, s44, 8
    s_cmp_ge_u32 s58, 11
    s_cselect_b32 s57, 11, 0
    s_sub_u32 s58, s58, s57
    s_lshl_b32 s94, s58, 6
    v_add_u32 v164, s94, v21
    v_mul_u32_u24 v165, 5958, v164
    v_lshrrev_b32 v165, 16, v165
    v_mul_u32_u24 v166, 11, v165
    v_sub_u32 v164, v164, v166
    v_and_b32 v166, 3, v165
    v_lshlrev_b32 v166, 2, v166
    v_bfe_u32 v167, v165, 2, 2
    v_and_b32 v165, -16, v165
    v_or3_b32 v165, v165, v166, v167
    v_mul_u32_u24 v178, 3840, v165
    v_lshrrev_b32 v165, 2, v164
    v_add_u32 v165, 1, v165
    v_mul_u32_u24 v165, 80, v165
    v_and_b32 v166, 3, v164
    v_bfe_u32 v167, v164, 1, 1
    v_add3_u32 v165, v165, v166, v167
    v_mul_u32_u24 v166, 80, v164
    v_subrev_u32 v166, 638, v166
    v_cmp_gt_u32 vcc, 8, v164
    s_nop 1
    v_cndmask_b32 v165, v166, v165, vcc
    v_lshl_add_u32 v178, v165, 4, v178
    s_add_u32 s94, s97, 8192
    s_mov_b32 m0, s94
    s_cmp_ge_u32 s44, 3
    s_cselect_b32 s95, s75, s74
    s_mul_i32 s95, s95, 245760
    s_add_u32 s95, s95, s62
    buffer_load_dwordx4 v178, s[16:19], s95 offen lds
    s_add_u32 s76, s96, 1
    s_cmp_ge_u32 s76, 10
    s_cselect_b32 s91, 10, 0
    s_sub_u32 s76, s76, s91
    s_mov_b32 s96, s76
    s_add_u32 s77, s96, 1
    s_cmp_ge_u32 s77, 10
    s_cselect_b32 s91, 10, 0
    s_sub_u32 s77, s77, s91
    s_mov_b32 s96, s77
    s_add_u32 s78, s96, 1
    s_cmp_ge_u32 s78, 10
    s_cselect_b32 s91, 10, 0
    s_sub_u32 s78, s78, s91
    s_mov_b32 s96, s78
    s_add_u32 s79, s96, 1
    s_cmp_ge_u32 s79, 10
    s_cselect_b32 s91, 10, 0
    s_sub_u32 s79, s79, s91
    s_mov_b32 s96, s79
    s_add_u32 s80, s96, 1
    s_cmp_ge_u32 s80, 10
    s_cselect_b32 s91, 10, 0
    s_sub_u32 s80, s80, s91
    s_mov_b32 s96, s80
    s_add_u32 s81, s96, 1
    s_cmp_ge_u32 s81, 10
    s_cselect_b32 s91, 10, 0
    s_sub_u32 s81, s81, s91
    s_mov_b32 s96, s81
    s_add_u32 s82, s96, 1
    s_cmp_ge_u32 s82, 10
    s_cselect_b32 s91, 10, 0
    s_sub_u32 s82, s82, s91
    s_mov_b32 s96, s82
    s_add_u32 s83, s96, 1
    s_cmp_ge_u32 s83, 10
    s_cselect_b32 s91, 10, 0
    s_sub_u32 s83, s83, s91
    s_mov_b32 s96, s83
    s_lshl_b32 s90, s75, 7
    s_add_u32 s90, s90, s86
    buffer_load_dwordx4 a[16:19], v188, s[12:15], s90 offen offset:0
    s_lshl_b32 s90, s75, 7
    s_add_u32 s90, s90, s87
    buffer_load_dwordx4 a[20:23], v188, s[12:15], s90 offen offset:0
    s_lshl_b32 s90, s75, 7
    s_add_u32 s90, s90, s86
    buffer_load_dwordx4 a[24:27], v188, s[12:15], s90 offen offset:64
    s_lshl_b32 s90, s75, 7
    s_add_u32 s90, s90, s87
    buffer_load_dwordx4 a[28:31], v188, s[12:15], s90 offen offset:64
    s_add_u32 s58, s44, 1
    s_cmp_ge_u32 s58, 11
    s_cselect_b32 s57, 11, 0
    s_sub_u32 s58, s58, s57
    s_lshl_b32 s94, s58, 6
    v_add_u32 v164, s94, v21
    v_mul_u32_u24 v165, 5958, v164
    v_lshrrev_b32 v165, 16, v165
    v_mul_u32_u24 v166, 11, v165
    v_sub_u32 v164, v164, v166
    v_and_b32 v166, 3, v165
    v_lshlrev_b32 v166, 2, v166
    v_bfe_u32 v167, v165, 2, 2
    v_and_b32 v165, -16, v165
    v_or3_b32 v165, v165, v166, v167
    v_mul_u32_u24 v179, 3840, v165
    v_lshrrev_b32 v165, 2, v164
    v_add_u32 v165, 1, v165
    v_mul_u32_u24 v165, 80, v165
    v_and_b32 v166, 3, v164
    v_bfe_u32 v167, v164, 1, 1
    v_add3_u32 v165, v165, v166, v167
    v_mul_u32_u24 v166, 80, v164
    v_subrev_u32 v166, 638, v166
    v_cmp_gt_u32 vcc, 8, v164
    s_nop 1
    v_cndmask_b32 v165, v166, v165, vcc
    v_lshl_add_u32 v179, v165, 4, v179
    s_add_u32 s94, s97, 12288
    s_mov_b32 m0, s94
    s_mul_i32 s95, s75, 245760
    s_add_u32 s95, s95, s62
    buffer_load_dwordx4 v179, s[16:19], s95 offen lds
    s_add_u32 s58, s44, 5
    s_cmp_ge_u32 s58, 11
    s_cselect_b32 s57, 11, 0
    s_sub_u32 s58, s58, s57
    s_lshl_b32 s94, s58, 6
    v_add_u32 v164, s94, v21
    v_mul_u32_u24 v165, 5958, v164
    v_lshrrev_b32 v165, 16, v165
    v_mul_u32_u24 v166, 11, v165
    v_sub_u32 v164, v164, v166
    v_and_b32 v166, 3, v165
    v_lshlrev_b32 v166, 2, v166
    v_bfe_u32 v167, v165, 2, 2
    v_and_b32 v165, -16, v165
    v_or3_b32 v165, v165, v166, v167
    v_mul_u32_u24 v180, 3840, v165
    v_lshrrev_b32 v165, 2, v164
    v_add_u32 v165, 1, v165
    v_mul_u32_u24 v165, 80, v165
    v_and_b32 v166, 3, v164
    v_bfe_u32 v167, v164, 1, 1
    v_add3_u32 v165, v165, v166, v167
    v_mul_u32_u24 v166, 80, v164
    v_subrev_u32 v166, 638, v166
    v_cmp_gt_u32 vcc, 8, v164
    s_nop 1
    v_cndmask_b32 v165, v166, v165, vcc
    v_lshl_add_u32 v180, v165, 4, v180
    s_add_u32 s94, s97, 16384
    s_mov_b32 m0, s94
    s_mul_i32 s95, s75, 245760
    s_add_u32 s95, s95, s62
    buffer_load_dwordx4 v180, s[16:19], s95 offen lds
    s_add_u32 s58, s44, 9
    s_cmp_ge_u32 s58, 11
    s_cselect_b32 s57, 11, 0
    s_sub_u32 s58, s58, s57
    s_lshl_b32 s94, s58, 6
    v_add_u32 v164, s94, v21
    v_mul_u32_u24 v165, 5958, v164
    v_lshrrev_b32 v165, 16, v165
    v_mul_u32_u24 v166, 11, v165
    v_sub_u32 v164, v164, v166
    v_and_b32 v166, 3, v165
    v_lshlrev_b32 v166, 2, v166
    v_bfe_u32 v167, v165, 2, 2
    v_and_b32 v165, -16, v165
    v_or3_b32 v165, v165, v166, v167
    v_mul_u32_u24 v181, 3840, v165
    v_lshrrev_b32 v165, 2, v164
    v_add_u32 v165, 1, v165
    v_mul_u32_u24 v165, 80, v165
    v_and_b32 v166, 3, v164
    v_bfe_u32 v167, v164, 1, 1
    v_add3_u32 v165, v165, v166, v167
    v_mul_u32_u24 v166, 80, v164
    v_subrev_u32 v166, 638, v166
    v_cmp_gt_u32 vcc, 8, v164
    s_nop 1
    v_cndmask_b32 v165, v166, v165, vcc
    v_lshl_add_u32 v181, v165, 4, v181
    s_add_u32 s94, s97, 20480
    s_mov_b32 m0, s94
    s_cmp_ge_u32 s44, 2
    s_cselect_b32 s95, s76, s75
    s_mul_i32 s95, s95, 245760
    s_add_u32 s95, s95, s62
    buffer_load_dwordx4 v181, s[16:19], s95 offen lds
    v_bfe_u32 v164, v21, 2, 2
    v_lshrrev_b32 v165, 5, v21
    v_lshlrev_b32 v166, 2, v164
    v_lshl_add_u32 v166, v165, 1, v166
    v_mul_u32_u24 v166, 176, v166
    v_bfe_u32 v167, v21, 4, 1
    v_bfe_u32 v168, v21, 1, 1
    v_lshl_add_u32 v167, v167, 1, v168
    v_and_b32 v168, 1, v21
    v_lshl_add_u32 v2, v167, 3, v166
    v_lshl_add_u32 v2, v168, 5, v2
    v_add_u32 v3, 56320, v2
    v_lshl_add_u32 v4, v167, 4, v166
    v_lshl_add_u32 v4, v168, 3, v4
    v_add_u32 v5, 56320, v4
    v_lshl_add_u32 v166, v165, 3, v164
    v_lshlrev_b32 v166, 6, v166
    v_lshl_add_u32 v166, v167, 3, v166
    v_lshl_add_u32 v166, v168, 5, v166
    v_add_u32 v6, 112640, v166
    v_lshrrev_b32 v166, 2, v21
    v_mul_u32_u24 v166, 160, v166
    v_and_b32 v167, 3, v21
    v_lshl_add_u32 v166, v167, 3, v166
    v_add_u32 v9, 51200, v166
    v_add_u32 v10, 51200, v1
    v_bfe_u32 v166, v21, 4, 1
    v_lshrrev_b32 v167, 5, v21
    v_lshl_add_u32 v166, v166, 1, v167
    v_and_b32 v167, 15, v21
    v_lshlrev_b32 v168, 9, v166
    v_lshl_add_u32 v168, v167, 4, v168
    s_and_b32 s52, s44, 1
    s_lshl_b32 s52, s52, 8
    v_add_u32 v11, s52, v168
    v_lshlrev_b32 v12, 3, v167
    v_bfe_u32 v166, v21, 4, 1
    v_lshl_add_u32 v168, v166, 10, v12
    v_lshl_add_u32 v13, v165, 9, v168
    v_mul_u32_u24 v168, 20480, v166
    v_lshl_add_u32 v168, v165, 9, v168
    v_lshl_add_u32 v14, v167, 4, v168
    s_cmp_eq_u32 s45, 0
    s_cselect_b32 s52, 0x80000000, 0
    s_cmp_lg_u32 s44, 0
    s_cselect_b32 s52, 0x80000000, s52
    v_or_b32 v15, s52, v1
    v_bfe_u32 v166, v21, 4, 1
    v_mul_u32_u24 v166, 144, v166
    v_add_u32 v166, v166, v167
    v_mul_u32_u24 v168, 48, v166
    v_mul_u32_u24 v166, 80, v166
    v_lshl_add_u32 v7, v165, 4, v168
    v_lshl_add_u32 v166, v165, 4, v166
    v_add_u32 v16, 13840, v166
    v_add_u32 v20, 13872, v166
    v_add_u32 v166, 13808, v166
    v_add_u32 v168, 32, v168
    v_cmp_gt_u32 vcc, 32, v21
    s_nop 1
    v_cndmask_b32 v8, v166, v168, vcc
    v_and_b32 v166, 31, v21
    v_mul_u32_u24 v168, 144, v165
    v_add_u32 v166, v166, v168
    s_lshl_b32 s52, s44, 5
    s_add_u32 s52, s52, 2
    v_add_u32 v166, s52, v166
    v_mul_u32_u24 v17, 48, v166
    v_mul_u32_u24 v166, 80, v166
    v_add_u32 v18, 13824, v166
    v_lshlrev_b32 v19, 8, v165
    v_add_u32 v19, 153600, v19
    v_lshrrev_b32 v164, 2, v21
    v_mul_u32_u24 v187, 3840, v164
    v_and_b32 v164, 3, v21
    v_bfe_u32 v165, v21, 1, 1
    v_add_u32 v164, v164, v165
    v_lshl_add_u32 v187, v164, 4, v187
    s_lshl_b32 s52, s44, 11
    s_add_u32 s52, s52, 155648
    v_add_u32 v216, s52, v1
    v_and_b32 v164, 31, v21
    v_lshlrev_b32 v164, 6, v164
    v_add_u32 v164, s52, v164
    v_bfe_u32 v165, v21, 2, 2
    v_lshrrev_b32 v166, 5, v21
    v_xor_b32 v165, v165, v166
    v_lshl_add_u32 v217, v165, 4, v164
    v_xor_b32 v218, 32, v217
    v_mov_b32 v212, -1
    v_mov_b32 v220, 0x3f803f80
    v_mov_b32 v213, -1
    v_mov_b32 v221, 0x3f803f80
    v_mov_b32 v214, -1
    v_mov_b32 v222, 0x3f803f80
    v_mov_b32 v215, -1
    v_mov_b32 v223, 0x3f803f80
    v_mov_b32 v189, 0
    v_mov_b32 v190, 0
    v_mov_b32 v191, 0
    v_mov_b32 v219, 0
    v_add_u32 v164, 153600, v1
    v_mov_b32 v168, 0
    v_mov_b32 v169, 0
    v_mov_b32 v170, 0
    v_mov_b32 v171, 0
    ds_write_b128 v164, v[168:171]
    s_lshl_b32 s52, s44, 6
    v_add_u32 v60, s52, v2
    v_add_u32 v61, 128, v4
    s_cmp_lt_u32 s44, 2
    s_cselect_b64 vcc, -1, 0
    v_cndmask_b32 v60, v61, v60, vcc
    v_add_u32 v61, 56320, v60
    s_lshl_b32 s90, s76, 7
    s_add_u32 s90, s90, s86
    buffer_load_dwordx4 a[32:35], v188, s[12:15], s90 offen offset:0
    s_lshl_b32 s90, s76, 7
    s_add_u32 s90, s90, s87
    buffer_load_dwordx4 a[36:39], v188, s[12:15], s90 offen offset:0
    s_lshl_b32 s90, s76, 7
    s_add_u32 s90, s90, s86
    buffer_load_dwordx4 a[40:43], v188, s[12:15], s90 offen offset:64
    s_lshl_b32 s90, s76, 7
    s_add_u32 s90, s90, s87
    buffer_load_dwordx4 a[44:47], v188, s[12:15], s90 offen offset:64
    s_add_u32 s58, s44, 2
    s_cmp_ge_u32 s58, 11
    s_cselect_b32 s57, 11, 0
    s_sub_u32 s58, s58, s57
    s_lshl_b32 s94, s58, 6
    v_add_u32 v164, s94, v21
    v_mul_u32_u24 v165, 5958, v164
    v_lshrrev_b32 v165, 16, v165
    v_mul_u32_u24 v166, 11, v165
    v_sub_u32 v164, v164, v166
    v_and_b32 v166, 3, v165
    v_lshlrev_b32 v166, 2, v166
    v_bfe_u32 v167, v165, 2, 2
    v_and_b32 v165, -16, v165
    v_or3_b32 v165, v165, v166, v167
    v_mul_u32_u24 v182, 3840, v165
    v_lshrrev_b32 v165, 2, v164
    v_add_u32 v165, 1, v165
    v_mul_u32_u24 v165, 80, v165
    v_and_b32 v166, 3, v164
    v_bfe_u32 v167, v164, 1, 1
    v_add3_u32 v165, v165, v166, v167
    v_mul_u32_u24 v166, 80, v164
    v_subrev_u32 v166, 638, v166
    v_cmp_gt_u32 vcc, 8, v164
    s_nop 1
    v_cndmask_b32 v165, v166, v165, vcc
    v_lshl_add_u32 v182, v165, 4, v182
    s_add_u32 s94, s97, 24576
    s_mov_b32 m0, s94
    s_mul_i32 s95, s76, 245760
    s_add_u32 s95, s95, s62
    buffer_load_dwordx4 v182, s[16:19], s95 offen lds
    s_add_u32 s58, s44, 6
    s_cmp_ge_u32 s58, 11
    s_cselect_b32 s57, 11, 0
    s_sub_u32 s58, s58, s57
    s_lshl_b32 s94, s58, 6
    v_add_u32 v164, s94, v21
    v_mul_u32_u24 v165, 5958, v164
    v_lshrrev_b32 v165, 16, v165
    v_mul_u32_u24 v166, 11, v165
    v_sub_u32 v164, v164, v166
    v_and_b32 v166, 3, v165
    v_lshlrev_b32 v166, 2, v166
    v_bfe_u32 v167, v165, 2, 2
    v_and_b32 v165, -16, v165
    v_or3_b32 v165, v165, v166, v167
    v_mul_u32_u24 v183, 3840, v165
    v_lshrrev_b32 v165, 2, v164
    v_add_u32 v165, 1, v165
    v_mul_u32_u24 v165, 80, v165
    v_and_b32 v166, 3, v164
    v_bfe_u32 v167, v164, 1, 1
    v_add3_u32 v165, v165, v166, v167
    v_mul_u32_u24 v166, 80, v164
    v_subrev_u32 v166, 638, v166
    v_cmp_gt_u32 vcc, 8, v164
    s_nop 1
    v_cndmask_b32 v165, v166, v165, vcc
    v_lshl_add_u32 v183, v165, 4, v183
    s_add_u32 s94, s97, 28672
    s_mov_b32 m0, s94
    s_mul_i32 s95, s76, 245760
    s_add_u32 s95, s95, s62
    buffer_load_dwordx4 v183, s[16:19], s95 offen lds
    s_add_u32 s58, s44, 10
    s_cmp_ge_u32 s58, 11
    s_cselect_b32 s57, 11, 0
    s_sub_u32 s58, s58, s57
    s_lshl_b32 s94, s58, 6
    v_add_u32 v164, s94, v21
    v_mul_u32_u24 v165, 5958, v164
    v_lshrrev_b32 v165, 16, v165
    v_mul_u32_u24 v166, 11, v165
    v_sub_u32 v164, v164, v166
    v_and_b32 v166, 3, v165
    v_lshlrev_b32 v166, 2, v166
    v_bfe_u32 v167, v165, 2, 2
    v_and_b32 v165, -16, v165
    v_or3_b32 v165, v165, v166, v167
    v_mul_u32_u24 v184, 3840, v165
    v_lshrrev_b32 v165, 2, v164
    v_add_u32 v165, 1, v165
    v_mul_u32_u24 v165, 80, v165
    v_and_b32 v166, 3, v164
    v_bfe_u32 v167, v164, 1, 1
    v_add3_u32 v165, v165, v166, v167
    v_mul_u32_u24 v166, 80, v164
    v_subrev_u32 v166, 638, v166
    v_cmp_gt_u32 vcc, 8, v164
    s_nop 1
    v_cndmask_b32 v165, v166, v165, vcc
    v_lshl_add_u32 v184, v165, 4, v184
    s_add_u32 s94, s97, 32768
    s_mov_b32 m0, s94
    s_cmp_ge_u32 s44, 1
    s_cselect_b32 s95, s77, s76
    s_mul_i32 s95, s95, 245760
    s_add_u32 s95, s95, s62
    buffer_load_dwordx4 v184, s[16:19], s95 offen lds
    s_lshl_b32 s90, s77, 7
    s_add_u32 s90, s90, s86
    buffer_load_dwordx4 a[48:51], v188, s[12:15], s90 offen offset:0
    s_lshl_b32 s90, s77, 7
    s_add_u32 s90, s90, s87
    buffer_load_dwordx4 a[52:55], v188, s[12:15], s90 offen offset:0
    s_lshl_b32 s90, s77, 7
    s_add_u32 s90, s90, s86
    buffer_load_dwordx4 a[56:59], v188, s[12:15], s90 offen offset:64
    s_lshl_b32 s90, s77, 7
    s_add_u32 s90, s90, s87
    buffer_load_dwordx4 a[60:63], v188, s[12:15], s90 offen offset:64
    s_add_u32 s58, s44, 3
    s_cmp_ge_u32 s58, 11
    s_cselect_b32 s57, 11, 0
    s_sub_u32 s58, s58, s57
    s_lshl_b32 s94, s58, 6
    v_add_u32 v164, s94, v21
    v_mul_u32_u24 v165, 5958, v164
    v_lshrrev_b32 v165, 16, v165
    v_mul_u32_u24 v166, 11, v165
    v_sub_u32 v164, v164, v166
    v_and_b32 v166, 3, v165
    v_lshlrev_b32 v166, 2, v166
    v_bfe_u32 v167, v165, 2, 2
    v_and_b32 v165, -16, v165
    v_or3_b32 v165, v165, v166, v167
    v_mul_u32_u24 v185, 3840, v165
    v_lshrrev_b32 v165, 2, v164
    v_add_u32 v165, 1, v165
    v_mul_u32_u24 v165, 80, v165
    v_and_b32 v166, 3, v164
    v_bfe_u32 v167, v164, 1, 1
    v_add3_u32 v165, v165, v166, v167
    v_mul_u32_u24 v166, 80, v164
    v_subrev_u32 v166, 638, v166
    v_cmp_gt_u32 vcc, 8, v164
    s_nop 1
    v_cndmask_b32 v165, v166, v165, vcc
    v_lshl_add_u32 v185, v165, 4, v185
    s_add_u32 s94, s97, 36864
    s_mov_b32 m0, s94
    s_mul_i32 s95, s77, 245760
    s_add_u32 s95, s95, s62
    buffer_load_dwordx4 v185, s[16:19], s95 offen lds
    s_add_u32 s58, s44, 7
    s_cmp_ge_u32 s58, 11
    s_cselect_b32 s57, 11, 0
    s_sub_u32 s58, s58, s57
    s_lshl_b32 s94, s58, 6
    v_add_u32 v164, s94, v21
    v_mul_u32_u24 v165, 5958, v164
    v_lshrrev_b32 v165, 16, v165
    v_mul_u32_u24 v166, 11, v165
    v_sub_u32 v164, v164, v166
    v_and_b32 v166, 3, v165
    v_lshlrev_b32 v166, 2, v166
    v_bfe_u32 v167, v165, 2, 2
    v_and_b32 v165, -16, v165
    v_or3_b32 v165, v165, v166, v167
    v_mul_u32_u24 v186, 3840, v165
    v_lshrrev_b32 v165, 2, v164
    v_add_u32 v165, 1, v165
    v_mul_u32_u24 v165, 80, v165
    v_and_b32 v166, 3, v164
    v_bfe_u32 v167, v164, 1, 1
    v_add3_u32 v165, v165, v166, v167
    v_mul_u32_u24 v166, 80, v164
    v_subrev_u32 v166, 638, v166
    v_cmp_gt_u32 vcc, 8, v164
    s_nop 1
    v_cndmask_b32 v165, v166, v165, vcc
    v_lshl_add_u32 v186, v165, 4, v186
    s_add_u32 s94, s97, 40960
    s_mov_b32 m0, s94
    s_mul_i32 s95, s77, 245760
    s_add_u32 s95, s95, s62
    buffer_load_dwordx4 v186, s[16:19], s95 offen lds
    s_waitcnt vmcnt(25)
    v_accvgpr_read_b32 v224, a0
    v_accvgpr_read_b32 v225, a1
    v_accvgpr_read_b32 v226, a2
    v_accvgpr_read_b32 v227, a3
    v_accvgpr_read_b32 v228, a4
    v_accvgpr_read_b32 v229, a5
    v_accvgpr_read_b32 v230, a6
    v_accvgpr_read_b32 v231, a7
    ds_write_b128 v216, a[0:3]
    ds_write_b128 v216, a[4:7] offset:1024
    ds_read_b128 a[0:3], v217
    ds_read_b128 a[4:7], v218
    s_waitcnt vmcnt(23)
    v_accvgpr_read_b32 v232, a8
    v_accvgpr_read_b32 v233, a9
    v_accvgpr_read_b32 v234, a10
    v_accvgpr_read_b32 v235, a11
    v_accvgpr_read_b32 v236, a12
    v_accvgpr_read_b32 v237, a13
    v_accvgpr_read_b32 v238, a14
    v_accvgpr_read_b32 v239, a15
    ds_write_b128 v216, a[8:11]
    ds_write_b128 v216, a[12:15] offset:1024
    ds_read_b128 a[8:11], v217
    ds_read_b128 a[12:15], v218
    s_waitcnt vmcnt(20)
    s_barrier
    ds_read_b64_tr_b16 v[128:129], v2 offset:0
    ds_read_b64_tr_b16 v[130:131], v2 offset:176
    ds_read_b64_tr_b16 v[132:133], v2 offset:64
    ds_read_b64_tr_b16 v[134:135], v2 offset:240
    ds_read_b64_tr_b16 v[136:137], v4 offset:128
    ds_read_b64_tr_b16 v[138:139], v4 offset:304
    ds_read_b64_tr_b16 v[140:141], v60 offset:0
    ds_read_b64_tr_b16 v[142:143], v60 offset:176
    ds_read_b64_tr_b16 v[144:145], v2 offset:2816
    ds_read_b64_tr_b16 v[146:147], v2 offset:2992
    ds_read_b64_tr_b16 v[148:149], v2 offset:2880
    ds_read_b64_tr_b16 v[150:151], v2 offset:3056
    s_waitcnt lgkmcnt(15)
    s_waitcnt lgkmcnt(10)
    v_mfma_f32_32x32x16_bf16 v[64:79], v[128:131], a[0:3], 0
    ds_read_b64_tr_b16 v[152:153], v4 offset:2944
    ds_read_b64_tr_b16 v[154:155], v4 offset:3120
    s_waitcnt vmcnt(18)
    v_accvgpr_read_b32 v240, a16
    v_accvgpr_read_b32 v241, a17
    v_accvgpr_read_b32 v242, a18
    v_accvgpr_read_b32 v243, a19
    v_dot2c_f32_bf16 v189, v224, v22
    v_dot2c_f32_bf16 v190, v224, v224
    v_dot2c_f32_bf16 v189, v225, v22
    s_lshl_b32 s58, s45, 1
    s_add_u32 s58, s58, s48
    s_lshl_b32 s58, s58, 2
    s_add_u32 s58, s58, s44
    s_mul_i32 s56, s58, 205
    s_lshr_b32 s56, s56, 10
    v_mov_b32 v164, s56
    v_bfe_u32 v166, v21, 3, 2
    v_lshrrev_b32 v167, 1, v166
    s_lshl_b32 s90, s78, 7
    s_add_u32 s90, s90, s86
    buffer_load_dwordx4 a[64:67], v188, s[12:15], s90 offen offset:0
    s_waitcnt lgkmcnt(10)
    v_mfma_f32_32x32x16_bf16 v[80:95], v[132:135], a[0:3], 0
    ds_read_b64_tr_b16 v[156:157], v60 offset:2816
    ds_read_b64_tr_b16 v[158:159], v60 offset:2992
    v_accvgpr_read_b32 v244, a20
    v_accvgpr_read_b32 v245, a21
    v_accvgpr_read_b32 v246, a22
    v_accvgpr_read_b32 v247, a23
    v_dot2c_f32_bf16 v190, v225, v225
    v_dot2c_f32_bf16 v189, v226, v22
    v_dot2c_f32_bf16 v190, v226, v226
    v_add_u32 v167, v167, v166
    v_lshlrev_b32 v167, 3, v167
    v_mad_u32_u24 v167, v164, 40, v167
    s_waitcnt lgkmcnt(10)
    v_mfma_f32_32x32x16_bf16 v[96:111], v[136:139], a[0:3], 0
    ds_read_b64_tr_b16 v[160:161], v2 offset:5632
    ds_read_b64_tr_b16 v[162:163], v2 offset:5808
    ds_write_b128 v216, a[16:19]
    ds_write_b128 v216, a[20:23] offset:1024
    v_dot2c_f32_bf16 v189, v227, v22
    v_dot2c_f32_bf16 v190, v227, v227
    v_dot2c_f32_bf16 v191, v228, v22
    v_lshl_add_u32 v166, v164, 2, v166
    v_mul_u32_u24 v166, 40, v166
    v_subrev_u32 v166, 2544, v166
    s_lshl_b32 s90, s78, 7
    s_add_u32 s90, s90, s87
    buffer_load_dwordx4 a[68:71], v188, s[12:15], s90 offen offset:0
    s_waitcnt lgkmcnt(12)
    v_mfma_f32_32x32x16_bf16 a[160:175], v[220:223], v[140:143], 0
    ds_read_b64_tr_b16 v[128:129], v2 offset:5696
    ds_read_b64_tr_b16 v[130:131], v2 offset:5872
    ds_read_b128 a[16:19], v217
    v_dot2c_f32_bf16 v219, v228, v228
    v_dot2c_f32_bf16 v191, v229, v22
    v_dot2c_f32_bf16 v219, v229, v229
    v_cmp_gt_u32 vcc, 16, v164
    s_nop 1
    v_cndmask_b32 v166, v166, v167, vcc
    v_mul_u32_u24 v164, 5, v164
    v_sub_u32 v164, s58, v164
    s_waitcnt lgkmcnt(13)
    v_mfma_f32_32x32x16_bf16 v[64:79], v[144:147], a[4:7], v[64:79]
    ds_read_b64_tr_b16 v[132:133], v4 offset:5760
    ds_read_b64_tr_b16 v[134:135], v4 offset:5936
    ds_read_b128 a[20:23], v218
    v_dot2c_f32_bf16 v191, v230, v22
    v_dot2c_f32_bf16 v219, v230, v230
    v_dot2c_f32_bf16 v191, v231, v22
    v_lshlrev_b32 v59, 5, v164
    v_and_b32 v164, 1, v21
    v_lshl_add_u32 v59, v164, 4, v59
    s_lshl_b32 s90, s78, 7
    s_add_u32 s90, s90, s86
    buffer_load_dwordx4 a[72:75], v188, s[12:15], s90 offen offset:64
    s_waitcnt lgkmcnt(14)
    v_mfma_f32_32x32x16_bf16 v[80:95], v[148:151], a[4:7], v[80:95]
    ds_read_b64_tr_b16 v[136:137], v60 offset:5632
    ds_read_b64_tr_b16 v[138:139], v60 offset:5808
    s_waitcnt vmcnt(19)
    v_accvgpr_read_b32 v248, a24
    v_accvgpr_read_b32 v249, a25
    v_accvgpr_read_b32 v250, a26
    v_accvgpr_read_b32 v251, a27
    v_dot2c_f32_bf16 v219, v231, v231
    v_dot2c_f32_bf16 v189, v232, v22
    v_dot2c_f32_bf16 v190, v232, v232
    v_lshrrev_b32 v164, 5, v21
    v_bfe_u32 v165, v21, 1, 2
    v_lshl_add_u32 v164, v164, 2, v165
    s_waitcnt lgkmcnt(14)
    v_mfma_f32_32x32x16_bf16 v[96:111], v[152:155], a[4:7], v[96:111]
    ds_read_b64_tr_b16 v[140:141], v2 offset:8448
    ds_read_b64_tr_b16 v[142:143], v2 offset:8624
    v_accvgpr_read_b32 v252, a28
    v_accvgpr_read_b32 v253, a29
    v_accvgpr_read_b32 v254, a30
    v_accvgpr_read_b32 v255, a31
    v_dot2c_f32_bf16 v189, v233, v22
    v_dot2c_f32_bf16 v190, v233, v233
    v_dot2c_f32_bf16 v189, v234, v22
    v_add_u32 v164, v164, v166
    v_mul_u32_u24 v164, 1280, v164
    v_add_u32 v59, v59, v164
    s_lshl_b32 s90, s78, 7
    s_add_u32 s90, s90, s87
    buffer_load_dwordx4 a[76:79], v188, s[12:15], s90 offen offset:64
    s_waitcnt lgkmcnt(14)
    v_mfma_f32_32x32x16_bf16 a[160:175], v[220:223], v[156:159], a[160:175]
    ds_read_b64_tr_b16 v[144:145], v2 offset:8512
    ds_read_b64_tr_b16 v[146:147], v2 offset:8688
    ds_write_b128 v216, a[24:27]
    ds_write_b128 v216, a[28:31] offset:1024
    v_dot2c_f32_bf16 v190, v234, v234
    v_dot2c_f32_bf16 v189, v235, v22
    v_dot2c_f32_bf16 v190, v235, v235
    s_cmp_lt_u32 s58, 100
    s_cselect_b32 s53, 0, 0x80000000
    s_lshl_b32 s58, s58, 10
    s_or_b32 s58, s58, s53
    v_or_b32 v59, s53, v59
    v_add_u32 v63, s58, v1
    s_add_u32 s56, s44, 1
    s_and_b32 s56, s56, 3
    s_mul_i32 s56, s56, 1280
    v_add_u32 v56, s56, v187
    s_waitcnt lgkmcnt(15)
    v_mfma_f32_32x32x16_bf16 v[64:79], v[160:163], a[8:11], v[64:79]
    ds_read_b64_tr_b16 v[148:149], v4 offset:8576
    ds_read_b64_tr_b16 v[150:151], v4 offset:8752
    ds_read_b128 a[24:27], v217
    v_dot2c_f32_bf16 v191, v236, v22
    v_dot2c_f32_bf16 v219, v236, v236
    v_dot2c_f32_bf16 v191, v237, v22
    v_and_b32 v168, 3, v21
    v_min_u32 v168, 2, v168
    v_mul_u32_u24 v168, 1280, v168
    s_add_u32 s94, s97, 45056
    s_mov_b32 m0, s94
    s_mul_i32 s95, s78, 245760
    s_add_u32 s95, s95, s62
    buffer_load_dwordx4 v176, s[16:19], s95 offen lds
    s_waitcnt lgkmcnt(15)
    v_mfma_f32_32x32x16_bf16 v[80:95], v[128:131], a[8:11], v[80:95]
    ds_read_b64_tr_b16 v[152:153], v60 offset:8448
    ds_read_b64_tr_b16 v[154:155], v60 offset:8624
    ds_read_b128 a[28:31], v218
    s_waitcnt vmcnt(5)
    s_barrier
    v_dot2c_f32_bf16 v219, v237, v237
    v_dot2c_f32_bf16 v191, v238, v22
    v_dot2c_f32_bf16 v219, v238, v238
    v_lshrrev_b32 v169, 2, v21
    v_mul_u32_u24 v169, 3840, v169
    v_add3_u32 v168, v168, v169, 32
    s_waitcnt lgkmcnt(15)
    v_mfma_f32_32x32x16_bf16 v[96:111], v[132:135], a[8:11], v[96:111]
    ds_read_b64_tr_b16 v[156:157], v2 offset:11264
    ds_read_b64_tr_b16 v[158:159], v2 offset:11440
    v_dot2c_f32_bf16 v191, v239, v22
    v_dot2c_f32_bf16 v219, v239, v239
    v_dot2c_f32_bf16 v189, v240, v22
    s_cmp_eq_u32 s44, 2
    s_cselect_b64 vcc, -1, 0
    v_cndmask_b32 v56, v56, v168, vcc
    v_sub_u32 v168, v216, v1
    v_add_u32 v58, v6, v168
    s_add_u32 s94, s97, 49152
    s_mov_b32 m0, s94
    s_mul_i32 s95, s78, 245760
    s_add_u32 s95, s95, s62
    buffer_load_dwordx4 v177, s[16:19], s95 offen lds
    s_waitcnt lgkmcnt(14)
    v_mfma_f32_32x32x16_bf16 a[160:175], v[220:223], v[136:139], a[160:175]
    ds_read_b64_tr_b16 v[160:161], v2 offset:11328
    ds_read_b64_tr_b16 v[162:163], v2 offset:11504
    v_dot2c_f32_bf16 v190, v240, v240
    v_dot2c_f32_bf16 v189, v241, v22
    v_dot2c_f32_bf16 v190, v241, v241
    v_subrev_u32 v58, 112640, v58
    v_bfe_u32 v168, v21, 4, 1
    v_bfe_u32 v169, v21, 1, 1
    s_waitcnt lgkmcnt(14)
    v_mfma_f32_32x32x16_bf16 v[64:79], v[140:143], a[12:15], v[64:79]
    ds_read_b64_tr_b16 v[128:129], v4 offset:11392
    ds_read_b64_tr_b16 v[130:131], v4 offset:11568
    v_dot2c_f32_bf16 v189, v242, v22
    v_dot2c_f32_bf16 v190, v242, v242
    v_dot2c_f32_bf16 v189, v243, v22
    v_lshl_add_u32 v168, v168, 1, v169
    v_and_b32 v169, 1, v21
    v_mul_u32_u24 v169, 3, v169
    s_add_u32 s94, s97, 53248
    s_mov_b32 m0, s94
    s_cmp_ge_u32 s44, 3
    s_cselect_b32 s95, s79, s78
    s_mul_i32 s95, s95, 245760
    s_add_u32 s95, s95, s62
    buffer_load_dwordx4 v178, s[16:19], s95 offen lds
    s_waitcnt lgkmcnt(14)
    v_mfma_f32_32x32x16_bf16 v[80:95], v[144:147], a[12:15], v[80:95]
    ds_read_b64_tr_b16 v[132:133], v60 offset:11264
    ds_read_b64_tr_b16 v[134:135], v60 offset:11440
    v_dot2c_f32_bf16 v190, v243, v243
    v_dot2c_f32_bf16 v191, v244, v22
    v_dot2c_f32_bf16 v219, v244, v244
    v_sub_u32 v168, v168, v169
    v_lshlrev_b32 v168, 3, v168
    v_add_u32 v168, v168, v58
    s_waitcnt lgkmcnt(12)
    v_mfma_f32_32x32x16_bf16 v[96:111], v[148:151], a[12:15], v[96:111]
    ds_read_b64_tr_b16 v[136:137], v2 offset:14080
    ds_read_b64_tr_b16 v[138:139], v2 offset:14256
    v_dot2c_f32_bf16 v191, v245, v22
    v_dot2c_f32_bf16 v219, v245, v245
    v_dot2c_f32_bf16 v191, v246, v22
    s_cmp_eq_u32 s44, 2
    s_cselect_b64 vcc, -1, 0
    v_cndmask_b32 v58, v58, v168, vcc
    v_lshrrev_b32 v168, 5, v21
    v_lshlrev_b32 v168, 7, v168
    s_lshl_b32 s90, s79, 7
    s_add_u32 s90, s90, s86
    buffer_load_dwordx4 a[80:83], v188, s[12:15], s90 offen offset:0
    s_waitcnt lgkmcnt(11)
    v_mfma_f32_32x32x16_bf16 a[160:175], v[220:223], v[152:155], a[160:175]
    ds_read_b64_tr_b16 v[140:141], v2 offset:14144
    ds_read_b64_tr_b16 v[142:143], v2 offset:14320
    v_dot2c_f32_bf16 v219, v246, v246
    v_dot2c_f32_bf16 v191, v247, v22
    v_dot2c_f32_bf16 v219, v247, v247
    v_sub_u32 v168, v1, v168
    v_and_b32 v169, 31, v21
    v_mov_b32 v170, 0x80000000
    s_waitcnt lgkmcnt(10)
    v_mfma_f32_32x32x16_bf16 v[64:79], v[156:159], a[16:19], v[64:79]
    ds_read_b64_tr_b16 v[144:145], v4 offset:14208
    ds_read_b64_tr_b16 v[146:147], v4 offset:14384
    v_accvgpr_read_b32 v224, a32
    v_accvgpr_read_b32 v225, a33
    v_accvgpr_read_b32 v226, a34
    v_accvgpr_read_b32 v227, a35
    v_dot2c_f32_bf16 v189, v248, v22
    v_dot2c_f32_bf16 v190, v248, v248
    v_dot2c_f32_bf16 v189, v249, v22
    v_cmp_gt_u32 vcc, 24, v169
    s_nop 1
    v_cndmask_b32 v168, v170, v168, vcc
    s_cmp_eq_u32 s44, 2
    s_cselect_b64 vcc, -1, 0
    v_cndmask_b32 v57, v1, v168, vcc
    s_lshl_b32 s90, s79, 7
    s_add_u32 s90, s90, s87
    buffer_load_dwordx4 a[84:87], v188, s[12:15], s90 offen offset:0
    s_waitcnt lgkmcnt(10)
    v_mfma_f32_32x32x16_bf16 v[80:95], v[160:163], a[16:19], v[80:95]
    ds_read_b64_tr_b16 v[148:149], v60 offset:14080
    ds_read_b64_tr_b16 v[150:151], v60 offset:14256
    v_accvgpr_read_b32 v228, a36
    v_accvgpr_read_b32 v229, a37
    v_accvgpr_read_b32 v230, a38
    v_accvgpr_read_b32 v231, a39
    v_dot2c_f32_bf16 v190, v249, v249
    v_dot2c_f32_bf16 v189, v250, v22
    v_dot2c_f32_bf16 v190, v250, v250
    s_waitcnt lgkmcnt(10)
    v_mfma_f32_32x32x16_bf16 v[96:111], v[128:131], a[16:19], v[96:111]
    ds_read_b64_tr_b16 v[152:153], v2 offset:16896
    ds_read_b64_tr_b16 v[154:155], v2 offset:17072
    ds_write_b128 v216, a[32:35]
    ds_write_b128 v216, a[36:39] offset:1024
    v_dot2c_f32_bf16 v189, v251, v22
    v_dot2c_f32_bf16 v190, v251, v251
    v_dot2c_f32_bf16 v191, v252, v22
    s_lshl_b32 s90, s79, 7
    s_add_u32 s90, s90, s86
    buffer_load_dwordx4 a[88:91], v188, s[12:15], s90 offen offset:64
    s_waitcnt lgkmcnt(12)
    v_mfma_f32_32x32x16_bf16 a[160:175], v[220:223], v[132:135], a[160:175]
    ds_read_b64_tr_b16 v[156:157], v2 offset:16960
    ds_read_b64_tr_b16 v[158:159], v2 offset:17136
    ds_read_b128 a[32:35], v217
    v_dot2c_f32_bf16 v219, v252, v252
    v_dot2c_f32_bf16 v191, v253, v22
    v_dot2c_f32_bf16 v219, v253, v253
    s_waitcnt lgkmcnt(13)
    v_mfma_f32_32x32x16_bf16 v[64:79], v[136:139], a[20:23], v[64:79]
    ds_read_b64_tr_b16 v[160:161], v4 offset:17024
    ds_read_b64_tr_b16 v[162:163], v4 offset:17200
    ds_read_b128 a[36:39], v218
    v_dot2c_f32_bf16 v191, v254, v22
    v_dot2c_f32_bf16 v219, v254, v254
    v_dot2c_f32_bf16 v191, v255, v22
    s_lshl_b32 s90, s79, 7
    s_add_u32 s90, s90, s87
    buffer_load_dwordx4 a[92:95], v188, s[12:15], s90 offen offset:64
    s_waitcnt lgkmcnt(14)
    v_mfma_f32_32x32x16_bf16 v[80:95], v[140:143], a[20:23], v[80:95]
    ds_read_b64_tr_b16 v[128:129], v60 offset:16896
    ds_read_b64_tr_b16 v[130:131], v60 offset:17072
    v_accvgpr_read_b32 v232, a40
    v_accvgpr_read_b32 v233, a41
    v_accvgpr_read_b32 v234, a42
    v_accvgpr_read_b32 v235, a43
    v_dot2c_f32_bf16 v219, v255, v255
    v_dot2c_f32_bf16 v189, v224, v22
    v_dot2c_f32_bf16 v190, v224, v224
    s_waitcnt lgkmcnt(14)
    v_mfma_f32_32x32x16_bf16 v[96:111], v[144:147], a[20:23], v[96:111]
    ds_read_b64_tr_b16 v[132:133], v2 offset:19712
    ds_read_b64_tr_b16 v[134:135], v2 offset:19888
    v_accvgpr_read_b32 v236, a44
    v_accvgpr_read_b32 v237, a45
    v_accvgpr_read_b32 v238, a46
    v_accvgpr_read_b32 v239, a47
    v_dot2c_f32_bf16 v189, v225, v22
    v_dot2c_f32_bf16 v190, v225, v225
    v_dot2c_f32_bf16 v189, v226, v22
    s_add_u32 s94, s97, 57344
    s_mov_b32 m0, s94
    s_mul_i32 s95, s79, 245760
    s_add_u32 s95, s95, s62
    buffer_load_dwordx4 v179, s[16:19], s95 offen lds
    s_waitcnt lgkmcnt(14)
    v_mfma_f32_32x32x16_bf16 a[160:175], v[220:223], v[148:151], a[160:175]
    ds_read_b64_tr_b16 v[136:137], v2 offset:19776
    ds_read_b64_tr_b16 v[138:139], v2 offset:19952
    ds_write_b128 v216, a[40:43]
    ds_write_b128 v216, a[44:47] offset:1024
    v_dot2c_f32_bf16 v190, v226, v226
    v_dot2c_f32_bf16 v189, v227, v22
    v_dot2c_f32_bf16 v190, v227, v227
    s_waitcnt lgkmcnt(15)
    v_mfma_f32_32x32x16_bf16 v[64:79], v[152:155], a[24:27], v[64:79]
    ds_read_b64_tr_b16 v[140:141], v4 offset:19840
    ds_read_b64_tr_b16 v[142:143], v4 offset:20016
    ds_read_b128 a[40:43], v217
    v_dot2c_f32_bf16 v191, v228, v22
    v_dot2c_f32_bf16 v219, v228, v228
    v_dot2c_f32_bf16 v191, v229, v22
    s_add_u32 s94, s97, 61440
    s_mov_b32 m0, s94
    s_mul_i32 s95, s79, 245760
    s_add_u32 s95, s95, s62
    buffer_load_dwordx4 v180, s[16:19], s95 offen lds
    s_waitcnt lgkmcnt(15)
    v_mfma_f32_32x32x16_bf16 v[80:95], v[156:159], a[24:27], v[80:95]
    ds_read_b64_tr_b16 v[144:145], v60 offset:19712
    ds_read_b64_tr_b16 v[146:147], v60 offset:19888
    ds_read_b128 a[44:47], v218
    v_dot2c_f32_bf16 v219, v229, v229
    v_dot2c_f32_bf16 v191, v230, v22
    v_dot2c_f32_bf16 v219, v230, v230
    s_waitcnt lgkmcnt(15)
    v_mfma_f32_32x32x16_bf16 v[96:111], v[160:163], a[24:27], v[96:111]
    ds_read_b64_tr_b16 v[148:149], v2 offset:22528
    ds_read_b64_tr_b16 v[150:151], v2 offset:22704
    v_dot2c_f32_bf16 v191, v231, v22
    v_dot2c_f32_bf16 v219, v231, v231
    v_dot2c_f32_bf16 v189, v232, v22
    s_add_u32 s94, s97, 65536
    s_mov_b32 m0, s94
    s_cmp_ge_u32 s44, 2
    s_cselect_b32 s95, s80, s79
    s_mul_i32 s95, s95, 245760
    s_add_u32 s95, s95, s62
    buffer_load_dwordx4 v181, s[16:19], s95 offen lds
    s_waitcnt lgkmcnt(14)
    v_mfma_f32_32x32x16_bf16 a[160:175], v[220:223], v[128:131], a[160:175]
    ds_read_b64_tr_b16 v[152:153], v2 offset:22592
    ds_read_b64_tr_b16 v[154:155], v2 offset:22768
    v_dot2c_f32_bf16 v190, v232, v232
    v_dot2c_f32_bf16 v189, v233, v22
    v_dot2c_f32_bf16 v190, v233, v233
    s_waitcnt lgkmcnt(14)
    v_mfma_f32_32x32x16_bf16 v[64:79], v[132:135], a[28:31], v[64:79]
    ds_read_b64_tr_b16 v[156:157], v4 offset:22656
    ds_read_b64_tr_b16 v[158:159], v4 offset:22832
    v_dot2c_f32_bf16 v189, v234, v22
    v_dot2c_f32_bf16 v190, v234, v234
    v_dot2c_f32_bf16 v189, v235, v22
    s_add_u32 s95, s45, 0
    s_mul_i32 s95, s95, 61440
    s_add_u32 s95, s95, s62
    buffer_load_dwordx4 v[192:195], v56, s[24:27], s95 offen
    s_waitcnt lgkmcnt(14)
    v_mfma_f32_32x32x16_bf16 v[80:95], v[136:139], a[28:31], v[80:95]
    ds_read_b64_tr_b16 v[160:161], v60 offset:22528
    ds_read_b64_tr_b16 v[162:163], v60 offset:22704
    v_dot2c_f32_bf16 v190, v235, v235
    v_dot2c_f32_bf16 v191, v236, v22
    v_dot2c_f32_bf16 v219, v236, v236
    s_waitcnt lgkmcnt(12)
    v_mfma_f32_32x32x16_bf16 v[96:111], v[140:143], a[28:31], v[96:111]
    ds_read_b64_tr_b16 v[128:129], v2 offset:25344
    ds_read_b64_tr_b16 v[130:131], v2 offset:25520
    v_dot2c_f32_bf16 v191, v237, v22
    v_dot2c_f32_bf16 v219, v237, v237
    v_dot2c_f32_bf16 v191, v238, v22
    s_add_u32 s95, s45, 16
    s_mul_i32 s95, s95, 61440
    s_add_u32 s95, s95, s62
    buffer_load_dwordx4 v[196:199], v56, s[24:27], s95 offen
    s_waitcnt lgkmcnt(11)
    v_mfma_f32_32x32x16_bf16 a[160:175], v[220:223], v[144:147], a[160:175]
    ds_read_b64_tr_b16 v[132:133], v2 offset:25408
    ds_read_b64_tr_b16 v[134:135], v2 offset:25584
    v_dot2c_f32_bf16 v219, v238, v238
    v_dot2c_f32_bf16 v191, v239, v22
    v_dot2c_f32_bf16 v219, v239, v239
    s_waitcnt lgkmcnt(10)
    v_mfma_f32_32x32x16_bf16 v[64:79], v[148:151], a[32:35], v[64:79]
    ds_read_b64_tr_b16 v[136:137], v4 offset:25472
    ds_read_b64_tr_b16 v[138:139], v4 offset:25648
    v_accvgpr_read_b32 v240, a48
    v_accvgpr_read_b32 v241, a49
    v_accvgpr_read_b32 v242, a50
    v_accvgpr_read_b32 v243, a51
    s_cmp_lt_u32 s45, 8
    s_cselect_b32 s95, 32, 0
    s_add_u32 s95, s95, s45
    s_mul_i32 s95, s95, 61440
    s_add_u32 s95, s95, s62
    buffer_load_dwordx4 v[44:47], v56, s[24:27], s95 offen
    s_waitcnt lgkmcnt(10)
    v_mfma_f32_32x32x16_bf16 v[80:95], v[152:155], a[32:35], v[80:95]
    ds_read_b64_tr_b16 v[140:141], v60 offset:25344
    ds_read_b64_tr_b16 v[142:143], v60 offset:25520
    v_accvgpr_read_b32 v244, a52
    v_accvgpr_read_b32 v245, a53
    v_accvgpr_read_b32 v246, a54
    v_accvgpr_read_b32 v247, a55
    v_dot2c_f32_bf16 v189, v240, v22
    v_dot2c_f32_bf16 v190, v240, v240
    v_dot2c_f32_bf16 v189, v241, v22
    s_waitcnt lgkmcnt(10)
    v_mfma_f32_32x32x16_bf16 v[96:111], v[156:159], a[32:35], v[96:111]
    ds_read_b64_tr_b16 v[144:145], v2 offset:28160
    ds_read_b64_tr_b16 v[146:147], v2 offset:28336
    ds_write_b128 v216, a[48:51]
    ds_write_b128 v216, a[52:55] offset:1024
    v_dot2c_f32_bf16 v190, v241, v241
    v_dot2c_f32_bf16 v189, v242, v22
    v_dot2c_f32_bf16 v190, v242, v242
    buffer_load_dwordx4 v[48:51], v59, s[20:23], s63 offen
    s_waitcnt lgkmcnt(12)
    v_mfma_f32_32x32x16_bf16 a[160:175], v[220:223], v[160:163], a[160:175]
    ds_read_b64_tr_b16 v[148:149], v2 offset:28224
    ds_read_b64_tr_b16 v[150:151], v2 offset:28400
    ds_read_b128 a[48:51], v217
    v_dot2c_f32_bf16 v189, v243, v22
    v_dot2c_f32_bf16 v190, v243, v243
    v_dot2c_f32_bf16 v191, v244, v22
    s_waitcnt lgkmcnt(13)
    v_mfma_f32_32x32x16_bf16 v[64:79], v[128:131], a[36:39], v[64:79]
    ds_read_b64_tr_b16 v[152:153], v4 offset:28288
    ds_read_b64_tr_b16 v[154:155], v4 offset:28464
    ds_read_b128 a[52:55], v218
    v_dot2c_f32_bf16 v219, v244, v244
    v_dot2c_f32_bf16 v191, v245, v22
    v_dot2c_f32_bf16 v219, v245, v245
    v_lshrrev_b32 v172, 5, v21
    s_waitcnt lgkmcnt(14)
    v_mfma_f32_32x32x16_bf16 v[80:95], v[132:135], a[36:39], v[80:95]
    ds_read_b64_tr_b16 v[156:157], v60 offset:28160
    ds_read_b64_tr_b16 v[158:159], v60 offset:28336
    v_accvgpr_read_b32 v248, a56
    v_accvgpr_read_b32 v249, a57
    v_accvgpr_read_b32 v250, a58
    v_accvgpr_read_b32 v251, a59
    v_dot2c_f32_bf16 v191, v246, v22
    v_dot2c_f32_bf16 v219, v246, v246
    v_dot2c_f32_bf16 v191, v247, v22
    s_waitcnt lgkmcnt(14)
    v_mfma_f32_32x32x16_bf16 v[96:111], v[136:139], a[36:39], v[96:111]
    ds_read_b64_tr_b16 v[160:161], v2 offset:30976
    ds_read_b64_tr_b16 v[162:163], v2 offset:31152
    v_accvgpr_read_b32 v252, a60
    v_accvgpr_read_b32 v253, a61
    v_accvgpr_read_b32 v254, a62
    v_accvgpr_read_b32 v255, a63
    v_dot2c_f32_bf16 v219, v247, v247
    v_dot2c_f32_bf16 v189, v248, v22
    v_dot2c_f32_bf16 v190, v248, v248
    v_lshlrev_b32 v173, 1, v12
    s_waitcnt lgkmcnt(14)
    v_mfma_f32_32x32x16_bf16 a[160:175], v[220:223], v[140:143], a[160:175]
    ds_read_b64_tr_b16 v[128:129], v2 offset:31040
    ds_read_b64_tr_b16 v[130:131], v2 offset:31216
    ds_write_b128 v216, a[56:59]
    ds_write_b128 v216, a[60:63] offset:1024
    v_dot2c_f32_bf16 v189, v249, v22
    v_dot2c_f32_bf16 v190, v249, v249
    v_dot2c_f32_bf16 v189, v250, v22
    s_waitcnt lgkmcnt(15)
    v_mfma_f32_32x32x16_bf16 v[64:79], v[144:147], a[40:43], v[64:79]
    ds_read_b64_tr_b16 v[132:133], v4 offset:31104
    ds_read_b64_tr_b16 v[134:135], v4 offset:31280
    ds_read_b128 a[56:59], v217
    v_dot2c_f32_bf16 v190, v250, v250
    v_dot2c_f32_bf16 v189, v251, v22
    v_dot2c_f32_bf16 v190, v251, v251
    v_lshl_add_u32 v172, v172, 8, v173
    s_waitcnt lgkmcnt(15)
    v_mfma_f32_32x32x16_bf16 v[80:95], v[148:151], a[40:43], v[80:95]
    ds_read_b64_tr_b16 v[136:137], v60 offset:30976
    ds_read_b64_tr_b16 v[138:139], v60 offset:31152
    ds_read_b128 a[60:63], v218
    v_dot2c_f32_bf16 v191, v252, v22
    v_dot2c_f32_bf16 v219, v252, v252
    v_dot2c_f32_bf16 v191, v253, v22
    s_waitcnt lgkmcnt(15)
    v_mfma_f32_32x32x16_bf16 v[96:111], v[152:155], a[40:43], v[96:111]
    ds_read_b64_tr_b16 v[140:141], v2 offset:33792
    ds_read_b64_tr_b16 v[142:143], v2 offset:33968
    v_dot2c_f32_bf16 v219, v253, v253
    v_dot2c_f32_bf16 v191, v254, v22
    v_dot2c_f32_bf16 v219, v254, v254
    s_lshl_b32 s70, s45, 4
    s_add_u32 s70, s70, s46
    s_lshl_b32 s70, s70, 12
    s_add_u32 s70, s70, 27918336
    s_cmp_eq_u32 s44, 3
    s_cselect_b32 s72, 0xffff0000, 0
    s_mov_b32 exec_lo, s72
    s_mov_b32 exec_hi, s72
    s_cbranch_scc0 L_hs_1
    buffer_store_dwordx4 v[212:215], v172, s[8:11], s70 offen offset:0 sc1
    buffer_store_dwordx4 v[212:215], v172, s[8:11], s70 offen offset:512 sc1
    buffer_store_dwordx4 v[212:215], v172, s[8:11], s70 offen offset:1024 sc1
    buffer_store_dwordx4 v[212:215], v172, s[8:11], s70 offen offset:1536 sc1
    buffer_store_dwordx4 v[212:215], v172, s[8:11], s70 offen offset:2048 sc1
    buffer_store_dwordx4 v[212:215], v172, s[8:11], s70 offen offset:2560 sc1
    buffer_store_dwordx4 v[212:215], v172, s[8:11], s70 offen offset:3072 sc1
    buffer_store_dwordx4 v[212:215], v172, s[8:11], s70 offen offset:3584 sc1
L_hs_1:
    s_mov_b64 exec, -1
    s_waitcnt lgkmcnt(14)
    v_mfma_f32_32x32x16_bf16 a[160:175], v[220:223], v[156:159], a[160:175]
    ds_read_b64_tr_b16 v[144:145], v2 offset:33856
    ds_read_b64_tr_b16 v[146:147], v2 offset:34032
    v_dot2c_f32_bf16 v191, v255, v22
    v_dot2c_f32_bf16 v219, v255, v255
    s_waitcnt lgkmcnt(14)
    v_mfma_f32_32x32x16_bf16 v[64:79], v[160:163], a[44:47], v[64:79]
    ds_read_b64_tr_b16 v[148:149], v4 offset:33920
    ds_read_b64_tr_b16 v[150:151], v4 offset:34096
    s_mul_i32 s70, s49, 40960
    s_lshl_b32 s71, s46, 10
    s_add_u32 s70, s70, 7864320
    s_add_u32 s71, s71, s70
    s_lshl_b32 s72, s46, 8
    s_add_u32 s72, s72, s70
    s_add_u32 s72, s72, 16384
    buffer_store_dwordx4 v[212:215], v14, s[8:11], s71 offen sc1
    s_waitcnt lgkmcnt(14)
    v_mfma_f32_32x32x16_bf16 v[80:95], v[128:131], a[44:47], v[80:95]
    ds_read_b64_tr_b16 v[152:153], v60 offset:33792
    ds_read_b64_tr_b16 v[154:155], v60 offset:33968
    s_waitcnt lgkmcnt(12)
    v_mfma_f32_32x32x16_bf16 v[96:111], v[132:135], a[44:47], v[96:111]
    ds_read_b64_tr_b16 v[156:157], v2 offset:36608
    ds_read_b64_tr_b16 v[158:159], v2 offset:36784
    buffer_store_dwordx4 v[212:215], v14, s[8:11], s71 offen offset:256 sc1
    s_waitcnt lgkmcnt(11)
    v_mfma_f32_32x32x16_bf16 a[160:175], v[220:223], v[136:139], a[160:175]
    ds_read_b64_tr_b16 v[160:161], v2 offset:36672
    ds_read_b64_tr_b16 v[162:163], v2 offset:36848
    s_waitcnt lgkmcnt(10)
    v_mfma_f32_32x32x16_bf16 v[64:79], v[140:143], a[48:51], v[64:79]
    ds_read_b64_tr_b16 v[128:129], v4 offset:36736
    ds_read_b64_tr_b16 v[130:131], v4 offset:36912
    s_waitcnt vmcnt(18)
    v_accvgpr_read_b32 v224, a64
    v_accvgpr_read_b32 v225, a65
    v_accvgpr_read_b32 v226, a66
    v_accvgpr_read_b32 v227, a67
    s_mov_b64 exec, 0xffffffff
    buffer_store_dwordx4 v[212:215], v14, s[8:11], s72 offen sc1
    s_mov_b64 exec, -1
    s_waitcnt lgkmcnt(10)
    v_mfma_f32_32x32x16_bf16 v[80:95], v[144:147], a[48:51], v[80:95]
    ds_read_b64_tr_b16 v[132:133], v60 offset:36608
    ds_read_b64_tr_b16 v[134:135], v60 offset:36784
    v_accvgpr_read_b32 v228, a68
    v_accvgpr_read_b32 v229, a69
    v_accvgpr_read_b32 v230, a70
    v_accvgpr_read_b32 v231, a71
    v_dot2c_f32_bf16 v189, v224, v22
    v_dot2c_f32_bf16 v190, v224, v224
    v_dot2c_f32_bf16 v189, v225, v22
    s_waitcnt lgkmcnt(10)
    v_mfma_f32_32x32x16_bf16 v[96:111], v[148:151], a[48:51], v[96:111]
    ds_read_b64_tr_b16 v[136:137], v2 offset:39424
    ds_read_b64_tr_b16 v[138:139], v2 offset:39600
    ds_write_b128 v216, a[64:67]
    ds_write_b128 v216, a[68:71] offset:1024
    v_dot2c_f32_bf16 v190, v225, v225
    v_dot2c_f32_bf16 v189, v226, v22
    v_dot2c_f32_bf16 v190, v226, v226
    s_lshl_b32 s90, s80, 7
    s_add_u32 s90, s90, s86
    buffer_load_dwordx4 a[96:99], v188, s[12:15], s90 offen offset:0
    s_waitcnt lgkmcnt(12)
    v_mfma_f32_32x32x16_bf16 a[160:175], v[220:223], v[152:155], a[160:175]
    ds_read_b64_tr_b16 v[140:141], v2 offset:39488
    ds_read_b64_tr_b16 v[142:143], v2 offset:39664
    ds_read_b128 a[64:67], v217
    v_dot2c_f32_bf16 v189, v227, v22
    v_dot2c_f32_bf16 v190, v227, v227
    v_dot2c_f32_bf16 v191, v228, v22
    s_waitcnt lgkmcnt(13)
    v_mfma_f32_32x32x16_bf16 v[64:79], v[156:159], a[52:55], v[64:79]
    ds_read_b64_tr_b16 v[144:145], v4 offset:39552
    ds_read_b64_tr_b16 v[146:147], v4 offset:39728
    ds_read_b128 a[68:71], v218
    v_dot2c_f32_bf16 v219, v228, v228
    v_dot2c_f32_bf16 v191, v229, v22
    v_dot2c_f32_bf16 v219, v229, v229
    s_lshl_b32 s90, s80, 7
    s_add_u32 s90, s90, s87
    buffer_load_dwordx4 a[100:103], v188, s[12:15], s90 offen offset:0
    s_waitcnt lgkmcnt(14)
    v_mfma_f32_32x32x16_bf16 v[80:95], v[160:163], a[52:55], v[80:95]
    ds_read_b64_tr_b16 v[148:149], v60 offset:39424
    ds_read_b64_tr_b16 v[150:151], v60 offset:39600
    s_waitcnt vmcnt(19)
    v_accvgpr_read_b32 v232, a72
    v_accvgpr_read_b32 v233, a73
    v_accvgpr_read_b32 v234, a74
    v_accvgpr_read_b32 v235, a75
    v_dot2c_f32_bf16 v191, v230, v22
    v_dot2c_f32_bf16 v219, v230, v230
    v_dot2c_f32_bf16 v191, v231, v22
    s_waitcnt lgkmcnt(14)
    v_mfma_f32_32x32x16_bf16 v[96:111], v[128:131], a[52:55], v[96:111]
    ds_read_b64_tr_b16 v[152:153], v2 offset:42240
    ds_read_b64_tr_b16 v[154:155], v2 offset:42416
    v_accvgpr_read_b32 v236, a76
    v_accvgpr_read_b32 v237, a77
    v_accvgpr_read_b32 v238, a78
    v_accvgpr_read_b32 v239, a79
    v_dot2c_f32_bf16 v219, v231, v231
    v_dot2c_f32_bf16 v189, v232, v22
    v_dot2c_f32_bf16 v190, v232, v232
    s_lshl_b32 s90, s80, 7
    s_add_u32 s90, s90, s86
    buffer_load_dwordx4 a[104:107], v188, s[12:15], s90 offen offset:64
    s_waitcnt lgkmcnt(14)
    v_mfma_f32_32x32x16_bf16 a[160:175], v[220:223], v[132:135], a[160:175]
    ds_read_b64_tr_b16 v[156:157], v2 offset:42304
    ds_read_b64_tr_b16 v[158:159], v2 offset:42480
    ds_write_b128 v216, a[72:75]
    ds_write_b128 v216, a[76:79] offset:1024
    v_dot2c_f32_bf16 v189, v233, v22
    v_dot2c_f32_bf16 v190, v233, v233
    v_dot2c_f32_bf16 v189, v234, v22
    s_waitcnt lgkmcnt(15)
    v_mfma_f32_32x32x16_bf16 v[64:79], v[136:139], a[56:59], v[64:79]
    ds_read_b64_tr_b16 v[160:161], v4 offset:42368
    ds_read_b64_tr_b16 v[162:163], v4 offset:42544
    ds_read_b128 a[72:75], v217
    v_dot2c_f32_bf16 v190, v234, v234
    v_dot2c_f32_bf16 v189, v235, v22
    v_dot2c_f32_bf16 v190, v235, v235
    s_lshl_b32 s90, s80, 7
    s_add_u32 s90, s90, s87
    buffer_load_dwordx4 a[108:111], v188, s[12:15], s90 offen offset:64
    s_waitcnt lgkmcnt(15)
    v_mfma_f32_32x32x16_bf16 v[80:95], v[140:143], a[56:59], v[80:95]
    ds_read_b64_tr_b16 v[128:129], v60 offset:42240
    ds_read_b64_tr_b16 v[130:131], v60 offset:42416
    ds_read_b128 a[76:79], v218
    s_add_u32 s94, s97, 69632
    s_mov_b32 m0, s94
    s_mul_i32 s95, s80, 245760
    s_add_u32 s95, s95, s62
    buffer_load_dwordx4 v182, s[16:19], s95 offen lds
    s_add_u32 s94, s97, 73728
    s_mov_b32 m0, s94
    s_mul_i32 s95, s80, 245760
    s_add_u32 s95, s95, s62
    buffer_load_dwordx4 v183, s[16:19], s95 offen lds
    s_add_u32 s94, s97, 77824
    s_mov_b32 m0, s94
    s_cmp_ge_u32 s44, 1
    s_cselect_b32 s95, s81, s80
    s_mul_i32 s95, s95, 245760
    s_add_u32 s95, s95, s62
    buffer_load_dwordx4 v184, s[16:19], s95 offen lds
    s_waitcnt vmcnt(0)
    s_barrier
    v_dot2c_f32_bf16 v191, v236, v22
    v_dot2c_f32_bf16 v219, v236, v236
    v_dot2c_f32_bf16 v191, v237, v22
    s_waitcnt lgkmcnt(15)
    v_mfma_f32_32x32x16_bf16 v[96:111], v[144:147], a[56:59], v[96:111]
    ds_read_b64_tr_b16 v[132:133], v2 offset:45056
    ds_read_b64_tr_b16 v[134:135], v2 offset:45232
    v_dot2c_f32_bf16 v219, v237, v237
    v_dot2c_f32_bf16 v191, v238, v22
    v_dot2c_f32_bf16 v219, v238, v238
    s_lshl_b32 s90, s81, 7
    s_add_u32 s90, s90, s86
    buffer_load_dwordx4 a[112:115], v188, s[12:15], s90 offen offset:0
    s_waitcnt lgkmcnt(14)
    v_mfma_f32_32x32x16_bf16 a[160:175], v[220:223], v[148:151], a[160:175]
    ds_read_b64_tr_b16 v[136:137], v2 offset:45120
    ds_read_b64_tr_b16 v[138:139], v2 offset:45296
    v_dot2c_f32_bf16 v191, v239, v22
    v_dot2c_f32_bf16 v219, v239, v239
    s_waitcnt lgkmcnt(14)
    v_mfma_f32_32x32x16_bf16 v[64:79], v[152:155], a[60:63], v[64:79]
    ds_read_b64_tr_b16 v[140:141], v4 offset:45184
    ds_read_b64_tr_b16 v[142:143], v4 offset:45360
    s_lshl_b32 s90, s81, 7
    s_add_u32 s90, s90, s87
    buffer_load_dwordx4 a[116:119], v188, s[12:15], s90 offen offset:0
    s_waitcnt lgkmcnt(14)
    v_mfma_f32_32x32x16_bf16 v[80:95], v[156:159], a[60:63], v[80:95]
    ds_read_b64_tr_b16 v[144:145], v60 offset:45056
    ds_read_b64_tr_b16 v[146:147], v60 offset:45232
    s_waitcnt lgkmcnt(12)
    v_mfma_f32_32x32x16_bf16 v[96:111], v[160:163], a[60:63], v[96:111]
    ds_read_b64_tr_b16 v[148:149], v2 offset:47872
    ds_read_b64_tr_b16 v[150:151], v2 offset:48048
    s_lshl_b32 s90, s81, 7
    s_add_u32 s90, s90, s86
    buffer_load_dwordx4 a[120:123], v188, s[12:15], s90 offen offset:64
    s_waitcnt lgkmcnt(11)
    v_mfma_f32_32x32x16_bf16 a[160:175], v[220:223], v[128:131], a[160:175]
    ds_read_b64_tr_b16 v[152:153], v2 offset:47936
    ds_read_b64_tr_b16 v[154:155], v2 offset:48112
    s_waitcnt lgkmcnt(10)
    v_mfma_f32_32x32x16_bf16 v[64:79], v[132:135], a[64:67], v[64:79]
    ds_read_b64_tr_b16 v[156:157], v4 offset:48000
    ds_read_b64_tr_b16 v[158:159], v4 offset:48176
    v_accvgpr_read_b32 v240, a80
    v_accvgpr_read_b32 v241, a81
    v_accvgpr_read_b32 v242, a82
    v_accvgpr_read_b32 v243, a83
    s_lshl_b32 s90, s81, 7
    s_add_u32 s90, s90, s87
    buffer_load_dwordx4 a[124:127], v188, s[12:15], s90 offen offset:64
    s_waitcnt lgkmcnt(10)
    v_mfma_f32_32x32x16_bf16 v[80:95], v[136:139], a[64:67], v[80:95]
    ds_read_b64_tr_b16 v[160:161], v60 offset:47872
    ds_read_b64_tr_b16 v[162:163], v60 offset:48048
    v_accvgpr_read_b32 v244, a84
    v_accvgpr_read_b32 v245, a85
    v_accvgpr_read_b32 v246, a86
    v_accvgpr_read_b32 v247, a87
    v_dot2c_f32_bf16 v189, v240, v22
    v_dot2c_f32_bf16 v190, v240, v240
    v_dot2c_f32_bf16 v189, v241, v22
    s_waitcnt lgkmcnt(10)
    v_mfma_f32_32x32x16_bf16 v[96:111], v[140:143], a[64:67], v[96:111]
    ds_read_b64_tr_b16 v[128:129], v2 offset:50688
    ds_read_b64_tr_b16 v[130:131], v2 offset:50864
    ds_write_b128 v216, a[80:83]
    ds_write_b128 v216, a[84:87] offset:1024
    v_dot2c_f32_bf16 v190, v241, v241
    v_dot2c_f32_bf16 v189, v242, v22
    v_dot2c_f32_bf16 v190, v242, v242
    s_add_u32 s94, s97, 81920
    s_mov_b32 m0, s94
    s_mul_i32 s95, s81, 245760
    s_add_u32 s95, s95, s62
    buffer_load_dwordx4 v185, s[16:19], s95 offen lds
    s_waitcnt lgkmcnt(12)
    v_mfma_f32_32x32x16_bf16 a[160:175], v[220:223], v[144:147], a[160:175]
    ds_read_b64_tr_b16 v[132:133], v2 offset:50752
    ds_read_b64_tr_b16 v[134:135], v2 offset:50928
    ds_read_b128 a[80:83], v217
    v_dot2c_f32_bf16 v189, v243, v22
    v_dot2c_f32_bf16 v190, v243, v243
    v_dot2c_f32_bf16 v191, v244, v22
    s_waitcnt lgkmcnt(13)
    v_mfma_f32_32x32x16_bf16 v[64:79], v[148:151], a[68:71], v[64:79]
    ds_read_b64_tr_b16 v[136:137], v4 offset:50816
    ds_read_b64_tr_b16 v[138:139], v4 offset:50992
    ds_read_b128 a[84:87], v218
    v_dot2c_f32_bf16 v219, v244, v244
    v_dot2c_f32_bf16 v191, v245, v22
    v_dot2c_f32_bf16 v219, v245, v245
    s_add_u32 s94, s97, 86016
    s_mov_b32 m0, s94
    s_mul_i32 s95, s81, 245760
    s_add_u32 s95, s95, s62
    buffer_load_dwordx4 v186, s[16:19], s95 offen lds
    s_waitcnt lgkmcnt(14)
    v_mfma_f32_32x32x16_bf16 v[80:95], v[152:155], a[68:71], v[80:95]
    ds_read_b64_tr_b16 v[140:141], v60 offset:50688
    ds_read_b64_tr_b16 v[142:143], v60 offset:50864
    v_accvgpr_read_b32 v248, a88
    v_accvgpr_read_b32 v249, a89
    v_accvgpr_read_b32 v250, a90
    v_accvgpr_read_b32 v251, a91
    v_dot2c_f32_bf16 v191, v246, v22
    v_dot2c_f32_bf16 v219, v246, v246
    v_dot2c_f32_bf16 v191, v247, v22
    s_waitcnt lgkmcnt(14)
    v_mfma_f32_32x32x16_bf16 v[96:111], v[156:159], a[68:71], v[96:111]
    ds_read_b64_tr_b16 v[144:145], v2 offset:53504
    ds_read_b64_tr_b16 v[146:147], v2 offset:53680
    v_accvgpr_read_b32 v252, a92
    v_accvgpr_read_b32 v253, a93
    v_accvgpr_read_b32 v254, a94
    v_accvgpr_read_b32 v255, a95
    v_dot2c_f32_bf16 v219, v247, v247
    v_dot2c_f32_bf16 v189, v248, v22
    v_dot2c_f32_bf16 v190, v248, v248
    s_lshl_b32 s90, s82, 7
    s_add_u32 s90, s90, s86
    buffer_load_dwordx4 a[128:131], v188, s[12:15], s90 offen offset:0
    s_waitcnt lgkmcnt(14)
    v_mfma_f32_32x32x16_bf16 a[160:175], v[220:223], v[160:163], a[160:175]
    ds_read_b64_tr_b16 v[148:149], v2 offset:53568
    ds_read_b64_tr_b16 v[150:151], v2 offset:53744
    ds_write_b128 v216, a[88:91]
    ds_write_b128 v216, a[92:95] offset:1024
    v_dot2c_f32_bf16 v189, v249, v22
    v_dot2c_f32_bf16 v190, v249, v249
    v_dot2c_f32_bf16 v189, v250, v22
    s_waitcnt lgkmcnt(15)
    v_mfma_f32_32x32x16_bf16 v[64:79], v[128:131], a[72:75], v[64:79]
    ds_read_b64_tr_b16 v[152:153], v4 offset:53632
    ds_read_b64_tr_b16 v[154:155], v4 offset:53808
    ds_read_b128 a[88:91], v217
    v_dot2c_f32_bf16 v190, v250, v250
    v_dot2c_f32_bf16 v189, v251, v22
    v_dot2c_f32_bf16 v190, v251, v251
    s_lshl_b32 s90, s82, 7
    s_add_u32 s90, s90, s87
    buffer_load_dwordx4 a[132:135], v188, s[12:15], s90 offen offset:0
    s_waitcnt lgkmcnt(15)
    v_mfma_f32_32x32x16_bf16 v[80:95], v[132:135], a[72:75], v[80:95]
    ds_read_b64_tr_b16 v[156:157], v60 offset:53504
    ds_read_b64_tr_b16 v[158:159], v60 offset:53680
    ds_read_b128 a[92:95], v218
    v_dot2c_f32_bf16 v191, v252, v22
    v_dot2c_f32_bf16 v219, v252, v252
    v_dot2c_f32_bf16 v191, v253, v22
    s_waitcnt lgkmcnt(15)
    v_mfma_f32_32x32x16_bf16 v[96:111], v[136:139], a[72:75], v[96:111]
    ds_read_b64_tr_b16 v[160:161], v3 offset:0
    ds_read_b64_tr_b16 v[162:163], v3 offset:176
    v_dot2c_f32_bf16 v219, v253, v253
    v_dot2c_f32_bf16 v191, v254, v22
    v_dot2c_f32_bf16 v219, v254, v254
    s_lshl_b32 s90, s82, 7
    s_add_u32 s90, s90, s86
    buffer_load_dwordx4 a[136:139], v188, s[12:15], s90 offen offset:64
    s_waitcnt lgkmcnt(14)
    v_mfma_f32_32x32x16_bf16 a[160:175], v[220:223], v[140:143], a[160:175]
    ds_read_b64_tr_b16 v[128:129], v3 offset:64
    ds_read_b64_tr_b16 v[130:131], v3 offset:240
    v_dot2c_f32_bf16 v191, v255, v22
    v_dot2c_f32_bf16 v219, v255, v255
    s_waitcnt lgkmcnt(14)
    v_mfma_f32_32x32x16_bf16 v[64:79], v[144:147], a[76:79], v[64:79]
    ds_read_b64_tr_b16 v[132:133], v5 offset:128
    ds_read_b64_tr_b16 v[134:135], v5 offset:304
    s_lshl_b32 s90, s82, 7
    s_add_u32 s90, s90, s87
    buffer_load_dwordx4 a[140:143], v188, s[12:15], s90 offen offset:64
    s_waitcnt lgkmcnt(14)
    v_mfma_f32_32x32x16_bf16 v[80:95], v[148:151], a[76:79], v[80:95]
    ds_read_b64_tr_b16 v[136:137], v61 offset:0
    ds_read_b64_tr_b16 v[138:139], v61 offset:176
    s_waitcnt lgkmcnt(12)
    v_mfma_f32_32x32x16_bf16 v[96:111], v[152:155], a[76:79], v[96:111]
    ds_read_b64_tr_b16 v[140:141], v3 offset:2816
    ds_read_b64_tr_b16 v[142:143], v3 offset:2992
    s_add_u32 s94, s97, 90112
    s_mov_b32 m0, s94
    s_mul_i32 s95, s82, 245760
    s_add_u32 s95, s95, s62
    buffer_load_dwordx4 v176, s[16:19], s95 offen lds
    s_waitcnt lgkmcnt(11)
    v_mfma_f32_32x32x16_bf16 a[160:175], v[220:223], v[156:159], a[160:175]
    ds_read_b64_tr_b16 v[144:145], v3 offset:2880
    ds_read_b64_tr_b16 v[146:147], v3 offset:3056
    s_waitcnt lgkmcnt(10)
    v_mfma_f32_32x32x16_bf16 v[64:79], v[160:163], a[80:83], v[64:79]
    ds_read_b64_tr_b16 v[148:149], v5 offset:2944
    ds_read_b64_tr_b16 v[150:151], v5 offset:3120
    v_accvgpr_read_b32 v224, a96
    v_accvgpr_read_b32 v225, a97
    v_accvgpr_read_b32 v226, a98
    v_accvgpr_read_b32 v227, a99
    s_add_u32 s94, s97, 94208
    s_mov_b32 m0, s94
    s_mul_i32 s95, s82, 245760
    s_add_u32 s95, s95, s62
    buffer_load_dwordx4 v177, s[16:19], s95 offen lds
    s_waitcnt lgkmcnt(10)
    v_mfma_f32_32x32x16_bf16 v[80:95], v[128:131], a[80:83], v[80:95]
    ds_read_b64_tr_b16 v[152:153], v61 offset:2816
    ds_read_b64_tr_b16 v[154:155], v61 offset:2992
    v_accvgpr_read_b32 v228, a100
    v_accvgpr_read_b32 v229, a101
    v_accvgpr_read_b32 v230, a102
    v_accvgpr_read_b32 v231, a103
    v_dot2c_f32_bf16 v189, v224, v22
    v_dot2c_f32_bf16 v190, v224, v224
    v_dot2c_f32_bf16 v189, v225, v22
    s_waitcnt lgkmcnt(10)
    v_mfma_f32_32x32x16_bf16 v[96:111], v[132:135], a[80:83], v[96:111]
    ds_read_b64_tr_b16 v[156:157], v3 offset:5632
    ds_read_b64_tr_b16 v[158:159], v3 offset:5808
    ds_write_b128 v216, a[96:99]
    ds_write_b128 v216, a[100:103] offset:1024
    v_dot2c_f32_bf16 v190, v225, v225
    v_dot2c_f32_bf16 v189, v226, v22
    v_dot2c_f32_bf16 v190, v226, v226
    s_add_u32 s94, s97, 98304
    s_mov_b32 m0, s94
    s_cmp_ge_u32 s44, 3
    s_cselect_b32 s95, s83, s82
    s_mul_i32 s95, s95, 245760
    s_add_u32 s95, s95, s62
    buffer_load_dwordx4 v178, s[16:19], s95 offen lds
    s_waitcnt lgkmcnt(12)
    v_mfma_f32_32x32x16_bf16 a[160:175], v[220:223], v[136:139], a[160:175]
    ds_read_b64_tr_b16 v[160:161], v3 offset:5696
    ds_read_b64_tr_b16 v[162:163], v3 offset:5872
    ds_read_b128 a[96:99], v217
    v_dot2c_f32_bf16 v189, v227, v22
    v_dot2c_f32_bf16 v190, v227, v227
    v_dot2c_f32_bf16 v191, v228, v22
    s_waitcnt lgkmcnt(13)
    v_mfma_f32_32x32x16_bf16 v[64:79], v[140:143], a[84:87], v[64:79]
    ds_read_b64_tr_b16 v[128:129], v5 offset:5760
    ds_read_b64_tr_b16 v[130:131], v5 offset:5936
    ds_read_b128 a[100:103], v218
    v_dot2c_f32_bf16 v219, v228, v228
    v_dot2c_f32_bf16 v191, v229, v22
    v_dot2c_f32_bf16 v219, v229, v229
    s_mov_b32 exec_hi, -1
    ds_write_b128 v216, v[192:195]
    ds_read_b64_tr_b16 v[192:193], v58 offset:0
    ds_read_b64_tr_b16 v[194:195], v58 offset:256
    ds_write_b128 v216, v[196:199]
    ds_read_b64_tr_b16 v[196:197], v58 offset:0
    ds_read_b64_tr_b16 v[198:199], v58 offset:256
    ds_write_b128 v216, v[44:47]
    ds_read_b64_tr_b16 v[44:45], v58 offset:0
    ds_read_b64_tr_b16 v[46:47], v58 offset:256
    s_mov_b64 exec, -1
    v_sub_u32 v43, v216, v1
    v_lshl_add_u32 v43, v21, 3, v43
    s_mov_b32 exec_hi, -1
    ds_write_b128 v216, v[48:51]
    ds_read_b64_tr_b16 v[48:49], v43 offset:0
    ds_read_b64_tr_b16 v[50:51], v43 offset:512
    s_mov_b64 exec, -1
    s_waitcnt lgkmcnt(0)
    s_add_u32 s95, s45, 0
    s_cmp_eq_u32 s44, 3
    s_movk_i32 s94, 2816
    s_cselect_b32 s94, 1024, s94
    s_mul_i32 s95, s95, s94
    s_cselect_b32 s94, 112640, s97
    s_add_u32 s95, s95, s94
    s_mul_i32 s94, s46, 153600
    s_add_u32 s94, s94, s95
    s_add_u32 s94, s94, 23461888
    buffer_store_dwordx4 v[192:195], v57, s[8:11], s94 offen sc1
    v_mfma_f32_32x32x16_bf16 v[80:95], v[144:147], a[84:87], v[80:95]
    ds_read_b64_tr_b16 v[132:133], v61 offset:5632
    ds_read_b64_tr_b16 v[134:135], v61 offset:5808
    v_accvgpr_read_b32 v232, a104
    v_accvgpr_read_b32 v233, a105
    v_accvgpr_read_b32 v234, a106
    v_accvgpr_read_b32 v235, a107
    v_dot2c_f32_bf16 v191, v230, v22
    v_dot2c_f32_bf16 v219, v230, v230
    v_dot2c_f32_bf16 v191, v231, v22
    v_mfma_f32_32x32x16_bf16 v[96:111], v[148:151], a[84:87], v[96:111]
    ds_read_b64_tr_b16 v[136:137], v3 offset:8448
    ds_read_b64_tr_b16 v[138:139], v3 offset:8624
    v_accvgpr_read_b32 v236, a108
    v_accvgpr_read_b32 v237, a109
    v_accvgpr_read_b32 v238, a110
    v_accvgpr_read_b32 v239, a111
    v_dot2c_f32_bf16 v219, v231, v231
    v_dot2c_f32_bf16 v189, v232, v22
    v_dot2c_f32_bf16 v190, v232, v232
    s_add_u32 s95, s45, 16
    s_cmp_eq_u32 s44, 3
    s_movk_i32 s94, 2816
    s_cselect_b32 s94, 1024, s94
    s_mul_i32 s95, s95, s94
    s_cselect_b32 s94, 112640, s97
    s_add_u32 s95, s95, s94
    s_mul_i32 s94, s46, 153600
    s_add_u32 s94, s94, s95
    s_add_u32 s94, s94, 23461888
    buffer_store_dwordx4 v[196:199], v57, s[8:11], s94 offen sc1
    v_mfma_f32_32x32x16_bf16 a[160:175], v[220:223], v[152:155], a[160:175]
    ds_read_b64_tr_b16 v[140:141], v3 offset:8512
    ds_read_b64_tr_b16 v[142:143], v3 offset:8688
    ds_write_b128 v216, a[104:107]
    ds_write_b128 v216, a[108:111] offset:1024
    v_dot2c_f32_bf16 v189, v233, v22
    v_dot2c_f32_bf16 v190, v233, v233
    v_dot2c_f32_bf16 v189, v234, v22
    v_mfma_f32_32x32x16_bf16 v[64:79], v[156:159], a[88:91], v[64:79]
    ds_read_b64_tr_b16 v[144:145], v5 offset:8576
    ds_read_b64_tr_b16 v[146:147], v5 offset:8752
    ds_read_b128 a[104:107], v217
    v_dot2c_f32_bf16 v190, v234, v234
    v_dot2c_f32_bf16 v189, v235, v22
    v_dot2c_f32_bf16 v190, v235, v235
    s_cmp_lt_u32 s45, 8
    s_cselect_b32 s95, 32, 0
    s_add_u32 s95, s95, s45
    s_cmp_eq_u32 s44, 3
    s_movk_i32 s94, 2816
    s_cselect_b32 s94, 1024, s94
    s_mul_i32 s95, s95, s94
    s_cselect_b32 s94, 112640, s97
    s_add_u32 s95, s95, s94
    s_mul_i32 s94, s46, 153600
    s_add_u32 s94, s94, s95
    s_add_u32 s94, s94, 23461888
    buffer_store_dwordx4 v[44:47], v57, s[8:11], s94 offen sc1
    v_mfma_f32_32x32x16_bf16 v[80:95], v[160:163], a[88:91], v[80:95]
    ds_read_b64_tr_b16 v[148:149], v61 offset:8448
    ds_read_b64_tr_b16 v[150:151], v61 offset:8624
    ds_read_b128 a[108:111], v218
    v_dot2c_f32_bf16 v191, v236, v22
    v_dot2c_f32_bf16 v219, v236, v236
    v_dot2c_f32_bf16 v191, v237, v22
    v_mfma_f32_32x32x16_bf16 v[96:111], v[128:131], a[88:91], v[96:111]
    ds_read_b64_tr_b16 v[152:153], v3 offset:11264
    ds_read_b64_tr_b16 v[154:155], v3 offset:11440
    v_dot2c_f32_bf16 v219, v237, v237
    v_dot2c_f32_bf16 v191, v238, v22
    v_dot2c_f32_bf16 v219, v238, v238
    s_mul_i32 s94, s47, 102400
    s_add_u32 s94, s94, 26214400
    buffer_store_dwordx4 v[48:51], v63, s[8:11], s94 offen sc1
    s_waitcnt lgkmcnt(14)
    v_mfma_f32_32x32x16_bf16 a[160:175], v[220:223], v[132:135], a[160:175]
    ds_read_b64_tr_b16 v[156:157], v3 offset:11328
    ds_read_b64_tr_b16 v[158:159], v3 offset:11504
    v_dot2c_f32_bf16 v191, v239, v22
    v_dot2c_f32_bf16 v219, v239, v239
    s_waitcnt lgkmcnt(14)
    v_mfma_f32_32x32x16_bf16 v[64:79], v[136:139], a[92:95], v[64:79]
    ds_read_b64_tr_b16 v[160:161], v5 offset:11392
    ds_read_b64_tr_b16 v[162:163], v5 offset:11568
    s_lshl_b32 s90, s83, 7
    s_add_u32 s90, s90, s86
    buffer_load_dwordx4 a[144:147], v188, s[12:15], s90 offen offset:0
    s_waitcnt lgkmcnt(14)
    v_mfma_f32_32x32x16_bf16 v[80:95], v[140:143], a[92:95], v[80:95]
    ds_read_b64_tr_b16 v[128:129], v61 offset:11264
    ds_read_b64_tr_b16 v[130:131], v61 offset:11440
    s_waitcnt lgkmcnt(12)
    v_mfma_f32_32x32x16_bf16 v[96:111], v[144:147], a[92:95], v[96:111]
    ds_read_b64_tr_b16 v[132:133], v3 offset:14080
    ds_read_b64_tr_b16 v[134:135], v3 offset:14256
    s_lshl_b32 s90, s83, 7
    s_add_u32 s90, s90, s87
    buffer_load_dwordx4 a[148:151], v188, s[12:15], s90 offen offset:0
    s_waitcnt lgkmcnt(11)
    v_mfma_f32_32x32x16_bf16 a[160:175], v[220:223], v[148:151], a[160:175]
    ds_read_b64_tr_b16 v[136:137], v3 offset:14144
    ds_read_b64_tr_b16 v[138:139], v3 offset:14320
    s_waitcnt lgkmcnt(10)
    v_mfma_f32_32x32x16_bf16 v[64:79], v[152:155], a[96:99], v[64:79]
    ds_read_b64_tr_b16 v[140:141], v5 offset:14208
    ds_read_b64_tr_b16 v[142:143], v5 offset:14384
    s_waitcnt vmcnt(17)
    v_accvgpr_read_b32 v240, a112
    v_accvgpr_read_b32 v241, a113
    v_accvgpr_read_b32 v242, a114
    v_accvgpr_read_b32 v243, a115
    s_lshl_b32 s90, s83, 7
    s_add_u32 s90, s90, s86
    buffer_load_dwordx4 a[152:155], v188, s[12:15], s90 offen offset:64
    s_waitcnt lgkmcnt(10)
    v_mfma_f32_32x32x16_bf16 v[80:95], v[156:159], a[96:99], v[80:95]
    ds_read_b64_tr_b16 v[144:145], v61 offset:14080
    ds_read_b64_tr_b16 v[146:147], v61 offset:14256
    v_accvgpr_read_b32 v244, a116
    v_accvgpr_read_b32 v245, a117
    v_accvgpr_read_b32 v246, a118
    v_accvgpr_read_b32 v247, a119
    v_dot2c_f32_bf16 v189, v240, v22
    v_dot2c_f32_bf16 v190, v240, v240
    v_dot2c_f32_bf16 v189, v241, v22
    s_waitcnt lgkmcnt(10)
    v_mfma_f32_32x32x16_bf16 v[96:111], v[160:163], a[96:99], v[96:111]
    ds_read_b64_tr_b16 v[148:149], v3 offset:16896
    ds_read_b64_tr_b16 v[150:151], v3 offset:17072
    ds_write_b128 v216, a[112:115]
    ds_write_b128 v216, a[116:119] offset:1024
    v_dot2c_f32_bf16 v190, v241, v241
    v_dot2c_f32_bf16 v189, v242, v22
    v_dot2c_f32_bf16 v190, v242, v242
    s_lshl_b32 s90, s83, 7
    s_add_u32 s90, s90, s87
    buffer_load_dwordx4 a[156:159], v188, s[12:15], s90 offen offset:64
    s_waitcnt lgkmcnt(12)
    v_mfma_f32_32x32x16_bf16 a[160:175], v[220:223], v[128:131], a[160:175]
    ds_read_b64_tr_b16 v[152:153], v3 offset:16960
    ds_read_b64_tr_b16 v[154:155], v3 offset:17136
    ds_read_b128 a[112:115], v217
    v_dot2c_f32_bf16 v189, v243, v22
    v_dot2c_f32_bf16 v190, v243, v243
    v_dot2c_f32_bf16 v191, v244, v22
    s_waitcnt lgkmcnt(13)
    v_mfma_f32_32x32x16_bf16 v[64:79], v[132:135], a[100:103], v[64:79]
    ds_read_b64_tr_b16 v[156:157], v5 offset:17024
    ds_read_b64_tr_b16 v[158:159], v5 offset:17200
    ds_read_b128 a[116:119], v218
    v_dot2c_f32_bf16 v219, v244, v244
    v_dot2c_f32_bf16 v191, v245, v22
    v_dot2c_f32_bf16 v219, v245, v245
    s_add_u32 s94, s97, 102400
    s_mov_b32 m0, s94
    s_mul_i32 s95, s83, 245760
    s_add_u32 s95, s95, s62
    buffer_load_dwordx4 v179, s[16:19], s95 offen lds
    s_waitcnt lgkmcnt(14)
    v_mfma_f32_32x32x16_bf16 v[80:95], v[136:139], a[100:103], v[80:95]
    ds_read_b64_tr_b16 v[160:161], v61 offset:16896
    ds_read_b64_tr_b16 v[162:163], v61 offset:17072
    s_waitcnt vmcnt(18)
    v_accvgpr_read_b32 v248, a120
    v_accvgpr_read_b32 v249, a121
    v_accvgpr_read_b32 v250, a122
    v_accvgpr_read_b32 v251, a123
    v_dot2c_f32_bf16 v191, v246, v22
    v_dot2c_f32_bf16 v219, v246, v246
    v_dot2c_f32_bf16 v191, v247, v22
    s_waitcnt lgkmcnt(14)
    v_mfma_f32_32x32x16_bf16 v[96:111], v[140:143], a[100:103], v[96:111]
    ds_read_b64_tr_b16 v[128:129], v3 offset:19712
    ds_read_b64_tr_b16 v[130:131], v3 offset:19888
    v_accvgpr_read_b32 v252, a124
    v_accvgpr_read_b32 v253, a125
    v_accvgpr_read_b32 v254, a126
    v_accvgpr_read_b32 v255, a127
    v_dot2c_f32_bf16 v219, v247, v247
    v_dot2c_f32_bf16 v189, v248, v22
    v_dot2c_f32_bf16 v190, v248, v248
    s_add_u32 s94, s97, 106496
    s_mov_b32 m0, s94
    s_mul_i32 s95, s83, 245760
    s_add_u32 s95, s95, s62
    buffer_load_dwordx4 v180, s[16:19], s95 offen lds
    s_waitcnt lgkmcnt(14)
    v_mfma_f32_32x32x16_bf16 a[160:175], v[220:223], v[144:147], a[160:175]
    ds_read_b64_tr_b16 v[132:133], v3 offset:19776
    ds_read_b64_tr_b16 v[134:135], v3 offset:19952
    ds_write_b128 v216, a[120:123]
    ds_write_b128 v216, a[124:127] offset:1024
    v_dot2c_f32_bf16 v189, v249, v22
    v_dot2c_f32_bf16 v190, v249, v249
    v_dot2c_f32_bf16 v189, v250, v22
    s_waitcnt lgkmcnt(15)
    v_mfma_f32_32x32x16_bf16 v[64:79], v[148:151], a[104:107], v[64:79]
    ds_read_b64_tr_b16 v[136:137], v5 offset:19840
    ds_read_b64_tr_b16 v[138:139], v5 offset:20016
    ds_read_b128 a[120:123], v217
    v_dot2c_f32_bf16 v190, v250, v250
    v_dot2c_f32_bf16 v189, v251, v22
    v_dot2c_f32_bf16 v190, v251, v251
    s_add_u32 s94, s97, 110592
    s_cmp_lt_u32 s44, 2
    s_cselect_b32 s94, s94, 0x30000
    s_mov_b32 m0, s94
    s_mul_i32 s95, s83, 245760
    s_add_u32 s95, s95, s62
    buffer_load_dwordx4 v181, s[16:19], s95 offen lds
    s_waitcnt lgkmcnt(15)
    v_mfma_f32_32x32x16_bf16 v[80:95], v[152:155], a[104:107], v[80:95]
    ds_read_b64_tr_b16 v[140:141], v61 offset:19712
    ds_read_b64_tr_b16 v[142:143], v61 offset:19888
    ds_read_b128 a[124:127], v218
    s_waitcnt vmcnt(11)
    s_barrier
    v_dot2c_f32_bf16 v191, v252, v22
    v_dot2c_f32_bf16 v219, v252, v252
    v_dot2c_f32_bf16 v191, v253, v22
    s_waitcnt lgkmcnt(15)
    v_mfma_f32_32x32x16_bf16 v[96:111], v[156:159], a[104:107], v[96:111]
    ds_read_b64_tr_b16 v[144:145], v3 offset:22528
    ds_read_b64_tr_b16 v[146:147], v3 offset:22704
    v_dot2c_f32_bf16 v219, v253, v253
    v_dot2c_f32_bf16 v191, v254, v22
    v_dot2c_f32_bf16 v219, v254, v254
    s_add_u32 s94, s97, 112640
    s_mov_b32 m0, s94
    s_lshl_b32 s95, s74, 2
    s_add_u32 s95, s95, s44
    s_mul_i32 s95, s95, 61440
    s_add_u32 s95, s95, s62
    buffer_load_dwordx4 v187, s[16:19], s95 offen lds
    s_waitcnt lgkmcnt(14)
    v_mfma_f32_32x32x16_bf16 a[160:175], v[220:223], v[160:163], a[160:175]
    ds_read_b64_tr_b16 v[148:149], v3 offset:22592
    ds_read_b64_tr_b16 v[150:151], v3 offset:22768
    v_dot2c_f32_bf16 v191, v255, v22
    v_dot2c_f32_bf16 v219, v255, v255
    s_waitcnt lgkmcnt(14)
    v_mfma_f32_32x32x16_bf16 v[64:79], v[128:131], a[108:111], v[64:79]
    ds_read_b64_tr_b16 v[152:153], v5 offset:22656
    ds_read_b64_tr_b16 v[154:155], v5 offset:22832
    s_add_u32 s94, s97, 116736
    s_mov_b32 m0, s94
    s_lshl_b32 s95, s75, 2
    s_add_u32 s95, s95, s44
    s_mul_i32 s95, s95, 61440
    s_add_u32 s95, s95, s62
    buffer_load_dwordx4 v187, s[16:19], s95 offen lds
    s_waitcnt lgkmcnt(14)
    v_mfma_f32_32x32x16_bf16 v[80:95], v[132:135], a[108:111], v[80:95]
    ds_read_b64_tr_b16 v[156:157], v61 offset:22528
    ds_read_b64_tr_b16 v[158:159], v61 offset:22704
    s_waitcnt lgkmcnt(12)
    v_mfma_f32_32x32x16_bf16 v[96:111], v[136:139], a[108:111], v[96:111]
    ds_read_b64_tr_b16 v[160:161], v3 offset:25344
    ds_read_b64_tr_b16 v[162:163], v3 offset:25520
    s_add_u32 s94, s97, 120832
    s_mov_b32 m0, s94
    s_lshl_b32 s95, s76, 2
    s_add_u32 s95, s95, s44
    s_mul_i32 s95, s95, 61440
    s_add_u32 s95, s95, s62
    buffer_load_dwordx4 v187, s[16:19], s95 offen lds
    s_waitcnt lgkmcnt(11)
    v_mfma_f32_32x32x16_bf16 a[160:175], v[220:223], v[140:143], a[160:175]
    ds_read_b64_tr_b16 v[128:129], v3 offset:25408
    ds_read_b64_tr_b16 v[130:131], v3 offset:25584
    s_waitcnt lgkmcnt(10)
    v_mfma_f32_32x32x16_bf16 v[64:79], v[144:147], a[112:115], v[64:79]
    ds_read_b64_tr_b16 v[132:133], v5 offset:25472
    ds_read_b64_tr_b16 v[134:135], v5 offset:25648
    v_accvgpr_read_b32 v224, a128
    v_accvgpr_read_b32 v225, a129
    v_accvgpr_read_b32 v226, a130
    v_accvgpr_read_b32 v227, a131
    s_add_u32 s94, s97, 124928
    s_mov_b32 m0, s94
    s_lshl_b32 s95, s77, 2
    s_add_u32 s95, s95, s44
    s_mul_i32 s95, s95, 61440
    s_add_u32 s95, s95, s62
    buffer_load_dwordx4 v187, s[16:19], s95 offen lds
    s_waitcnt lgkmcnt(10)
    v_mfma_f32_32x32x16_bf16 v[80:95], v[148:151], a[112:115], v[80:95]
    ds_read_b64_tr_b16 v[136:137], v61 offset:25344
    ds_read_b64_tr_b16 v[138:139], v61 offset:25520
    v_accvgpr_read_b32 v228, a132
    v_accvgpr_read_b32 v229, a133
    v_accvgpr_read_b32 v230, a134
    v_accvgpr_read_b32 v231, a135
    v_dot2c_f32_bf16 v189, v224, v22
    v_dot2c_f32_bf16 v190, v224, v224
    v_dot2c_f32_bf16 v189, v225, v22
    s_waitcnt lgkmcnt(10)
    v_mfma_f32_32x32x16_bf16 v[96:111], v[152:155], a[112:115], v[96:111]
    ds_read_b64_tr_b16 v[140:141], v3 offset:28160
    ds_read_b64_tr_b16 v[142:143], v3 offset:28336
    ds_write_b128 v216, a[128:131]
    ds_write_b128 v216, a[132:135] offset:1024
    v_dot2c_f32_bf16 v190, v225, v225
    v_dot2c_f32_bf16 v189, v226, v22
    v_dot2c_f32_bf16 v190, v226, v226
    s_add_u32 s94, s97, 129024
    s_mov_b32 m0, s94
    s_lshl_b32 s95, s78, 2
    s_add_u32 s95, s95, s44
    s_mul_i32 s95, s95, 61440
    s_add_u32 s95, s95, s62
    buffer_load_dwordx4 v187, s[16:19], s95 offen lds
    s_waitcnt lgkmcnt(12)
    v_mfma_f32_32x32x16_bf16 a[160:175], v[220:223], v[156:159], a[160:175]
    ds_read_b64_tr_b16 v[144:145], v3 offset:28224
    ds_read_b64_tr_b16 v[146:147], v3 offset:28400
    ds_read_b128 a[128:131], v217
    v_dot2c_f32_bf16 v189, v227, v22
    v_dot2c_f32_bf16 v190, v227, v227
    v_dot2c_f32_bf16 v191, v228, v22
    s_waitcnt lgkmcnt(13)
    v_mfma_f32_32x32x16_bf16 v[64:79], v[160:163], a[116:119], v[64:79]
    ds_read_b64_tr_b16 v[148:149], v5 offset:28288
    ds_read_b64_tr_b16 v[150:151], v5 offset:28464
    ds_read_b128 a[132:135], v218
    v_dot2c_f32_bf16 v219, v228, v228
    v_dot2c_f32_bf16 v191, v229, v22
    v_dot2c_f32_bf16 v219, v229, v229
    s_add_u32 s94, s97, 133120
    s_mov_b32 m0, s94
    s_lshl_b32 s95, s79, 2
    s_add_u32 s95, s95, s44
    s_mul_i32 s95, s95, 61440
    s_add_u32 s95, s95, s62
    buffer_load_dwordx4 v187, s[16:19], s95 offen lds
    s_waitcnt lgkmcnt(14)
    v_mfma_f32_32x32x16_bf16 v[80:95], v[128:131], a[116:119], v[80:95]
    ds_read_b64_tr_b16 v[152:153], v61 offset:28160
    ds_read_b64_tr_b16 v[154:155], v61 offset:28336
    v_accvgpr_read_b32 v232, a136
    v_accvgpr_read_b32 v233, a137
    v_accvgpr_read_b32 v234, a138
    v_accvgpr_read_b32 v235, a139
    v_dot2c_f32_bf16 v191, v230, v22
    v_dot2c_f32_bf16 v219, v230, v230
    v_dot2c_f32_bf16 v191, v231, v22
    s_waitcnt lgkmcnt(14)
    v_mfma_f32_32x32x16_bf16 v[96:111], v[132:135], a[116:119], v[96:111]
    ds_read_b64_tr_b16 v[156:157], v3 offset:30976
    ds_read_b64_tr_b16 v[158:159], v3 offset:31152
    v_accvgpr_read_b32 v236, a140
    v_accvgpr_read_b32 v237, a141
    v_accvgpr_read_b32 v238, a142
    v_accvgpr_read_b32 v239, a143
    v_dot2c_f32_bf16 v219, v231, v231
    v_dot2c_f32_bf16 v189, v232, v22
    v_dot2c_f32_bf16 v190, v232, v232
    s_add_u32 s94, s97, 137216
    s_mov_b32 m0, s94
    s_lshl_b32 s95, s80, 2
    s_add_u32 s95, s95, s44
    s_mul_i32 s95, s95, 61440
    s_add_u32 s95, s95, s62
    buffer_load_dwordx4 v187, s[16:19], s95 offen lds
    s_waitcnt lgkmcnt(14)
    v_mfma_f32_32x32x16_bf16 a[160:175], v[220:223], v[136:139], a[160:175]
    ds_read_b64_tr_b16 v[160:161], v3 offset:31040
    ds_read_b64_tr_b16 v[162:163], v3 offset:31216
    ds_write_b128 v216, a[136:139]
    ds_write_b128 v216, a[140:143] offset:1024
    v_dot2c_f32_bf16 v189, v233, v22
    v_dot2c_f32_bf16 v190, v233, v233
    v_dot2c_f32_bf16 v189, v234, v22
    s_waitcnt lgkmcnt(15)
    v_mfma_f32_32x32x16_bf16 v[64:79], v[140:143], a[120:123], v[64:79]
    ds_read_b64_tr_b16 v[128:129], v5 offset:31104
    ds_read_b64_tr_b16 v[130:131], v5 offset:31280
    ds_read_b128 a[136:139], v217
    v_dot2c_f32_bf16 v190, v234, v234
    v_dot2c_f32_bf16 v189, v235, v22
    v_dot2c_f32_bf16 v190, v235, v235
    s_add_u32 s94, s97, 141312
    s_mov_b32 m0, s94
    s_lshl_b32 s95, s81, 2
    s_add_u32 s95, s95, s44
    s_mul_i32 s95, s95, 61440
    s_add_u32 s95, s95, s62
    buffer_load_dwordx4 v187, s[16:19], s95 offen lds
    s_waitcnt lgkmcnt(15)
    v_mfma_f32_32x32x16_bf16 v[80:95], v[144:147], a[120:123], v[80:95]
    ds_read_b64_tr_b16 v[132:133], v61 offset:30976
    ds_read_b64_tr_b16 v[134:135], v61 offset:31152
    ds_read_b128 a[140:143], v218
    s_add_u32 s94, s97, 145408
    s_mov_b32 m0, s94
    s_lshl_b32 s95, s82, 2
    s_add_u32 s95, s95, s44
    s_mul_i32 s95, s95, 61440
    s_add_u32 s95, s95, s62
    buffer_load_dwordx4 v187, s[16:19], s95 offen lds
    s_add_u32 s94, s97, 149504
    s_mov_b32 m0, s94
    s_lshl_b32 s95, s83, 2
    s_add_u32 s95, s95, s44
    s_mul_i32 s95, s95, 61440
    s_add_u32 s95, s95, s62
    buffer_load_dwordx4 v187, s[16:19], s95 offen lds
    s_waitcnt vmcnt(10)
    s_barrier
    s_and_b32 s56, s2, 3
    s_lshl_b32 s56, s56, 5
    s_add_u32 s56, s56, 0
    s_cmp_eq_u32 s44, 0
    s_cselect_b32 s57, 0, 0x80000000
    s_or_b32 s56, s56, s57
    v_mov_b32 v174, s56
    v_mov_b32 v175, 1
    s_mov_b64 exec, 1
    buffer_atomic_add v175, v174, s[40:43], 0 offen sc1
    s_mov_b64 exec, -1
    v_dot2c_f32_bf16 v191, v236, v22
    v_dot2c_f32_bf16 v219, v236, v236
    v_dot2c_f32_bf16 v191, v237, v22
    s_waitcnt lgkmcnt(15)
    v_mfma_f32_32x32x16_bf16 v[96:111], v[148:151], a[120:123], v[96:111]
    ds_read_b64_tr_b16 v[136:137], v3 offset:33792
    ds_read_b64_tr_b16 v[138:139], v3 offset:33968
    v_dot2c_f32_bf16 v219, v237, v237
    v_dot2c_f32_bf16 v191, v238, v22
    v_dot2c_f32_bf16 v219, v238, v238
    s_add_u32 s95, s45, 0
    s_mul_i32 s95, s95, 61440
    s_add_u32 s95, s95, s62
    buffer_load_dwordx4 v[192:195], v56, s[16:19], s95 offen
    s_waitcnt lgkmcnt(14)
    v_mfma_f32_32x32x16_bf16 a[160:175], v[220:223], v[152:155], a[160:175]
    ds_read_b64_tr_b16 v[140:141], v3 offset:33856
    ds_read_b64_tr_b16 v[142:143], v3 offset:34032
    v_dot2c_f32_bf16 v191, v239, v22
    v_dot2c_f32_bf16 v219, v239, v239
    s_waitcnt lgkmcnt(14)
    v_mfma_f32_32x32x16_bf16 v[64:79], v[156:159], a[124:127], v[64:79]
    ds_read_b64_tr_b16 v[144:145], v5 offset:33920
    ds_read_b64_tr_b16 v[146:147], v5 offset:34096
    s_add_u32 s95, s45, 16
    s_mul_i32 s95, s95, 61440
    s_add_u32 s95, s95, s62
    buffer_load_dwordx4 v[196:199], v56, s[16:19], s95 offen
    s_waitcnt lgkmcnt(14)
    v_mfma_f32_32x32x16_bf16 v[80:95], v[160:163], a[124:127], v[80:95]
    ds_read_b64_tr_b16 v[148:149], v61 offset:33792
    ds_read_b64_tr_b16 v[150:151], v61 offset:33968
    s_waitcnt lgkmcnt(12)
    v_mfma_f32_32x32x16_bf16 v[96:111], v[128:131], a[124:127], v[96:111]
    ds_read_b64_tr_b16 v[152:153], v3 offset:36608
    ds_read_b64_tr_b16 v[154:155], v3 offset:36784
    s_cmp_lt_u32 s45, 8
    s_cselect_b32 s95, 32, 0
    s_add_u32 s95, s95, s45
    s_mul_i32 s95, s95, 61440
    s_add_u32 s95, s95, s62
    buffer_load_dwordx4 v[44:47], v56, s[16:19], s95 offen
    s_waitcnt lgkmcnt(11)
    v_mfma_f32_32x32x16_bf16 a[160:175], v[220:223], v[132:135], a[160:175]
    ds_read_b64_tr_b16 v[156:157], v3 offset:36672
    ds_read_b64_tr_b16 v[158:159], v3 offset:36848
    s_waitcnt lgkmcnt(10)
    v_mfma_f32_32x32x16_bf16 v[64:79], v[136:139], a[128:131], v[64:79]
    ds_read_b64_tr_b16 v[160:161], v5 offset:36736
    ds_read_b64_tr_b16 v[162:163], v5 offset:36912
    v_accvgpr_read_b32 v240, a144
    v_accvgpr_read_b32 v241, a145
    v_accvgpr_read_b32 v242, a146
    v_accvgpr_read_b32 v243, a147
    buffer_load_dwordx4 v[52:55], v59, s[32:35], s63 offen
    s_waitcnt lgkmcnt(10)
    v_mfma_f32_32x32x16_bf16 v[80:95], v[140:143], a[128:131], v[80:95]
    ds_read_b64_tr_b16 v[128:129], v61 offset:36608
    ds_read_b64_tr_b16 v[130:131], v61 offset:36784
    v_accvgpr_read_b32 v244, a148
    v_accvgpr_read_b32 v245, a149
    v_accvgpr_read_b32 v246, a150
    v_accvgpr_read_b32 v247, a151
    v_dot2c_f32_bf16 v189, v240, v22
    v_dot2c_f32_bf16 v190, v240, v240
    v_dot2c_f32_bf16 v189, v241, v22
    s_waitcnt lgkmcnt(10)
    v_mfma_f32_32x32x16_bf16 v[96:111], v[144:147], a[128:131], v[96:111]
    ds_read_b64_tr_b16 v[132:133], v3 offset:39424
    ds_read_b64_tr_b16 v[134:135], v3 offset:39600
    ds_write_b128 v216, a[144:147]
    ds_write_b128 v216, a[148:151] offset:1024
    v_dot2c_f32_bf16 v190, v241, v241
    v_dot2c_f32_bf16 v189, v242, v22
    v_dot2c_f32_bf16 v190, v242, v242
    v_and_b32 v42, 15, v21
    s_waitcnt lgkmcnt(12)
    v_mfma_f32_32x32x16_bf16 a[160:175], v[220:223], v[148:151], a[160:175]
    ds_read_b64_tr_b16 v[136:137], v3 offset:39488
    ds_read_b64_tr_b16 v[138:139], v3 offset:39664
    ds_read_b128 a[144:147], v217
    v_dot2c_f32_bf16 v189, v243, v22
    v_dot2c_f32_bf16 v190, v243, v243
    v_dot2c_f32_bf16 v191, v244, v22
    s_waitcnt lgkmcnt(13)
    v_mfma_f32_32x32x16_bf16 v[64:79], v[152:155], a[132:135], v[64:79]
    ds_read_b64_tr_b16 v[140:141], v5 offset:39552
    ds_read_b64_tr_b16 v[142:143], v5 offset:39728
    ds_read_b128 a[148:151], v218
    v_dot2c_f32_bf16 v219, v244, v244
    v_dot2c_f32_bf16 v191, v245, v22
    v_dot2c_f32_bf16 v219, v245, v245
    v_mul_u32_u24 v42, 1280, v42
    s_waitcnt lgkmcnt(14)
    v_mfma_f32_32x32x16_bf16 v[80:95], v[156:159], a[132:135], v[80:95]
    ds_read_b64_tr_b16 v[144:145], v61 offset:39424
    ds_read_b64_tr_b16 v[146:147], v61 offset:39600
    v_accvgpr_read_b32 v248, a152
    v_accvgpr_read_b32 v249, a153
    v_accvgpr_read_b32 v250, a154
    v_accvgpr_read_b32 v251, a155
    v_dot2c_f32_bf16 v191, v246, v22
    v_dot2c_f32_bf16 v219, v246, v246
    v_dot2c_f32_bf16 v191, v247, v22
    s_waitcnt lgkmcnt(14)
    v_mfma_f32_32x32x16_bf16 v[96:111], v[160:163], a[132:135], v[96:111]
    ds_read_b64_tr_b16 v[148:149], v3 offset:42240
    ds_read_b64_tr_b16 v[150:151], v3 offset:42416
    v_accvgpr_read_b32 v252, a156
    v_accvgpr_read_b32 v253, a157
    v_accvgpr_read_b32 v254, a158
    v_accvgpr_read_b32 v255, a159
    v_dot2c_f32_bf16 v219, v247, v247
    v_dot2c_f32_bf16 v189, v248, v22
    v_dot2c_f32_bf16 v190, v248, v248
    v_lshrrev_b32 v40, 4, v21
    s_waitcnt lgkmcnt(14)
    v_mfma_f32_32x32x16_bf16 a[160:175], v[220:223], v[128:131], a[160:175]
    ds_read_b64_tr_b16 v[152:153], v3 offset:42304
    ds_read_b64_tr_b16 v[154:155], v3 offset:42480
    ds_write_b128 v216, a[152:155]
    ds_write_b128 v216, a[156:159] offset:1024
    v_dot2c_f32_bf16 v189, v249, v22
    v_dot2c_f32_bf16 v190, v249, v249
    v_dot2c_f32_bf16 v189, v250, v22
    s_waitcnt lgkmcnt(15)
    v_mfma_f32_32x32x16_bf16 v[64:79], v[132:135], a[136:139], v[64:79]
    ds_read_b64_tr_b16 v[156:157], v5 offset:42368
    ds_read_b64_tr_b16 v[158:159], v5 offset:42544
    ds_read_b128 a[152:155], v217
    v_dot2c_f32_bf16 v190, v250, v250
    v_dot2c_f32_bf16 v189, v251, v22
    v_dot2c_f32_bf16 v190, v251, v251
    v_lshl_add_u32 v42, v40, 3, v42
    s_waitcnt lgkmcnt(15)
    v_mfma_f32_32x32x16_bf16 v[80:95], v[136:139], a[136:139], v[80:95]
    ds_read_b64_tr_b16 v[160:161], v61 offset:42240
    ds_read_b64_tr_b16 v[162:163], v61 offset:42416
    ds_read_b128 a[156:159], v218
    v_dot2c_f32_bf16 v191, v252, v22
    v_dot2c_f32_bf16 v219, v252, v252
    v_dot2c_f32_bf16 v191, v253, v22
    s_waitcnt lgkmcnt(15)
    v_mfma_f32_32x32x16_bf16 v[96:111], v[140:143], a[136:139], v[96:111]
    ds_read_b64_tr_b16 v[128:129], v3 offset:45056
    ds_read_b64_tr_b16 v[130:131], v3 offset:45232
    v_dot2c_f32_bf16 v219, v253, v253
    v_dot2c_f32_bf16 v191, v254, v22
    v_dot2c_f32_bf16 v219, v254, v254
    s_mul_i32 s98, s50, 20480
    s_add_u32 s98, s98, s63
    buffer_load_dwordx2 v[200:201], v42, s[12:15], s98 offen offset:0
    s_waitcnt lgkmcnt(14)
    v_mfma_f32_32x32x16_bf16 a[160:175], v[220:223], v[144:147], a[160:175]
    ds_read_b64_tr_b16 v[132:133], v3 offset:45120
    ds_read_b64_tr_b16 v[134:135], v3 offset:45296
    v_dot2c_f32_bf16 v191, v255, v22
    v_dot2c_f32_bf16 v219, v255, v255
    s_waitcnt lgkmcnt(14)
    v_mfma_f32_32x32x16_bf16 v[64:79], v[148:151], a[140:143], v[64:79]
    ds_read_b64_tr_b16 v[136:137], v5 offset:45184
    ds_read_b64_tr_b16 v[138:139], v5 offset:45360
    buffer_load_dwordx2 v[202:203], v42, s[12:15], s98 offen offset:32
    s_waitcnt lgkmcnt(14)
    v_mfma_f32_32x32x16_bf16 v[80:95], v[152:155], a[140:143], v[80:95]
    ds_read_b64_tr_b16 v[140:141], v61 offset:45056
    ds_read_b64_tr_b16 v[142:143], v61 offset:45232
    s_waitcnt lgkmcnt(12)
    v_mfma_f32_32x32x16_bf16 v[96:111], v[156:159], a[140:143], v[96:111]
    ds_read_b64_tr_b16 v[144:145], v3 offset:47872
    ds_read_b64_tr_b16 v[146:147], v3 offset:48048
    buffer_load_dwordx2 v[204:205], v42, s[12:15], s98 offen offset:64
    s_waitcnt lgkmcnt(11)
    v_mfma_f32_32x32x16_bf16 a[160:175], v[220:223], v[160:163], a[160:175]
    ds_read_b64_tr_b16 v[148:149], v3 offset:47936
    ds_read_b64_tr_b16 v[150:151], v3 offset:48112
    s_waitcnt lgkmcnt(10)
    v_mfma_f32_32x32x16_bf16 v[64:79], v[128:131], a[144:147], v[64:79]
    ds_read_b64_tr_b16 v[152:153], v5 offset:48000
    ds_read_b64_tr_b16 v[154:155], v5 offset:48176
    buffer_load_dwordx2 v[206:207], v42, s[12:15], s98 offen offset:96
    s_waitcnt lgkmcnt(10)
    v_mfma_f32_32x32x16_bf16 v[80:95], v[132:135], a[144:147], v[80:95]
    ds_read_b64_tr_b16 v[156:157], v61 offset:47872
    ds_read_b64_tr_b16 v[158:159], v61 offset:48048
    s_waitcnt lgkmcnt(10)
    v_mfma_f32_32x32x16_bf16 v[96:111], v[136:139], a[144:147], v[96:111]
    ds_read_b64_tr_b16 v[160:161], v3 offset:50688
    ds_read_b64_tr_b16 v[162:163], v3 offset:50864
    buffer_load_dwordx2 v[208:209], v42, s[12:15], s98 offen offset:128
    s_waitcnt lgkmcnt(10)
    v_mfma_f32_32x32x16_bf16 a[160:175], v[220:223], v[140:143], a[160:175]
    ds_read_b64_tr_b16 v[128:129], v3 offset:50752
    ds_read_b64_tr_b16 v[130:131], v3 offset:50928
    s_waitcnt lgkmcnt(10)
    v_mfma_f32_32x32x16_bf16 v[64:79], v[144:147], a[148:151], v[64:79]
    ds_read_b64_tr_b16 v[132:133], v5 offset:50816
    ds_read_b64_tr_b16 v[134:135], v5 offset:50992
    v_lshrrev_b32 v172, 4, v21
    s_waitcnt lgkmcnt(10)
    v_mfma_f32_32x32x16_bf16 v[80:95], v[148:151], a[148:151], v[80:95]
    ds_read_b64_tr_b16 v[136:137], v61 offset:50688
    ds_read_b64_tr_b16 v[138:139], v61 offset:50864
    s_waitcnt lgkmcnt(10)
    v_mfma_f32_32x32x16_bf16 v[96:111], v[152:155], a[148:151], v[96:111]
    ds_read_b64_tr_b16 v[140:141], v3 offset:53504
    ds_read_b64_tr_b16 v[142:143], v3 offset:53680
    v_mul_u32_u24 v172, 384, v172
    s_waitcnt lgkmcnt(10)
    v_mfma_f32_32x32x16_bf16 a[160:175], v[220:223], v[156:159], a[160:175]
    ds_read_b64_tr_b16 v[144:145], v3 offset:53568
    ds_read_b64_tr_b16 v[146:147], v3 offset:53744
    s_waitcnt lgkmcnt(10)
    v_mfma_f32_32x32x16_bf16 v[64:79], v[160:163], a[152:155], v[64:79]
    ds_read_b64_tr_b16 v[148:149], v5 offset:53632
    ds_read_b64_tr_b16 v[150:151], v5 offset:53808
    v_and_b32 v173, 15, v21
    s_waitcnt lgkmcnt(10)
    v_mfma_f32_32x32x16_bf16 v[80:95], v[128:131], a[152:155], v[80:95]
    ds_read_b64_tr_b16 v[152:153], v61 offset:53504
    ds_read_b64_tr_b16 v[154:155], v61 offset:53680
    s_waitcnt lgkmcnt(10)
    v_mfma_f32_32x32x16_bf16 v[96:111], v[132:135], a[152:155], v[96:111]
    v_lshl_add_u32 v172, v173, 4, v172
    s_waitcnt lgkmcnt(8)
    v_mfma_f32_32x32x16_bf16 a[160:175], v[220:223], v[136:139], a[160:175]
    s_waitcnt lgkmcnt(6)
    v_mfma_f32_32x32x16_bf16 v[64:79], v[140:143], a[156:159], v[64:79]
    s_lshl_b32 s70, s46, 4
    s_add_u32 s70, s70, s45
    s_lshl_b32 s70, s70, 12
    s_add_u32 s70, s70, 18743296
    s_lshr_b32 s71, s44, 1
    s_mul_i32 s71, s71, 1920
    s_add_u32 s70, s70, s71
    s_and_b32 s71, s44, 1
    s_lshl_b32 s72, s71, 8
    s_add_u32 s70, s70, s72
    s_cmp_eq_u32 s71, 0
    s_cselect_b32 s72, -1, 0x00ff00ff
    s_and_b32 s73, s72, 0xffff
    s_mov_b32 exec_lo, s72
    s_mov_b32 exec_hi, s72
    buffer_store_dwordx4 v[212:215], v172, s[8:11], s70 offen sc1
    s_mov_b32 exec_lo, s73
    s_mov_b32 exec_hi, 0
    buffer_store_dwordx4 v[212:215], v172, s[8:11], s70 offen offset:1536 sc1
    s_mov_b64 exec, -1
    s_waitcnt lgkmcnt(4)
    v_mfma_f32_32x32x16_bf16 v[80:95], v[144:147], a[156:159], v[80:95]
    s_waitcnt lgkmcnt(2)
    v_mfma_f32_32x32x16_bf16 v[96:111], v[148:151], a[156:159], v[96:111]
    s_lshr_b32 s70, s50, 1
    s_mul_i32 s70, s70, 40960
    s_mul_i32 s71, s47, 5120
    s_add_u32 s70, s70, s71
    s_add_u32 s70, s70, 0
    s_add_u32 s71, s70, 4096
    s_lshl_b32 s72, s50, 10
    s_lshl_b32 s73, s47, 7
    s_add_u32 s72, s72, s73
    s_add_u32 s72, s72, 18350080
    buffer_store_dwordx4 v[212:215], v11, s[8:11], s70 offen sc1
    s_waitcnt lgkmcnt(0)
    v_mfma_f32_32x32x16_bf16 a[160:175], v[220:223], v[152:155], a[160:175]
    v_add_f32_dpp v189, v189, v189 quad_perm:[1,0,3,2] row_mask:0xf bank_mask:0xf
    v_add_f32_dpp v190, v190, v190 quad_perm:[1,0,3,2] row_mask:0xf bank_mask:0xf
    v_add_f32_dpp v191, v191, v191 quad_perm:[1,0,3,2] row_mask:0xf bank_mask:0xf
    v_add_f32_dpp v219, v219, v219 quad_perm:[1,0,3,2] row_mask:0xf bank_mask:0xf
    v_add_f32_dpp v189, v189, v189 quad_perm:[2,3,0,1] row_mask:0xf bank_mask:0xf
    v_add_f32_dpp v190, v190, v190 quad_perm:[2,3,0,1] row_mask:0xf bank_mask:0xf
    v_add_f32_dpp v191, v191, v191 quad_perm:[2,3,0,1] row_mask:0xf bank_mask:0xf
    v_add_f32_dpp v219, v219, v219 quad_perm:[2,3,0,1] row_mask:0xf bank_mask:0xf
    v_and_b32 v166, 15, v21
    v_lshlrev_b32 v166, 4, v166
    ds_bpermute_b32 v172, v166, v189
    ds_bpermute_b32 v173, v166, v190
    ds_bpermute_b32 v174, v166, v191
    ds_bpermute_b32 v175, v166, v219
    v_bfe_u32 v164, v21, 2, 1
    v_lshlrev_b32 v164, 8, v164
    v_and_b32 v165, 3, v21
    v_lshl_add_u32 v164, v165, 2, v164
    v_bfe_u32 v165, v21, 3, 2
    v_lshl_add_u32 v164, v165, 4, v164
    v_add_u32 v164, 153600, v164
    s_min_u32 s52, s44, 2
    s_lshl_b32 s52, s52, 6
    v_add_u32 v164, s52, v164
    s_mov_b64 exec, 0xffffffff
    ds_write_b32 v164, a160 offset:0
    s_mov_b64 exec, -1
    v_and_b32 v167, 16, v21
    v_cmp_eq_u32 vcc, 0, v167
    s_waitcnt lgkmcnt(0)
    s_barrier
    v_cndmask_b32 v164, v174, v172, vcc
    v_cndmask_b32 v165, v175, v173, vcc
    ds_read_b128 v[128:131], v19 offset:0
    ds_read_b128 v[132:135], v19 offset:16
    ds_read_b128 v[136:139], v19 offset:32
    ds_read_b128 v[140:143], v19 offset:48
    ds_read_b128 v[144:147], v19 offset:64
    ds_read_b128 v[148:151], v19 offset:80
    ds_read_b128 v[152:155], v19 offset:96
    ds_read_b128 v[156:159], v19 offset:112
    ds_read_b128 v[112:115], v19 offset:128
    ds_read_b128 v[116:119], v19 offset:144
    ds_read_b128 v[120:123], v19 offset:160
    ds_read_b128 v[124:127], v19 offset:176
    s_mov_b32 s56, 0x3acccccd
    v_mul_f32 v210, s56, v164
    v_mul_f32 v0, s56, v165
    v_fma_f32 v0, -v210, v210, v0
    v_max_f32 v0, 0, v0
    v_add_f32 v0, 0x3727c5ac, v0
    v_rsq_f32 v0, v0
    v_sub_f32 v210, 0, v210
    s_waitcnt lgkmcnt(8)
    v_pk_fma_f32 v[64:65], v[128:129], v[210:211], v[64:65] op_sel_hi:[1,0,1]
    v_pk_fma_f32 v[66:67], v[130:131], v[210:211], v[66:67] op_sel_hi:[1,0,1]
    v_pk_fma_f32 v[68:69], v[132:133], v[210:211], v[68:69] op_sel_hi:[1,0,1]
    v_pk_fma_f32 v[70:71], v[134:135], v[210:211], v[70:71] op_sel_hi:[1,0,1]
    v_pk_fma_f32 v[72:73], v[136:137], v[210:211], v[72:73] op_sel_hi:[1,0,1]
    v_pk_fma_f32 v[74:75], v[138:139], v[210:211], v[74:75] op_sel_hi:[1,0,1]
    v_pk_fma_f32 v[76:77], v[140:141], v[210:211], v[76:77] op_sel_hi:[1,0,1]
    v_pk_fma_f32 v[78:79], v[142:143], v[210:211], v[78:79] op_sel_hi:[1,0,1]
    s_waitcnt lgkmcnt(4)
    v_pk_fma_f32 v[80:81], v[144:145], v[210:211], v[80:81] op_sel_hi:[1,0,1]
    v_pk_fma_f32 v[82:83], v[146:147], v[210:211], v[82:83] op_sel_hi:[1,0,1]
    v_pk_fma_f32 v[84:85], v[148:149], v[210:211], v[84:85] op_sel_hi:[1,0,1]
    v_pk_fma_f32 v[86:87], v[150:151], v[210:211], v[86:87] op_sel_hi:[1,0,1]
    v_pk_fma_f32 v[88:89], v[152:153], v[210:211], v[88:89] op_sel_hi:[1,0,1]
    v_pk_fma_f32 v[90:91], v[154:155], v[210:211], v[90:91] op_sel_hi:[1,0,1]
    v_pk_fma_f32 v[92:93], v[156:157], v[210:211], v[92:93] op_sel_hi:[1,0,1]
    v_pk_fma_f32 v[94:95], v[158:159], v[210:211], v[94:95] op_sel_hi:[1,0,1]
    s_waitcnt lgkmcnt(0)
    v_pk_fma_f32 v[96:97], v[112:113], v[210:211], v[96:97] op_sel_hi:[1,0,1]
    v_pk_fma_f32 v[98:99], v[114:115], v[210:211], v[98:99] op_sel_hi:[1,0,1]
    v_pk_fma_f32 v[100:101], v[116:117], v[210:211], v[100:101] op_sel_hi:[1,0,1]
    v_pk_fma_f32 v[102:103], v[118:119], v[210:211], v[102:103] op_sel_hi:[1,0,1]
    v_pk_fma_f32 v[104:105], v[120:121], v[210:211], v[104:105] op_sel_hi:[1,0,1]
    v_pk_fma_f32 v[106:107], v[122:123], v[210:211], v[106:107] op_sel_hi:[1,0,1]
    v_pk_fma_f32 v[108:109], v[124:125], v[210:211], v[108:109] op_sel_hi:[1,0,1]
    v_pk_fma_f32 v[110:111], v[126:127], v[210:211], v[110:111] op_sel_hi:[1,0,1]
    v_pk_mul_f32 v[64:65], v[64:65], v[0:1] op_sel_hi:[1,0]
    v_pk_mul_f32 v[66:67], v[66:67], v[0:1] op_sel_hi:[1,0]
    v_pk_mul_f32 v[68:69], v[68:69], v[0:1] op_sel_hi:[1,0]
    v_pk_mul_f32 v[70:71], v[70:71], v[0:1] op_sel_hi:[1,0]
    v_pk_mul_f32 v[72:73], v[72:73], v[0:1] op_sel_hi:[1,0]
    v_pk_mul_f32 v[74:75], v[74:75], v[0:1] op_sel_hi:[1,0]
    v_pk_mul_f32 v[76:77], v[76:77], v[0:1] op_sel_hi:[1,0]
    v_pk_mul_f32 v[78:79], v[78:79], v[0:1] op_sel_hi:[1,0]
    v_pk_mul_f32 v[100:101], v[100:101], v[0:1] op_sel_hi:[1,0]
    v_pk_mul_f32 v[102:103], v[102:103], v[0:1] op_sel_hi:[1,0]
    v_pk_mul_f32 v[104:105], v[104:105], v[0:1] op_sel_hi:[1,0]
    v_pk_mul_f32 v[106:107], v[106:107], v[0:1] op_sel_hi:[1,0]
    v_pk_mul_f32 v[80:81], v[80:81], v[0:1] op_sel_hi:[1,0]
    v_pk_mul_f32 v[82:83], v[82:83], v[0:1] op_sel_hi:[1,0]
    v_pk_mul_f32 v[84:85], v[84:85], v[0:1] op_sel_hi:[1,0]
    v_pk_mul_f32 v[86:87], v[86:87], v[0:1] op_sel_hi:[1,0]
    v_pk_mul_f32 v[88:89], v[88:89], v[0:1] op_sel_hi:[1,0]
    v_pk_mul_f32 v[90:91], v[90:91], v[0:1] op_sel_hi:[1,0]
    v_pk_mul_f32 v[92:93], v[92:93], v[0:1] op_sel_hi:[1,0]
    v_pk_mul_f32 v[94:95], v[94:95], v[0:1] op_sel_hi:[1,0]
    v_cvt_pk_bf16_f32 v64, v64, v65
    v_cvt_pk_bf16_f32 v65, v66, v67
    v_cvt_pk_bf16_f32 v66, v68, v69
    v_cvt_pk_bf16_f32 v67, v70, v71
    v_cvt_pk_bf16_f32 v68, v72, v73
    v_cvt_pk_bf16_f32 v69, v74, v75
    v_cvt_pk_bf16_f32 v70, v76, v77
    v_cvt_pk_bf16_f32 v71, v78, v79
    v_cvt_pk_bf16_f32 v72, v100, v101
    v_cvt_pk_bf16_f32 v73, v102, v103
    v_lshrrev_b32 v164, 5, v21
    v_lshlrev_b32 v165, 1, v12
    v_lshl_add_u32 v164, v164, 8, v165
    s_lshl_b32 s52, s45, 4
    s_add_u32 s52, s52, s46
    s_lshl_b32 s52, s52, 12
    s_add_u32 s52, s52, 27918336
    s_cmp_eq_u32 s44, 3
    s_cselect_b32 s54, 0xffff0000, 0
    s_mov_b32 exec_lo, s54
    s_mov_b32 exec_hi, s54
    s_cbranch_scc0 L_hs_2
    buffer_store_dwordx4 v[64:67], v164, s[8:11], s52 offen offset:0 sc1
    buffer_store_dwordx4 v[68:71], v164, s[8:11], s52 offen offset:512 sc1
    buffer_store_dwordx4 v[72:75], v164, s[8:11], s52 offen offset:1024 sc1
    buffer_store_dwordx4 v[80:83], v164, s[8:11], s52 offen offset:1536 sc1
    buffer_store_dwordx4 v[84:87], v164, s[8:11], s52 offen offset:2048 sc1
    buffer_store_dwordx4 v[88:91], v164, s[8:11], s52 offen offset:2560 sc1
    buffer_store_dwordx4 v[92:95], v164, s[8:11], s52 offen offset:3072 sc1
    buffer_store_dwordx4 v[104:107], v164, s[8:11], s52 offen offset:3584 sc1
L_hs_2:
    s_mov_b64 exec, -1
    s_waitcnt vmcnt(13)
    s_barrier
    s_mul_i32 s52, s44, 10240
    v_add_u32 v41, s52, v6
    ds_read_b64_tr_b16 v[128:129], v6 offset:0
    ds_read_b64_tr_b16 v[130:131], v6 offset:256
    ds_read_b64_tr_b16 v[132:133], v6 offset:1024
    ds_read_b64_tr_b16 v[134:135], v6 offset:1280
    ds_read_b64_tr_b16 v[136:137], v6 offset:2048
    ds_read_b64_tr_b16 v[138:139], v6 offset:2304
    ds_read_b64_tr_b16 v[140:141], v6 offset:3072
    ds_read_b64_tr_b16 v[142:143], v6 offset:3328
    ds_read_b64_tr_b16 v[144:145], v41 offset:0
    ds_read_b64_tr_b16 v[146:147], v41 offset:256
    ds_read_b64_tr_b16 v[148:149], v6 offset:4096
    ds_read_b64_tr_b16 v[150:151], v6 offset:4352
    s_waitcnt lgkmcnt(10)
    v_mfma_f32_32x32x16_bf16 v[112:127], v[128:131], a[0:3], 0
    ds_read_b64_tr_b16 v[152:153], v6 offset:5120
    ds_read_b64_tr_b16 v[154:155], v6 offset:5376
    buffer_store_dwordx4 v[212:215], v11, s[8:11], s70 offen offset:2048 sc1
    s_waitcnt lgkmcnt(10)
    v_mfma_f32_32x32x16_bf16 v[112:127], v[132:135], a[4:7], v[112:127]
    ds_read_b64_tr_b16 v[156:157], v6 offset:6144
    ds_read_b64_tr_b16 v[158:159], v6 offset:6400
    ds_write_b128 v17, v[64:67] offset:672
    s_waitcnt lgkmcnt(11)
    v_mfma_f32_32x32x16_bf16 v[112:127], v[136:139], a[8:11], v[112:127]
    ds_read_b64_tr_b16 v[160:161], v6 offset:7168
    ds_read_b64_tr_b16 v[162:163], v6 offset:7424
    s_mov_b32 exec_lo, 0xffff
    s_mov_b32 exec_hi, 0xffff
    buffer_store_dwordx4 v[212:215], v11, s[8:11], s71 offen sc1
    s_mov_b64 exec, 0xffff
    buffer_store_dwordx2 v[212:213], v12, s[8:11], s72 offen sc1
    s_mov_b64 exec, -1
    s_waitcnt vmcnt(11)
    s_mov_b32 exec_hi, -1
    ds_write_b128 v216, v[192:195]
    ds_read_b64_tr_b16 v[192:193], v58 offset:0
    ds_read_b64_tr_b16 v[194:195], v58 offset:256
    ds_write_b128 v216, v[196:199]
    ds_read_b64_tr_b16 v[196:197], v58 offset:0
    ds_read_b64_tr_b16 v[198:199], v58 offset:256
    ds_write_b128 v216, v[44:47]
    ds_read_b64_tr_b16 v[44:45], v58 offset:0
    ds_read_b64_tr_b16 v[46:47], v58 offset:256
    s_mov_b64 exec, -1
    v_sub_u32 v43, v216, v1
    v_lshl_add_u32 v43, v21, 3, v43
    s_mov_b32 exec_hi, -1
    ds_write_b128 v216, v[52:55]
    ds_read_b64_tr_b16 v[52:53], v43 offset:0
    ds_read_b64_tr_b16 v[54:55], v43 offset:512
    s_mov_b64 exec, -1
    s_waitcnt lgkmcnt(15)
    v_mfma_f32_32x32x16_bf16 v[112:127], v[140:143], a[12:15], v[112:127]
    ds_read_b64_tr_b16 v[128:129], v41 offset:1024
    ds_read_b64_tr_b16 v[130:131], v41 offset:1280
    ds_write_b128 v17, v[68:71] offset:688
    v_mfma_f32_32x32x16_bf16 a[160:175], v[220:223], v[144:147], 0
    ds_read_b64_tr_b16 v[132:133], v6 offset:8192
    ds_read_b64_tr_b16 v[134:135], v6 offset:8448
    s_waitcnt lgkmcnt(5)
    s_add_u32 s95, s45, 0
    s_cmp_eq_u32 s44, 3
    s_movk_i32 s94, 2816
    s_cselect_b32 s94, 1024, s94
    s_mul_i32 s95, s95, s94
    s_cselect_b32 s94, 112640, s97
    s_add_u32 s95, s95, s94
    s_mul_i32 s94, s46, 153600
    s_add_u32 s94, s94, s95
    s_add_u32 s94, s94, 20971520
    buffer_store_dwordx4 v[192:195], v57, s[8:11], s94 offen sc1
    v_mfma_f32_32x32x16_bf16 v[112:127], v[148:151], a[16:19], v[112:127]
    ds_read_b64_tr_b16 v[136:137], v6 offset:9216
    ds_read_b64_tr_b16 v[138:139], v6 offset:9472
    ds_write_b64 v17, v[72:73] offset:704
    v_mfma_f32_32x32x16_bf16 v[112:127], v[152:155], a[20:23], v[112:127]
    ds_read_b64_tr_b16 v[140:141], v6 offset:10240
    ds_read_b64_tr_b16 v[142:143], v6 offset:10496
    s_add_u32 s95, s45, 16
    s_cmp_eq_u32 s44, 3
    s_movk_i32 s94, 2816
    s_cselect_b32 s94, 1024, s94
    s_mul_i32 s95, s95, s94
    s_cselect_b32 s94, 112640, s97
    s_add_u32 s95, s95, s94
    s_mul_i32 s94, s46, 153600
    s_add_u32 s94, s94, s95
    s_add_u32 s94, s94, 20971520
    buffer_store_dwordx4 v[196:199], v57, s[8:11], s94 offen sc1
    v_mfma_f32_32x32x16_bf16 v[112:127], v[156:159], a[24:27], v[112:127]
    ds_read_b64_tr_b16 v[144:145], v6 offset:11264
    ds_read_b64_tr_b16 v[146:147], v6 offset:11520
    ds_write_b128 v18, v[80:83] offset:1120
    v_mfma_f32_32x32x16_bf16 v[112:127], v[160:163], a[28:31], v[112:127]
    ds_read_b64_tr_b16 v[148:149], v41 offset:2048
    ds_read_b64_tr_b16 v[150:151], v41 offset:2304
    s_cmp_lt_u32 s45, 8
    s_cselect_b32 s95, 32, 0
    s_add_u32 s95, s95, s45
    s_cmp_eq_u32 s44, 3
    s_movk_i32 s94, 2816
    s_cselect_b32 s94, 1024, s94
    s_mul_i32 s95, s95, s94
    s_cselect_b32 s94, 112640, s97
    s_add_u32 s95, s95, s94
    s_mul_i32 s94, s46, 153600
    s_add_u32 s94, s94, s95
    s_add_u32 s94, s94, 20971520
    buffer_store_dwordx4 v[44:47], v57, s[8:11], s94 offen sc1
    s_waitcnt lgkmcnt(13)
    v_mfma_f32_32x32x16_bf16 a[160:175], v[220:223], v[128:131], a[160:175]
    ds_read_b64_tr_b16 v[152:153], v6 offset:12288
    ds_read_b64_tr_b16 v[154:155], v6 offset:12544
    ds_write_b128 v18, v[84:87] offset:1136
    s_waitcnt lgkmcnt(13)
    v_mfma_f32_32x32x16_bf16 v[112:127], v[132:135], a[32:35], v[112:127]
    ds_read_b64_tr_b16 v[156:157], v6 offset:13312
    ds_read_b64_tr_b16 v[158:159], v6 offset:13568
    s_mul_i32 s94, s47, 102400
    s_add_u32 s94, s94, 27066368
    buffer_store_dwordx4 v[52:55], v63, s[8:11], s94 offen sc1
    s_waitcnt lgkmcnt(13)
    v_mfma_f32_32x32x16_bf16 v[112:127], v[136:139], a[36:39], v[112:127]
    ds_read_b64_tr_b16 v[160:161], v6 offset:14336
    ds_read_b64_tr_b16 v[162:163], v6 offset:14592
    ds_write_b128 v18, v[88:91] offset:1152
    s_waitcnt lgkmcnt(13)
    v_mfma_f32_32x32x16_bf16 v[112:127], v[140:143], a[40:43], v[112:127]
    ds_read_b64_tr_b16 v[128:129], v6 offset:15360
    ds_read_b64_tr_b16 v[130:131], v6 offset:15616
    s_mul_i32 s70, s49, 40960
    s_lshl_b32 s71, s46, 10
    s_add_u32 s70, s70, 10485760
    s_add_u32 s71, s71, s70
    s_lshl_b32 s72, s46, 8
    s_add_u32 s72, s72, s70
    s_add_u32 s72, s72, 16384
    buffer_store_dwordx4 v[212:215], v14, s[8:11], s71 offen sc1
    s_waitcnt lgkmcnt(13)
    v_mfma_f32_32x32x16_bf16 v[112:127], v[144:147], a[44:47], v[112:127]
    ds_read_b64_tr_b16 v[132:133], v41 offset:3072
    ds_read_b64_tr_b16 v[134:135], v41 offset:3328
    ds_write_b128 v18, v[92:95] offset:1168
    s_waitcnt lgkmcnt(13)
    v_mfma_f32_32x32x16_bf16 a[160:175], v[220:223], v[148:151], a[160:175]
    ds_read_b64_tr_b16 v[136:137], v6 offset:16384
    ds_read_b64_tr_b16 v[138:139], v6 offset:16640
    buffer_store_dwordx4 v[212:215], v14, s[8:11], s71 offen offset:256 sc1
    s_waitcnt lgkmcnt(13)
    v_mfma_f32_32x32x16_bf16 v[112:127], v[152:155], a[48:51], v[112:127]
    ds_read_b64_tr_b16 v[140:141], v6 offset:17408
    ds_read_b64_tr_b16 v[142:143], v6 offset:17664
    ds_write_b128 v18, v[104:107] offset:1184
    s_waitcnt lgkmcnt(13)
    v_mfma_f32_32x32x16_bf16 v[112:127], v[156:159], a[52:55], v[112:127]
    ds_read_b64_tr_b16 v[144:145], v6 offset:18432
    ds_read_b64_tr_b16 v[146:147], v6 offset:18688
    s_mov_b64 exec, 0xffffffff
    buffer_store_dwordx4 v[212:215], v14, s[8:11], s72 offen sc1
    s_mov_b64 exec, -1
    s_waitcnt lgkmcnt(13)
    v_mfma_f32_32x32x16_bf16 v[112:127], v[160:163], a[56:59], v[112:127]
    ds_read_b64_tr_b16 v[148:149], v6 offset:19456
    ds_read_b64_tr_b16 v[150:151], v6 offset:19712
    s_waitcnt lgkmcnt(12)
    v_mfma_f32_32x32x16_bf16 v[112:127], v[128:131], a[60:63], v[112:127]
    ds_read_b64_tr_b16 v[152:153], v41 offset:4096
    ds_read_b64_tr_b16 v[154:155], v41 offset:4352
    s_waitcnt lgkmcnt(12)
    v_mfma_f32_32x32x16_bf16 a[160:175], v[220:223], v[132:135], a[160:175]
    ds_read_b64_tr_b16 v[156:157], v6 offset:20480
    ds_read_b64_tr_b16 v[158:159], v6 offset:20736
    s_waitcnt lgkmcnt(11)
    v_mfma_f32_32x32x16_bf16 v[112:127], v[136:139], a[64:67], v[112:127]
    ds_read_b64_tr_b16 v[160:161], v6 offset:21504
    ds_read_b64_tr_b16 v[162:163], v6 offset:21760
    s_waitcnt lgkmcnt(11)
    v_mfma_f32_32x32x16_bf16 v[112:127], v[140:143], a[68:71], v[112:127]
    ds_read_b64_tr_b16 v[128:129], v6 offset:22528
    ds_read_b64_tr_b16 v[130:131], v6 offset:22784
    s_waitcnt lgkmcnt(10)
    v_mfma_f32_32x32x16_bf16 v[112:127], v[144:147], a[72:75], v[112:127]
    ds_read_b64_tr_b16 v[132:133], v6 offset:23552
    ds_read_b64_tr_b16 v[134:135], v6 offset:23808
    s_waitcnt lgkmcnt(10)
    v_mfma_f32_32x32x16_bf16 v[112:127], v[148:151], a[76:79], v[112:127]
    ds_read_b64_tr_b16 v[136:137], v41 offset:5120
    ds_read_b64_tr_b16 v[138:139], v41 offset:5376
    s_waitcnt lgkmcnt(10)
    v_mfma_f32_32x32x16_bf16 a[160:175], v[220:223], v[152:155], a[160:175]
    ds_read_b64_tr_b16 v[140:141], v6 offset:24576
    ds_read_b64_tr_b16 v[142:143], v6 offset:24832
    v_lshlrev_b32 v171, 5, v21
    s_lshl_b32 s94, s44, 12
    v_add_u32 v171, s94, v171
    s_mov_b64 exec, 15
    buffer_load_dword v236, v171, s[40:43], 0 offen offset:0
    s_mov_b64 exec, -1
    s_waitcnt lgkmcnt(10)
    v_mfma_f32_32x32x16_bf16 v[112:127], v[156:159], a[80:83], v[112:127]
    ds_read_b64_tr_b16 v[144:145], v6 offset:25600
    ds_read_b64_tr_b16 v[146:147], v6 offset:25856
    s_waitcnt lgkmcnt(10)
    v_mfma_f32_32x32x16_bf16 v[112:127], v[160:163], a[84:87], v[112:127]
    ds_read_b64_tr_b16 v[148:149], v6 offset:26624
    ds_read_b64_tr_b16 v[150:151], v6 offset:26880
    s_waitcnt lgkmcnt(10)
    v_mfma_f32_32x32x16_bf16 v[112:127], v[128:131], a[88:91], v[112:127]
    ds_read_b64_tr_b16 v[152:153], v6 offset:27648
    ds_read_b64_tr_b16 v[154:155], v6 offset:27904
    s_waitcnt lgkmcnt(10)
    v_mfma_f32_32x32x16_bf16 v[112:127], v[132:135], a[92:95], v[112:127]
    ds_read_b64_tr_b16 v[156:157], v41 offset:6144
    ds_read_b64_tr_b16 v[158:159], v41 offset:6400
    s_waitcnt lgkmcnt(10)
    v_mfma_f32_32x32x16_bf16 a[160:175], v[220:223], v[136:139], a[160:175]
    ds_read_b64_tr_b16 v[160:161], v6 offset:28672
    ds_read_b64_tr_b16 v[162:163], v6 offset:28928
    s_waitcnt lgkmcnt(10)
    v_mfma_f32_32x32x16_bf16 v[112:127], v[140:143], a[96:99], v[112:127]
    ds_read_b64_tr_b16 v[128:129], v6 offset:29696
    ds_read_b64_tr_b16 v[130:131], v6 offset:29952
    s_waitcnt lgkmcnt(10)
    v_mfma_f32_32x32x16_bf16 v[112:127], v[144:147], a[100:103], v[112:127]
    ds_read_b64_tr_b16 v[132:133], v6 offset:30720
    ds_read_b64_tr_b16 v[134:135], v6 offset:30976
    s_waitcnt lgkmcnt(10)
    v_mfma_f32_32x32x16_bf16 v[112:127], v[148:151], a[104:107], v[112:127]
    ds_read_b64_tr_b16 v[136:137], v6 offset:31744
    ds_read_b64_tr_b16 v[138:139], v6 offset:32000
    s_waitcnt lgkmcnt(10)
    v_mfma_f32_32x32x16_bf16 v[112:127], v[152:155], a[108:111], v[112:127]
    ds_read_b64_tr_b16 v[140:141], v41 offset:7168
    ds_read_b64_tr_b16 v[142:143], v41 offset:7424
    s_waitcnt lgkmcnt(10)
    v_mfma_f32_32x32x16_bf16 a[160:175], v[220:223], v[156:159], a[160:175]
    ds_read_b64_tr_b16 v[144:145], v6 offset:32768
    ds_read_b64_tr_b16 v[146:147], v6 offset:33024
    s_waitcnt lgkmcnt(10)
    v_mfma_f32_32x32x16_bf16 v[112:127], v[160:163], a[112:115], v[112:127]
    ds_read_b64_tr_b16 v[148:149], v6 offset:33792
    ds_read_b64_tr_b16 v[150:151], v6 offset:34048
    s_waitcnt lgkmcnt(10)
    v_mfma_f32_32x32x16_bf16 v[112:127], v[128:131], a[116:119], v[112:127]
    ds_read_b64_tr_b16 v[152:153], v6 offset:34816
    ds_read_b64_tr_b16 v[154:155], v6 offset:35072
    s_waitcnt lgkmcnt(10)
    v_mfma_f32_32x32x16_bf16 v[112:127], v[132:135], a[120:123], v[112:127]
    ds_read_b64_tr_b16 v[156:157], v6 offset:35840
    ds_read_b64_tr_b16 v[158:159], v6 offset:36096
    s_waitcnt lgkmcnt(10)
    v_mfma_f32_32x32x16_bf16 v[112:127], v[136:139], a[124:127], v[112:127]
    ds_read_b64_tr_b16 v[160:161], v41 offset:8192
    ds_read_b64_tr_b16 v[162:163], v41 offset:8448
    s_waitcnt lgkmcnt(10)
    v_mfma_f32_32x32x16_bf16 a[160:175], v[220:223], v[140:143], a[160:175]
    ds_read_b64_tr_b16 v[128:129], v6 offset:36864
    ds_read_b64_tr_b16 v[130:131], v6 offset:37120
    s_waitcnt lgkmcnt(10)
    v_mfma_f32_32x32x16_bf16 v[112:127], v[144:147], a[128:131], v[112:127]
    ds_read_b64_tr_b16 v[132:133], v6 offset:37888
    ds_read_b64_tr_b16 v[134:135], v6 offset:38144
    s_waitcnt lgkmcnt(10)
    v_mfma_f32_32x32x16_bf16 v[112:127], v[148:151], a[132:135], v[112:127]
    ds_read_b64_tr_b16 v[136:137], v6 offset:38912
    ds_read_b64_tr_b16 v[138:139], v6 offset:39168
    s_waitcnt lgkmcnt(10)
    v_mfma_f32_32x32x16_bf16 v[112:127], v[152:155], a[136:139], v[112:127]
    ds_read_b64_tr_b16 v[140:141], v6 offset:39936
    ds_read_b64_tr_b16 v[142:143], v6 offset:40192
    s_waitcnt lgkmcnt(10)
    v_mfma_f32_32x32x16_bf16 v[112:127], v[156:159], a[140:143], v[112:127]
    ds_read_b64_tr_b16 v[144:145], v41 offset:9216
    ds_read_b64_tr_b16 v[146:147], v41 offset:9472
    s_waitcnt lgkmcnt(10)
    v_mfma_f32_32x32x16_bf16 a[160:175], v[220:223], v[160:163], a[160:175]
    s_cmp_lg_u32 s44, 0
    s_cbranch_scc1 L_iok_3
    s_waitcnt vmcnt(0)
    s_mov_b64 exec, 15
    v_cmp_gt_u32 vcc, 64, v236
    s_cbranch_vccz L_iok_3
    v_lshlrev_b32 v170, 5, v21
L_iwp_4:
    buffer_load_dword v236, v170, s[40:43], 0 offen offset:0 sc1
    s_waitcnt vmcnt(0)
    v_cmp_gt_u32 vcc, 64, v236
    s_cbranch_vccz L_ok_5
    s_add_u32 s51, s51, 1
    s_cmp_gt_u32 s51, 200000
    s_cbranch_scc1 L_ok_5
    s_waitcnt vmcnt(0) lgkmcnt(0)
    s_sleep 4
    s_branch L_iwp_4
L_ok_5:
L_iok_3:
    s_mov_b64 exec, -1
    s_lshl_b32 s94, s45, 4
    s_add_u32 s94, s94, s46
    s_lshl_b32 s94, s94, 12
    s_add_u32 s94, s94, 27852800
    buffer_load_dwordx4 v[24:27], v15, s[8:11], s94 offen offset:0 sc1
    buffer_load_dwordx4 v[28:31], v15, s[8:11], s94 offen offset:1024 sc1
    buffer_load_dwordx4 v[32:35], v15, s[8:11], s94 offen offset:2048 sc1
    buffer_load_dwordx4 v[36:39], v15, s[8:11], s94 offen offset:3072 sc1
    s_waitcnt lgkmcnt(8)
    v_mfma_f32_32x32x16_bf16 v[112:127], v[128:131], a[144:147], v[112:127]
    s_waitcnt lgkmcnt(6)
    v_mfma_f32_32x32x16_bf16 v[112:127], v[132:135], a[148:151], v[112:127]
    s_waitcnt lgkmcnt(4)
    v_mfma_f32_32x32x16_bf16 v[112:127], v[136:139], a[152:155], v[112:127]
    s_waitcnt lgkmcnt(2)
    v_mfma_f32_32x32x16_bf16 v[112:127], v[140:143], a[156:159], v[112:127]
    s_waitcnt lgkmcnt(0)
    v_mfma_f32_32x32x16_bf16 a[160:175], v[220:223], v[144:147], a[160:175]
    v_bfe_u32 v164, v21, 2, 1
    v_lshlrev_b32 v164, 8, v164
    v_and_b32 v165, 3, v21
    v_lshl_add_u32 v164, v165, 2, v164
    v_bfe_u32 v165, v21, 3, 2
    v_lshl_add_u32 v164, v165, 4, v164
    v_add_u32 v164, 153600, v164
    s_mov_b64 exec, 0xffffffff
    s_nop 3
    ds_add_f32 v164, a160 offset:192
    s_mov_b64 exec, -1
    v_mov_b32 v2, v1
    v_add_u32 v3, 56320, v1
    v_add_u32 v6, 112640, v1
    v_and_b32 v164, 31, v21
    v_min_u32 v164, 23, v164
    v_lshrrev_b32 v165, 5, v21
    v_mul_u32_u24 v165, 384, v165
    v_lshl_add_u32 v4, v164, 4, v165
    v_add_u32 v5, 56320, v4
    s_waitcnt vmcnt(8)
    s_waitcnt lgkmcnt(0)
    s_barrier
    s_mul_i32 s96, s47, 102400
    s_lshl_b32 s97, s44, 10
    s_add_u32 s96, s96, s97
    s_add_u32 s96, s96, 26214400
    s_and_b32 s56, s2, 3
    s_lshl_b32 s56, s56, 5
    s_add_u32 s56, s56, 128
    s_cmp_eq_u32 s44, 0
    s_cselect_b32 s57, 0, 0x80000000
    s_or_b32 s56, s56, s57
    v_mov_b32 v174, s56
    v_mov_b32 v175, 1
    s_mov_b64 exec, 1
    buffer_atomic_add v175, v174, s[40:43], 0 offen sc1
    s_mov_b64 exec, -1
    s_lshl_b32 s94, s44, 10
    s_mul_i32 s95, s46, 1600
    s_add_u32 s95, s95, s94
    s_add_u32 s94, s94, 161792
    s_mov_b32 m0, s94
    s_nop 0
    buffer_load_dwordx4 v1, s[28:31], s95 offen lds
    v_mov_b32 v164, 0
    v_mov_b32 v165, 0
    v_mov_b32 v166, 0
    v_mov_b32 v167, 0
    v_add_u32 v168, 154624, v1
    ds_write_b128 v168, v[164:167]
    ds_read_b128 v[44:47], v19 offset:192
    ds_read_b128 v[48:51], v19 offset:208
    ds_read_b128 v[52:55], v19 offset:224
    ds_read_b128 v[56:59], v19 offset:240
    s_waitcnt lgkmcnt(0)
    v_pk_fma_f32 v[112:113], v[44:45], v[210:211], v[112:113] op_sel_hi:[1,0,1]
    v_pk_fma_f32 v[114:115], v[46:47], v[210:211], v[114:115] op_sel_hi:[1,0,1]
    v_pk_fma_f32 v[116:117], v[48:49], v[210:211], v[116:117] op_sel_hi:[1,0,1]
    v_pk_fma_f32 v[118:119], v[50:51], v[210:211], v[118:119] op_sel_hi:[1,0,1]
    v_pk_fma_f32 v[120:121], v[52:53], v[210:211], v[120:121] op_sel_hi:[1,0,1]
    v_pk_fma_f32 v[122:123], v[54:55], v[210:211], v[122:123] op_sel_hi:[1,0,1]
    v_pk_fma_f32 v[124:125], v[56:57], v[210:211], v[124:125] op_sel_hi:[1,0,1]
    v_pk_fma_f32 v[126:127], v[58:59], v[210:211], v[126:127] op_sel_hi:[1,0,1]
    ds_read_b128 v[140:143], v17 offset:576
    ds_read_b128 v[144:147], v17 offset:592
    ds_read_b64 v[148:149], v17 offset:608
    ds_read_b128 v[152:155], v17 offset:480
    ds_read_b128 v[156:159], v17 offset:496
    ds_read_b64 v[160:161], v17 offset:512
    ds_read_b128 v[128:131], v17 offset:384
    ds_read_b128 v[132:135], v17 offset:400
    s_add_u32 s94, s97, 51200
    s_mov_b32 m0, s94
    s_add_u32 s95, s96, 0
    buffer_load_dwordx4 v1, s[8:11], s95 offen lds
    ds_read_b64 v[136:137], v17 offset:416
    v_pk_mul_f32 v[112:113], v[112:113], v[0:1] op_sel_hi:[1,0]
    v_pk_mul_f32 v[114:115], v[114:115], v[0:1] op_sel_hi:[1,0]
    v_pk_mul_f32 v[116:117], v[116:117], v[0:1] op_sel_hi:[1,0]
    v_pk_mul_f32 v[118:119], v[118:119], v[0:1] op_sel_hi:[1,0]
    v_pk_mul_f32 v[120:121], v[120:121], v[0:1] op_sel_hi:[1,0]
    v_pk_mul_f32 v[122:123], v[122:123], v[0:1] op_sel_hi:[1,0]
    v_pk_mul_f32 v[124:125], v[124:125], v[0:1] op_sel_hi:[1,0]
    s_add_u32 s94, s97, 55296
    s_mov_b32 m0, s94
    s_add_u32 s95, s96, 4096
    buffer_load_dwordx4 v1, s[8:11], s95 offen lds
    v_pk_mul_f32 v[126:127], v[126:127], v[0:1] op_sel_hi:[1,0]
    v_pk_mul_f32 v[96:97], v[96:97], v[0:1] op_sel_hi:[1,0]
    v_pk_mul_f32 v[98:99], v[98:99], v[0:1] op_sel_hi:[1,0]
    v_cvt_pk_bf16_f32 v112, v112, v113
    v_cvt_pk_bf16_f32 v113, v114, v115
    v_cvt_pk_bf16_f32 v114, v116, v117
    v_cvt_pk_bf16_f32 v115, v118, v119
    v_cvt_pk_bf16_f32 v116, v120, v121
    s_add_u32 s94, s97, 59392
    s_mov_b32 m0, s94
    s_add_u32 s95, s96, 8192
    buffer_load_dwordx4 v1, s[8:11], s95 offen lds
    v_cvt_pk_bf16_f32 v117, v122, v123
    v_cvt_pk_bf16_f32 v118, v124, v125
    v_cvt_pk_bf16_f32 v119, v126, v127
    v_cvt_pk_bf16_f32 v120, v96, v97
    v_cvt_pk_bf16_f32 v121, v98, v99
    v_mov_b32 v164, 0
    v_mov_b32 v165, 0
    v_mov_b32 v166, 0
    s_add_u32 s94, s97, 63488
    s_mov_b32 m0, s94
    s_add_u32 s95, s96, 12288
    buffer_load_dwordx4 v1, s[8:11], s95 offen lds
    v_mov_b32 v167, 0
    v_mov_b32 v168, 0
    v_mov_b32 v169, 0
    v_mov_b32 v170, 0
    v_mov_b32 v171, 0
    v_dot2c_f32_bf16 v164, v112, v64
    v_dot2c_f32_bf16 v164, v113, v65
    v_dot2c_f32_bf16 v164, v114, v66
    s_add_u32 s94, s97, 67584
    s_mov_b32 m0, s94
    s_add_u32 s95, s96, 16384
    buffer_load_dwordx4 v1, s[8:11], s95 offen lds
    v_dot2c_f32_bf16 v164, v115, v67
    v_dot2c_f32_bf16 v164, v116, v68
    v_dot2c_f32_bf16 v164, v117, v69
    v_dot2c_f32_bf16 v164, v118, v70
    v_dot2c_f32_bf16 v164, v119, v71
    v_dot2c_f32_bf16 v164, v120, v72
    v_dot2c_f32_bf16 v164, v121, v73
    s_cmp_lg_u32 s44, 0
    s_cbranch_scc1 L_hk_6
    s_waitcnt vmcnt(7)
    s_branch L_hc_7
L_hl_8:
    s_lshl_b32 s94, s45, 4
    s_add_u32 s94, s94, s46
    s_lshl_b32 s94, s94, 12
    s_add_u32 s94, s94, 27852800
    buffer_load_dwordx4 v[24:27], v15, s[8:11], s94 offen offset:0 sc1
    buffer_load_dwordx4 v[28:31], v15, s[8:11], s94 offen offset:1024 sc1
    buffer_load_dwordx4 v[32:35], v15, s[8:11], s94 offen offset:2048 sc1
    buffer_load_dwordx4 v[36:39], v15, s[8:11], s94 offen offset:3072 sc1
    s_waitcnt vmcnt(0)
L_hc_7:
    v_max3_u32 v40, v24, v25, v26
    v_max3_u32 v40, v40, v27, v28
    v_max3_u32 v40, v40, v29, v30
    v_max3_u32 v40, v40, v31, v32
    v_max3_u32 v40, v40, v33, v34
    v_max3_u32 v40, v40, v35, v36
    v_max3_u32 v40, v40, v37, v38
    v_max_u32 v40, v40, v39
    v_cmp_eq_u32 vcc, -1, v40
    s_cbranch_vccz L_ok_9
    s_add_u32 s51, s51, 1
    s_cmp_gt_u32 s51, 200000
    s_cbranch_scc1 L_ok_9
    s_waitcnt vmcnt(0) lgkmcnt(0)
    s_sleep 1
    s_branch L_hl_8
L_ok_9:
    ds_write_b128 v7, v[24:27]
    ds_write_b128 v8, v[28:31]
    ds_write_b128 v16, v[32:35]
    ds_write_b128 v20, v[36:39]
    s_waitcnt lgkmcnt(0)
    ds_read_b128 v[140:143], v17 offset:576
    ds_read_b128 v[144:147], v17 offset:592
    ds_read_b64 v[148:149], v17 offset:608
    ds_read_b128 v[152:155], v17 offset:480
    ds_read_b128 v[156:159], v17 offset:496
    ds_read_b64 v[160:161], v17 offset:512
    ds_read_b128 v[128:131], v17 offset:384
    ds_read_b128 v[132:135], v17 offset:400
    ds_read_b64 v[136:137], v17 offset:416
    s_waitcnt lgkmcnt(0)
L_hk_6:
    s_waitcnt lgkmcnt(6)
    v_dot2c_f32_bf16 v165, v112, v140
    s_add_u32 s94, s97, 71680
    s_mov_b32 m0, s94
    s_add_u32 s95, s96, 20480
    buffer_load_dwordx4 v1, s[8:11], s95 offen lds
    v_dot2c_f32_bf16 v165, v113, v141
    v_dot2c_f32_bf16 v165, v114, v142
    v_dot2c_f32_bf16 v165, v115, v143
    v_dot2c_f32_bf16 v165, v116, v144
    v_dot2c_f32_bf16 v165, v117, v145
    v_dot2c_f32_bf16 v165, v118, v146
    v_dot2c_f32_bf16 v165, v119, v147
    v_dot2c_f32_bf16 v165, v120, v148
    s_add_u32 s94, s97, 75776
    s_mov_b32 m0, s94
    s_add_u32 s95, s96, 24576
    buffer_load_dwordx4 v1, s[8:11], s95 offen lds
    v_dot2c_f32_bf16 v165, v121, v149
    ds_read_b128 v[140:143], v17 offset:288
    ds_read_b128 v[144:147], v17 offset:304
    ds_read_b64 v[148:149], v17 offset:320
    s_waitcnt lgkmcnt(6)
    v_dot2c_f32_bf16 v166, v112, v152
    v_dot2c_f32_bf16 v166, v113, v153
    v_dot2c_f32_bf16 v166, v114, v154
    v_dot2c_f32_bf16 v166, v115, v155
    s_add_u32 s94, s97, 79872
    s_mov_b32 m0, s94
    s_add_u32 s95, s96, 28672
    buffer_load_dwordx4 v1, s[8:11], s95 offen lds
    v_dot2c_f32_bf16 v166, v116, v156
    v_dot2c_f32_bf16 v166, v117, v157
    v_dot2c_f32_bf16 v166, v118, v158
    v_dot2c_f32_bf16 v166, v119, v159
    v_dot2c_f32_bf16 v166, v120, v160
    v_dot2c_f32_bf16 v166, v121, v161
    ds_read_b128 v[152:155], v17 offset:192
    ds_read_b128 v[156:159], v17 offset:208
    s_add_u32 s94, s97, 83968
    s_mov_b32 m0, s94
    s_add_u32 s95, s96, 32768
    buffer_load_dwordx4 v1, s[8:11], s95 offen lds
    ds_read_b64 v[160:161], v17 offset:224
    s_waitcnt lgkmcnt(6)
    v_dot2c_f32_bf16 v167, v112, v128
    v_dot2c_f32_bf16 v167, v113, v129
    v_dot2c_f32_bf16 v167, v114, v130
    v_dot2c_f32_bf16 v167, v115, v131
    v_dot2c_f32_bf16 v167, v116, v132
    v_dot2c_f32_bf16 v167, v117, v133
    v_dot2c_f32_bf16 v167, v118, v134
    s_add_u32 s94, s97, 88064
    s_mov_b32 m0, s94
    s_add_u32 s95, s96, 36864
    buffer_load_dwordx4 v1, s[8:11], s95 offen lds
    v_dot2c_f32_bf16 v167, v119, v135
    v_dot2c_f32_bf16 v167, v120, v136
    v_dot2c_f32_bf16 v167, v121, v137
    ds_read_b128 v[128:131], v17 offset:96
    ds_read_b128 v[132:135], v17 offset:112
    ds_read_b64 v[136:137], v17 offset:128
    s_waitcnt lgkmcnt(6)
    v_dot2c_f32_bf16 v168, v112, v140
    v_dot2c_f32_bf16 v168, v113, v141
    s_add_u32 s94, s97, 92160
    s_mov_b32 m0, s94
    s_add_u32 s95, s96, 40960
    buffer_load_dwordx4 v1, s[8:11], s95 offen lds
    v_dot2c_f32_bf16 v168, v114, v142
    v_dot2c_f32_bf16 v168, v115, v143
    v_dot2c_f32_bf16 v168, v116, v144
    v_dot2c_f32_bf16 v168, v117, v145
    v_dot2c_f32_bf16 v168, v118, v146
    v_dot2c_f32_bf16 v168, v119, v147
    v_dot2c_f32_bf16 v168, v120, v148
    v_dot2c_f32_bf16 v168, v121, v149
    s_add_u32 s94, s97, 96256
    s_mov_b32 m0, s94
    s_add_u32 s95, s96, 45056
    buffer_load_dwordx4 v1, s[8:11], s95 offen lds
    ds_read_b128 v[140:143], v17 offset:0
    ds_read_b128 v[144:147], v17 offset:16
    ds_read_b64 v[148:149], v17 offset:32
    s_waitcnt lgkmcnt(6)
    v_dot2c_f32_bf16 v169, v112, v152
    v_dot2c_f32_bf16 v169, v113, v153
    v_dot2c_f32_bf16 v169, v114, v154
    v_dot2c_f32_bf16 v169, v115, v155
    v_dot2c_f32_bf16 v169, v116, v156
    s_add_u32 s94, s97, 100352
    s_mov_b32 m0, s94
    s_add_u32 s95, s96, 49152
    buffer_load_dwordx4 v1, s[8:11], s95 offen lds
    v_dot2c_f32_bf16 v169, v117, v157
    v_dot2c_f32_bf16 v169, v118, v158
    v_dot2c_f32_bf16 v169, v119, v159
    v_dot2c_f32_bf16 v169, v120, v160
    v_dot2c_f32_bf16 v169, v121, v161
    ds_read_b128 v[44:47], v18 offset:960
    ds_read_b128 v[48:51], v18 offset:976
    ds_read_b128 v[52:55], v18 offset:992
    s_add_u32 s94, s97, 104448
    s_mov_b32 m0, s94
    s_add_u32 s95, s96, 53248
    buffer_load_dwordx4 v1, s[8:11], s95 offen lds
    ds_read_b128 v[56:59], v18 offset:1008
    ds_read_b128 v[60:63], v18 offset:1024
    s_waitcnt lgkmcnt(8)
    v_dot2c_f32_bf16 v170, v112, v128
    v_dot2c_f32_bf16 v170, v113, v129
    v_dot2c_f32_bf16 v170, v114, v130
    v_dot2c_f32_bf16 v170, v115, v131
    v_dot2c_f32_bf16 v170, v116, v132
    v_dot2c_f32_bf16 v170, v117, v133
    s_add_u32 s94, s97, 108544
    s_mov_b32 m0, s94
    s_add_u32 s95, s96, 57344
    buffer_load_dwordx4 v1, s[8:11], s95 offen lds
    v_dot2c_f32_bf16 v170, v118, v134
    v_dot2c_f32_bf16 v170, v119, v135
    v_dot2c_f32_bf16 v170, v120, v136
    v_dot2c_f32_bf16 v170, v121, v137
    ds_read_b128 v[212:215], v18 offset:800
    ds_read_b128 v[216:219], v18 offset:816
    ds_read_b128 v[220:223], v18 offset:832
    ds_read_b128 v[224:227], v18 offset:848
    s_add_u32 s94, s97, 112640
    s_mov_b32 m0, s94
    s_add_u32 s95, s96, 61440
    buffer_load_dwordx4 v1, s[8:11], s95 offen lds
    ds_read_b128 v[228:231], v18 offset:864
    s_waitcnt lgkmcnt(10)
    v_dot2c_f32_bf16 v171, v112, v140
    v_dot2c_f32_bf16 v171, v113, v141
    v_dot2c_f32_bf16 v171, v114, v142
    v_dot2c_f32_bf16 v171, v115, v143
    v_dot2c_f32_bf16 v171, v116, v144
    v_dot2c_f32_bf16 v171, v117, v145
    v_dot2c_f32_bf16 v171, v118, v146
    s_add_u32 s94, s97, 116736
    s_mov_b32 m0, s94
    s_add_u32 s95, s96, 65536
    buffer_load_dwordx4 v1, s[8:11], s95 offen lds
    v_dot2c_f32_bf16 v171, v119, v147
    v_dot2c_f32_bf16 v171, v120, v148
    v_dot2c_f32_bf16 v171, v121, v149
    s_waitcnt vmcnt(19)
    ds_read_b128 v[24:27], v18 offset:640
    ds_read_b128 v[28:31], v18 offset:656
    ds_read_b128 v[32:35], v18 offset:672
    ds_read_b128 v[36:39], v18 offset:688
    ds_read_b128 v[40:43], v18 offset:704
    s_add_u32 s94, s97, 120832
    s_mov_b32 m0, s94
    s_add_u32 s95, s96, 69632
    buffer_load_dwordx4 v1, s[8:11], s95 offen lds
    s_cmp_lg_u32 s49, 0
    s_cbranch_scc1 L_nomask_10
    v_and_b32 v172, 31, v21
    v_mov_b32 v173, 0xff800000
    v_cmp_le_u32 vcc, 2, v172
    s_nop 1
    v_cndmask_b32 v165, v173, v165, vcc
    v_cmp_le_u32 vcc, 4, v172
    s_nop 1
    v_cndmask_b32 v166, v173, v166, vcc
    v_cmp_le_u32 vcc, 6, v172
    s_nop 1
    v_cndmask_b32 v167, v173, v167, vcc
    v_cmp_le_u32 vcc, 8, v172
    s_nop 1
    v_cndmask_b32 v168, v173, v168, vcc
    v_cmp_le_u32 vcc, 10, v172
    s_nop 1
    v_cndmask_b32 v169, v173, v169, vcc
    v_cmp_le_u32 vcc, 12, v172
    s_nop 1
    v_cndmask_b32 v170, v173, v170, vcc
    v_cmp_le_u32 vcc, 14, v172
    s_nop 1
    v_cndmask_b32 v171, v173, v171, vcc
    s_nop 2
L_nomask_10:
    v_max3_f32 v172, v164, v165, v166
    v_max3_f32 v173, v167, v168, v169
    v_max3_f32 v172, v172, v170, v171
    v_max_f32 v172, v172, v173
    s_mov_b32 s56, 0x3ea52b5c
    v_mul_f32 v172, s56, v172
    v_fma_f32 v164, v164, s56, -v172
    v_fma_f32 v165, v165, s56, -v172
    v_fma_f32 v166, v166, s56, -v172
    s_add_u32 s94, s97, 124928
    s_mov_b32 m0, s94
    s_add_u32 s95, s96, 73728
    buffer_load_dwordx4 v1, s[8:11], s95 offen lds
    v_fma_f32 v167, v167, s56, -v172
    v_fma_f32 v168, v168, s56, -v172
    v_fma_f32 v169, v169, s56, -v172
    v_fma_f32 v170, v170, s56, -v172
    v_fma_f32 v171, v171, s56, -v172
    v_exp_f32 v164, v164
    v_exp_f32 v165, v165
    s_add_u32 s94, s97, 129024
    s_mov_b32 m0, s94
    s_add_u32 s95, s96, 77824
    buffer_load_dwordx4 v1, s[8:11], s95 offen lds
    v_exp_f32 v166, v166
    v_exp_f32 v167, v167
    v_exp_f32 v168, v168
    v_exp_f32 v169, v169
    s_add_u32 s94, s97, 133120
    s_mov_b32 m0, s94
    s_add_u32 s95, s96, 81920
    buffer_load_dwordx4 v1, s[8:11], s95 offen lds
    v_exp_f32 v170, v170
    v_exp_f32 v171, v171
    v_pk_add_f32 v[172:173], v[164:165], v[166:167]
    v_pk_add_f32 v[174:175], v[168:169], v[170:171]
    v_pk_add_f32 v[172:173], v[172:173], v[174:175]
    v_add_f32 v172, v172, v173
    s_add_u32 s94, s97, 137216
    s_mov_b32 m0, s94
    s_add_u32 s95, s96, 86016
    buffer_load_dwordx4 v1, s[8:11], s95 offen lds
    v_rcp_f32 v172, v172
    v_pk_mul_f32 v[80:81], v[80:81], v[164:165] op_sel_hi:[1,0]
    v_pk_mul_f32 v[82:83], v[82:83], v[164:165] op_sel_hi:[1,0]
    v_pk_mul_f32 v[84:85], v[84:85], v[164:165] op_sel_hi:[1,0]
    v_pk_mul_f32 v[86:87], v[86:87], v[164:165] op_sel_hi:[1,0]
    v_pk_mul_f32 v[88:89], v[88:89], v[164:165] op_sel_hi:[1,0]
    v_pk_mul_f32 v[90:91], v[90:91], v[164:165] op_sel_hi:[1,0]
    s_add_u32 s94, s97, 141312
    s_mov_b32 m0, s94
    s_add_u32 s95, s96, 90112
    buffer_load_dwordx4 v1, s[8:11], s95 offen lds
    v_pk_mul_f32 v[92:93], v[92:93], v[164:165] op_sel_hi:[1,0]
    v_pk_mul_f32 v[94:95], v[94:95], v[164:165] op_sel_hi:[1,0]
    v_pk_mul_f32 v[104:105], v[104:105], v[164:165] op_sel_hi:[1,0]
    v_pk_mul_f32 v[106:107], v[106:107], v[164:165] op_sel_hi:[1,0]
    s_waitcnt lgkmcnt(10)
    v_pk_fma_f32 v[80:81], v[44:45], v[164:165], v[80:81] op_sel:[0,1,0] op_sel_hi:[1,1,1]
    v_pk_fma_f32 v[82:83], v[46:47], v[164:165], v[82:83] op_sel:[0,1,0] op_sel_hi:[1,1,1]
    v_pk_fma_f32 v[84:85], v[48:49], v[164:165], v[84:85] op_sel:[0,1,0] op_sel_hi:[1,1,1]
    v_pk_fma_f32 v[86:87], v[50:51], v[164:165], v[86:87] op_sel:[0,1,0] op_sel_hi:[1,1,1]
    s_add_u32 s94, s97, 145408
    s_mov_b32 m0, s94
    s_add_u32 s95, s96, 94208
    buffer_load_dwordx4 v1, s[8:11], s95 offen lds
    v_pk_fma_f32 v[88:89], v[52:53], v[164:165], v[88:89] op_sel:[0,1,0] op_sel_hi:[1,1,1]
    v_pk_fma_f32 v[90:91], v[54:55], v[164:165], v[90:91] op_sel:[0,1,0] op_sel_hi:[1,1,1]
    v_pk_fma_f32 v[92:93], v[56:57], v[164:165], v[92:93] op_sel:[0,1,0] op_sel_hi:[1,1,1]
    v_pk_fma_f32 v[94:95], v[58:59], v[164:165], v[94:95] op_sel:[0,1,0] op_sel_hi:[1,1,1]
    v_pk_fma_f32 v[104:105], v[60:61], v[164:165], v[104:105] op_sel:[0,1,0] op_sel_hi:[1,1,1]
    v_pk_fma_f32 v[106:107], v[62:63], v[164:165], v[106:107] op_sel:[0,1,0] op_sel_hi:[1,1,1]
    ds_read_b128 v[44:47], v18 offset:480
    ds_read_b128 v[48:51], v18 offset:496
    s_add_u32 s94, s97, 149504
    s_mov_b32 m0, s94
    s_add_u32 s95, s96, 98304
    buffer_load_dwordx4 v1, s[8:11], s95 offen lds
    ds_read_b128 v[52:55], v18 offset:512
    ds_read_b128 v[56:59], v18 offset:528
    ds_read_b128 v[60:63], v18 offset:544
    s_waitcnt lgkmcnt(10)
    v_pk_fma_f32 v[80:81], v[212:213], v[166:167], v[80:81] op_sel:[0,0,0] op_sel_hi:[1,0,1]
    v_pk_fma_f32 v[82:83], v[214:215], v[166:167], v[82:83] op_sel:[0,0,0] op_sel_hi:[1,0,1]
    v_pk_fma_f32 v[84:85], v[216:217], v[166:167], v[84:85] op_sel:[0,0,0] op_sel_hi:[1,0,1]
    v_pk_fma_f32 v[86:87], v[218:219], v[166:167], v[86:87] op_sel:[0,0,0] op_sel_hi:[1,0,1]
    v_pk_fma_f32 v[88:89], v[220:221], v[166:167], v[88:89] op_sel:[0,0,0] op_sel_hi:[1,0,1]
    s_add_u32 s95, s88, 0
    buffer_load_dwordx4 a[160:163], v1, s[8:11], s95 offen
    v_pk_fma_f32 v[90:91], v[222:223], v[166:167], v[90:91] op_sel:[0,0,0] op_sel_hi:[1,0,1]
    v_pk_fma_f32 v[92:93], v[224:225], v[166:167], v[92:93] op_sel:[0,0,0] op_sel_hi:[1,0,1]
    v_pk_fma_f32 v[94:95], v[226:227], v[166:167], v[94:95] op_sel:[0,0,0] op_sel_hi:[1,0,1]
    v_pk_fma_f32 v[104:105], v[228:229], v[166:167], v[104:105] op_sel:[0,0,0] op_sel_hi:[1,0,1]
    v_pk_fma_f32 v[106:107], v[230:231], v[166:167], v[106:107] op_sel:[0,0,0] op_sel_hi:[1,0,1]
    ds_read_b128 v[212:215], v18 offset:320
    ds_read_b128 v[216:219], v18 offset:336
    ds_read_b128 v[220:223], v18 offset:352
    s_add_u32 s95, s88, 4096
    buffer_load_dwordx4 a[164:167], v1, s[8:11], s95 offen
    ds_read_b128 v[224:227], v18 offset:368
    ds_read_b128 v[228:231], v18 offset:384
    s_waitcnt lgkmcnt(10)
    v_pk_fma_f32 v[80:81], v[24:25], v[166:167], v[80:81] op_sel:[0,1,0] op_sel_hi:[1,1,1]
    v_pk_fma_f32 v[82:83], v[26:27], v[166:167], v[82:83] op_sel:[0,1,0] op_sel_hi:[1,1,1]
    v_pk_fma_f32 v[84:85], v[28:29], v[166:167], v[84:85] op_sel:[0,1,0] op_sel_hi:[1,1,1]
    v_pk_fma_f32 v[86:87], v[30:31], v[166:167], v[86:87] op_sel:[0,1,0] op_sel_hi:[1,1,1]
    v_pk_fma_f32 v[88:89], v[32:33], v[166:167], v[88:89] op_sel:[0,1,0] op_sel_hi:[1,1,1]
    v_pk_fma_f32 v[90:91], v[34:35], v[166:167], v[90:91] op_sel:[0,1,0] op_sel_hi:[1,1,1]
    s_add_u32 s95, s88, 8192
    buffer_load_dwordx4 a[168:171], v1, s[8:11], s95 offen
    v_pk_fma_f32 v[92:93], v[36:37], v[166:167], v[92:93] op_sel:[0,1,0] op_sel_hi:[1,1,1]
    v_pk_fma_f32 v[94:95], v[38:39], v[166:167], v[94:95] op_sel:[0,1,0] op_sel_hi:[1,1,1]
    v_pk_fma_f32 v[104:105], v[40:41], v[166:167], v[104:105] op_sel:[0,1,0] op_sel_hi:[1,1,1]
    v_pk_fma_f32 v[106:107], v[42:43], v[166:167], v[106:107] op_sel:[0,1,0] op_sel_hi:[1,1,1]
    ds_read_b128 v[24:27], v18 offset:160
    ds_read_b128 v[28:31], v18 offset:176
    ds_read_b128 v[32:35], v18 offset:192
    ds_read_b128 v[36:39], v18 offset:208
    s_add_u32 s95, s88, 12288
    buffer_load_dwordx4 a[172:175], v1, s[8:11], s95 offen
    ds_read_b128 v[40:43], v18 offset:224
    s_waitcnt lgkmcnt(10)
    v_pk_fma_f32 v[80:81], v[44:45], v[168:169], v[80:81] op_sel:[0,0,0] op_sel_hi:[1,0,1]
    v_pk_fma_f32 v[82:83], v[46:47], v[168:169], v[82:83] op_sel:[0,0,0] op_sel_hi:[1,0,1]
    v_pk_fma_f32 v[84:85], v[48:49], v[168:169], v[84:85] op_sel:[0,0,0] op_sel_hi:[1,0,1]
    v_pk_fma_f32 v[86:87], v[50:51], v[168:169], v[86:87] op_sel:[0,0,0] op_sel_hi:[1,0,1]
    v_pk_fma_f32 v[88:89], v[52:53], v[168:169], v[88:89] op_sel:[0,0,0] op_sel_hi:[1,0,1]
    v_pk_fma_f32 v[90:91], v[54:55], v[168:169], v[90:91] op_sel:[0,0,0] op_sel_hi:[1,0,1]
    v_pk_fma_f32 v[92:93], v[56:57], v[168:169], v[92:93] op_sel:[0,0,0] op_sel_hi:[1,0,1]
    s_add_u32 s95, s88, 16384
    buffer_load_dwordx4 a[176:179], v1, s[8:11], s95 offen
    v_pk_fma_f32 v[94:95], v[58:59], v[168:169], v[94:95] op_sel:[0,0,0] op_sel_hi:[1,0,1]
    v_pk_fma_f32 v[104:105], v[60:61], v[168:169], v[104:105] op_sel:[0,0,0] op_sel_hi:[1,0,1]
    v_pk_fma_f32 v[106:107], v[62:63], v[168:169], v[106:107] op_sel:[0,0,0] op_sel_hi:[1,0,1]
    ds_read_b128 v[44:47], v18 offset:0
    ds_read_b128 v[48:51], v18 offset:16
    ds_read_b128 v[52:55], v18 offset:32
    ds_read_b128 v[56:59], v18 offset:48
    ds_read_b128 v[60:63], v18 offset:64
    s_add_u32 s95, s88, 20480
    buffer_load_dwordx4 a[180:183], v1, s[8:11], s95 offen
    s_waitcnt lgkmcnt(10)
    v_pk_fma_f32 v[80:81], v[212:213], v[168:169], v[80:81] op_sel:[0,1,0] op_sel_hi:[1,1,1]
    v_pk_fma_f32 v[82:83], v[214:215], v[168:169], v[82:83] op_sel:[0,1,0] op_sel_hi:[1,1,1]
    v_pk_fma_f32 v[84:85], v[216:217], v[168:169], v[84:85] op_sel:[0,1,0] op_sel_hi:[1,1,1]
    v_pk_fma_f32 v[86:87], v[218:219], v[168:169], v[86:87] op_sel:[0,1,0] op_sel_hi:[1,1,1]
    v_pk_fma_f32 v[88:89], v[220:221], v[168:169], v[88:89] op_sel:[0,1,0] op_sel_hi:[1,1,1]
    v_pk_fma_f32 v[90:91], v[222:223], v[168:169], v[90:91] op_sel:[0,1,0] op_sel_hi:[1,1,1]
    v_pk_fma_f32 v[92:93], v[224:225], v[168:169], v[92:93] op_sel:[0,1,0] op_sel_hi:[1,1,1]
    v_pk_fma_f32 v[94:95], v[226:227], v[168:169], v[94:95] op_sel:[0,1,0] op_sel_hi:[1,1,1]
    s_add_u32 s95, s88, 24576
    buffer_load_dwordx4 a[184:187], v1, s[8:11], s95 offen
    v_pk_fma_f32 v[104:105], v[228:229], v[168:169], v[104:105] op_sel:[0,1,0] op_sel_hi:[1,1,1]
    v_pk_fma_f32 v[106:107], v[230:231], v[168:169], v[106:107] op_sel:[0,1,0] op_sel_hi:[1,1,1]
    s_waitcnt lgkmcnt(5)
    v_pk_fma_f32 v[80:81], v[24:25], v[170:171], v[80:81] op_sel:[0,0,0] op_sel_hi:[1,0,1]
    v_pk_fma_f32 v[82:83], v[26:27], v[170:171], v[82:83] op_sel:[0,0,0] op_sel_hi:[1,0,1]
    v_pk_fma_f32 v[84:85], v[28:29], v[170:171], v[84:85] op_sel:[0,0,0] op_sel_hi:[1,0,1]
    v_pk_fma_f32 v[86:87], v[30:31], v[170:171], v[86:87] op_sel:[0,0,0] op_sel_hi:[1,0,1]
    v_pk_fma_f32 v[88:89], v[32:33], v[170:171], v[88:89] op_sel:[0,0,0] op_sel_hi:[1,0,1]
    v_pk_fma_f32 v[90:91], v[34:35], v[170:171], v[90:91] op_sel:[0,0,0] op_sel_hi:[1,0,1]
    s_add_u32 s95, s88, 28672
    buffer_load_dwordx4 a[188:191], v1, s[8:11], s95 offen
    v_pk_fma_f32 v[92:93], v[36:37], v[170:171], v[92:93] op_sel:[0,0,0] op_sel_hi:[1,0,1]
    v_pk_fma_f32 v[94:95], v[38:39], v[170:171], v[94:95] op_sel:[0,0,0] op_sel_hi:[1,0,1]
    v_pk_fma_f32 v[104:105], v[40:41], v[170:171], v[104:105] op_sel:[0,0,0] op_sel_hi:[1,0,1]
    v_pk_fma_f32 v[106:107], v[42:43], v[170:171], v[106:107] op_sel:[0,0,0] op_sel_hi:[1,0,1]
    s_waitcnt lgkmcnt(0)
    v_pk_fma_f32 v[80:81], v[44:45], v[170:171], v[80:81] op_sel:[0,1,0] op_sel_hi:[1,1,1]
    v_pk_fma_f32 v[82:83], v[46:47], v[170:171], v[82:83] op_sel:[0,1,0] op_sel_hi:[1,1,1]
    v_pk_fma_f32 v[84:85], v[48:49], v[170:171], v[84:85] op_sel:[0,1,0] op_sel_hi:[1,1,1]
    v_pk_fma_f32 v[86:87], v[50:51], v[170:171], v[86:87] op_sel:[0,1,0] op_sel_hi:[1,1,1]
    s_add_u32 s95, s88, 32768
    buffer_load_dwordx4 a[192:195], v1, s[8:11], s95 offen
    v_pk_fma_f32 v[88:89], v[52:53], v[170:171], v[88:89] op_sel:[0,1,0] op_sel_hi:[1,1,1]
    v_pk_fma_f32 v[90:91], v[54:55], v[170:171], v[90:91] op_sel:[0,1,0] op_sel_hi:[1,1,1]
    v_pk_fma_f32 v[92:93], v[56:57], v[170:171], v[92:93] op_sel:[0,1,0] op_sel_hi:[1,1,1]
    v_pk_fma_f32 v[94:95], v[58:59], v[170:171], v[94:95] op_sel:[0,1,0] op_sel_hi:[1,1,1]
    v_pk_fma_f32 v[104:105], v[60:61], v[170:171], v[104:105] op_sel:[0,1,0] op_sel_hi:[1,1,1]
    v_pk_fma_f32 v[106:107], v[62:63], v[170:171], v[106:107] op_sel:[0,1,0] op_sel_hi:[1,1,1]
    v_pk_mul_f32 v[80:81], v[80:81], v[172:173] op_sel_hi:[1,0]
    v_pk_mul_f32 v[82:83], v[82:83], v[172:173] op_sel_hi:[1,0]
    s_add_u32 s95, s88, 36864
    buffer_load_dwordx4 a[196:199], v1, s[8:11], s95 offen
    v_pk_mul_f32 v[84:85], v[84:85], v[172:173] op_sel_hi:[1,0]
    v_pk_mul_f32 v[86:87], v[86:87], v[172:173] op_sel_hi:[1,0]
    v_pk_mul_f32 v[88:89], v[88:89], v[172:173] op_sel_hi:[1,0]
    v_pk_mul_f32 v[90:91], v[90:91], v[172:173] op_sel_hi:[1,0]
    v_pk_mul_f32 v[92:93], v[92:93], v[172:173] op_sel_hi:[1,0]
    v_pk_mul_f32 v[94:95], v[94:95], v[172:173] op_sel_hi:[1,0]
    v_pk_mul_f32 v[104:105], v[104:105], v[172:173] op_sel_hi:[1,0]
    v_pk_mul_f32 v[106:107], v[106:107], v[172:173] op_sel_hi:[1,0]
    s_add_u32 s95, s88, 40960
    buffer_load_dwordx4 a[200:203], v1, s[8:11], s95 offen
    v_cvt_pk_bf16_f32 v80, v80, v81
    v_cvt_pk_bf16_f32 v81, v82, v83
    v_cvt_pk_bf16_f32 v82, v84, v85
    v_cvt_pk_bf16_f32 v83, v86, v87
    v_cvt_pk_bf16_f32 v84, v88, v89
    v_cvt_pk_bf16_f32 v85, v90, v91
    v_cvt_pk_bf16_f32 v86, v92, v93
    v_cvt_pk_bf16_f32 v87, v94, v95
    s_add_u32 s95, s88, 45056
    buffer_load_dwordx4 a[204:207], v1, s[8:11], s95 offen
    v_cvt_pk_bf16_f32 v88, v104, v105
    v_cvt_pk_bf16_f32 v89, v106, v107
    s_nop 0
    v_permlane32_swap_b32 v88, v90
    v_permlane32_swap_b32 v89, v91
    s_mul_i32 s52, s49, 40960
    s_lshl_b32 s53, s46, 10
    s_add_u32 s52, s52, 7864320
    s_add_u32 s53, s53, s52
    s_lshl_b32 s54, s46, 8
    s_add_u32 s54, s54, s52
    s_add_u32 s54, s54, 16384
    buffer_store_dwordx4 v[80:83], v14, s[8:11], s53 offen sc1
    buffer_store_dwordx4 v[84:87], v14, s[8:11], s53 offen offset:256 sc1
    s_mov_b64 exec, 0xffffffff
    buffer_store_dwordx4 v[88:91], v14, s[8:11], s54 offen sc1
    s_mov_b64 exec, -1
    s_waitcnt vmcnt(15)
    s_barrier
    s_mul_i32 s59, s50, 20480
    s_add_u32 s59, s59, 7864320
    s_add_u32 s60, s59, 16384
    s_movk_i32 s57, 960
    s_movk_i32 s56, 160
    v_bfe_u32 v164, v21, 2, 2
    v_mul_u32_u24 v164, 40, v164
    v_bfe_u32 v165, v21, 4, 1
    v_bfe_u32 v166, v21, 1, 1
    v_lshl_add_u32 v165, v165, 1, v166
    v_lshl_add_u32 v164, v165, 3, v164
    v_add_u32 v164, 161792, v164
    v_lshrrev_b32 v166, 5, v21
    v_and_b32 v167, 1, v21
    v_mov_b32 v172, 154624
    v_mad_u32_u24 v168, v166, s57, v164
    v_mad_u32_u24 v169, v166, s56, v164
    v_add_u32 v169, 640, v169
    v_cmp_eq_u32 vcc, v166, v167
    s_nop 1
    v_cndmask_b32 v168, v172, v168, vcc
    v_cndmask_b32 v169, v172, v169, vcc
    v_cmp_eq_u32 vcc, 0, v165
    s_nop 1
    v_cndmask_b32 v170, v172, v168, vcc
    v_cndmask_b32 v171, v172, v169, vcc
    ds_read_b64_tr_b16 v[176:177], v168 offset:0
    ds_read_b64_tr_b16 v[178:179], v168 offset:160
    ds_read_b64_tr_b16 v[180:181], v168 offset:320
    ds_read_b64_tr_b16 v[182:183], v168 offset:480
    ds_read_b64_tr_b16 v[184:185], v169 offset:0
    v_mov_b32 v186, 0
    v_mov_b32 v187, 0
    ds_read_b64_tr_b16 v[188:189], v170 offset:32
    ds_read_b64_tr_b16 v[190:191], v170 offset:192
    ds_read_b64_tr_b16 v[192:193], v170 offset:352
    ds_read_b64_tr_b16 v[194:195], v170 offset:512
    ds_read_b64_tr_b16 v[196:197], v171 offset:32
    v_mov_b32 v198, 0
    v_mov_b32 v199, 0
    s_waitcnt lgkmcnt(0)
    v_add_u32 v166, s89, v1
    v_add_u32 v167, 0x10000, v166
    s_waitcnt vmcnt(14)
    ds_write_b128 v166, a[160:163] offset:0
    s_waitcnt vmcnt(13)
    ds_write_b128 v166, a[164:167] offset:4096
    s_waitcnt vmcnt(12)
    ds_write_b128 v166, a[168:171] offset:8192
    s_waitcnt vmcnt(11)
    ds_write_b128 v166, a[172:175] offset:12288
    s_waitcnt vmcnt(10)
    ds_write_b128 v166, a[176:179] offset:16384
    s_waitcnt vmcnt(9)
    ds_write_b128 v166, a[180:183] offset:20480
    s_waitcnt vmcnt(8)
    ds_write_b128 v166, a[184:187] offset:24576
    s_waitcnt vmcnt(7)
    ds_write_b128 v166, a[188:191] offset:28672
    s_waitcnt vmcnt(6)
    ds_write_b128 v166, a[192:195] offset:32768
    s_waitcnt vmcnt(5)
    ds_write_b128 v166, a[196:199] offset:36864
    s_waitcnt vmcnt(4)
    ds_write_b128 v166, a[200:203] offset:40960
    s_waitcnt vmcnt(3)
    ds_write_b128 v166, a[204:207] offset:45056
    v_mov_b32 v228, 0x3f803f80
    v_mov_b32 v229, 0x3f803f80
    v_mov_b32 v230, 0x3f803f80
    v_mov_b32 v231, 0x3f803f80
    s_waitcnt lgkmcnt(0)
    s_barrier
    s_lshl_b32 s52, s44, 10
    v_add_u32 v164, s52, v2
    v_add_u32 v165, 2048, v4
    s_cmp_lt_u32 s44, 2
    s_cselect_b64 vcc, -1, 0
    v_cndmask_b32 v164, v165, v164, vcc
    v_add_u32 v164, 0, v164
    ds_read_b128 v[52:55], v164 offset:0
    ds_read_b128 v[56:59], v164 offset:2816
    ds_read_b128 v[60:63], v164 offset:5632
    ds_read_b128 v[152:155], v164 offset:8448
    ds_read_b128 v[156:159], v164 offset:11264
    s_waitcnt lgkmcnt(4)
    v_mfma_f32_32x32x16_bf16 v[120:135], v[228:231], v[52:55], 0
    ds_read_b128 v[160:163], v164 offset:14080
    s_waitcnt lgkmcnt(4)
    v_mfma_f32_32x32x16_bf16 v[120:135], v[228:231], v[56:59], v[120:135]
    ds_read_b128 v[52:55], v164 offset:16896
    s_waitcnt lgkmcnt(4)
    v_mfma_f32_32x32x16_bf16 v[120:135], v[228:231], v[60:63], v[120:135]
    ds_read_b128 v[56:59], v164 offset:19712
    s_waitcnt lgkmcnt(4)
    v_mfma_f32_32x32x16_bf16 v[120:135], v[228:231], v[152:155], v[120:135]
    ds_read_b128 v[60:63], v164 offset:22528
    s_waitcnt lgkmcnt(4)
    v_mfma_f32_32x32x16_bf16 v[120:135], v[228:231], v[156:159], v[120:135]
    ds_read_b128 v[152:155], v164 offset:25344
    s_waitcnt lgkmcnt(4)
    v_mfma_f32_32x32x16_bf16 v[120:135], v[228:231], v[160:163], v[120:135]
    ds_read_b128 v[156:159], v164 offset:28160
    s_waitcnt lgkmcnt(4)
    v_mfma_f32_32x32x16_bf16 v[120:135], v[228:231], v[52:55], v[120:135]
    ds_read_b128 v[160:163], v164 offset:30976
    s_waitcnt lgkmcnt(4)
    v_mfma_f32_32x32x16_bf16 v[120:135], v[228:231], v[56:59], v[120:135]
    ds_read_b128 v[52:55], v164 offset:33792
    s_waitcnt lgkmcnt(4)
    v_mfma_f32_32x32x16_bf16 v[120:135], v[228:231], v[60:63], v[120:135]
    ds_read_b128 v[56:59], v164 offset:36608
    s_waitcnt lgkmcnt(4)
    v_mfma_f32_32x32x16_bf16 v[120:135], v[228:231], v[152:155], v[120:135]
    ds_read_b128 v[60:63], v164 offset:39424
    s_waitcnt lgkmcnt(4)
    v_mfma_f32_32x32x16_bf16 v[120:135], v[228:231], v[156:159], v[120:135]
    ds_read_b128 v[152:155], v164 offset:42240
    s_waitcnt lgkmcnt(4)
    v_mfma_f32_32x32x16_bf16 v[120:135], v[228:231], v[160:163], v[120:135]
    s_waitcnt lgkmcnt(3)
    v_mfma_f32_32x32x16_bf16 v[120:135], v[228:231], v[52:55], v[120:135]
    s_waitcnt lgkmcnt(2)
    v_mfma_f32_32x32x16_bf16 v[120:135], v[228:231], v[56:59], v[120:135]
    s_waitcnt lgkmcnt(1)
    v_mfma_f32_32x32x16_bf16 v[120:135], v[228:231], v[60:63], v[120:135]
    s_waitcnt lgkmcnt(0)
    v_mfma_f32_32x32x16_bf16 v[120:135], v[228:231], v[152:155], v[120:135]
    v_add_u32 v175, 0x10000, v10
L_wo_11:
    buffer_load_dwordx4 v[24:27], v1, s[8:11], s60 offen offset:0 sc1
    buffer_load_dwordx4 v[28:31], v1, s[8:11], s60 offen offset:1024 sc1
    buffer_load_dwordx4 v[32:35], v1, s[8:11], s60 offen offset:2048 sc1
    buffer_load_dwordx4 v[36:39], v1, s[8:11], s60 offen offset:3072 sc1
    v_lshlrev_b32 v64, 16, v200
    v_and_b32 v65, 0xffff0000, v200
    v_lshlrev_b32 v66, 16, v201
    v_and_b32 v67, 0xffff0000, v201
    v_lshlrev_b32 v68, 16, v202
    v_and_b32 v69, 0xffff0000, v202
    v_lshlrev_b32 v70, 16, v203
    v_and_b32 v71, 0xffff0000, v203
    v_lshlrev_b32 v72, 16, v204
    v_and_b32 v73, 0xffff0000, v204
    v_lshlrev_b32 v74, 16, v205
    v_and_b32 v75, 0xffff0000, v205
    v_lshlrev_b32 v76, 16, v206
    v_and_b32 v77, 0xffff0000, v206
    v_lshlrev_b32 v78, 16, v207
    v_and_b32 v79, 0xffff0000, v207
    v_lshlrev_b32 v80, 16, v208
    v_and_b32 v81, 0xffff0000, v208
    v_lshlrev_b32 v82, 16, v209
    v_and_b32 v83, 0xffff0000, v209
    s_waitcnt vmcnt(0)
    v_max3_u32 v164, v24, v25, v26
    v_max3_u32 v164, v164, v27, v28
    v_max3_u32 v164, v164, v29, v30
    v_max3_u32 v164, v164, v31, v32
    v_max3_u32 v164, v164, v33, v34
    v_max3_u32 v164, v164, v35, v36
    v_max3_u32 v164, v164, v37, v38
    v_max_u32 v164, v164, v39
    v_cmp_eq_u32 vcc, -1, v164
    s_cbranch_vccz L_ok_12
    s_add_u32 s51, s51, 1
    s_cmp_gt_u32 s51, 200000
    s_cbranch_scc1 L_ok_12
    s_waitcnt vmcnt(0) lgkmcnt(0)
    s_sleep 2
    s_branch L_wo_11
L_ok_12:
    s_add_u32 s61, s59, 0
    buffer_load_dwordx4 a[0:3], v1, s[8:11], s61 offen offset:0 sc1
    buffer_load_dwordx4 a[4:7], v1, s[8:11], s61 offen offset:1024 sc1
    buffer_load_dwordx4 a[8:11], v1, s[8:11], s61 offen offset:2048 sc1
    buffer_load_dwordx4 a[12:15], v1, s[8:11], s61 offen offset:3072 sc1
    s_add_u32 s61, s59, 4096
    buffer_load_dwordx4 a[16:19], v1, s[8:11], s61 offen offset:0 sc1
    buffer_load_dwordx4 a[20:23], v1, s[8:11], s61 offen offset:1024 sc1
    buffer_load_dwordx4 a[24:27], v1, s[8:11], s61 offen offset:2048 sc1
    buffer_load_dwordx4 a[28:31], v1, s[8:11], s61 offen offset:3072 sc1
    s_add_u32 s61, s59, 8192
    buffer_load_dwordx4 a[32:35], v1, s[8:11], s61 offen offset:0 sc1
    buffer_load_dwordx4 a[36:39], v1, s[8:11], s61 offen offset:1024 sc1
    ds_read_b128 v[84:87], v175 offset:16384
    ds_read_b128 v[88:91], v175 offset:17408
    ds_read_b128 v[92:95], v175 offset:18432
    ds_read_b128 v[96:99], v175 offset:19456
    ds_read_b128 v[100:103], v175 offset:20480
    ds_read_b128 v[104:107], v175 offset:21504
    ds_read_b128 v[108:111], v175 offset:22528
    s_waitcnt lgkmcnt(6)
    v_mfma_f32_16x16x32_bf16 v[64:67], v[84:87], v[24:27], v[64:67]
    ds_read_b128 v[112:115], v175 offset:23552
    buffer_load_dwordx4 a[40:43], v1, s[8:11], s61 offen offset:2048 sc1
    s_waitcnt lgkmcnt(6)
    v_mfma_f32_16x16x32_bf16 v[68:71], v[88:91], v[24:27], v[68:71]
    ds_read_b128 v[116:119], v175 offset:24576
    s_waitcnt lgkmcnt(6)
    v_mfma_f32_16x16x32_bf16 v[72:75], v[92:95], v[24:27], v[72:75]
    ds_read_b128 v[84:87], v175 offset:25600
    s_waitcnt lgkmcnt(6)
    v_mfma_f32_16x16x32_bf16 v[76:79], v[96:99], v[24:27], v[76:79]
    ds_read_b128 v[88:91], v175 offset:26624
    s_waitcnt lgkmcnt(6)
    v_mfma_f32_16x16x32_bf16 v[80:83], v[100:103], v[24:27], v[80:83]
    ds_read_b128 v[92:95], v175 offset:27648
    buffer_load_dwordx4 a[44:47], v1, s[8:11], s61 offen offset:3072 sc1
    s_waitcnt lgkmcnt(6)
    v_mfma_f32_16x16x32_bf16 v[64:67], v[104:107], v[28:31], v[64:67]
    ds_read_b128 v[96:99], v175 offset:28672
    s_waitcnt lgkmcnt(6)
    v_mfma_f32_16x16x32_bf16 v[68:71], v[108:111], v[28:31], v[68:71]
    ds_read_b128 v[100:103], v175 offset:29696
    s_waitcnt lgkmcnt(6)
    v_mfma_f32_16x16x32_bf16 v[72:75], v[112:115], v[28:31], v[72:75]
    ds_read_b128 v[104:107], v175 offset:30720
    s_waitcnt lgkmcnt(6)
    v_mfma_f32_16x16x32_bf16 v[76:79], v[116:119], v[28:31], v[76:79]
    ds_read_b128 v[108:111], v175 offset:31744
    s_add_u32 s61, s59, 12288
    buffer_load_dwordx4 a[48:51], v1, s[8:11], s61 offen offset:0 sc1
    s_waitcnt lgkmcnt(6)
    v_mfma_f32_16x16x32_bf16 v[80:83], v[84:87], v[28:31], v[80:83]
    ds_read_b128 v[112:115], v175 offset:32768
    s_waitcnt lgkmcnt(6)
    v_mfma_f32_16x16x32_bf16 v[64:67], v[88:91], v[32:35], v[64:67]
    ds_read_b128 v[116:119], v175 offset:33792
    s_waitcnt lgkmcnt(6)
    v_mfma_f32_16x16x32_bf16 v[68:71], v[92:95], v[32:35], v[68:71]
    ds_read_b128 v[84:87], v175 offset:34816
    s_waitcnt lgkmcnt(6)
    v_mfma_f32_16x16x32_bf16 v[72:75], v[96:99], v[32:35], v[72:75]
    ds_read_b128 v[88:91], v175 offset:35840
    buffer_load_dwordx4 a[52:55], v1, s[8:11], s61 offen offset:1024 sc1
    s_waitcnt lgkmcnt(6)
    v_mfma_f32_16x16x32_bf16 v[76:79], v[100:103], v[32:35], v[76:79]
    ds_read_b128 v[92:95], v10 offset:0
    s_waitcnt lgkmcnt(6)
    v_mfma_f32_16x16x32_bf16 v[80:83], v[104:107], v[32:35], v[80:83]
    ds_read_b128 v[96:99], v10 offset:1024
    s_waitcnt lgkmcnt(6)
    v_mfma_f32_16x16x32_bf16 v[64:67], v[108:111], v[36:39], v[64:67]
    ds_read_b128 v[100:103], v10 offset:2048
    s_waitcnt lgkmcnt(6)
    v_mfma_f32_16x16x32_bf16 v[68:71], v[112:115], v[36:39], v[68:71]
    ds_read_b128 v[104:107], v10 offset:3072
    buffer_load_dwordx4 a[56:59], v1, s[8:11], s61 offen offset:2048 sc1
    s_waitcnt lgkmcnt(6)
    v_mfma_f32_16x16x32_bf16 v[72:75], v[116:119], v[36:39], v[72:75]
    ds_read_b128 v[108:111], v10 offset:4096
    s_waitcnt lgkmcnt(6)
    v_mfma_f32_16x16x32_bf16 v[76:79], v[84:87], v[36:39], v[76:79]
    ds_read_b128 v[112:115], v10 offset:5120
    s_waitcnt lgkmcnt(6)
    v_mfma_f32_16x16x32_bf16 v[80:83], v[88:91], v[36:39], v[80:83]
    ds_read_b128 v[116:119], v10 offset:6144
    s_waitcnt vmcnt(14) lgkmcnt(6)
    v_mfma_f32_16x16x32_bf16 v[64:67], v[92:95], a[0:3], v[64:67]
    ds_read_b128 v[84:87], v10 offset:7168
    buffer_load_dwordx4 a[60:63], v1, s[8:11], s61 offen offset:3072 sc1
    s_waitcnt lgkmcnt(6)
    v_mfma_f32_16x16x32_bf16 v[68:71], v[96:99], a[0:3], v[68:71]
    ds_read_b128 v[88:91], v10 offset:8192
    s_waitcnt lgkmcnt(6)
    v_mfma_f32_16x16x32_bf16 v[72:75], v[100:103], a[0:3], v[72:75]
    ds_read_b128 v[92:95], v10 offset:9216
    s_waitcnt lgkmcnt(6)
    v_mfma_f32_16x16x32_bf16 v[76:79], v[104:107], a[0:3], v[76:79]
    ds_read_b128 v[96:99], v10 offset:10240
    s_waitcnt lgkmcnt(6)
    v_mfma_f32_16x16x32_bf16 v[80:83], v[108:111], a[0:3], v[80:83]
    ds_read_b128 v[100:103], v10 offset:11264
    s_add_u32 s95, s88, 49152
    buffer_load_dwordx4 a[208:211], v1, s[8:11], s95 offen
    s_waitcnt vmcnt(15) lgkmcnt(6)
    v_mfma_f32_16x16x32_bf16 v[64:67], v[112:115], a[4:7], v[64:67]
    ds_read_b128 v[104:107], v10 offset:12288
    s_waitcnt lgkmcnt(6)
    v_mfma_f32_16x16x32_bf16 v[68:71], v[116:119], a[4:7], v[68:71]
    ds_read_b128 v[108:111], v10 offset:13312
    s_waitcnt lgkmcnt(6)
    v_mfma_f32_16x16x32_bf16 v[72:75], v[84:87], a[4:7], v[72:75]
    ds_read_b128 v[112:115], v10 offset:14336
    s_waitcnt lgkmcnt(6)
    v_mfma_f32_16x16x32_bf16 v[76:79], v[88:91], a[4:7], v[76:79]
    ds_read_b128 v[116:119], v10 offset:15360
    s_add_u32 s95, s88, 53248
    buffer_load_dwordx4 a[212:215], v1, s[8:11], s95 offen
    s_waitcnt lgkmcnt(6)
    v_mfma_f32_16x16x32_bf16 v[80:83], v[92:95], a[4:7], v[80:83]
    ds_read_b128 v[84:87], v10 offset:16384
    s_waitcnt vmcnt(15) lgkmcnt(6)
    v_mfma_f32_16x16x32_bf16 v[64:67], v[96:99], a[8:11], v[64:67]
    ds_read_b128 v[88:91], v10 offset:17408
    s_waitcnt lgkmcnt(6)
    v_mfma_f32_16x16x32_bf16 v[68:71], v[100:103], a[8:11], v[68:71]
    ds_read_b128 v[92:95], v10 offset:18432
    s_waitcnt lgkmcnt(6)
    v_mfma_f32_16x16x32_bf16 v[72:75], v[104:107], a[8:11], v[72:75]
    ds_read_b128 v[96:99], v10 offset:19456
    s_add_u32 s95, s88, 57344
    buffer_load_dwordx4 a[216:219], v1, s[8:11], s95 offen
    s_waitcnt lgkmcnt(6)
    v_mfma_f32_16x16x32_bf16 v[76:79], v[108:111], a[8:11], v[76:79]
    ds_read_b128 v[100:103], v10 offset:20480
    s_waitcnt lgkmcnt(6)
    v_mfma_f32_16x16x32_bf16 v[80:83], v[112:115], a[8:11], v[80:83]
    ds_read_b128 v[104:107], v10 offset:21504
    s_waitcnt vmcnt(15) lgkmcnt(6)
    v_mfma_f32_16x16x32_bf16 v[64:67], v[116:119], a[12:15], v[64:67]
    ds_read_b128 v[108:111], v10 offset:22528
    s_waitcnt lgkmcnt(6)
    v_mfma_f32_16x16x32_bf16 v[68:71], v[84:87], a[12:15], v[68:71]
    ds_read_b128 v[112:115], v10 offset:23552
    s_add_u32 s95, s88, 61440
    buffer_load_dwordx4 a[220:223], v1, s[8:11], s95 offen
    s_waitcnt lgkmcnt(6)
    v_mfma_f32_16x16x32_bf16 v[72:75], v[88:91], a[12:15], v[72:75]
    ds_read_b128 v[116:119], v10 offset:24576
    s_waitcnt lgkmcnt(6)
    v_mfma_f32_16x16x32_bf16 v[76:79], v[92:95], a[12:15], v[76:79]
    ds_read_b128 v[84:87], v10 offset:25600
    s_waitcnt lgkmcnt(6)
    v_mfma_f32_16x16x32_bf16 v[80:83], v[96:99], a[12:15], v[80:83]
    ds_read_b128 v[88:91], v10 offset:26624
    s_waitcnt vmcnt(15) lgkmcnt(6)
    v_mfma_f32_16x16x32_bf16 v[64:67], v[100:103], a[16:19], v[64:67]
    ds_read_b128 v[92:95], v10 offset:27648
    s_add_u32 s95, s88, 65536
    buffer_load_dwordx4 a[224:227], v1, s[8:11], s95 offen
    s_waitcnt lgkmcnt(6)
    v_mfma_f32_16x16x32_bf16 v[68:71], v[104:107], a[16:19], v[68:71]
    ds_read_b128 v[96:99], v10 offset:28672
    s_waitcnt lgkmcnt(6)
    v_mfma_f32_16x16x32_bf16 v[72:75], v[108:111], a[16:19], v[72:75]
    ds_read_b128 v[100:103], v10 offset:29696
    s_waitcnt lgkmcnt(6)
    v_mfma_f32_16x16x32_bf16 v[76:79], v[112:115], a[16:19], v[76:79]
    ds_read_b128 v[104:107], v10 offset:30720
    s_waitcnt lgkmcnt(6)
    v_mfma_f32_16x16x32_bf16 v[80:83], v[116:119], a[16:19], v[80:83]
    ds_read_b128 v[108:111], v10 offset:31744
    s_add_u32 s95, s88, 69632
    buffer_load_dwordx4 a[228:231], v1, s[8:11], s95 offen
    s_waitcnt vmcnt(16) lgkmcnt(6)
    v_mfma_f32_16x16x32_bf16 v[64:67], v[84:87], a[20:23], v[64:67]
    ds_read_b128 v[112:115], v10 offset:32768
    s_waitcnt lgkmcnt(6)
    v_mfma_f32_16x16x32_bf16 v[68:71], v[88:91], a[20:23], v[68:71]
    ds_read_b128 v[116:119], v10 offset:33792
    s_waitcnt lgkmcnt(6)
    v_mfma_f32_16x16x32_bf16 v[72:75], v[92:95], a[20:23], v[72:75]
    ds_read_b128 v[84:87], v10 offset:34816
    s_waitcnt lgkmcnt(6)
    v_mfma_f32_16x16x32_bf16 v[76:79], v[96:99], a[20:23], v[76:79]
    ds_read_b128 v[88:91], v10 offset:35840
    s_add_u32 s95, s88, 73728
    buffer_load_dwordx4 a[232:235], v1, s[8:11], s95 offen
    s_waitcnt lgkmcnt(6)
    v_mfma_f32_16x16x32_bf16 v[80:83], v[100:103], a[20:23], v[80:83]
    ds_read_b128 v[92:95], v10 offset:36864
    s_waitcnt vmcnt(16) lgkmcnt(6)
    v_mfma_f32_16x16x32_bf16 v[64:67], v[104:107], a[24:27], v[64:67]
    ds_read_b128 v[96:99], v10 offset:37888
    s_waitcnt lgkmcnt(6)
    v_mfma_f32_16x16x32_bf16 v[68:71], v[108:111], a[24:27], v[68:71]
    ds_read_b128 v[100:103], v10 offset:38912
    s_waitcnt lgkmcnt(6)
    v_mfma_f32_16x16x32_bf16 v[72:75], v[112:115], a[24:27], v[72:75]
    ds_read_b128 v[104:107], v10 offset:39936
    s_add_u32 s95, s88, 77824
    buffer_load_dwordx4 a[236:239], v1, s[8:11], s95 offen
    s_waitcnt lgkmcnt(6)
    v_mfma_f32_16x16x32_bf16 v[76:79], v[116:119], a[24:27], v[76:79]
    ds_read_b128 v[108:111], v10 offset:40960
    s_waitcnt lgkmcnt(6)
    v_mfma_f32_16x16x32_bf16 v[80:83], v[84:87], a[24:27], v[80:83]
    ds_read_b128 v[112:115], v10 offset:41984
    s_waitcnt vmcnt(16) lgkmcnt(6)
    v_mfma_f32_16x16x32_bf16 v[64:67], v[88:91], a[28:31], v[64:67]
    ds_read_b128 v[116:119], v10 offset:43008
    s_waitcnt lgkmcnt(6)
    v_mfma_f32_16x16x32_bf16 v[68:71], v[92:95], a[28:31], v[68:71]
    ds_read_b128 v[84:87], v10 offset:44032
    s_add_u32 s95, s88, 81920
    buffer_load_dwordx4 a[240:243], v1, s[8:11], s95 offen
    s_waitcnt lgkmcnt(6)
    v_mfma_f32_16x16x32_bf16 v[72:75], v[96:99], a[28:31], v[72:75]
    ds_read_b128 v[88:91], v10 offset:45056
    s_waitcnt lgkmcnt(6)
    v_mfma_f32_16x16x32_bf16 v[76:79], v[100:103], a[28:31], v[76:79]
    ds_read_b128 v[92:95], v10 offset:46080
    s_waitcnt lgkmcnt(6)
    v_mfma_f32_16x16x32_bf16 v[80:83], v[104:107], a[28:31], v[80:83]
    ds_read_b128 v[96:99], v10 offset:47104
    s_waitcnt vmcnt(16) lgkmcnt(6)
    v_mfma_f32_16x16x32_bf16 v[64:67], v[108:111], a[32:35], v[64:67]
    ds_read_b128 v[100:103], v10 offset:48128
    s_add_u32 s95, s88, 86016
    buffer_load_dwordx4 a[244:247], v1, s[8:11], s95 offen
    s_waitcnt lgkmcnt(6)
    v_mfma_f32_16x16x32_bf16 v[68:71], v[112:115], a[32:35], v[68:71]
    ds_read_b128 v[104:107], v10 offset:49152
    s_waitcnt lgkmcnt(6)
    v_mfma_f32_16x16x32_bf16 v[72:75], v[116:119], a[32:35], v[72:75]
    ds_read_b128 v[108:111], v10 offset:50176
    s_waitcnt lgkmcnt(6)
    v_mfma_f32_16x16x32_bf16 v[76:79], v[84:87], a[32:35], v[76:79]
    ds_read_b128 v[112:115], v10 offset:51200
    s_waitcnt lgkmcnt(6)
    v_mfma_f32_16x16x32_bf16 v[80:83], v[88:91], a[32:35], v[80:83]
    ds_read_b128 v[116:119], v10 offset:52224
    s_add_u32 s95, s88, 90112
    buffer_load_dwordx4 a[248:251], v1, s[8:11], s95 offen
    s_waitcnt vmcnt(17) lgkmcnt(6)
    v_mfma_f32_16x16x32_bf16 v[64:67], v[92:95], a[36:39], v[64:67]
    ds_read_b128 v[84:87], v10 offset:53248
    s_waitcnt lgkmcnt(6)
    v_mfma_f32_16x16x32_bf16 v[68:71], v[96:99], a[36:39], v[68:71]
    ds_read_b128 v[88:91], v10 offset:54272
    s_waitcnt lgkmcnt(6)
    v_mfma_f32_16x16x32_bf16 v[72:75], v[100:103], a[36:39], v[72:75]
    ds_read_b128 v[92:95], v10 offset:55296
    s_waitcnt lgkmcnt(6)
    v_mfma_f32_16x16x32_bf16 v[76:79], v[104:107], a[36:39], v[76:79]
    ds_read_b128 v[96:99], v10 offset:56320
    s_add_u32 s95, s88, 94208
    buffer_load_dwordx4 a[252:255], v1, s[8:11], s95 offen
    s_waitcnt lgkmcnt(6)
    v_mfma_f32_16x16x32_bf16 v[80:83], v[108:111], a[36:39], v[80:83]
    ds_read_b128 v[100:103], v10 offset:57344
    s_waitcnt vmcnt(17) lgkmcnt(6)
    v_mfma_f32_16x16x32_bf16 v[64:67], v[112:115], a[40:43], v[64:67]
    ds_read_b128 v[104:107], v10 offset:58368
    s_waitcnt lgkmcnt(6)
    v_mfma_f32_16x16x32_bf16 v[68:71], v[116:119], a[40:43], v[68:71]
    ds_read_b128 v[108:111], v10 offset:59392
    s_waitcnt lgkmcnt(6)
    v_mfma_f32_16x16x32_bf16 v[72:75], v[84:87], a[40:43], v[72:75]
    ds_read_b128 v[112:115], v10 offset:60416
    s_add_u32 s95, s88, 98304
    buffer_load_dwordx4 v[240:243], v1, s[8:11], s95 offen
    s_waitcnt lgkmcnt(6)
    v_mfma_f32_16x16x32_bf16 v[76:79], v[88:91], a[40:43], v[76:79]
    ds_read_b128 v[116:119], v10 offset:61440
    s_waitcnt lgkmcnt(6)
    v_mfma_f32_16x16x32_bf16 v[80:83], v[92:95], a[40:43], v[80:83]
    ds_read_b128 v[84:87], v10 offset:62464
    s_waitcnt vmcnt(17) lgkmcnt(6)
    v_mfma_f32_16x16x32_bf16 v[64:67], v[96:99], a[44:47], v[64:67]
    ds_read_b128 v[88:91], v10 offset:63488
    s_waitcnt lgkmcnt(6)
    v_mfma_f32_16x16x32_bf16 v[68:71], v[100:103], a[44:47], v[68:71]
    ds_read_b128 v[92:95], v10 offset:64512
    s_add_u32 s95, s88, 102400
    buffer_load_dwordx4 v[244:247], v1, s[8:11], s95 offen
    s_waitcnt lgkmcnt(6)
    v_mfma_f32_16x16x32_bf16 v[72:75], v[104:107], a[44:47], v[72:75]
    ds_read_b128 v[96:99], v175 offset:0
    s_waitcnt lgkmcnt(6)
    v_mfma_f32_16x16x32_bf16 v[76:79], v[108:111], a[44:47], v[76:79]
    ds_read_b128 v[100:103], v175 offset:1024
    s_waitcnt lgkmcnt(6)
    v_mfma_f32_16x16x32_bf16 v[80:83], v[112:115], a[44:47], v[80:83]
    ds_read_b128 v[104:107], v175 offset:2048
    s_waitcnt vmcnt(17) lgkmcnt(6)
    v_mfma_f32_16x16x32_bf16 v[64:67], v[116:119], a[48:51], v[64:67]
    ds_read_b128 v[108:111], v175 offset:3072
    s_add_u32 s95, s88, 106496
    buffer_load_dwordx4 v[248:251], v1, s[8:11], s95 offen
    s_waitcnt lgkmcnt(6)
    v_mfma_f32_16x16x32_bf16 v[68:71], v[84:87], a[48:51], v[68:71]
    ds_read_b128 v[112:115], v175 offset:4096
    s_waitcnt lgkmcnt(6)
    v_mfma_f32_16x16x32_bf16 v[72:75], v[88:91], a[48:51], v[72:75]
    ds_read_b128 v[116:119], v175 offset:5120
    s_waitcnt lgkmcnt(6)
    v_mfma_f32_16x16x32_bf16 v[76:79], v[92:95], a[48:51], v[76:79]
    ds_read_b128 v[84:87], v175 offset:6144
    s_waitcnt lgkmcnt(6)
    v_mfma_f32_16x16x32_bf16 v[80:83], v[96:99], a[48:51], v[80:83]
    ds_read_b128 v[88:91], v175 offset:7168
    s_add_u32 s95, s88, 110592
    buffer_load_dwordx4 v[252:255], v1, s[8:11], s95 offen
    s_waitcnt vmcnt(18) lgkmcnt(6)
    v_mfma_f32_16x16x32_bf16 v[64:67], v[100:103], a[52:55], v[64:67]
    ds_read_b128 v[92:95], v175 offset:8192
    s_waitcnt lgkmcnt(6)
    v_mfma_f32_16x16x32_bf16 v[68:71], v[104:107], a[52:55], v[68:71]
    ds_read_b128 v[96:99], v175 offset:9216
    s_waitcnt lgkmcnt(6)
    v_mfma_f32_16x16x32_bf16 v[72:75], v[108:111], a[52:55], v[72:75]
    ds_read_b128 v[100:103], v175 offset:10240
    s_waitcnt lgkmcnt(6)
    v_mfma_f32_16x16x32_bf16 v[76:79], v[112:115], a[52:55], v[76:79]
    ds_read_b128 v[104:107], v175 offset:11264
    v_lshlrev_b32 v172, 5, v21
    s_waitcnt lgkmcnt(6)
    v_mfma_f32_16x16x32_bf16 v[80:83], v[116:119], a[52:55], v[80:83]
    ds_read_b128 v[108:111], v175 offset:12288
    s_waitcnt vmcnt(17) lgkmcnt(6)
    v_mfma_f32_16x16x32_bf16 v[64:67], v[84:87], a[56:59], v[64:67]
    ds_read_b128 v[112:115], v175 offset:13312
    s_waitcnt lgkmcnt(6)
    v_mfma_f32_16x16x32_bf16 v[68:71], v[88:91], a[56:59], v[68:71]
    ds_read_b128 v[116:119], v175 offset:14336
    s_waitcnt lgkmcnt(6)
    v_mfma_f32_16x16x32_bf16 v[72:75], v[92:95], a[56:59], v[72:75]
    ds_read_b128 v[84:87], v175 offset:15360
    s_lshl_b32 s94, s44, 12
    v_add_u32 v172, s94, v172
    s_waitcnt lgkmcnt(6)
    v_mfma_f32_16x16x32_bf16 v[76:79], v[96:99], a[56:59], v[76:79]
    s_waitcnt lgkmcnt(5)
    v_mfma_f32_16x16x32_bf16 v[80:83], v[100:103], a[56:59], v[80:83]
    s_waitcnt vmcnt(16) lgkmcnt(4)
    v_mfma_f32_16x16x32_bf16 v[64:67], v[104:107], a[60:63], v[64:67]
    s_waitcnt lgkmcnt(3)
    v_mfma_f32_16x16x32_bf16 v[68:71], v[108:111], a[60:63], v[68:71]
    s_mov_b64 exec, 15
    buffer_load_dword v236, v172, s[40:43], 0 offen offset:128
    s_mov_b64 exec, -1
    s_waitcnt lgkmcnt(2)
    v_mfma_f32_16x16x32_bf16 v[72:75], v[112:115], a[60:63], v[72:75]
    s_waitcnt lgkmcnt(1)
    v_mfma_f32_16x16x32_bf16 v[76:79], v[116:119], a[60:63], v[76:79]
    s_waitcnt lgkmcnt(0)
    v_mfma_f32_16x16x32_bf16 v[80:83], v[84:87], a[60:63], v[80:83]
    s_nop 7
    v_cmp_u_f32 vcc, v80, v80
    s_cbranch_vccz L_ok_13
    s_add_u32 s51, s51, 1
    s_cmp_gt_u32 s51, 200000
    s_cbranch_scc1 L_ok_13
    s_waitcnt vmcnt(0) lgkmcnt(0)
    s_sleep 2
    s_branch L_wo_11
L_ok_13:
    v_cvt_pk_bf16_f32 v40, v64, v65
    v_cvt_pk_bf16_f32 v41, v66, v67
    v_cvt_pk_bf16_f32 v42, v68, v69
    v_cvt_pk_bf16_f32 v43, v70, v71
    v_cvt_pk_bf16_f32 v44, v72, v73
    v_cvt_pk_bf16_f32 v45, v74, v75
    v_cvt_pk_bf16_f32 v46, v76, v77
    v_cvt_pk_bf16_f32 v47, v78, v79
    v_cvt_pk_bf16_f32 v48, v80, v81
    v_cvt_pk_bf16_f32 v49, v82, v83
    v_mov_b32 v200, v40
    v_mov_b32 v201, v41
    v_mov_b32 v202, v42
    v_mov_b32 v203, v43
    v_mov_b32 v204, v44
    v_mov_b32 v205, v45
    v_mov_b32 v206, v46
    v_mov_b32 v207, v47
    v_mov_b32 v208, v48
    v_mov_b32 v209, v49
    v_permlane16_swap_b32 v40, v42
    v_permlane16_swap_b32 v41, v43
    v_permlane16_swap_b32 v44, v46
    v_permlane16_swap_b32 v45, v47
    v_permlane16_swap_b32 v48, v50
    v_permlane16_swap_b32 v49, v51
    s_lshr_b32 s52, s50, 1
    s_mul_i32 s52, s52, 40960
    s_mul_i32 s53, s47, 5120
    s_add_u32 s52, s52, s53
    s_add_u32 s52, s52, 0
    s_add_u32 s53, s52, 4096
    s_lshl_b32 s54, s50, 10
    s_lshl_b32 s55, s47, 7
    s_add_u32 s54, s54, s55
    s_add_u32 s54, s54, 18350080
    buffer_store_dwordx4 v[40:43], v11, s[8:11], s52 offen sc1
    buffer_store_dwordx4 v[44:47], v11, s[8:11], s52 offen offset:2048 sc1
    s_mov_b32 exec_lo, 0xffff
    s_mov_b32 exec_hi, 0xffff
    buffer_store_dwordx4 v[48:51], v11, s[8:11], s53 offen sc1
    s_mov_b64 exec, -1
    v_mov_b32 v164, 0
    v_mov_b32 v165, 0
    v_dot2c_f32_bf16 v164, v200, v22
    v_dot2c_f32_bf16 v165, v200, v200
    v_dot2c_f32_bf16 v164, v201, v22
    v_dot2c_f32_bf16 v165, v201, v201
    v_dot2c_f32_bf16 v164, v202, v22
    v_dot2c_f32_bf16 v165, v202, v202
    v_dot2c_f32_bf16 v164, v203, v22
    v_dot2c_f32_bf16 v165, v203, v203
    v_dot2c_f32_bf16 v164, v204, v22
    v_dot2c_f32_bf16 v165, v204, v204
    v_dot2c_f32_bf16 v164, v205, v22
    v_dot2c_f32_bf16 v165, v205, v205
    v_dot2c_f32_bf16 v164, v206, v22
    v_dot2c_f32_bf16 v165, v206, v206
    v_dot2c_f32_bf16 v164, v207, v22
    v_dot2c_f32_bf16 v165, v207, v207
    v_dot2c_f32_bf16 v164, v208, v22
    v_dot2c_f32_bf16 v165, v208, v208
    v_dot2c_f32_bf16 v164, v209, v22
    v_dot2c_f32_bf16 v165, v209, v209
    s_nop 1
    v_mov_b32 v166, v164
    v_mov_b32 v167, v165
    s_nop 0
    v_permlane16_swap_b32 v164, v166
    v_permlane16_swap_b32 v165, v167
    v_pk_add_f32 v[164:165], v[164:165], v[166:167]
    v_mov_b32 v166, v164
    v_mov_b32 v167, v165
    s_nop 0
    v_permlane32_swap_b32 v164, v166
    v_permlane32_swap_b32 v165, v167
    v_pk_add_f32 v[164:165], v[164:165], v[166:167]
    s_mov_b64 exec, 0xffff
    buffer_store_dwordx2 v[164:165], v12, s[8:11], s54 offen sc1
    s_mov_b64 exec, -1
    s_cmp_lg_u32 s44, 0
    s_cbranch_scc1 L_iok_14
    s_waitcnt vmcnt(4)
    s_mov_b64 exec, 15
    v_cmp_gt_u32 vcc, 64, v236
    s_cbranch_vccz L_iok_14
    v_lshlrev_b32 v170, 5, v21
L_iwp_15:
    buffer_load_dword v236, v170, s[40:43], 0 offen offset:128 sc1
    s_waitcnt vmcnt(0)
    v_cmp_gt_u32 vcc, 64, v236
    s_cbranch_vccz L_ok_16
    s_add_u32 s51, s51, 1
    s_cmp_gt_u32 s51, 200000
    s_cbranch_scc1 L_ok_16
    s_waitcnt vmcnt(0) lgkmcnt(0)
    s_sleep 4
    s_branch L_iwp_15
L_ok_16:
L_iok_14:
    s_mov_b64 exec, -1
    s_barrier
    v_add_u32 v172, s89, v1
    v_add_u32 v173, 0x10000, v172
    s_waitcnt vmcnt(20)
    ds_write_b128 v172, a[208:211] offset:49152
    s_waitcnt vmcnt(19)
    ds_write_b128 v172, a[212:215] offset:53248
    s_waitcnt vmcnt(18)
    ds_write_b128 v172, a[216:219] offset:57344
    s_waitcnt vmcnt(17)
    ds_write_b128 v172, a[220:223] offset:61440
    s_waitcnt vmcnt(16)
    ds_write_b128 v173, a[224:227] offset:0
    s_waitcnt vmcnt(15)
    ds_write_b128 v173, a[228:231] offset:4096
    s_waitcnt vmcnt(14)
    ds_write_b128 v173, a[232:235] offset:8192
    s_waitcnt vmcnt(13)
    ds_write_b128 v173, a[236:239] offset:12288
    s_waitcnt vmcnt(12)
    ds_write_b128 v173, a[240:243] offset:16384
    s_waitcnt vmcnt(11)
    ds_write_b128 v173, a[244:247] offset:20480
    s_waitcnt vmcnt(10)
    ds_write_b128 v173, a[248:251] offset:24576
    s_waitcnt vmcnt(9)
    ds_write_b128 v173, a[252:255] offset:28672
    s_waitcnt vmcnt(8)
    ds_write_b128 v173, v[240:243] offset:32768
    s_waitcnt vmcnt(7)
    ds_write_b128 v173, v[244:247] offset:36864
    s_waitcnt vmcnt(6)
    ds_write_b128 v173, v[248:251] offset:40960
    s_waitcnt vmcnt(5)
    ds_write_b128 v173, v[252:255] offset:45056
    s_mov_b32 s98, s88
    s_mul_i32 s88, s46, 153600
    s_lshl_b32 s89, s44, 10
    s_add_u32 s88, s88, s89
    s_add_u32 s88, s88, 20971520
    s_lshl_b32 s59, s49, 11
    s_add_u32 s59, s59, 18350080
    s_mul_i32 s60, s49, 40960
    s_add_u32 s60, s60, 0
    s_mov_b32 s99, 0
L_qkv_17:
    buffer_load_dwordx2 v[164:165], v13, s[8:11], s59 offen offset:0 sc1
    buffer_load_dwordx2 v[166:167], v13, s[8:11], s59 offen offset:128 sc1
    buffer_load_dwordx2 v[168:169], v13, s[8:11], s59 offen offset:256 sc1
    buffer_load_dwordx2 v[170:171], v13, s[8:11], s59 offen offset:384 sc1
    s_waitcnt vmcnt(0)
    v_pk_add_f32 v[164:165], v[164:165], v[166:167]
    v_pk_add_f32 v[168:169], v[168:169], v[170:171]
    v_pk_add_f32 v[164:165], v[164:165], v[168:169]
    v_cmp_u_f32 vcc, v164, v164
    s_cbranch_vccz L_ok_18
    s_add_u32 s51, s51, 1
    s_cmp_gt_u32 s51, 200000
    s_cbranch_scc1 L_ok_18
    s_waitcnt vmcnt(0) lgkmcnt(0)
    s_sleep 2
    s_branch L_qkv_17
L_ok_18:
    s_add_u32 s61, s60, 0
    buffer_load_dwordx4 a[0:3], v1, s[8:11], s61 offen offset:0 sc1
    buffer_load_dwordx4 a[4:7], v1, s[8:11], s61 offen offset:1024 sc1
    buffer_load_dwordx4 a[8:11], v1, s[8:11], s61 offen offset:2048 sc1
    buffer_load_dwordx4 a[12:15], v1, s[8:11], s61 offen offset:3072 sc1
    s_add_u32 s61, s60, 4096
    buffer_load_dwordx4 a[16:19], v1, s[8:11], s61 offen offset:0 sc1
    buffer_load_dwordx4 a[20:23], v1, s[8:11], s61 offen offset:1024 sc1
    buffer_load_dwordx4 a[24:27], v1, s[8:11], s61 offen offset:2048 sc1
    buffer_load_dwordx4 a[28:31], v1, s[8:11], s61 offen offset:3072 sc1
    s_add_u32 s61, s60, 8192
    buffer_load_dwordx4 a[32:35], v1, s[8:11], s61 offen offset:0 sc1
    buffer_load_dwordx4 a[36:39], v1, s[8:11], s61 offen offset:1024 sc1
    buffer_load_dwordx4 a[40:43], v1, s[8:11], s61 offen offset:2048 sc1
    buffer_load_dwordx4 a[44:47], v1, s[8:11], s61 offen offset:3072 sc1
    s_add_u32 s61, s60, 12288
    buffer_load_dwordx4 a[48:51], v1, s[8:11], s61 offen offset:0 sc1
    buffer_load_dwordx4 a[52:55], v1, s[8:11], s61 offen offset:1024 sc1
    buffer_load_dwordx4 a[56:59], v1, s[8:11], s61 offen offset:2048 sc1
    buffer_load_dwordx4 a[60:63], v1, s[8:11], s61 offen offset:3072 sc1
    v_mov_b32 v166, v164
    v_mov_b32 v167, v165
    s_nop 0
    v_permlane32_swap_b32 v164, v166
    v_permlane32_swap_b32 v165, v167
    v_pk_add_f32 v[164:165], v[164:165], v[166:167]
    s_mov_b32 s56, 0x3acccccd
    v_mul_f32 v210, s56, v164
    v_mul_f32 v0, s56, v165
    v_fma_f32 v0, -v210, v210, v0
    v_max_f32 v0, 0, v0
    v_add_f32 v0, 0x3727c5ac, v0
    v_rsq_f32 v0, v0
    v_sub_f32 v210, 0, v210
    s_waitcnt lgkmcnt(0)
    s_cmp_eq_u32 s99, 0
    s_cbranch_scc0 L_skb_20
    s_barrier
    s_mov_b32 s99, 1
    s_lshl_b32 s52, s44, 10
    v_add_u32 v168, s52, v2
    v_add_u32 v169, 2048, v4
    s_cmp_lt_u32 s44, 2
    s_cselect_b64 vcc, -1, 0
    v_cndmask_b32 v168, v169, v168, vcc
    v_add_u32 v168, 45056, v168
    ds_read_b128 v[52:55], v168 offset:0
    ds_read_b128 v[56:59], v168 offset:2816
    ds_read_b128 v[60:63], v168 offset:5632
    ds_read_b128 v[152:155], v168 offset:8448
    ds_read_b128 v[156:159], v168 offset:11264
    s_waitcnt lgkmcnt(4)
    v_mfma_f32_32x32x16_bf16 v[120:135], v[228:231], v[52:55], v[120:135]
    ds_read_b128 v[160:163], v168 offset:14080
    s_waitcnt lgkmcnt(4)
    v_mfma_f32_32x32x16_bf16 v[120:135], v[228:231], v[56:59], v[120:135]
    ds_read_b128 v[52:55], v168 offset:16896
    s_waitcnt lgkmcnt(4)
    v_mfma_f32_32x32x16_bf16 v[120:135], v[228:231], v[60:63], v[120:135]
    ds_read_b128 v[56:59], v168 offset:19712
    s_waitcnt lgkmcnt(4)
    v_mfma_f32_32x32x16_bf16 v[120:135], v[228:231], v[152:155], v[120:135]
    ds_read_b128 v[60:63], v168 offset:22528
    s_waitcnt lgkmcnt(4)
    v_mfma_f32_32x32x16_bf16 v[120:135], v[228:231], v[156:159], v[120:135]
    ds_read_b128 v[152:155], v168 offset:25344
    s_waitcnt lgkmcnt(4)
    v_mfma_f32_32x32x16_bf16 v[120:135], v[228:231], v[160:163], v[120:135]
    ds_read_b128 v[156:159], v168 offset:28160
    s_waitcnt lgkmcnt(4)
    v_mfma_f32_32x32x16_bf16 v[120:135], v[228:231], v[52:55], v[120:135]
    ds_read_b128 v[160:163], v168 offset:30976
    s_waitcnt lgkmcnt(4)
    v_mfma_f32_32x32x16_bf16 v[120:135], v[228:231], v[56:59], v[120:135]
    ds_read_b128 v[52:55], v168 offset:33792
    s_waitcnt lgkmcnt(4)
    v_mfma_f32_32x32x16_bf16 v[120:135], v[228:231], v[60:63], v[120:135]
    ds_read_b128 v[56:59], v168 offset:36608
    s_waitcnt lgkmcnt(4)
    v_mfma_f32_32x32x16_bf16 v[120:135], v[228:231], v[152:155], v[120:135]
    ds_read_b128 v[60:63], v168 offset:39424
    s_waitcnt lgkmcnt(4)
    v_mfma_f32_32x32x16_bf16 v[120:135], v[228:231], v[156:159], v[120:135]
    ds_read_b128 v[152:155], v168 offset:42240
    s_waitcnt lgkmcnt(4)
    v_mfma_f32_32x32x16_bf16 v[120:135], v[228:231], v[160:163], v[120:135]
    ds_read_b128 v[156:159], v168 offset:45056
    s_waitcnt lgkmcnt(4)
    v_mfma_f32_32x32x16_bf16 v[120:135], v[228:231], v[52:55], v[120:135]
    ds_read_b128 v[160:163], v168 offset:47872
    s_waitcnt lgkmcnt(4)
    v_mfma_f32_32x32x16_bf16 v[120:135], v[228:231], v[56:59], v[120:135]
    ds_read_b128 v[52:55], v168 offset:50688
    s_waitcnt lgkmcnt(4)
    v_mfma_f32_32x32x16_bf16 v[120:135], v[228:231], v[60:63], v[120:135]
    ds_read_b128 v[56:59], v168 offset:53504
    s_waitcnt lgkmcnt(4)
    v_mfma_f32_32x32x16_bf16 v[120:135], v[228:231], v[152:155], v[120:135]
    ds_read_b128 v[60:63], v168 offset:56320
    s_waitcnt lgkmcnt(4)
    v_mfma_f32_32x32x16_bf16 v[120:135], v[228:231], v[156:159], v[120:135]
    ds_read_b128 v[152:155], v168 offset:59136
    s_waitcnt lgkmcnt(4)
    v_mfma_f32_32x32x16_bf16 v[120:135], v[228:231], v[160:163], v[120:135]
    ds_read_b128 v[156:159], v168 offset:61952
    s_waitcnt lgkmcnt(4)
    v_mfma_f32_32x32x16_bf16 v[120:135], v[228:231], v[52:55], v[120:135]
    ds_read_b128 v[160:163], v168 offset:64768
    s_waitcnt lgkmcnt(4)
    v_mfma_f32_32x32x16_bf16 v[120:135], v[228:231], v[56:59], v[120:135]
    s_waitcnt lgkmcnt(3)
    v_mfma_f32_32x32x16_bf16 v[120:135], v[228:231], v[60:63], v[120:135]
    s_waitcnt lgkmcnt(2)
    v_mfma_f32_32x32x16_bf16 v[120:135], v[228:231], v[152:155], v[120:135]
    s_waitcnt lgkmcnt(1)
    v_mfma_f32_32x32x16_bf16 v[120:135], v[228:231], v[156:159], v[120:135]
    s_waitcnt lgkmcnt(0)
    v_mfma_f32_32x32x16_bf16 v[120:135], v[228:231], v[160:163], v[120:135]
    v_bfe_u32 v168, v21, 2, 1
    v_lshlrev_b32 v168, 8, v168
    v_and_b32 v169, 3, v21
    v_lshl_add_u32 v168, v169, 2, v168
    v_bfe_u32 v169, v21, 3, 2
    v_lshl_add_u32 v168, v169, 4, v168
    v_add_u32 v168, 153600, v168
    s_min_u32 s52, s44, 2
    s_lshl_b32 s52, s52, 6
    v_add_u32 v168, s52, v168
    s_mov_b64 exec, 0xffffffff
    s_nop 0
    ds_write_b32 v168, v120 offset:512
    s_mov_b64 exec, -1
    s_waitcnt lgkmcnt(0)
L_skb_20:
    ds_read_b128 v[128:131], v2 offset:0
    ds_read_b128 v[132:135], v2 offset:1024
    ds_read_b128 v[136:139], v4 offset:2048
    ds_read_b128 v[140:143], v2 offset:2816
    ds_read_b128 v[144:147], v2 offset:3840
    ds_read_b128 v[148:151], v4 offset:4864
    s_waitcnt vmcnt(15) lgkmcnt(5)
    v_mfma_f32_32x32x16_bf16 v[64:79], v[128:131], a[0:3], 0
    ds_read_b128 v[152:155], v2 offset:5632
    s_waitcnt lgkmcnt(5)
    v_mfma_f32_32x32x16_bf16 v[80:95], v[132:135], a[0:3], 0
    ds_read_b128 v[156:159], v2 offset:6656
    s_add_u32 s61, s60, 16384
    buffer_load_dwordx4 a[64:67], v1, s[8:11], s61 offen offset:0 sc1
    s_waitcnt lgkmcnt(5)
    v_mfma_f32_32x32x16_bf16 v[96:111], v[136:139], a[0:3], 0
    ds_read_b128 v[160:163], v4 offset:7680
    s_waitcnt vmcnt(15) lgkmcnt(5)
    v_mfma_f32_32x32x16_bf16 v[64:79], v[140:143], a[4:7], v[64:79]
    ds_read_b128 v[128:131], v2 offset:8448
    buffer_load_dwordx4 a[68:71], v1, s[8:11], s61 offen offset:1024 sc1
    s_waitcnt lgkmcnt(5)
    v_mfma_f32_32x32x16_bf16 v[80:95], v[144:147], a[4:7], v[80:95]
    ds_read_b128 v[132:135], v2 offset:9472
    s_waitcnt lgkmcnt(5)
    v_mfma_f32_32x32x16_bf16 v[96:111], v[148:151], a[4:7], v[96:111]
    ds_read_b128 v[136:139], v4 offset:10496
    buffer_load_dwordx4 a[72:75], v1, s[8:11], s61 offen offset:2048 sc1
    s_waitcnt vmcnt(16) lgkmcnt(5)
    v_mfma_f32_32x32x16_bf16 v[64:79], v[152:155], a[8:11], v[64:79]
    ds_read_b128 v[140:143], v2 offset:11264
    s_waitcnt lgkmcnt(5)
    v_mfma_f32_32x32x16_bf16 v[80:95], v[156:159], a[8:11], v[80:95]
    ds_read_b128 v[144:147], v2 offset:12288
    buffer_load_dwordx4 a[76:79], v1, s[8:11], s61 offen offset:3072 sc1
    s_waitcnt lgkmcnt(5)
    v_mfma_f32_32x32x16_bf16 v[96:111], v[160:163], a[8:11], v[96:111]
    ds_read_b128 v[148:151], v4 offset:13312
    s_waitcnt vmcnt(16) lgkmcnt(5)
    v_mfma_f32_32x32x16_bf16 v[64:79], v[128:131], a[12:15], v[64:79]
    ds_read_b128 v[152:155], v2 offset:14080
    s_add_u32 s61, s60, 20480
    buffer_load_dwordx4 a[80:83], v1, s[8:11], s61 offen offset:0 sc1
    s_waitcnt lgkmcnt(5)
    v_mfma_f32_32x32x16_bf16 v[80:95], v[132:135], a[12:15], v[80:95]
    ds_read_b128 v[156:159], v2 offset:15104
    s_waitcnt lgkmcnt(5)
    v_mfma_f32_32x32x16_bf16 v[96:111], v[136:139], a[12:15], v[96:111]
    ds_read_b128 v[160:163], v4 offset:16128
    buffer_load_dwordx4 a[84:87], v1, s[8:11], s61 offen offset:1024 sc1
    s_waitcnt vmcnt(17) lgkmcnt(5)
    v_mfma_f32_32x32x16_bf16 v[64:79], v[140:143], a[16:19], v[64:79]
    ds_read_b128 v[128:131], v2 offset:16896
    s_waitcnt lgkmcnt(5)
    v_mfma_f32_32x32x16_bf16 v[80:95], v[144:147], a[16:19], v[80:95]
    ds_read_b128 v[132:135], v2 offset:17920
    buffer_load_dwordx4 a[88:91], v1, s[8:11], s61 offen offset:2048 sc1
    s_waitcnt lgkmcnt(5)
    v_mfma_f32_32x32x16_bf16 v[96:111], v[148:151], a[16:19], v[96:111]
    ds_read_b128 v[136:139], v4 offset:18944
    s_waitcnt vmcnt(17) lgkmcnt(5)
    v_mfma_f32_32x32x16_bf16 v[64:79], v[152:155], a[20:23], v[64:79]
    ds_read_b128 v[140:143], v2 offset:19712
    buffer_load_dwordx4 a[92:95], v1, s[8:11], s61 offen offset:3072 sc1
    s_waitcnt lgkmcnt(5)
    v_mfma_f32_32x32x16_bf16 v[80:95], v[156:159], a[20:23], v[80:95]
    ds_read_b128 v[144:147], v2 offset:20736
    s_waitcnt lgkmcnt(5)
    v_mfma_f32_32x32x16_bf16 v[96:111], v[160:163], a[20:23], v[96:111]
    ds_read_b128 v[148:151], v4 offset:21760
    s_add_u32 s61, s60, 24576
    buffer_load_dwordx4 a[96:99], v1, s[8:11], s61 offen offset:0 sc1
    s_waitcnt vmcnt(18) lgkmcnt(5)
    v_mfma_f32_32x32x16_bf16 v[64:79], v[128:131], a[24:27], v[64:79]
    ds_read_b128 v[152:155], v2 offset:22528
    s_waitcnt lgkmcnt(5)
    v_mfma_f32_32x32x16_bf16 v[80:95], v[132:135], a[24:27], v[80:95]
    ds_read_b128 v[156:159], v2 offset:23552
    buffer_load_dwordx4 a[100:103], v1, s[8:11], s61 offen offset:1024 sc1
    s_waitcnt lgkmcnt(5)
    v_mfma_f32_32x32x16_bf16 v[96:111], v[136:139], a[24:27], v[96:111]
    ds_read_b128 v[160:163], v4 offset:24576
    s_waitcnt vmcnt(18) lgkmcnt(5)
    v_mfma_f32_32x32x16_bf16 v[64:79], v[140:143], a[28:31], v[64:79]
    ds_read_b128 v[128:131], v2 offset:25344
    buffer_load_dwordx4 a[104:107], v1, s[8:11], s61 offen offset:2048 sc1
    s_waitcnt lgkmcnt(5)
    v_mfma_f32_32x32x16_bf16 v[80:95], v[144:147], a[28:31], v[80:95]
    ds_read_b128 v[132:135], v2 offset:26368
    s_waitcnt lgkmcnt(5)
    v_mfma_f32_32x32x16_bf16 v[96:111], v[148:151], a[28:31], v[96:111]
    ds_read_b128 v[136:139], v4 offset:27392
    buffer_load_dwordx4 a[108:111], v1, s[8:11], s61 offen offset:3072 sc1
    s_waitcnt vmcnt(19) lgkmcnt(5)
    v_mfma_f32_32x32x16_bf16 v[64:79], v[152:155], a[32:35], v[64:79]
    ds_read_b128 v[140:143], v2 offset:28160
    s_waitcnt lgkmcnt(5)
    v_mfma_f32_32x32x16_bf16 v[80:95], v[156:159], a[32:35], v[80:95]
    ds_read_b128 v[144:147], v2 offset:29184
    s_add_u32 s61, s60, 28672
    buffer_load_dwordx4 a[112:115], v1, s[8:11], s61 offen offset:0 sc1
    s_waitcnt lgkmcnt(5)
    v_mfma_f32_32x32x16_bf16 v[96:111], v[160:163], a[32:35], v[96:111]
    ds_read_b128 v[148:151], v4 offset:30208
    s_waitcnt vmcnt(19) lgkmcnt(5)
    v_mfma_f32_32x32x16_bf16 v[64:79], v[128:131], a[36:39], v[64:79]
    ds_read_b128 v[152:155], v2 offset:30976
    buffer_load_dwordx4 a[116:119], v1, s[8:11], s61 offen offset:1024 sc1
    s_waitcnt lgkmcnt(5)
    v_mfma_f32_32x32x16_bf16 v[80:95], v[132:135], a[36:39], v[80:95]
    ds_read_b128 v[156:159], v2 offset:32000
    s_waitcnt lgkmcnt(5)
    v_mfma_f32_32x32x16_bf16 v[96:111], v[136:139], a[36:39], v[96:111]
    ds_read_b128 v[160:163], v4 offset:33024
    buffer_load_dwordx4 a[120:123], v1, s[8:11], s61 offen offset:2048 sc1
    s_waitcnt vmcnt(20) lgkmcnt(5)
    v_mfma_f32_32x32x16_bf16 v[64:79], v[140:143], a[40:43], v[64:79]
    ds_read_b128 v[128:131], v2 offset:33792
    s_waitcnt lgkmcnt(5)
    v_mfma_f32_32x32x16_bf16 v[80:95], v[144:147], a[40:43], v[80:95]
    ds_read_b128 v[132:135], v2 offset:34816
    buffer_load_dwordx4 a[124:127], v1, s[8:11], s61 offen offset:3072 sc1
    s_waitcnt lgkmcnt(5)
    v_mfma_f32_32x32x16_bf16 v[96:111], v[148:151], a[40:43], v[96:111]
    ds_read_b128 v[136:139], v4 offset:35840
    s_waitcnt vmcnt(20) lgkmcnt(5)
    v_mfma_f32_32x32x16_bf16 v[64:79], v[152:155], a[44:47], v[64:79]
    ds_read_b128 v[140:143], v2 offset:36608
    s_add_u32 s61, s60, 32768
    buffer_load_dwordx4 a[128:131], v1, s[8:11], s61 offen offset:0 sc1
    s_waitcnt lgkmcnt(5)
    v_mfma_f32_32x32x16_bf16 v[80:95], v[156:159], a[44:47], v[80:95]
    ds_read_b128 v[144:147], v2 offset:37632
    s_waitcnt lgkmcnt(5)
    v_mfma_f32_32x32x16_bf16 v[96:111], v[160:163], a[44:47], v[96:111]
    ds_read_b128 v[148:151], v4 offset:38656
    buffer_load_dwordx4 a[132:135], v1, s[8:11], s61 offen offset:1024 sc1
    s_waitcnt vmcnt(21) lgkmcnt(5)
    v_mfma_f32_32x32x16_bf16 v[64:79], v[128:131], a[48:51], v[64:79]
    ds_read_b128 v[152:155], v2 offset:39424
    s_waitcnt lgkmcnt(5)
    v_mfma_f32_32x32x16_bf16 v[80:95], v[132:135], a[48:51], v[80:95]
    ds_read_b128 v[156:159], v2 offset:40448
    buffer_load_dwordx4 a[136:139], v1, s[8:11], s61 offen offset:2048 sc1
    s_waitcnt lgkmcnt(5)
    v_mfma_f32_32x32x16_bf16 v[96:111], v[136:139], a[48:51], v[96:111]
    ds_read_b128 v[160:163], v4 offset:41472
    s_waitcnt vmcnt(21) lgkmcnt(5)
    v_mfma_f32_32x32x16_bf16 v[64:79], v[140:143], a[52:55], v[64:79]
    ds_read_b128 v[128:131], v2 offset:42240
    buffer_load_dwordx4 a[140:143], v1, s[8:11], s61 offen offset:3072 sc1
    s_waitcnt lgkmcnt(5)
    v_mfma_f32_32x32x16_bf16 v[80:95], v[144:147], a[52:55], v[80:95]
    ds_read_b128 v[132:135], v2 offset:43264
    s_waitcnt lgkmcnt(5)
    v_mfma_f32_32x32x16_bf16 v[96:111], v[148:151], a[52:55], v[96:111]
    ds_read_b128 v[136:139], v4 offset:44288
    s_add_u32 s61, s60, 36864
    buffer_load_dwordx4 a[144:147], v1, s[8:11], s61 offen offset:0 sc1
    s_waitcnt vmcnt(22) lgkmcnt(5)
    v_mfma_f32_32x32x16_bf16 v[64:79], v[152:155], a[56:59], v[64:79]
    ds_read_b128 v[140:143], v2 offset:45056
    s_waitcnt lgkmcnt(5)
    v_mfma_f32_32x32x16_bf16 v[80:95], v[156:159], a[56:59], v[80:95]
    ds_read_b128 v[144:147], v2 offset:46080
    buffer_load_dwordx4 a[148:151], v1, s[8:11], s61 offen offset:1024 sc1
    s_waitcnt lgkmcnt(5)
    v_mfma_f32_32x32x16_bf16 v[96:111], v[160:163], a[56:59], v[96:111]
    ds_read_b128 v[148:151], v4 offset:47104
    s_waitcnt vmcnt(22) lgkmcnt(5)
    v_mfma_f32_32x32x16_bf16 v[64:79], v[128:131], a[60:63], v[64:79]
    ds_read_b128 v[152:155], v2 offset:47872
    buffer_load_dwordx4 a[152:155], v1, s[8:11], s61 offen offset:2048 sc1
    s_waitcnt lgkmcnt(5)
    v_mfma_f32_32x32x16_bf16 v[80:95], v[132:135], a[60:63], v[80:95]
    ds_read_b128 v[156:159], v2 offset:48896
    s_waitcnt lgkmcnt(5)
    v_mfma_f32_32x32x16_bf16 v[96:111], v[136:139], a[60:63], v[96:111]
    ds_read_b128 v[160:163], v4 offset:49920
    buffer_load_dwordx4 a[156:159], v1, s[8:11], s61 offen offset:3072 sc1
    s_waitcnt vmcnt(23) lgkmcnt(5)
    v_mfma_f32_32x32x16_bf16 v[64:79], v[140:143], a[64:67], v[64:79]
    ds_read_b128 v[128:131], v2 offset:50688
    s_waitcnt lgkmcnt(5)
    v_mfma_f32_32x32x16_bf16 v[80:95], v[144:147], a[64:67], v[80:95]
    ds_read_b128 v[132:135], v2 offset:51712
    s_add_u32 s94, s89, 114688
    s_mov_b32 m0, s94
    s_add_u32 s95, s98, 114688
    buffer_load_dwordx4 v1, s[8:11], s95 offen lds
    s_waitcnt lgkmcnt(5)
    v_mfma_f32_32x32x16_bf16 v[96:111], v[148:151], a[64:67], v[96:111]
    ds_read_b128 v[136:139], v4 offset:52736
    s_waitcnt vmcnt(23) lgkmcnt(5)
    v_mfma_f32_32x32x16_bf16 v[64:79], v[152:155], a[68:71], v[64:79]
    ds_read_b128 v[140:143], v2 offset:53504
    s_add_u32 s94, s89, 118784
    s_mov_b32 m0, s94
    s_add_u32 s95, s98, 118784
    buffer_load_dwordx4 v1, s[8:11], s95 offen lds
    s_waitcnt lgkmcnt(5)
    v_mfma_f32_32x32x16_bf16 v[80:95], v[156:159], a[68:71], v[80:95]
    ds_read_b128 v[144:147], v2 offset:54528
    s_waitcnt lgkmcnt(5)
    v_mfma_f32_32x32x16_bf16 v[96:111], v[160:163], a[68:71], v[96:111]
    ds_read_b128 v[148:151], v4 offset:55552
    s_add_u32 s94, s89, 122880
    s_mov_b32 m0, s94
    s_add_u32 s95, s98, 122880
    buffer_load_dwordx4 v1, s[8:11], s95 offen lds
    s_waitcnt vmcnt(24) lgkmcnt(5)
    v_mfma_f32_32x32x16_bf16 v[64:79], v[128:131], a[72:75], v[64:79]
    ds_read_b128 v[152:155], v3 offset:0
    s_waitcnt lgkmcnt(5)
    v_mfma_f32_32x32x16_bf16 v[80:95], v[132:135], a[72:75], v[80:95]
    ds_read_b128 v[156:159], v3 offset:1024
    s_add_u32 s94, s89, 126976
    s_mov_b32 m0, s94
    s_add_u32 s95, s98, 126976
    buffer_load_dwordx4 v1, s[8:11], s95 offen lds
    s_waitcnt lgkmcnt(5)
    v_mfma_f32_32x32x16_bf16 v[96:111], v[136:139], a[72:75], v[96:111]
    ds_read_b128 v[160:163], v5 offset:2048
    s_waitcnt vmcnt(24) lgkmcnt(5)
    v_mfma_f32_32x32x16_bf16 v[64:79], v[140:143], a[76:79], v[64:79]
    ds_read_b128 v[128:131], v3 offset:2816
    s_add_u32 s94, s89, 131072
    s_mov_b32 m0, s94
    s_add_u32 s95, s98, 131072
    buffer_load_dwordx4 v1, s[8:11], s95 offen lds
    s_waitcnt lgkmcnt(5)
    v_mfma_f32_32x32x16_bf16 v[80:95], v[144:147], a[76:79], v[80:95]
    ds_read_b128 v[132:135], v3 offset:3840
    s_waitcnt lgkmcnt(5)
    v_mfma_f32_32x32x16_bf16 v[96:111], v[148:151], a[76:79], v[96:111]
    ds_read_b128 v[136:139], v5 offset:4864
    s_add_u32 s94, s89, 135168
    s_mov_b32 m0, s94
    s_add_u32 s95, s98, 135168
    buffer_load_dwordx4 v1, s[8:11], s95 offen lds
    s_waitcnt vmcnt(25) lgkmcnt(5)
    v_mfma_f32_32x32x16_bf16 v[64:79], v[152:155], a[80:83], v[64:79]
    ds_read_b128 v[140:143], v3 offset:5632
    s_waitcnt lgkmcnt(5)
    v_mfma_f32_32x32x16_bf16 v[80:95], v[156:159], a[80:83], v[80:95]
    ds_read_b128 v[144:147], v3 offset:6656
    s_add_u32 s94, s89, 139264
    s_mov_b32 m0, s94
    s_add_u32 s95, s98, 139264
    buffer_load_dwordx4 v1, s[8:11], s95 offen lds
    s_waitcnt lgkmcnt(5)
    v_mfma_f32_32x32x16_bf16 v[96:111], v[160:163], a[80:83], v[96:111]
    ds_read_b128 v[148:151], v5 offset:7680
    s_waitcnt vmcnt(25) lgkmcnt(5)
    v_mfma_f32_32x32x16_bf16 v[64:79], v[128:131], a[84:87], v[64:79]
    ds_read_b128 v[152:155], v3 offset:8448
    s_add_u32 s94, s89, 143360
    s_mov_b32 m0, s94
    s_add_u32 s95, s98, 143360
    buffer_load_dwordx4 v1, s[8:11], s95 offen lds
    s_waitcnt lgkmcnt(5)
    v_mfma_f32_32x32x16_bf16 v[80:95], v[132:135], a[84:87], v[80:95]
    ds_read_b128 v[156:159], v3 offset:9472
    s_waitcnt lgkmcnt(5)
    v_mfma_f32_32x32x16_bf16 v[96:111], v[136:139], a[84:87], v[96:111]
    ds_read_b128 v[160:163], v5 offset:10496
    s_add_u32 s94, s89, 147456
    s_mov_b32 m0, s94
    s_add_u32 s95, s98, 147456
    buffer_load_dwordx4 v1, s[8:11], s95 offen lds
    s_waitcnt vmcnt(26) lgkmcnt(5)
    v_mfma_f32_32x32x16_bf16 v[64:79], v[140:143], a[88:91], v[64:79]
    ds_read_b128 v[128:131], v3 offset:11264
    s_waitcnt lgkmcnt(5)
    v_mfma_f32_32x32x16_bf16 v[80:95], v[144:147], a[88:91], v[80:95]
    ds_read_b128 v[132:135], v3 offset:12288
    s_add_u32 s94, s89, 151552
    s_cmp_lt_u32 s44, 2
    s_cselect_b32 s94, s94, 0x30000
    s_mov_b32 m0, s94
    s_add_u32 s95, s98, 151552
    buffer_load_dwordx4 v1, s[8:11], s95 offen lds
    v_mov_b32 v228, -1
    v_mov_b32 v229, -1
    s_waitcnt lgkmcnt(5)
    v_mfma_f32_32x32x16_bf16 v[96:111], v[148:151], a[88:91], v[96:111]
    ds_read_b128 v[136:139], v5 offset:13312
    v_mov_b32 v230, -1
    v_mov_b32 v231, -1
    s_waitcnt vmcnt(26) lgkmcnt(5)
    v_mfma_f32_32x32x16_bf16 v[64:79], v[152:155], a[92:95], v[64:79]
    ds_read_b128 v[140:143], v3 offset:14080
    v_lshrrev_b32 v172, 5, v21
    v_lshlrev_b32 v173, 1, v12
    s_waitcnt lgkmcnt(5)
    v_mfma_f32_32x32x16_bf16 v[80:95], v[156:159], a[92:95], v[80:95]
    ds_read_b128 v[144:147], v3 offset:15104
    v_lshl_add_u32 v172, v172, 8, v173
    s_waitcnt lgkmcnt(5)
    v_mfma_f32_32x32x16_bf16 v[96:111], v[160:163], a[92:95], v[96:111]
    ds_read_b128 v[148:151], v5 offset:16128
    s_lshl_b32 s70, s45, 4
    s_add_u32 s70, s70, s46
    s_lshl_b32 s70, s70, 12
    s_add_u32 s70, s70, 28966912
    s_cmp_eq_u32 s44, 3
    s_cselect_b32 s72, 0xffff0000, 0
    s_mov_b32 exec_lo, s72
    s_mov_b32 exec_hi, s72
    s_cbranch_scc0 L_hs_19
    buffer_store_dwordx4 v[228:231], v172, s[8:11], s70 offen offset:0 sc1
    buffer_store_dwordx4 v[228:231], v172, s[8:11], s70 offen offset:512 sc1
    buffer_store_dwordx4 v[228:231], v172, s[8:11], s70 offen offset:1024 sc1
    buffer_store_dwordx4 v[228:231], v172, s[8:11], s70 offen offset:1536 sc1
    buffer_store_dwordx4 v[228:231], v172, s[8:11], s70 offen offset:2048 sc1
    buffer_store_dwordx4 v[228:231], v172, s[8:11], s70 offen offset:2560 sc1
    buffer_store_dwordx4 v[228:231], v172, s[8:11], s70 offen offset:3072 sc1
    buffer_store_dwordx4 v[228:231], v172, s[8:11], s70 offen offset:3584 sc1
L_hs_19:
    s_mov_b64 exec, -1
    s_waitcnt vmcnt(25) lgkmcnt(5)
    v_mfma_f32_32x32x16_bf16 v[64:79], v[128:131], a[96:99], v[64:79]
    ds_read_b128 v[152:155], v3 offset:16896
    s_waitcnt lgkmcnt(5)
    v_mfma_f32_32x32x16_bf16 v[80:95], v[132:135], a[96:99], v[80:95]
    ds_read_b128 v[156:159], v3 offset:17920
    s_lshr_b32 s70, s50, 1
    s_mul_i32 s70, s70, 40960
    s_mul_i32 s71, s47, 5120
    s_add_u32 s70, s70, s71
    s_add_u32 s70, s70, 2621440
    s_add_u32 s71, s70, 4096
    s_lshl_b32 s72, s50, 10
    s_lshl_b32 s73, s47, 7
    s_add_u32 s72, s72, s73
    s_add_u32 s72, s72, 18481152
    buffer_store_dwordx4 v[228:231], v11, s[8:11], s70 offen sc1
    s_waitcnt lgkmcnt(5)
    v_mfma_f32_32x32x16_bf16 v[96:111], v[136:139], a[96:99], v[96:111]
    ds_read_b128 v[160:163], v5 offset:18944
    s_waitcnt vmcnt(25) lgkmcnt(5)
    v_mfma_f32_32x32x16_bf16 v[64:79], v[140:143], a[100:103], v[64:79]
    ds_read_b128 v[128:131], v3 offset:19712
    buffer_store_dwordx4 v[228:231], v11, s[8:11], s70 offen offset:2048 sc1
    s_waitcnt lgkmcnt(5)
    v_mfma_f32_32x32x16_bf16 v[80:95], v[144:147], a[100:103], v[80:95]
    ds_read_b128 v[132:135], v3 offset:20736
    s_waitcnt lgkmcnt(5)
    v_mfma_f32_32x32x16_bf16 v[96:111], v[148:151], a[100:103], v[96:111]
    ds_read_b128 v[136:139], v5 offset:21760
    s_mov_b32 exec_lo, 0xffff
    s_mov_b32 exec_hi, 0xffff
    buffer_store_dwordx4 v[228:231], v11, s[8:11], s71 offen sc1
    s_mov_b64 exec, 0xffff
    buffer_store_dwordx2 v[228:229], v12, s[8:11], s72 offen sc1
    s_mov_b64 exec, -1
    v_lshrrev_b32 v172, 4, v21
    v_mul_u32_u24 v172, 384, v172
    s_waitcnt vmcnt(27) lgkmcnt(5)
    v_mfma_f32_32x32x16_bf16 v[64:79], v[152:155], a[104:107], v[64:79]
    ds_read_b128 v[140:143], v3 offset:22528
    v_and_b32 v173, 15, v21
    v_lshl_add_u32 v172, v173, 4, v172
    s_waitcnt lgkmcnt(5)
    v_mfma_f32_32x32x16_bf16 v[80:95], v[156:159], a[104:107], v[80:95]
    ds_read_b128 v[144:147], v3 offset:23552
    s_lshl_b32 s70, s46, 4
    s_add_u32 s70, s70, s45
    s_lshl_b32 s70, s70, 12
    s_add_u32 s70, s70, 19791872
    s_lshr_b32 s71, s44, 1
    s_mul_i32 s71, s71, 1920
    s_add_u32 s70, s70, s71
    s_and_b32 s71, s44, 1
    s_lshl_b32 s72, s71, 8
    s_add_u32 s70, s70, s72
    s_cmp_eq_u32 s71, 0
    s_cselect_b32 s72, -1, 0x00ff00ff
    s_and_b32 s73, s72, 0xffff
    s_mov_b32 exec_lo, s72
    s_mov_b32 exec_hi, s72
    buffer_store_dwordx4 v[228:231], v172, s[8:11], s70 offen sc1
    s_mov_b32 exec_lo, s73
    s_mov_b32 exec_hi, 0
    buffer_store_dwordx4 v[228:231], v172, s[8:11], s70 offen offset:1536 sc1
    s_mov_b64 exec, -1
    s_waitcnt lgkmcnt(5)
    v_mfma_f32_32x32x16_bf16 v[96:111], v[160:163], a[104:107], v[96:111]
    ds_read_b128 v[148:151], v5 offset:24576
    s_waitcnt vmcnt(28) lgkmcnt(5)
    v_mfma_f32_32x32x16_bf16 v[64:79], v[128:131], a[108:111], v[64:79]
    ds_read_b128 v[152:155], v3 offset:25344
    s_mul_i32 s70, s49, 40960
    s_lshl_b32 s71, s46, 10
    s_add_u32 s70, s70, 13107200
    s_add_u32 s71, s71, s70
    s_lshl_b32 s72, s46, 8
    s_add_u32 s72, s72, s70
    s_add_u32 s72, s72, 16384
    buffer_store_dwordx4 v[228:231], v14, s[8:11], s71 offen sc1
    s_waitcnt lgkmcnt(5)
    v_mfma_f32_32x32x16_bf16 v[80:95], v[132:135], a[108:111], v[80:95]
    ds_read_b128 v[156:159], v3 offset:26368
    s_waitcnt lgkmcnt(5)
    v_mfma_f32_32x32x16_bf16 v[96:111], v[136:139], a[108:111], v[96:111]
    ds_read_b128 v[160:163], v5 offset:27392
    buffer_store_dwordx4 v[228:231], v14, s[8:11], s71 offen offset:256 sc1
    s_waitcnt vmcnt(29) lgkmcnt(5)
    v_mfma_f32_32x32x16_bf16 v[64:79], v[140:143], a[112:115], v[64:79]
    ds_read_b128 v[128:131], v3 offset:28160
    s_waitcnt lgkmcnt(5)
    v_mfma_f32_32x32x16_bf16 v[80:95], v[144:147], a[112:115], v[80:95]
    ds_read_b128 v[132:135], v3 offset:29184
    s_mov_b64 exec, 0xffffffff
    buffer_store_dwordx4 v[228:231], v14, s[8:11], s72 offen sc1
    s_mov_b64 exec, -1
    s_waitcnt lgkmcnt(5)
    v_mfma_f32_32x32x16_bf16 v[96:111], v[148:151], a[112:115], v[96:111]
    ds_read_b128 v[136:139], v5 offset:30208
    s_waitcnt vmcnt(29) lgkmcnt(5)
    v_mfma_f32_32x32x16_bf16 v[64:79], v[152:155], a[116:119], v[64:79]
    ds_read_b128 v[140:143], v3 offset:30976
    s_add_u32 s95, s88, 0
    buffer_load_dwordx4 a[160:163], v1, s[8:11], s95 offen
    s_waitcnt lgkmcnt(5)
    v_mfma_f32_32x32x16_bf16 v[80:95], v[156:159], a[116:119], v[80:95]
    ds_read_b128 v[144:147], v3 offset:32000
    s_waitcnt lgkmcnt(5)
    v_mfma_f32_32x32x16_bf16 v[96:111], v[160:163], a[116:119], v[96:111]
    ds_read_b128 v[148:151], v5 offset:33024
    s_add_u32 s95, s88, 4096
    buffer_load_dwordx4 a[164:167], v1, s[8:11], s95 offen
    s_waitcnt vmcnt(30) lgkmcnt(5)
    v_mfma_f32_32x32x16_bf16 v[64:79], v[128:131], a[120:123], v[64:79]
    ds_read_b128 v[152:155], v3 offset:33792
    s_waitcnt lgkmcnt(5)
    v_mfma_f32_32x32x16_bf16 v[80:95], v[132:135], a[120:123], v[80:95]
    ds_read_b128 v[156:159], v3 offset:34816
    s_add_u32 s95, s88, 8192
    buffer_load_dwordx4 a[168:171], v1, s[8:11], s95 offen
    s_waitcnt lgkmcnt(5)
    v_mfma_f32_32x32x16_bf16 v[96:111], v[136:139], a[120:123], v[96:111]
    ds_read_b128 v[160:163], v5 offset:35840
    s_waitcnt vmcnt(30) lgkmcnt(5)
    v_mfma_f32_32x32x16_bf16 v[64:79], v[140:143], a[124:127], v[64:79]
    ds_read_b128 v[128:131], v3 offset:36608
    s_add_u32 s95, s88, 12288
    buffer_load_dwordx4 a[172:175], v1, s[8:11], s95 offen
    s_waitcnt lgkmcnt(5)
    v_mfma_f32_32x32x16_bf16 v[80:95], v[144:147], a[124:127], v[80:95]
    ds_read_b128 v[132:135], v3 offset:37632
    s_waitcnt lgkmcnt(5)
    v_mfma_f32_32x32x16_bf16 v[96:111], v[148:151], a[124:127], v[96:111]
    ds_read_b128 v[136:139], v5 offset:38656
    s_add_u32 s95, s88, 16384
    buffer_load_dwordx4 a[176:179], v1, s[8:11], s95 offen
    s_waitcnt vmcnt(31) lgkmcnt(5)
    v_mfma_f32_32x32x16_bf16 v[64:79], v[152:155], a[128:131], v[64:79]
    ds_read_b128 v[140:143], v3 offset:39424
    s_waitcnt lgkmcnt(5)
    v_mfma_f32_32x32x16_bf16 v[80:95], v[156:159], a[128:131], v[80:95]
    ds_read_b128 v[144:147], v3 offset:40448
    s_add_u32 s95, s88, 20480
    buffer_load_dwordx4 a[180:183], v1, s[8:11], s95 offen
    s_waitcnt lgkmcnt(5)
    v_mfma_f32_32x32x16_bf16 v[96:111], v[160:163], a[128:131], v[96:111]
    ds_read_b128 v[148:151], v5 offset:41472
    s_waitcnt vmcnt(31) lgkmcnt(5)
    v_mfma_f32_32x32x16_bf16 v[64:79], v[128:131], a[132:135], v[64:79]
    ds_read_b128 v[152:155], v3 offset:42240
    s_add_u32 s95, s88, 24576
    buffer_load_dwordx4 a[184:187], v1, s[8:11], s95 offen
    s_waitcnt lgkmcnt(5)
    v_mfma_f32_32x32x16_bf16 v[80:95], v[132:135], a[132:135], v[80:95]
    ds_read_b128 v[156:159], v3 offset:43264
    s_waitcnt lgkmcnt(5)
    v_mfma_f32_32x32x16_bf16 v[96:111], v[136:139], a[132:135], v[96:111]
    ds_read_b128 v[160:163], v5 offset:44288
    s_add_u32 s95, s88, 28672
    buffer_load_dwordx4 a[188:191], v1, s[8:11], s95 offen
    s_waitcnt vmcnt(32) lgkmcnt(5)
    v_mfma_f32_32x32x16_bf16 v[64:79], v[140:143], a[136:139], v[64:79]
    ds_read_b128 v[128:131], v3 offset:45056
    s_waitcnt lgkmcnt(5)
    v_mfma_f32_32x32x16_bf16 v[80:95], v[144:147], a[136:139], v[80:95]
    ds_read_b128 v[132:135], v3 offset:46080
    s_add_u32 s95, s88, 32768
    buffer_load_dwordx4 a[192:195], v1, s[8:11], s95 offen
    s_waitcnt lgkmcnt(5)
    v_mfma_f32_32x32x16_bf16 v[96:111], v[148:151], a[136:139], v[96:111]
    ds_read_b128 v[136:139], v5 offset:47104
    s_waitcnt vmcnt(32) lgkmcnt(5)
    v_mfma_f32_32x32x16_bf16 v[64:79], v[152:155], a[140:143], v[64:79]
    ds_read_b128 v[140:143], v3 offset:47872
    s_add_u32 s95, s88, 36864
    buffer_load_dwordx4 a[196:199], v1, s[8:11], s95 offen
    s_waitcnt lgkmcnt(5)
    v_mfma_f32_32x32x16_bf16 v[80:95], v[156:159], a[140:143], v[80:95]
    ds_read_b128 v[144:147], v3 offset:48896
    s_waitcnt lgkmcnt(5)
    v_mfma_f32_32x32x16_bf16 v[96:111], v[160:163], a[140:143], v[96:111]
    ds_read_b128 v[148:151], v5 offset:49920
    s_add_u32 s95, s88, 40960
    buffer_load_dwordx4 a[200:203], v1, s[8:11], s95 offen
    s_waitcnt vmcnt(33) lgkmcnt(5)
    v_mfma_f32_32x32x16_bf16 v[64:79], v[128:131], a[144:147], v[64:79]
    ds_read_b128 v[152:155], v3 offset:50688
    s_waitcnt lgkmcnt(5)
    v_mfma_f32_32x32x16_bf16 v[80:95], v[132:135], a[144:147], v[80:95]
    ds_read_b128 v[156:159], v3 offset:51712
    s_add_u32 s95, s88, 45056
    buffer_load_dwordx4 a[204:207], v1, s[8:11], s95 offen
    s_waitcnt lgkmcnt(5)
    v_mfma_f32_32x32x16_bf16 v[96:111], v[136:139], a[144:147], v[96:111]
    ds_read_b128 v[160:163], v5 offset:52736
    s_waitcnt vmcnt(33) lgkmcnt(5)
    v_mfma_f32_32x32x16_bf16 v[64:79], v[140:143], a[148:151], v[64:79]
    ds_read_b128 v[128:131], v3 offset:53504
    s_add_u32 s95, s88, 49152
    buffer_load_dwordx4 a[208:211], v1, s[8:11], s95 offen
    s_waitcnt lgkmcnt(5)
    v_mfma_f32_32x32x16_bf16 v[80:95], v[144:147], a[148:151], v[80:95]
    ds_read_b128 v[132:135], v3 offset:54528
    s_waitcnt lgkmcnt(5)
    v_mfma_f32_32x32x16_bf16 v[96:111], v[148:151], a[148:151], v[96:111]
    ds_read_b128 v[136:139], v5 offset:55552
    s_add_u32 s95, s88, 53248
    buffer_load_dwordx4 a[212:215], v1, s[8:11], s95 offen
    s_waitcnt vmcnt(34) lgkmcnt(5)
    v_mfma_f32_32x32x16_bf16 v[64:79], v[152:155], a[152:155], v[64:79]
    s_waitcnt lgkmcnt(4)
    v_mfma_f32_32x32x16_bf16 v[80:95], v[156:159], a[152:155], v[80:95]
    s_add_u32 s95, s88, 57344
    buffer_load_dwordx4 a[216:219], v1, s[8:11], s95 offen
    s_waitcnt lgkmcnt(3)
    v_mfma_f32_32x32x16_bf16 v[96:111], v[160:163], a[152:155], v[96:111]
    s_waitcnt vmcnt(34) lgkmcnt(2)
    v_mfma_f32_32x32x16_bf16 v[64:79], v[128:131], a[156:159], v[64:79]
    s_add_u32 s95, s88, 61440
    buffer_load_dwordx4 a[220:223], v1, s[8:11], s95 offen
    s_waitcnt lgkmcnt(1)
    v_mfma_f32_32x32x16_bf16 v[80:95], v[132:135], a[156:159], v[80:95]
    s_waitcnt lgkmcnt(0)
    v_mfma_f32_32x32x16_bf16 v[96:111], v[136:139], a[156:159], v[96:111]
    s_add_u32 s95, s88, 65536
    buffer_load_dwordx4 a[224:227], v1, s[8:11], s95 offen
    s_nop 9
    v_cmp_u_f32 vcc, v96, v96
    s_cbranch_vccz L_ok_21
    s_add_u32 s51, s51, 1
    s_cmp_gt_u32 s51, 200000
    s_cbranch_scc1 L_ok_21
    s_waitcnt vmcnt(0) lgkmcnt(0)
    s_sleep 2
    s_branch L_qkv_17
L_ok_21:
    s_waitcnt vmcnt(26)
    s_waitcnt lgkmcnt(0)
    s_barrier
    ds_read_b128 v[120:123], v19 offset:512
    ds_read_b128 v[124:127], v19 offset:528
    ds_read_b128 v[128:131], v19 offset:544
    ds_read_b128 v[132:135], v19 offset:560
    ds_read_b128 v[136:139], v19 offset:576
    ds_read_b128 v[140:143], v19 offset:592
    ds_read_b128 v[144:147], v19 offset:608
    ds_read_b128 v[148:151], v19 offset:624
    ds_read_b128 v[212:215], v19 offset:640
    ds_read_b128 v[216:219], v19 offset:656
    ds_read_b128 v[220:223], v19 offset:672
    ds_read_b128 v[224:227], v19 offset:688
    s_waitcnt lgkmcnt(8)
    v_pk_fma_f32 v[64:65], v[120:121], v[210:211], v[64:65] op_sel_hi:[1,0,1]
    v_pk_fma_f32 v[66:67], v[122:123], v[210:211], v[66:67] op_sel_hi:[1,0,1]
    v_pk_fma_f32 v[68:69], v[124:125], v[210:211], v[68:69] op_sel_hi:[1,0,1]
    v_pk_fma_f32 v[70:71], v[126:127], v[210:211], v[70:71] op_sel_hi:[1,0,1]
    v_pk_fma_f32 v[72:73], v[128:129], v[210:211], v[72:73] op_sel_hi:[1,0,1]
    v_pk_fma_f32 v[74:75], v[130:131], v[210:211], v[74:75] op_sel_hi:[1,0,1]
    v_pk_fma_f32 v[76:77], v[132:133], v[210:211], v[76:77] op_sel_hi:[1,0,1]
    v_pk_fma_f32 v[78:79], v[134:135], v[210:211], v[78:79] op_sel_hi:[1,0,1]
    s_waitcnt lgkmcnt(4)
    v_pk_fma_f32 v[80:81], v[136:137], v[210:211], v[80:81] op_sel_hi:[1,0,1]
    v_pk_fma_f32 v[82:83], v[138:139], v[210:211], v[82:83] op_sel_hi:[1,0,1]
    v_pk_fma_f32 v[84:85], v[140:141], v[210:211], v[84:85] op_sel_hi:[1,0,1]
    v_pk_fma_f32 v[86:87], v[142:143], v[210:211], v[86:87] op_sel_hi:[1,0,1]
    v_pk_fma_f32 v[88:89], v[144:145], v[210:211], v[88:89] op_sel_hi:[1,0,1]
    v_pk_fma_f32 v[90:91], v[146:147], v[210:211], v[90:91] op_sel_hi:[1,0,1]
    v_pk_fma_f32 v[92:93], v[148:149], v[210:211], v[92:93] op_sel_hi:[1,0,1]
    v_pk_fma_f32 v[94:95], v[150:151], v[210:211], v[94:95] op_sel_hi:[1,0,1]
    s_waitcnt lgkmcnt(0)
    v_pk_fma_f32 v[96:97], v[212:213], v[210:211], v[96:97] op_sel_hi:[1,0,1]
    v_pk_fma_f32 v[98:99], v[214:215], v[210:211], v[98:99] op_sel_hi:[1,0,1]
    v_pk_fma_f32 v[100:101], v[216:217], v[210:211], v[100:101] op_sel_hi:[1,0,1]
    v_pk_fma_f32 v[102:103], v[218:219], v[210:211], v[102:103] op_sel_hi:[1,0,1]
    v_pk_fma_f32 v[104:105], v[220:221], v[210:211], v[104:105] op_sel_hi:[1,0,1]
    v_pk_fma_f32 v[106:107], v[222:223], v[210:211], v[106:107] op_sel_hi:[1,0,1]
    v_pk_fma_f32 v[108:109], v[224:225], v[210:211], v[108:109] op_sel_hi:[1,0,1]
    v_pk_fma_f32 v[110:111], v[226:227], v[210:211], v[110:111] op_sel_hi:[1,0,1]
    s_mul_i32 s96, s47, 102400
    s_lshl_b32 s97, s44, 10
    s_add_u32 s96, s96, s97
    s_add_u32 s96, s96, 27066368
    v_pk_mul_f32 v[64:65], v[64:65], v[0:1] op_sel_hi:[1,0]
    v_pk_mul_f32 v[66:67], v[66:67], v[0:1] op_sel_hi:[1,0]
    v_pk_mul_f32 v[68:69], v[68:69], v[0:1] op_sel_hi:[1,0]
    v_pk_mul_f32 v[70:71], v[70:71], v[0:1] op_sel_hi:[1,0]
    v_pk_mul_f32 v[72:73], v[72:73], v[0:1] op_sel_hi:[1,0]
    v_pk_mul_f32 v[74:75], v[74:75], v[0:1] op_sel_hi:[1,0]
    v_pk_mul_f32 v[76:77], v[76:77], v[0:1] op_sel_hi:[1,0]
    v_pk_mul_f32 v[78:79], v[78:79], v[0:1] op_sel_hi:[1,0]
    v_pk_mul_f32 v[100:101], v[100:101], v[0:1] op_sel_hi:[1,0]
    v_pk_mul_f32 v[102:103], v[102:103], v[0:1] op_sel_hi:[1,0]
    v_pk_mul_f32 v[104:105], v[104:105], v[0:1] op_sel_hi:[1,0]
    v_pk_mul_f32 v[106:107], v[106:107], v[0:1] op_sel_hi:[1,0]
    v_pk_mul_f32 v[80:81], v[80:81], v[0:1] op_sel_hi:[1,0]
    v_pk_mul_f32 v[82:83], v[82:83], v[0:1] op_sel_hi:[1,0]
    v_pk_mul_f32 v[84:85], v[84:85], v[0:1] op_sel_hi:[1,0]
    v_pk_mul_f32 v[86:87], v[86:87], v[0:1] op_sel_hi:[1,0]
    s_add_u32 s94, s97, 59392
    s_mov_b32 m0, s94
    s_add_u32 s95, s96, 8192
    buffer_load_dwordx4 v1, s[8:11], s95 offen lds
    v_pk_mul_f32 v[88:89], v[88:89], v[0:1] op_sel_hi:[1,0]
    v_pk_mul_f32 v[90:91], v[90:91], v[0:1] op_sel_hi:[1,0]
    v_pk_mul_f32 v[92:93], v[92:93], v[0:1] op_sel_hi:[1,0]
    v_pk_mul_f32 v[94:95], v[94:95], v[0:1] op_sel_hi:[1,0]
    v_cvt_pk_bf16_f32 v80, v80, v81
    v_cvt_pk_bf16_f32 v81, v82, v83
    v_cvt_pk_bf16_f32 v82, v84, v85
    v_cvt_pk_bf16_f32 v83, v86, v87
    v_cvt_pk_bf16_f32 v84, v88, v89
    v_cvt_pk_bf16_f32 v85, v90, v91
    v_cvt_pk_bf16_f32 v86, v92, v93
    v_cvt_pk_bf16_f32 v87, v94, v95
    v_cvt_pk_bf16_f32 v88, v104, v105
    v_cvt_pk_bf16_f32 v89, v106, v107
    v_mov_b32 v90, 0x3f80
    v_mov_b32 v91, 0
    v_lshrrev_b32 v172, 5, v21
    v_lshlrev_b32 v172, 7, v172
    v_and_b32 v173, 31, v21
    v_add_u32 v172, v172, v173
    s_lshl_b32 s52, s44, 5
    v_add_u32 v172, s52, v172
    v_mul_u32_u24 v172, 160, v172
    ds_write_b128 v172, v[80:83] offset:80
    ds_write_b128 v172, v[84:87] offset:96
    ds_write_b128 v172, v[88:91] offset:112
    v_cvt_pk_bf16_f32 v64, v64, v65
    v_cvt_pk_bf16_f32 v65, v66, v67
    s_add_u32 s94, s97, 63488
    s_mov_b32 m0, s94
    s_add_u32 s95, s96, 12288
    buffer_load_dwordx4 v1, s[8:11], s95 offen lds
    v_cvt_pk_bf16_f32 v66, v68, v69
    v_cvt_pk_bf16_f32 v67, v70, v71
    v_cvt_pk_bf16_f32 v68, v72, v73
    v_cvt_pk_bf16_f32 v69, v74, v75
    v_cvt_pk_bf16_f32 v70, v76, v77
    v_cvt_pk_bf16_f32 v71, v78, v79
    v_cvt_pk_bf16_f32 v72, v100, v101
    v_cvt_pk_bf16_f32 v73, v102, v103
    v_mov_b32 v74, 0
    v_mov_b32 v75, 0
    v_mfma_f32_32x32x16_bf16 v[212:227], v[176:179], v[64:67], 0
    s_add_u32 s94, s97, 67584
    s_mov_b32 m0, s94
    s_add_u32 s95, s96, 16384
    buffer_load_dwordx4 v1, s[8:11], s95 offen lds
    v_mfma_f32_32x32x16_bf16 v[24:39], v[188:191], v[64:67], 0
    v_mfma_f32_32x32x16_bf16 v[212:227], v[180:183], v[68:71], v[212:227]
    v_mfma_f32_32x32x16_bf16 v[24:39], v[192:195], v[68:71], v[24:39]
    s_add_u32 s94, s97, 71680
    s_mov_b32 m0, s94
    s_add_u32 s95, s96, 20480
    buffer_load_dwordx4 v1, s[8:11], s95 offen lds
    v_mfma_f32_32x32x16_bf16 v[212:227], v[184:187], v[72:75], v[212:227]
    v_mfma_f32_32x32x16_bf16 v[24:39], v[196:199], v[72:75], v[24:39]
    s_nop 10
    v_max3_f32 v164, v212, v213, v214
    v_max3_f32 v164, v164, v215, v216
    v_max3_f32 v164, v164, v217, v218
    v_max3_f32 v164, v164, v219, v220
    s_add_u32 s94, s97, 75776
    s_mov_b32 m0, s94
    s_add_u32 s95, s96, 24576
    buffer_load_dwordx4 v1, s[8:11], s95 offen lds
    v_max3_f32 v164, v164, v221, v222
    v_max3_f32 v164, v164, v223, v224
    v_max3_f32 v164, v164, v225, v226
    v_max3_f32 v164, v164, v227, v24
    v_max3_f32 v164, v164, v25, v26
    v_max_f32 v164, v164, v27
    v_min3_f32 v166, v212, v213, v214
    v_min3_f32 v166, v166, v215, v216
    v_min3_f32 v166, v166, v217, v218
    v_min3_f32 v166, v166, v219, v220
    v_min3_f32 v166, v166, v221, v222
    v_min3_f32 v166, v166, v223, v224
    v_min3_f32 v166, v166, v225, v226
    v_min3_f32 v166, v166, v227, v24
    v_min3_f32 v166, v166, v25, v26
    v_min_f32 v166, v166, v27
    s_add_u32 s94, s97, 79872
    s_mov_b32 m0, s94
    s_add_u32 s95, s96, 28672
    buffer_load_dwordx4 v1, s[8:11], s95 offen lds
    s_mov_b32 s56, 0x3fb8aa3b
    s_mov_b32 s57, 0xbfb8aa3b
    v_mul_f32 v164, s57, v164
    v_mul_f32 v166, s56, v166
    v_mov_b32 v168, s56
    v_mov_b32 v170, s57
    v_pk_fma_f32 v[128:129], v[212:213], v[168:169], v[164:165] op_sel_hi:[1,0,0]
    v_pk_fma_f32 v[130:131], v[214:215], v[168:169], v[164:165] op_sel_hi:[1,0,0]
    v_pk_fma_f32 v[132:133], v[216:217], v[168:169], v[164:165] op_sel_hi:[1,0,0]
    v_pk_fma_f32 v[134:135], v[218:219], v[168:169], v[164:165] op_sel_hi:[1,0,0]
    v_pk_fma_f32 v[136:137], v[220:221], v[168:169], v[164:165] op_sel_hi:[1,0,0]
    v_pk_fma_f32 v[138:139], v[222:223], v[168:169], v[164:165] op_sel_hi:[1,0,0]
    v_pk_fma_f32 v[140:141], v[224:225], v[168:169], v[164:165] op_sel_hi:[1,0,0]
    v_pk_fma_f32 v[142:143], v[226:227], v[168:169], v[164:165] op_sel_hi:[1,0,0]
    v_pk_fma_f32 v[144:145], v[24:25], v[168:169], v[164:165] op_sel_hi:[1,0,0]
    v_pk_fma_f32 v[146:147], v[26:27], v[168:169], v[164:165] op_sel_hi:[1,0,0]
    v_exp_f32 v128, v128
    s_add_u32 s94, s97, 83968
    s_mov_b32 m0, s94
    s_add_u32 s95, s96, 32768
    buffer_load_dwordx4 v1, s[8:11], s95 offen lds
    v_exp_f32 v129, v129
    v_exp_f32 v130, v130
    v_exp_f32 v131, v131
    v_exp_f32 v132, v132
    v_exp_f32 v133, v133
    v_exp_f32 v134, v134
    v_exp_f32 v135, v135
    v_exp_f32 v136, v136
    s_add_u32 s94, s97, 88064
    s_mov_b32 m0, s94
    s_add_u32 s95, s96, 36864
    buffer_load_dwordx4 v1, s[8:11], s95 offen lds
    v_exp_f32 v137, v137
    v_exp_f32 v138, v138
    v_exp_f32 v139, v139
    v_exp_f32 v140, v140
    v_exp_f32 v141, v141
    v_exp_f32 v142, v142
    v_exp_f32 v143, v143
    v_exp_f32 v144, v144
    s_add_u32 s94, s97, 92160
    s_mov_b32 m0, s94
    s_add_u32 s95, s96, 40960
    buffer_load_dwordx4 v1, s[8:11], s95 offen lds
    v_exp_f32 v145, v145
    v_exp_f32 v146, v146
    v_exp_f32 v147, v147
    v_pk_fma_f32 v[40:41], v[212:213], v[170:171], v[166:167] op_sel_hi:[1,0,0]
    v_pk_fma_f32 v[42:43], v[214:215], v[170:171], v[166:167] op_sel_hi:[1,0,0]
    v_pk_fma_f32 v[44:45], v[216:217], v[170:171], v[166:167] op_sel_hi:[1,0,0]
    v_pk_fma_f32 v[46:47], v[218:219], v[170:171], v[166:167] op_sel_hi:[1,0,0]
    v_pk_fma_f32 v[48:49], v[220:221], v[170:171], v[166:167] op_sel_hi:[1,0,0]
    v_pk_fma_f32 v[50:51], v[222:223], v[170:171], v[166:167] op_sel_hi:[1,0,0]
    v_pk_fma_f32 v[52:53], v[224:225], v[170:171], v[166:167] op_sel_hi:[1,0,0]
    v_pk_fma_f32 v[54:55], v[226:227], v[170:171], v[166:167] op_sel_hi:[1,0,0]
    v_pk_fma_f32 v[56:57], v[24:25], v[170:171], v[166:167] op_sel_hi:[1,0,0]
    v_pk_fma_f32 v[58:59], v[26:27], v[170:171], v[166:167] op_sel_hi:[1,0,0]
    s_add_u32 s94, s97, 96256
    s_mov_b32 m0, s94
    s_add_u32 s95, s96, 45056
    buffer_load_dwordx4 v1, s[8:11], s95 offen lds
    v_exp_f32 v40, v40
    v_exp_f32 v41, v41
    v_exp_f32 v42, v42
    v_exp_f32 v43, v43
    v_exp_f32 v44, v44
    v_exp_f32 v45, v45
    v_exp_f32 v46, v46
    v_exp_f32 v47, v47
    s_add_u32 s94, s97, 100352
    s_mov_b32 m0, s94
    s_add_u32 s95, s96, 49152
    buffer_load_dwordx4 v1, s[8:11], s95 offen lds
    v_exp_f32 v48, v48
    v_exp_f32 v49, v49
    v_exp_f32 v50, v50
    v_exp_f32 v51, v51
    v_exp_f32 v52, v52
    v_exp_f32 v53, v53
    v_exp_f32 v54, v54
    v_exp_f32 v55, v55
    s_add_u32 s94, s97, 104448
    s_mov_b32 m0, s94
    s_add_u32 s95, s96, 53248
    buffer_load_dwordx4 v1, s[8:11], s95 offen lds
    v_exp_f32 v56, v56
    v_exp_f32 v57, v57
    v_exp_f32 v58, v58
    v_exp_f32 v59, v59
    v_pk_add_f32 v[164:165], v[128:129], v[130:131]
    v_pk_add_f32 v[164:165], v[164:165], v[132:133]
    v_pk_add_f32 v[164:165], v[164:165], v[134:135]
    v_pk_add_f32 v[164:165], v[164:165], v[136:137]
    v_pk_add_f32 v[164:165], v[164:165], v[138:139]
    v_pk_add_f32 v[164:165], v[164:165], v[140:141]
    v_pk_add_f32 v[164:165], v[164:165], v[142:143]
    v_pk_add_f32 v[164:165], v[164:165], v[144:145]
    s_add_u32 s94, s97, 108544
    s_mov_b32 m0, s94
    s_add_u32 s95, s96, 57344
    buffer_load_dwordx4 v1, s[8:11], s95 offen lds
    v_pk_add_f32 v[164:165], v[164:165], v[146:147]
    v_add_f32 v164, v164, v165
    v_rcp_f32 v164, v164
    v_pk_add_f32 v[166:167], v[40:41], v[42:43]
    v_pk_add_f32 v[166:167], v[166:167], v[44:45]
    v_pk_add_f32 v[166:167], v[166:167], v[46:47]
    v_pk_add_f32 v[166:167], v[166:167], v[48:49]
    v_pk_add_f32 v[166:167], v[166:167], v[50:51]
    v_pk_add_f32 v[166:167], v[166:167], v[52:53]
    v_pk_add_f32 v[166:167], v[166:167], v[54:55]
    v_pk_add_f32 v[166:167], v[166:167], v[56:57]
    v_pk_add_f32 v[166:167], v[166:167], v[58:59]
    v_add_f32 v166, v166, v167
    v_rcp_f32 v166, v166
    v_pk_mul_f32 v[128:129], v[128:129], v[164:165] op_sel_hi:[1,0]
    v_pk_mul_f32 v[130:131], v[130:131], v[164:165] op_sel_hi:[1,0]
    v_pk_mul_f32 v[132:133], v[132:133], v[164:165] op_sel_hi:[1,0]
    v_pk_mul_f32 v[134:135], v[134:135], v[164:165] op_sel_hi:[1,0]
    v_pk_mul_f32 v[136:137], v[136:137], v[164:165] op_sel_hi:[1,0]
    v_pk_mul_f32 v[138:139], v[138:139], v[164:165] op_sel_hi:[1,0]
    v_pk_mul_f32 v[140:141], v[140:141], v[164:165] op_sel_hi:[1,0]
    v_pk_mul_f32 v[142:143], v[142:143], v[164:165] op_sel_hi:[1,0]
    v_pk_mul_f32 v[144:145], v[144:145], v[164:165] op_sel_hi:[1,0]
    v_pk_mul_f32 v[146:147], v[146:147], v[164:165] op_sel_hi:[1,0]
    v_pk_mul_f32 v[40:41], v[40:41], v[166:167] op_sel_hi:[1,0]
    v_pk_mul_f32 v[42:43], v[42:43], v[166:167] op_sel_hi:[1,0]
    v_pk_mul_f32 v[44:45], v[44:45], v[166:167] op_sel_hi:[1,0]
    v_pk_mul_f32 v[46:47], v[46:47], v[166:167] op_sel_hi:[1,0]
    v_pk_mul_f32 v[48:49], v[48:49], v[166:167] op_sel_hi:[1,0]
    v_pk_mul_f32 v[50:51], v[50:51], v[166:167] op_sel_hi:[1,0]
    s_add_u32 s95, s88, 69632
    buffer_load_dwordx4 a[228:231], v1, s[8:11], s95 offen
    v_pk_mul_f32 v[52:53], v[52:53], v[166:167] op_sel_hi:[1,0]
    v_pk_mul_f32 v[54:55], v[54:55], v[166:167] op_sel_hi:[1,0]
    v_pk_mul_f32 v[56:57], v[56:57], v[166:167] op_sel_hi:[1,0]
    v_pk_mul_f32 v[58:59], v[58:59], v[166:167] op_sel_hi:[1,0]
    v_cvt_pk_bf16_f32 v128, v128, v129
    v_cvt_pk_bf16_f32 v129, v130, v131
    v_cvt_pk_bf16_f32 v130, v132, v133
    v_cvt_pk_bf16_f32 v131, v134, v135
    v_cvt_pk_bf16_f32 v132, v136, v137
    v_cvt_pk_bf16_f32 v133, v138, v139
    v_cvt_pk_bf16_f32 v134, v140, v141
    v_cvt_pk_bf16_f32 v135, v142, v143
    v_cvt_pk_bf16_f32 v136, v144, v145
    v_cvt_pk_bf16_f32 v137, v146, v147
    v_cvt_pk_bf16_f32 v138, v40, v41
    v_cvt_pk_bf16_f32 v139, v42, v43
    s_add_u32 s95, s88, 73728
    buffer_load_dwordx4 a[232:235], v1, s[8:11], s95 offen
    v_cvt_pk_bf16_f32 v140, v44, v45
    v_cvt_pk_bf16_f32 v141, v46, v47
    v_cvt_pk_bf16_f32 v142, v48, v49
    v_cvt_pk_bf16_f32 v143, v50, v51
    v_cvt_pk_bf16_f32 v144, v52, v53
    v_cvt_pk_bf16_f32 v145, v54, v55
    v_cvt_pk_bf16_f32 v146, v56, v57
    v_cvt_pk_bf16_f32 v147, v58, v59
    ds_write_b128 v172, v[128:131] offset:0
    ds_write_b128 v172, v[132:135] offset:16
    ds_write_b128 v172, v[136:139] offset:32
    ds_write_b128 v172, v[140:143] offset:48
    ds_write_b128 v172, v[144:147] offset:64
    s_lshr_b32 s52, s44, 1
    s_mul_i32 s52, s52, 20480
    s_sub_u32 s52, s52, 51200
    s_and_b32 s53, s44, 1
    s_lshl_b32 s53, s53, 5
    v_add_u32 v166, s52, v9
    v_add_u32 v167, s53, v166
    s_waitcnt vmcnt(32)
    s_waitcnt lgkmcnt(0)
    s_barrier
    ds_read_b64_tr_b16 v[24:25], v167 offset:80
    ds_read_b64_tr_b16 v[26:27], v167 offset:2640
    ds_read_b64_tr_b16 v[28:29], v167 offset:5200
    ds_read_b64_tr_b16 v[30:31], v167 offset:7760
    ds_read_b64_tr_b16 v[32:33], v167 offset:10320
    ds_read_b64_tr_b16 v[34:35], v167 offset:12880
    ds_read_b64_tr_b16 v[36:37], v167 offset:15440
    ds_read_b64_tr_b16 v[38:39], v167 offset:18000
    ds_read_b64_tr_b16 v[128:129], v166 offset:0
    ds_read_b64_tr_b16 v[130:131], v166 offset:2560
    ds_read_b64_tr_b16 v[132:133], v166 offset:32
    ds_read_b64_tr_b16 v[134:135], v166 offset:2592
    ds_read_b64_tr_b16 v[136:137], v166 offset:64
    ds_read_b64_tr_b16 v[138:139], v166 offset:2624
    s_waitcnt lgkmcnt(4)
    v_mfma_f32_16x16x32_bf16 v[40:43], v[128:131], v[24:27], 0
    ds_read_b64_tr_b16 v[140:141], v166 offset:5120
    ds_read_b64_tr_b16 v[142:143], v166 offset:7680
    s_waitcnt lgkmcnt(4)
    v_mfma_f32_16x16x32_bf16 v[44:47], v[132:135], v[24:27], 0
    ds_read_b64_tr_b16 v[144:145], v166 offset:5152
    ds_read_b64_tr_b16 v[146:147], v166 offset:7712
    s_waitcnt lgkmcnt(4)
    v_mfma_f32_16x16x32_bf16 v[48:51], v[136:139], v[24:27], 0
    ds_read_b64_tr_b16 v[148:149], v166 offset:5184
    ds_read_b64_tr_b16 v[150:151], v166 offset:7744
    s_waitcnt lgkmcnt(4)
    v_mfma_f32_16x16x32_bf16 v[40:43], v[140:143], v[28:31], v[40:43]
    ds_read_b64_tr_b16 v[152:153], v166 offset:10240
    ds_read_b64_tr_b16 v[154:155], v166 offset:12800
    s_waitcnt lgkmcnt(4)
    v_mfma_f32_16x16x32_bf16 v[44:47], v[144:147], v[28:31], v[44:47]
    ds_read_b64_tr_b16 v[128:129], v166 offset:10272
    ds_read_b64_tr_b16 v[130:131], v166 offset:12832
    s_waitcnt lgkmcnt(4)
    v_mfma_f32_16x16x32_bf16 v[48:51], v[148:151], v[28:31], v[48:51]
    ds_read_b64_tr_b16 v[132:133], v166 offset:10304
    ds_read_b64_tr_b16 v[134:135], v166 offset:12864
    s_waitcnt lgkmcnt(4)
    v_mfma_f32_16x16x32_bf16 v[40:43], v[152:155], v[32:35], v[40:43]
    ds_read_b64_tr_b16 v[136:137], v166 offset:15360
    ds_read_b64_tr_b16 v[138:139], v166 offset:17920
    s_waitcnt lgkmcnt(4)
    v_mfma_f32_16x16x32_bf16 v[44:47], v[128:131], v[32:35], v[44:47]
    ds_read_b64_tr_b16 v[140:141], v166 offset:15392
    ds_read_b64_tr_b16 v[142:143], v166 offset:17952
    s_waitcnt lgkmcnt(4)
    v_mfma_f32_16x16x32_bf16 v[48:51], v[132:135], v[32:35], v[48:51]
    ds_read_b64_tr_b16 v[144:145], v166 offset:15424
    ds_read_b64_tr_b16 v[146:147], v166 offset:17984
    s_waitcnt lgkmcnt(4)
    v_mfma_f32_16x16x32_bf16 v[40:43], v[136:139], v[36:39], v[40:43]
    s_waitcnt lgkmcnt(2)
    v_mfma_f32_16x16x32_bf16 v[44:47], v[140:143], v[36:39], v[44:47]
    s_waitcnt lgkmcnt(0)
    v_mfma_f32_16x16x32_bf16 v[48:51], v[144:147], v[36:39], v[48:51]
    s_nop 3
    v_cvt_pk_bf16_f32 v52, v40, v41
    v_cvt_pk_bf16_f32 v53, v42, v43
    v_cvt_pk_bf16_f32 v54, v44, v45
    v_cvt_pk_bf16_f32 v55, v46, v47
    v_cvt_pk_bf16_f32 v56, v48, v49
    v_cvt_pk_bf16_f32 v57, v50, v51
    s_nop 0
    v_permlane16_swap_b32 v56, v58
    v_permlane16_swap_b32 v57, v59
    v_lshrrev_b32 v164, 4, v21
    v_mul_u32_u24 v164, 384, v164
    v_and_b32 v165, 15, v21
    v_lshl_add_u32 v164, v165, 4, v164
    s_lshl_b32 s52, s46, 4
    s_add_u32 s52, s52, s45
    s_lshl_b32 s52, s52, 12
    s_add_u32 s52, s52, 18743296
    s_lshr_b32 s53, s44, 1
    s_mul_i32 s53, s53, 1920
    s_add_u32 s52, s52, s53
    s_and_b32 s53, s44, 1
    s_lshl_b32 s54, s53, 8
    s_add_u32 s52, s52, s54
    s_cmp_eq_u32 s53, 0
    s_cselect_b32 s54, -1, 0x00ff00ff
    s_and_b32 s55, s54, 0xffff
    s_mov_b32 exec_lo, s54
    s_mov_b32 exec_hi, s54
    buffer_store_dwordx4 v[52:55], v164, s[8:11], s52 offen sc1
    s_mov_b32 exec_lo, s55
    s_mov_b32 exec_hi, 0
    buffer_store_dwordx4 v[56:59], v164, s[8:11], s52 offen offset:1536 sc1
    s_mov_b64 exec, -1
    s_lshl_b32 s59, s46, 16
    s_lshl_b32 s52, s44, 10
    s_add_u32 s59, s59, s52
    s_add_u32 s59, s59, 18743296
    v_lshlrev_b32 v236, 12, v21
    v_mov_b32 v238, 0x3f80
    v_mov_b32 v239, 1.0
    v_cmp_gt_u32 vcc, 16, v21
    v_mov_b32 v237, 0x80000000
    s_nop 0
    v_cndmask_b32 v236, v237, v236, vcc
    s_lshl_b32 s52, s44, 6
    v_add_u32 v174, s52, v21
    v_cmp_gt_u32 vcc, 240, v174
    s_nop 1
    v_cndmask_b32 v175, v237, v1, vcc
    v_mov_b32 v60, 0x3f803f80
    v_mov_b32 v61, 0x3f803f80
    v_mov_b32 v62, 0x3f803f80
    v_mov_b32 v63, 0x3f803f80
    s_mul_i32 s56, s44, 10240
    v_add_u32 v228, s56, v6
    ds_read_b128 v[128:131], v6 offset:0
    ds_read_b128 v[132:135], v6 offset:1024
    ds_read_b128 v[136:139], v6 offset:2048
    ds_read_b128 v[140:143], v6 offset:3072
    ds_read_b128 v[144:147], v228 offset:0
    s_waitcnt lgkmcnt(4)
    v_mfma_f32_32x32x16_bf16 v[112:127], v[128:131], a[0:3], 0
    ds_read_b128 v[148:151], v6 offset:4096
    s_add_u32 s95, s88, 77824
    buffer_load_dwordx4 a[236:239], v1, s[8:11], s95 offen
    s_waitcnt lgkmcnt(4)
    v_mfma_f32_32x32x16_bf16 v[112:127], v[132:135], a[4:7], v[112:127]
    ds_read_b128 v[152:155], v6 offset:5120
    s_waitcnt lgkmcnt(4)
    v_mfma_f32_32x32x16_bf16 v[112:127], v[136:139], a[8:11], v[112:127]
    ds_read_b128 v[128:131], v6 offset:6144
    s_add_u32 s95, s88, 81920
    buffer_load_dwordx4 a[240:243], v1, s[8:11], s95 offen
    s_waitcnt lgkmcnt(4)
    v_mfma_f32_32x32x16_bf16 v[112:127], v[140:143], a[12:15], v[112:127]
    ds_read_b128 v[132:135], v6 offset:7168
    s_waitcnt lgkmcnt(4)
    v_mfma_f32_32x32x16_bf16 v[80:95], v[60:63], v[144:147], 0
    ds_read_b128 v[136:139], v228 offset:1024
    s_add_u32 s95, s88, 86016
    buffer_load_dwordx4 a[244:247], v1, s[8:11], s95 offen
    s_waitcnt lgkmcnt(4)
    v_mfma_f32_32x32x16_bf16 v[112:127], v[148:151], a[16:19], v[112:127]
    ds_read_b128 v[140:143], v6 offset:8192
    s_waitcnt lgkmcnt(4)
    v_mfma_f32_32x32x16_bf16 v[112:127], v[152:155], a[20:23], v[112:127]
    ds_read_b128 v[144:147], v6 offset:9216
    s_add_u32 s95, s88, 90112
    buffer_load_dwordx4 a[248:251], v1, s[8:11], s95 offen
    s_waitcnt lgkmcnt(4)
    v_mfma_f32_32x32x16_bf16 v[112:127], v[128:131], a[24:27], v[112:127]
    ds_read_b128 v[148:151], v6 offset:10240
    s_waitcnt lgkmcnt(4)
    v_mfma_f32_32x32x16_bf16 v[112:127], v[132:135], a[28:31], v[112:127]
    ds_read_b128 v[152:155], v6 offset:11264
    s_add_u32 s95, s88, 94208
    buffer_load_dwordx4 a[252:255], v1, s[8:11], s95 offen
    s_waitcnt lgkmcnt(4)
    v_mfma_f32_32x32x16_bf16 v[80:95], v[60:63], v[136:139], v[80:95]
    ds_read_b128 v[128:131], v228 offset:2048
    s_waitcnt lgkmcnt(4)
    v_mfma_f32_32x32x16_bf16 v[112:127], v[140:143], a[32:35], v[112:127]
    ds_read_b128 v[132:135], v6 offset:12288
    s_add_u32 s95, s88, 98304
    buffer_load_dwordx4 v[240:243], v1, s[8:11], s95 offen
    s_waitcnt lgkmcnt(4)
    v_mfma_f32_32x32x16_bf16 v[112:127], v[144:147], a[36:39], v[112:127]
    ds_read_b128 v[136:139], v6 offset:13312
    s_waitcnt lgkmcnt(4)
    v_mfma_f32_32x32x16_bf16 v[112:127], v[148:151], a[40:43], v[112:127]
    ds_read_b128 v[140:143], v6 offset:14336
    s_add_u32 s95, s88, 102400
    buffer_load_dwordx4 v[244:247], v1, s[8:11], s95 offen
    s_waitcnt lgkmcnt(4)
    v_mfma_f32_32x32x16_bf16 v[112:127], v[152:155], a[44:47], v[112:127]
    ds_read_b128 v[144:147], v6 offset:15360
    s_waitcnt lgkmcnt(4)
    v_mfma_f32_32x32x16_bf16 v[80:95], v[60:63], v[128:131], v[80:95]
    ds_read_b128 v[148:151], v228 offset:3072
    s_add_u32 s95, s88, 106496
    buffer_load_dwordx4 v[248:251], v1, s[8:11], s95 offen
    s_waitcnt lgkmcnt(4)
    v_mfma_f32_32x32x16_bf16 v[112:127], v[132:135], a[48:51], v[112:127]
    ds_read_b128 v[152:155], v6 offset:16384
    s_waitcnt lgkmcnt(4)
    v_mfma_f32_32x32x16_bf16 v[112:127], v[136:139], a[52:55], v[112:127]
    ds_read_b128 v[128:131], v6 offset:17408
    s_add_u32 s95, s88, 110592
    buffer_load_dwordx4 v[252:255], v1, s[8:11], s95 offen
    s_waitcnt lgkmcnt(4)
    v_mfma_f32_32x32x16_bf16 v[112:127], v[140:143], a[56:59], v[112:127]
    ds_read_b128 v[132:135], v6 offset:18432
    s_waitcnt lgkmcnt(4)
    v_mfma_f32_32x32x16_bf16 v[112:127], v[144:147], a[60:63], v[112:127]
    ds_read_b128 v[136:139], v6 offset:19456
    s_waitcnt lgkmcnt(4)
    v_mfma_f32_32x32x16_bf16 v[80:95], v[60:63], v[148:151], v[80:95]
    ds_read_b128 v[140:143], v228 offset:4096
    s_waitcnt lgkmcnt(4)
    v_mfma_f32_32x32x16_bf16 v[112:127], v[152:155], a[64:67], v[112:127]
    ds_read_b128 v[144:147], v6 offset:20480
    s_waitcnt lgkmcnt(4)
    v_mfma_f32_32x32x16_bf16 v[112:127], v[128:131], a[68:71], v[112:127]
    ds_read_b128 v[148:151], v6 offset:21504
    s_waitcnt lgkmcnt(4)
    v_mfma_f32_32x32x16_bf16 v[112:127], v[132:135], a[72:75], v[112:127]
    ds_read_b128 v[152:155], v6 offset:22528
    s_waitcnt lgkmcnt(4)
    v_mfma_f32_32x32x16_bf16 v[112:127], v[136:139], a[76:79], v[112:127]
    ds_read_b128 v[128:131], v6 offset:23552
    s_waitcnt lgkmcnt(4)
    v_mfma_f32_32x32x16_bf16 v[80:95], v[60:63], v[140:143], v[80:95]
    ds_read_b128 v[132:135], v228 offset:5120
    s_waitcnt lgkmcnt(4)
    v_mfma_f32_32x32x16_bf16 v[112:127], v[144:147], a[80:83], v[112:127]
    ds_read_b128 v[136:139], v6 offset:24576
    s_waitcnt lgkmcnt(4)
    v_mfma_f32_32x32x16_bf16 v[112:127], v[148:151], a[84:87], v[112:127]
    ds_read_b128 v[140:143], v6 offset:25600
    s_waitcnt lgkmcnt(4)
    v_mfma_f32_32x32x16_bf16 v[112:127], v[152:155], a[88:91], v[112:127]
    ds_read_b128 v[144:147], v6 offset:26624
    s_waitcnt lgkmcnt(4)
    v_mfma_f32_32x32x16_bf16 v[112:127], v[128:131], a[92:95], v[112:127]
    ds_read_b128 v[148:151], v6 offset:27648
    s_waitcnt lgkmcnt(4)
    v_mfma_f32_32x32x16_bf16 v[80:95], v[60:63], v[132:135], v[80:95]
    ds_read_b128 v[152:155], v228 offset:6144
    s_waitcnt lgkmcnt(4)
    v_mfma_f32_32x32x16_bf16 v[112:127], v[136:139], a[96:99], v[112:127]
    ds_read_b128 v[128:131], v6 offset:28672
    s_waitcnt lgkmcnt(4)
    v_mfma_f32_32x32x16_bf16 v[112:127], v[140:143], a[100:103], v[112:127]
    ds_read_b128 v[132:135], v6 offset:29696
    s_waitcnt lgkmcnt(4)
    v_mfma_f32_32x32x16_bf16 v[112:127], v[144:147], a[104:107], v[112:127]
    ds_read_b128 v[136:139], v6 offset:30720
    s_waitcnt lgkmcnt(4)
    v_mfma_f32_32x32x16_bf16 v[112:127], v[148:151], a[108:111], v[112:127]
    ds_read_b128 v[140:143], v6 offset:31744
    s_waitcnt lgkmcnt(4)
    v_mfma_f32_32x32x16_bf16 v[80:95], v[60:63], v[152:155], v[80:95]
    ds_read_b128 v[144:147], v228 offset:7168
    buffer_load_dword v237, v236, s[8:11], s59 offen offset:752 sc1
    s_waitcnt lgkmcnt(4)
    v_mfma_f32_32x32x16_bf16 v[112:127], v[128:131], a[112:115], v[112:127]
    ds_read_b128 v[148:151], v6 offset:32768
    s_waitcnt lgkmcnt(4)
    v_mfma_f32_32x32x16_bf16 v[112:127], v[132:135], a[116:119], v[112:127]
    ds_read_b128 v[152:155], v6 offset:33792
    s_waitcnt lgkmcnt(4)
    v_mfma_f32_32x32x16_bf16 v[112:127], v[136:139], a[120:123], v[112:127]
    ds_read_b128 v[128:131], v6 offset:34816
    s_waitcnt lgkmcnt(4)
    v_mfma_f32_32x32x16_bf16 v[112:127], v[140:143], a[124:127], v[112:127]
    ds_read_b128 v[132:135], v6 offset:35840
    s_waitcnt lgkmcnt(4)
    v_mfma_f32_32x32x16_bf16 v[80:95], v[60:63], v[144:147], v[80:95]
    ds_read_b128 v[136:139], v228 offset:8192
    s_waitcnt lgkmcnt(4)
    v_mfma_f32_32x32x16_bf16 v[112:127], v[148:151], a[128:131], v[112:127]
    ds_read_b128 v[140:143], v6 offset:36864
    s_waitcnt lgkmcnt(4)
    v_mfma_f32_32x32x16_bf16 v[112:127], v[152:155], a[132:135], v[112:127]
    ds_read_b128 v[144:147], v6 offset:37888
    s_waitcnt lgkmcnt(4)
    v_mfma_f32_32x32x16_bf16 v[112:127], v[128:131], a[136:139], v[112:127]
    ds_read_b128 v[148:151], v6 offset:38912
    s_waitcnt lgkmcnt(4)
    v_mfma_f32_32x32x16_bf16 v[112:127], v[132:135], a[140:143], v[112:127]
    ds_read_b128 v[152:155], v6 offset:39936
    s_waitcnt lgkmcnt(4)
    v_mfma_f32_32x32x16_bf16 v[80:95], v[60:63], v[136:139], v[80:95]
    ds_read_b128 v[128:131], v228 offset:9216
    s_waitcnt lgkmcnt(4)
    v_mfma_f32_32x32x16_bf16 v[112:127], v[140:143], a[144:147], v[112:127]
    s_waitcnt lgkmcnt(3)
    v_mfma_f32_32x32x16_bf16 v[112:127], v[144:147], a[148:151], v[112:127]
    s_waitcnt lgkmcnt(2)
    v_mfma_f32_32x32x16_bf16 v[112:127], v[148:151], a[152:155], v[112:127]
    s_waitcnt lgkmcnt(1)
    v_mfma_f32_32x32x16_bf16 v[112:127], v[152:155], a[156:159], v[112:127]
    s_waitcnt lgkmcnt(0)
    v_mfma_f32_32x32x16_bf16 v[80:95], v[60:63], v[128:131], v[80:95]
    v_bfe_u32 v164, v21, 2, 1
    v_lshlrev_b32 v164, 8, v164
    v_and_b32 v165, 3, v21
    v_lshl_add_u32 v164, v165, 2, v164
    v_bfe_u32 v165, v21, 3, 2
    v_lshl_add_u32 v164, v165, 4, v164
    v_add_u32 v164, 153600, v164
    s_mov_b64 exec, 0xffffffff
    s_nop 3
    ds_add_f32 v164, v80 offset:704
    s_mov_b64 exec, -1
    s_waitcnt lgkmcnt(0)
    s_barrier
    ds_read_b128 v[24:27], v19 offset:704
    ds_read_b128 v[28:31], v19 offset:720
    ds_read_b128 v[32:35], v19 offset:736
    ds_read_b128 v[36:39], v19 offset:752
    s_waitcnt lgkmcnt(0)
    v_pk_fma_f32 v[112:113], v[24:25], v[210:211], v[112:113] op_sel_hi:[1,0,1]
    v_pk_fma_f32 v[114:115], v[26:27], v[210:211], v[114:115] op_sel_hi:[1,0,1]
    v_pk_fma_f32 v[116:117], v[28:29], v[210:211], v[116:117] op_sel_hi:[1,0,1]
    v_pk_fma_f32 v[118:119], v[30:31], v[210:211], v[118:119] op_sel_hi:[1,0,1]
    v_pk_fma_f32 v[120:121], v[32:33], v[210:211], v[120:121] op_sel_hi:[1,0,1]
    v_pk_fma_f32 v[122:123], v[34:35], v[210:211], v[122:123] op_sel_hi:[1,0,1]
    v_pk_fma_f32 v[124:125], v[36:37], v[210:211], v[124:125] op_sel_hi:[1,0,1]
    v_pk_fma_f32 v[126:127], v[38:39], v[210:211], v[126:127] op_sel_hi:[1,0,1]
    v_pk_mul_f32 v[112:113], v[112:113], v[0:1] op_sel_hi:[1,0]
    v_pk_mul_f32 v[114:115], v[114:115], v[0:1] op_sel_hi:[1,0]
    v_pk_mul_f32 v[116:117], v[116:117], v[0:1] op_sel_hi:[1,0]
    v_pk_mul_f32 v[118:119], v[118:119], v[0:1] op_sel_hi:[1,0]
    v_pk_mul_f32 v[120:121], v[120:121], v[0:1] op_sel_hi:[1,0]
    v_pk_mul_f32 v[122:123], v[122:123], v[0:1] op_sel_hi:[1,0]
    v_pk_mul_f32 v[124:125], v[124:125], v[0:1] op_sel_hi:[1,0]
    v_pk_mul_f32 v[126:127], v[126:127], v[0:1] op_sel_hi:[1,0]
    v_pk_mul_f32 v[96:97], v[96:97], v[0:1] op_sel_hi:[1,0]
    v_pk_mul_f32 v[98:99], v[98:99], v[0:1] op_sel_hi:[1,0]
    v_cvt_pk_bf16_f32 v112, v112, v113
    v_cvt_pk_bf16_f32 v113, v114, v115
    v_cvt_pk_bf16_f32 v114, v116, v117
    v_cvt_pk_bf16_f32 v115, v118, v119
    v_cvt_pk_bf16_f32 v116, v120, v121
    v_cvt_pk_bf16_f32 v117, v122, v123
    v_cvt_pk_bf16_f32 v118, v124, v125
    v_cvt_pk_bf16_f32 v119, v126, v127
    v_cvt_pk_bf16_f32 v120, v96, v97
    v_cvt_pk_bf16_f32 v121, v98, v99
    s_waitcnt vmcnt(0)
    v_cmp_eq_u32 vcc, -1, v237
    s_cbranch_vccz L_kvok_23
L_kvp_22:
    buffer_load_dword v237, v236, s[8:11], s59 offen offset:752 sc1
    s_waitcnt vmcnt(0)
    v_cmp_eq_u32 vcc, -1, v237
    s_cbranch_vccz L_ok_24
    s_add_u32 s51, s51, 1
    s_cmp_gt_u32 s51, 200000
    s_cbranch_scc1 L_ok_24
    s_waitcnt vmcnt(0) lgkmcnt(0)
    s_sleep 1
    s_branch L_kvp_22
L_ok_24:
L_kvok_23:
    s_add_u32 s95, s59, 0
    buffer_load_dwordx4 v[64:67], v175, s[8:11], s95 offen sc1
    s_add_u32 s95, s59, 4096
    buffer_load_dwordx4 v[68:71], v175, s[8:11], s95 offen sc1
    s_add_u32 s95, s59, 8192
    buffer_load_dwordx4 v[72:75], v175, s[8:11], s95 offen sc1
    s_add_u32 s95, s59, 12288
    buffer_load_dwordx4 v[76:79], v175, s[8:11], s95 offen sc1
    s_add_u32 s95, s59, 16384
    buffer_load_dwordx4 v[80:83], v175, s[8:11], s95 offen sc1
    s_add_u32 s95, s59, 20480
    buffer_load_dwordx4 v[84:87], v175, s[8:11], s95 offen sc1
    v_mov_b32 v122, 0
    v_mov_b32 v123, 0
    v_mfma_f32_32x32x16_bf16 v[212:227], v[176:179], v[112:115], 0
    s_add_u32 s95, s59, 24576
    buffer_load_dwordx4 v[88:91], v175, s[8:11], s95 offen sc1
    v_mfma_f32_32x32x16_bf16 v[24:39], v[188:191], v[112:115], 0
    v_mfma_f32_32x32x16_bf16 v[212:227], v[180:183], v[116:119], v[212:227]
    s_add_u32 s95, s59, 28672
    buffer_load_dwordx4 v[92:95], v175, s[8:11], s95 offen sc1
    v_mfma_f32_32x32x16_bf16 v[24:39], v[192:195], v[116:119], v[24:39]
    v_mfma_f32_32x32x16_bf16 v[212:227], v[184:187], v[120:123], v[212:227]
    s_add_u32 s95, s59, 32768
    buffer_load_dwordx4 v[148:151], v175, s[8:11], s95 offen sc1
    v_mfma_f32_32x32x16_bf16 v[24:39], v[196:199], v[120:123], v[24:39]
    s_nop 8
    v_max3_f32 v164, v212, v213, v214
    v_max3_f32 v164, v164, v215, v216
    s_add_u32 s95, s59, 36864
    buffer_load_dwordx4 v[152:155], v175, s[8:11], s95 offen sc1
    v_max3_f32 v164, v164, v217, v218
    v_max3_f32 v164, v164, v219, v220
    v_max3_f32 v164, v164, v221, v222
    v_max3_f32 v164, v164, v223, v224
    v_max3_f32 v164, v164, v225, v226
    v_max3_f32 v164, v164, v227, v24
    v_max3_f32 v164, v164, v25, v26
    v_max_f32 v164, v164, v27
    s_add_u32 s95, s59, 40960
    buffer_load_dwordx4 v[156:159], v175, s[8:11], s95 offen sc1
    v_min3_f32 v166, v212, v213, v214
    v_min3_f32 v166, v166, v215, v216
    v_min3_f32 v166, v166, v217, v218
    v_min3_f32 v166, v166, v219, v220
    v_min3_f32 v166, v166, v221, v222
    v_min3_f32 v166, v166, v223, v224
    v_min3_f32 v166, v166, v225, v226
    v_min3_f32 v166, v166, v227, v24
    s_add_u32 s95, s59, 45056
    buffer_load_dwordx4 v[160:163], v175, s[8:11], s95 offen sc1
    v_min3_f32 v166, v166, v25, v26
    v_min_f32 v166, v166, v27
    s_mov_b32 s56, 0x3fb8aa3b
    s_mov_b32 s57, 0xbfb8aa3b
    v_mul_f32 v164, s57, v164
    v_mul_f32 v166, s56, v166
    v_mov_b32 v168, s56
    v_mov_b32 v170, s57
    v_pk_fma_f32 v[128:129], v[212:213], v[168:169], v[164:165] op_sel_hi:[1,0,0]
    v_pk_fma_f32 v[130:131], v[214:215], v[168:169], v[164:165] op_sel_hi:[1,0,0]
    s_add_u32 s95, s59, 49152
    buffer_load_dwordx4 v[60:63], v175, s[8:11], s95 offen sc1
    v_pk_fma_f32 v[132:133], v[216:217], v[168:169], v[164:165] op_sel_hi:[1,0,0]
    v_pk_fma_f32 v[134:135], v[218:219], v[168:169], v[164:165] op_sel_hi:[1,0,0]
    v_pk_fma_f32 v[136:137], v[220:221], v[168:169], v[164:165] op_sel_hi:[1,0,0]
    v_pk_fma_f32 v[138:139], v[222:223], v[168:169], v[164:165] op_sel_hi:[1,0,0]
    v_pk_fma_f32 v[140:141], v[224:225], v[168:169], v[164:165] op_sel_hi:[1,0,0]
    v_pk_fma_f32 v[142:143], v[226:227], v[168:169], v[164:165] op_sel_hi:[1,0,0]
    v_pk_fma_f32 v[144:145], v[24:25], v[168:169], v[164:165] op_sel_hi:[1,0,0]
    v_pk_fma_f32 v[146:147], v[26:27], v[168:169], v[164:165] op_sel_hi:[1,0,0]
    s_add_u32 s95, s59, 53248
    buffer_load_dwordx4 v[96:99], v175, s[8:11], s95 offen sc1
    v_exp_f32 v128, v128
    v_exp_f32 v129, v129
    v_exp_f32 v130, v130
    v_exp_f32 v131, v131
    s_add_u32 s95, s59, 57344
    buffer_load_dwordx4 v[100:103], v175, s[8:11], s95 offen sc1
    v_exp_f32 v132, v132
    v_exp_f32 v133, v133
    v_exp_f32 v134, v134
    v_exp_f32 v135, v135
    s_add_u32 s95, s59, 61440
    buffer_load_dwordx4 v[124:127], v175, s[8:11], s95 offen sc1
    v_exp_f32 v136, v136
    v_exp_f32 v137, v137
    v_exp_f32 v138, v138
    v_exp_f32 v139, v139
    s_add_u32 s94, s97, 51200
    s_mov_b32 m0, s94
    s_add_u32 s95, s96, 0
    buffer_load_dwordx4 v1, s[8:11], s95 offen lds
    v_exp_f32 v140, v140
    v_exp_f32 v141, v141
    v_exp_f32 v142, v142
    v_exp_f32 v143, v143
    s_add_u32 s94, s97, 55296
    s_mov_b32 m0, s94
    s_add_u32 s95, s96, 4096
    buffer_load_dwordx4 v1, s[8:11], s95 offen lds
    v_exp_f32 v144, v144
    v_exp_f32 v145, v145
    v_exp_f32 v146, v146
    v_exp_f32 v147, v147
    s_add_u32 s94, s97, 112640
    s_mov_b32 m0, s94
    s_add_u32 s95, s96, 61440
    buffer_load_dwordx4 v1, s[8:11], s95 offen lds
    v_pk_fma_f32 v[40:41], v[212:213], v[170:171], v[166:167] op_sel_hi:[1,0,0]
    v_pk_fma_f32 v[42:43], v[214:215], v[170:171], v[166:167] op_sel_hi:[1,0,0]
    v_pk_fma_f32 v[44:45], v[216:217], v[170:171], v[166:167] op_sel_hi:[1,0,0]
    v_pk_fma_f32 v[46:47], v[218:219], v[170:171], v[166:167] op_sel_hi:[1,0,0]
    v_pk_fma_f32 v[48:49], v[220:221], v[170:171], v[166:167] op_sel_hi:[1,0,0]
    v_pk_fma_f32 v[50:51], v[222:223], v[170:171], v[166:167] op_sel_hi:[1,0,0]
    v_pk_fma_f32 v[52:53], v[224:225], v[170:171], v[166:167] op_sel_hi:[1,0,0]
    v_pk_fma_f32 v[54:55], v[226:227], v[170:171], v[166:167] op_sel_hi:[1,0,0]
    s_add_u32 s94, s97, 116736
    s_mov_b32 m0, s94
    s_add_u32 s95, s96, 65536
    buffer_load_dwordx4 v1, s[8:11], s95 offen lds
    v_pk_fma_f32 v[56:57], v[24:25], v[170:171], v[166:167] op_sel_hi:[1,0,0]
    v_pk_fma_f32 v[58:59], v[26:27], v[170:171], v[166:167] op_sel_hi:[1,0,0]
    v_exp_f32 v40, v40
    v_exp_f32 v41, v41
    v_exp_f32 v42, v42
    s_add_u32 s94, s97, 120832
    s_mov_b32 m0, s94
    s_add_u32 s95, s96, 69632
    buffer_load_dwordx4 v1, s[8:11], s95 offen lds
    v_exp_f32 v43, v43
    v_exp_f32 v44, v44
    v_exp_f32 v45, v45
    v_exp_f32 v46, v46
    s_add_u32 s94, s97, 124928
    s_mov_b32 m0, s94
    s_add_u32 s95, s96, 73728
    buffer_load_dwordx4 v1, s[8:11], s95 offen lds
    v_exp_f32 v47, v47
    v_exp_f32 v48, v48
    v_exp_f32 v49, v49
    v_exp_f32 v50, v50
    s_add_u32 s94, s97, 129024
    s_mov_b32 m0, s94
    s_add_u32 s95, s96, 77824
    buffer_load_dwordx4 v1, s[8:11], s95 offen lds
    v_exp_f32 v51, v51
    v_exp_f32 v52, v52
    v_exp_f32 v53, v53
    v_exp_f32 v54, v54
    s_add_u32 s94, s97, 133120
    s_mov_b32 m0, s94
    s_add_u32 s95, s96, 81920
    buffer_load_dwordx4 v1, s[8:11], s95 offen lds
    v_exp_f32 v55, v55
    v_exp_f32 v56, v56
    v_exp_f32 v57, v57
    v_exp_f32 v58, v58
    s_add_u32 s94, s97, 137216
    s_mov_b32 m0, s94
    s_add_u32 s95, s96, 86016
    buffer_load_dwordx4 v1, s[8:11], s95 offen lds
    v_exp_f32 v59, v59
    v_pk_add_f32 v[164:165], v[128:129], v[130:131]
    v_pk_add_f32 v[164:165], v[164:165], v[132:133]
    v_pk_add_f32 v[164:165], v[164:165], v[134:135]
    v_pk_add_f32 v[164:165], v[164:165], v[136:137]
    v_pk_add_f32 v[164:165], v[164:165], v[138:139]
    v_pk_add_f32 v[164:165], v[164:165], v[140:141]
    s_add_u32 s94, s97, 141312
    s_mov_b32 m0, s94
    s_add_u32 s95, s96, 90112
    buffer_load_dwordx4 v1, s[8:11], s95 offen lds
    v_pk_add_f32 v[164:165], v[164:165], v[142:143]
    v_pk_add_f32 v[164:165], v[164:165], v[144:145]
    v_pk_add_f32 v[164:165], v[164:165], v[146:147]
    v_add_f32 v164, v164, v165
    v_rcp_f32 v164, v164
    v_pk_add_f32 v[166:167], v[40:41], v[42:43]
    v_pk_add_f32 v[166:167], v[166:167], v[44:45]
    s_add_u32 s94, s97, 145408
    s_mov_b32 m0, s94
    s_add_u32 s95, s96, 94208
    buffer_load_dwordx4 v1, s[8:11], s95 offen lds
    v_pk_add_f32 v[166:167], v[166:167], v[46:47]
    v_pk_add_f32 v[166:167], v[166:167], v[48:49]
    v_pk_add_f32 v[166:167], v[166:167], v[50:51]
    v_pk_add_f32 v[166:167], v[166:167], v[52:53]
    v_pk_add_f32 v[166:167], v[166:167], v[54:55]
    v_pk_add_f32 v[166:167], v[166:167], v[56:57]
    v_pk_add_f32 v[166:167], v[166:167], v[58:59]
    v_add_f32 v166, v166, v167
    s_add_u32 s94, s97, 149504
    s_mov_b32 m0, s94
    s_add_u32 s95, s96, 98304
    buffer_load_dwordx4 v1, s[8:11], s95 offen lds
    v_rcp_f32 v166, v166
    v_pk_mul_f32 v[128:129], v[128:129], v[164:165] op_sel_hi:[1,0]
    v_pk_mul_f32 v[130:131], v[130:131], v[164:165] op_sel_hi:[1,0]
    v_pk_mul_f32 v[132:133], v[132:133], v[164:165] op_sel_hi:[1,0]
    v_pk_mul_f32 v[134:135], v[134:135], v[164:165] op_sel_hi:[1,0]
    v_pk_mul_f32 v[136:137], v[136:137], v[164:165] op_sel_hi:[1,0]
    v_pk_mul_f32 v[138:139], v[138:139], v[164:165] op_sel_hi:[1,0]
    v_pk_mul_f32 v[140:141], v[140:141], v[164:165] op_sel_hi:[1,0]
    v_pk_mul_f32 v[142:143], v[142:143], v[164:165] op_sel_hi:[1,0]
    v_pk_mul_f32 v[144:145], v[144:145], v[164:165] op_sel_hi:[1,0]
    v_pk_mul_f32 v[146:147], v[146:147], v[164:165] op_sel_hi:[1,0]
    v_pk_mul_f32 v[40:41], v[40:41], v[166:167] op_sel_hi:[1,0]
    v_pk_mul_f32 v[42:43], v[42:43], v[166:167] op_sel_hi:[1,0]
    v_pk_mul_f32 v[44:45], v[44:45], v[166:167] op_sel_hi:[1,0]
    v_pk_mul_f32 v[46:47], v[46:47], v[166:167] op_sel_hi:[1,0]
    v_pk_mul_f32 v[48:49], v[48:49], v[166:167] op_sel_hi:[1,0]
    v_pk_mul_f32 v[50:51], v[50:51], v[166:167] op_sel_hi:[1,0]
    v_pk_mul_f32 v[52:53], v[52:53], v[166:167] op_sel_hi:[1,0]
    v_pk_mul_f32 v[54:55], v[54:55], v[166:167] op_sel_hi:[1,0]
    v_pk_mul_f32 v[56:57], v[56:57], v[166:167] op_sel_hi:[1,0]
    v_pk_mul_f32 v[58:59], v[58:59], v[166:167] op_sel_hi:[1,0]
    v_cvt_pk_bf16_f32 v104, v128, v129
    v_cvt_pk_bf16_f32 v105, v130, v131
    v_cvt_pk_bf16_f32 v106, v144, v145
    v_cvt_pk_bf16_f32 v107, v146, v147
    v_cvt_pk_bf16_f32 v108, v132, v133
    v_cvt_pk_bf16_f32 v109, v134, v135
    v_cvt_pk_bf16_f32 v110, v40, v41
    v_cvt_pk_bf16_f32 v111, v42, v43
    v_cvt_pk_bf16_f32 v112, v136, v137
    v_cvt_pk_bf16_f32 v113, v138, v139
    v_cvt_pk_bf16_f32 v114, v44, v45
    v_cvt_pk_bf16_f32 v115, v46, v47
    v_cvt_pk_bf16_f32 v116, v140, v141
    v_cvt_pk_bf16_f32 v117, v142, v143
    v_cvt_pk_bf16_f32 v118, v48, v49
    v_cvt_pk_bf16_f32 v119, v50, v51
    v_cvt_pk_bf16_f32 v120, v52, v53
    v_cvt_pk_bf16_f32 v121, v54, v55
    v_cvt_pk_bf16_f32 v122, v56, v57
    v_cvt_pk_bf16_f32 v123, v58, v59
    v_mov_b32 v228, 0
    v_mov_b32 v229, 0
    v_mov_b32 v230, 0
    v_mov_b32 v231, 0
    v_mov_b32 v232, 0
    v_mov_b32 v233, 0
    v_mov_b32 v234, 0
    v_mov_b32 v235, 0
    s_waitcnt vmcnt(27)
    v_dot2c_f32_bf16 v228, v64, v238
    v_dot2c_f32_bf16 v229, v64, v239
    v_dot2c_f32_bf16 v230, v65, v238
    v_dot2c_f32_bf16 v231, v65, v239
    v_dot2c_f32_bf16 v232, v66, v238
    v_dot2c_f32_bf16 v233, v66, v239
    v_dot2c_f32_bf16 v234, v67, v238
    v_dot2c_f32_bf16 v235, v67, v239
    s_waitcnt vmcnt(26)
    v_dot2c_f32_bf16 v228, v68, v238
    v_dot2c_f32_bf16 v229, v68, v239
    v_dot2c_f32_bf16 v230, v69, v238
    v_dot2c_f32_bf16 v231, v69, v239
    v_dot2c_f32_bf16 v232, v70, v238
    v_dot2c_f32_bf16 v233, v70, v239
    v_dot2c_f32_bf16 v234, v71, v238
    v_dot2c_f32_bf16 v235, v71, v239
    s_waitcnt vmcnt(25)
    v_dot2c_f32_bf16 v228, v72, v238
    v_dot2c_f32_bf16 v229, v72, v239
    v_dot2c_f32_bf16 v230, v73, v238
    v_dot2c_f32_bf16 v231, v73, v239
    v_dot2c_f32_bf16 v232, v74, v238
    v_dot2c_f32_bf16 v233, v74, v239
    v_dot2c_f32_bf16 v234, v75, v238
    v_dot2c_f32_bf16 v235, v75, v239
    s_waitcnt vmcnt(24)
    v_dot2c_f32_bf16 v228, v76, v238
    v_dot2c_f32_bf16 v229, v76, v239
    v_dot2c_f32_bf16 v230, v77, v238
    v_dot2c_f32_bf16 v231, v77, v239
    v_dot2c_f32_bf16 v232, v78, v238
    v_dot2c_f32_bf16 v233, v78, v239
    v_dot2c_f32_bf16 v234, v79, v238
    v_dot2c_f32_bf16 v235, v79, v239
    s_waitcnt vmcnt(23)
    v_dot2c_f32_bf16 v228, v80, v238
    v_dot2c_f32_bf16 v229, v80, v239
    v_dot2c_f32_bf16 v230, v81, v238
    v_dot2c_f32_bf16 v231, v81, v239
    v_dot2c_f32_bf16 v232, v82, v238
    v_dot2c_f32_bf16 v233, v82, v239
    v_dot2c_f32_bf16 v234, v83, v238
    v_dot2c_f32_bf16 v235, v83, v239
    s_waitcnt vmcnt(22)
    v_dot2c_f32_bf16 v228, v84, v238
    v_dot2c_f32_bf16 v229, v84, v239
    v_dot2c_f32_bf16 v230, v85, v238
    v_dot2c_f32_bf16 v231, v85, v239
    v_dot2c_f32_bf16 v232, v86, v238
    v_dot2c_f32_bf16 v233, v86, v239
    v_dot2c_f32_bf16 v234, v87, v238
    v_dot2c_f32_bf16 v235, v87, v239
    s_waitcnt vmcnt(21)
    v_dot2c_f32_bf16 v228, v88, v238
    v_dot2c_f32_bf16 v229, v88, v239
    v_dot2c_f32_bf16 v230, v89, v238
    v_dot2c_f32_bf16 v231, v89, v239
    v_dot2c_f32_bf16 v232, v90, v238
    v_dot2c_f32_bf16 v233, v90, v239
    v_dot2c_f32_bf16 v234, v91, v238
    v_dot2c_f32_bf16 v235, v91, v239
    s_waitcnt vmcnt(20)
    v_dot2c_f32_bf16 v228, v92, v238
    v_dot2c_f32_bf16 v229, v92, v239
    v_dot2c_f32_bf16 v230, v93, v238
    v_dot2c_f32_bf16 v231, v93, v239
    v_dot2c_f32_bf16 v232, v94, v238
    v_dot2c_f32_bf16 v233, v94, v239
    v_dot2c_f32_bf16 v234, v95, v238
    v_dot2c_f32_bf16 v235, v95, v239
    s_waitcnt vmcnt(19)
    v_dot2c_f32_bf16 v228, v148, v238
    v_dot2c_f32_bf16 v229, v148, v239
    v_dot2c_f32_bf16 v230, v149, v238
    v_dot2c_f32_bf16 v231, v149, v239
    v_dot2c_f32_bf16 v232, v150, v238
    v_dot2c_f32_bf16 v233, v150, v239
    v_dot2c_f32_bf16 v234, v151, v238
    v_dot2c_f32_bf16 v235, v151, v239
    s_waitcnt vmcnt(18)
    v_dot2c_f32_bf16 v228, v152, v238
    v_dot2c_f32_bf16 v229, v152, v239
    v_dot2c_f32_bf16 v230, v153, v238
    v_dot2c_f32_bf16 v231, v153, v239
    v_dot2c_f32_bf16 v232, v154, v238
    v_dot2c_f32_bf16 v233, v154, v239
    v_dot2c_f32_bf16 v234, v155, v238
    v_dot2c_f32_bf16 v235, v155, v239
    s_waitcnt vmcnt(17)
    v_dot2c_f32_bf16 v228, v156, v238
    v_dot2c_f32_bf16 v229, v156, v239
    v_dot2c_f32_bf16 v230, v157, v238
    v_dot2c_f32_bf16 v231, v157, v239
    v_dot2c_f32_bf16 v232, v158, v238
    v_dot2c_f32_bf16 v233, v158, v239
    v_dot2c_f32_bf16 v234, v159, v238
    v_dot2c_f32_bf16 v235, v159, v239
    s_waitcnt vmcnt(16)
    v_dot2c_f32_bf16 v228, v160, v238
    v_dot2c_f32_bf16 v229, v160, v239
    v_dot2c_f32_bf16 v230, v161, v238
    v_dot2c_f32_bf16 v231, v161, v239
    v_dot2c_f32_bf16 v232, v162, v238
    v_dot2c_f32_bf16 v233, v162, v239
    v_dot2c_f32_bf16 v234, v163, v238
    v_dot2c_f32_bf16 v235, v163, v239
    s_waitcnt vmcnt(15)
    v_dot2c_f32_bf16 v228, v60, v238
    v_dot2c_f32_bf16 v229, v60, v239
    v_dot2c_f32_bf16 v230, v61, v238
    v_dot2c_f32_bf16 v231, v61, v239
    v_dot2c_f32_bf16 v232, v62, v238
    v_dot2c_f32_bf16 v233, v62, v239
    v_dot2c_f32_bf16 v234, v63, v238
    v_dot2c_f32_bf16 v235, v63, v239
    s_waitcnt vmcnt(14)
    v_dot2c_f32_bf16 v228, v96, v238
    v_dot2c_f32_bf16 v229, v96, v239
    v_dot2c_f32_bf16 v230, v97, v238
    v_dot2c_f32_bf16 v231, v97, v239
    v_dot2c_f32_bf16 v232, v98, v238
    v_dot2c_f32_bf16 v233, v98, v239
    v_dot2c_f32_bf16 v234, v99, v238
    v_dot2c_f32_bf16 v235, v99, v239
    s_waitcnt vmcnt(13)
    v_dot2c_f32_bf16 v228, v100, v238
    v_dot2c_f32_bf16 v229, v100, v239
    v_dot2c_f32_bf16 v230, v101, v238
    v_dot2c_f32_bf16 v231, v101, v239
    v_dot2c_f32_bf16 v232, v102, v238
    v_dot2c_f32_bf16 v233, v102, v239
    v_dot2c_f32_bf16 v234, v103, v238
    v_dot2c_f32_bf16 v235, v103, v239
    s_waitcnt vmcnt(12)
    v_dot2c_f32_bf16 v228, v124, v238
    v_dot2c_f32_bf16 v229, v124, v239
    v_dot2c_f32_bf16 v230, v125, v238
    v_dot2c_f32_bf16 v231, v125, v239
    v_dot2c_f32_bf16 v232, v126, v238
    v_dot2c_f32_bf16 v233, v126, v239
    v_dot2c_f32_bf16 v234, v127, v238
    v_dot2c_f32_bf16 v235, v127, v239
    v_mul_u32_u24 v167, 2731, v174
    v_lshrrev_b32 v167, 16, v167
    v_mul_u32_u24 v167, 24, v167
    v_sub_u32 v167, v174, v167
    v_add_f32 v168, v228, v230
    v_add_f32 v169, v232, v234
    v_add_f32 v168, v168, v169
    v_cmp_gt_u32 s[90:91], 21, v167
    v_cmp_u_f32 vcc, v168, v168
    s_nop 0
    s_and_b64 vcc, vcc, s[90:91]
    s_cbranch_vccz L_gok_25
L_glp_26:
    s_waitcnt vmcnt(0)
    s_add_u32 s95, s59, 0
    buffer_load_dwordx4 v[64:67], v175, s[8:11], s95 offen sc1
    s_add_u32 s95, s59, 4096
    buffer_load_dwordx4 v[68:71], v175, s[8:11], s95 offen sc1
    s_add_u32 s95, s59, 8192
    buffer_load_dwordx4 v[72:75], v175, s[8:11], s95 offen sc1
    s_add_u32 s95, s59, 12288
    buffer_load_dwordx4 v[76:79], v175, s[8:11], s95 offen sc1
    s_add_u32 s95, s59, 16384
    buffer_load_dwordx4 v[80:83], v175, s[8:11], s95 offen sc1
    s_add_u32 s95, s59, 20480
    buffer_load_dwordx4 v[84:87], v175, s[8:11], s95 offen sc1
    s_add_u32 s95, s59, 24576
    buffer_load_dwordx4 v[88:91], v175, s[8:11], s95 offen sc1
    s_add_u32 s95, s59, 28672
    buffer_load_dwordx4 v[92:95], v175, s[8:11], s95 offen sc1
    s_add_u32 s95, s59, 32768
    buffer_load_dwordx4 v[148:151], v175, s[8:11], s95 offen sc1
    s_add_u32 s95, s59, 36864
    buffer_load_dwordx4 v[152:155], v175, s[8:11], s95 offen sc1
    s_add_u32 s95, s59, 40960
    buffer_load_dwordx4 v[156:159], v175, s[8:11], s95 offen sc1
    s_add_u32 s95, s59, 45056
    buffer_load_dwordx4 v[160:163], v175, s[8:11], s95 offen sc1
    s_add_u32 s95, s59, 49152
    buffer_load_dwordx4 v[60:63], v175, s[8:11], s95 offen sc1
    s_add_u32 s95, s59, 53248
    buffer_load_dwordx4 v[96:99], v175, s[8:11], s95 offen sc1
    s_add_u32 s95, s59, 57344
    buffer_load_dwordx4 v[100:103], v175, s[8:11], s95 offen sc1
    s_add_u32 s95, s59, 61440
    buffer_load_dwordx4 v[124:127], v175, s[8:11], s95 offen sc1
    v_mov_b32 v228, 0
    v_mov_b32 v229, 0
    v_mov_b32 v230, 0
    v_mov_b32 v231, 0
    v_mov_b32 v232, 0
    v_mov_b32 v233, 0
    v_mov_b32 v234, 0
    v_mov_b32 v235, 0
    s_waitcnt vmcnt(15)
    v_dot2c_f32_bf16 v228, v64, v238
    v_dot2c_f32_bf16 v229, v64, v239
    v_dot2c_f32_bf16 v230, v65, v238
    v_dot2c_f32_bf16 v231, v65, v239
    v_dot2c_f32_bf16 v232, v66, v238
    v_dot2c_f32_bf16 v233, v66, v239
    v_dot2c_f32_bf16 v234, v67, v238
    v_dot2c_f32_bf16 v235, v67, v239
    s_waitcnt vmcnt(14)
    v_dot2c_f32_bf16 v228, v68, v238
    v_dot2c_f32_bf16 v229, v68, v239
    v_dot2c_f32_bf16 v230, v69, v238
    v_dot2c_f32_bf16 v231, v69, v239
    v_dot2c_f32_bf16 v232, v70, v238
    v_dot2c_f32_bf16 v233, v70, v239
    v_dot2c_f32_bf16 v234, v71, v238
    v_dot2c_f32_bf16 v235, v71, v239
    s_waitcnt vmcnt(13)
    v_dot2c_f32_bf16 v228, v72, v238
    v_dot2c_f32_bf16 v229, v72, v239
    v_dot2c_f32_bf16 v230, v73, v238
    v_dot2c_f32_bf16 v231, v73, v239
    v_dot2c_f32_bf16 v232, v74, v238
    v_dot2c_f32_bf16 v233, v74, v239
    v_dot2c_f32_bf16 v234, v75, v238
    v_dot2c_f32_bf16 v235, v75, v239
    s_waitcnt vmcnt(12)
    v_dot2c_f32_bf16 v228, v76, v238
    v_dot2c_f32_bf16 v229, v76, v239
    v_dot2c_f32_bf16 v230, v77, v238
    v_dot2c_f32_bf16 v231, v77, v239
    v_dot2c_f32_bf16 v232, v78, v238
    v_dot2c_f32_bf16 v233, v78, v239
    v_dot2c_f32_bf16 v234, v79, v238
    v_dot2c_f32_bf16 v235, v79, v239
    s_waitcnt vmcnt(11)
    v_dot2c_f32_bf16 v228, v80, v238
    v_dot2c_f32_bf16 v229, v80, v239
    v_dot2c_f32_bf16 v230, v81, v238
    v_dot2c_f32_bf16 v231, v81, v239
    v_dot2c_f32_bf16 v232, v82, v238
    v_dot2c_f32_bf16 v233, v82, v239
    v_dot2c_f32_bf16 v234, v83, v238
    v_dot2c_f32_bf16 v235, v83, v239
    s_waitcnt vmcnt(10)
    v_dot2c_f32_bf16 v228, v84, v238
    v_dot2c_f32_bf16 v229, v84, v239
    v_dot2c_f32_bf16 v230, v85, v238
    v_dot2c_f32_bf16 v231, v85, v239
    v_dot2c_f32_bf16 v232, v86, v238
    v_dot2c_f32_bf16 v233, v86, v239
    v_dot2c_f32_bf16 v234, v87, v238
    v_dot2c_f32_bf16 v235, v87, v239
    s_waitcnt vmcnt(9)
    v_dot2c_f32_bf16 v228, v88, v238
    v_dot2c_f32_bf16 v229, v88, v239
    v_dot2c_f32_bf16 v230, v89, v238
    v_dot2c_f32_bf16 v231, v89, v239
    v_dot2c_f32_bf16 v232, v90, v238
    v_dot2c_f32_bf16 v233, v90, v239
    v_dot2c_f32_bf16 v234, v91, v238
    v_dot2c_f32_bf16 v235, v91, v239
    s_waitcnt vmcnt(8)
    v_dot2c_f32_bf16 v228, v92, v238
    v_dot2c_f32_bf16 v229, v92, v239
    v_dot2c_f32_bf16 v230, v93, v238
    v_dot2c_f32_bf16 v231, v93, v239
    v_dot2c_f32_bf16 v232, v94, v238
    v_dot2c_f32_bf16 v233, v94, v239
    v_dot2c_f32_bf16 v234, v95, v238
    v_dot2c_f32_bf16 v235, v95, v239
    s_waitcnt vmcnt(7)
    v_dot2c_f32_bf16 v228, v148, v238
    v_dot2c_f32_bf16 v229, v148, v239
    v_dot2c_f32_bf16 v230, v149, v238
    v_dot2c_f32_bf16 v231, v149, v239
    v_dot2c_f32_bf16 v232, v150, v238
    v_dot2c_f32_bf16 v233, v150, v239
    v_dot2c_f32_bf16 v234, v151, v238
    v_dot2c_f32_bf16 v235, v151, v239
    s_waitcnt vmcnt(6)
    v_dot2c_f32_bf16 v228, v152, v238
    v_dot2c_f32_bf16 v229, v152, v239
    v_dot2c_f32_bf16 v230, v153, v238
    v_dot2c_f32_bf16 v231, v153, v239
    v_dot2c_f32_bf16 v232, v154, v238
    v_dot2c_f32_bf16 v233, v154, v239
    v_dot2c_f32_bf16 v234, v155, v238
    v_dot2c_f32_bf16 v235, v155, v239
    s_waitcnt vmcnt(5)
    v_dot2c_f32_bf16 v228, v156, v238
    v_dot2c_f32_bf16 v229, v156, v239
    v_dot2c_f32_bf16 v230, v157, v238
    v_dot2c_f32_bf16 v231, v157, v239
    v_dot2c_f32_bf16 v232, v158, v238
    v_dot2c_f32_bf16 v233, v158, v239
    v_dot2c_f32_bf16 v234, v159, v238
    v_dot2c_f32_bf16 v235, v159, v239
    s_waitcnt vmcnt(4)
    v_dot2c_f32_bf16 v228, v160, v238
    v_dot2c_f32_bf16 v229, v160, v239
    v_dot2c_f32_bf16 v230, v161, v238
    v_dot2c_f32_bf16 v231, v161, v239
    v_dot2c_f32_bf16 v232, v162, v238
    v_dot2c_f32_bf16 v233, v162, v239
    v_dot2c_f32_bf16 v234, v163, v238
    v_dot2c_f32_bf16 v235, v163, v239
    s_waitcnt vmcnt(3)
    v_dot2c_f32_bf16 v228, v60, v238
    v_dot2c_f32_bf16 v229, v60, v239
    v_dot2c_f32_bf16 v230, v61, v238
    v_dot2c_f32_bf16 v231, v61, v239
    v_dot2c_f32_bf16 v232, v62, v238
    v_dot2c_f32_bf16 v233, v62, v239
    v_dot2c_f32_bf16 v234, v63, v238
    v_dot2c_f32_bf16 v235, v63, v239
    s_waitcnt vmcnt(2)
    v_dot2c_f32_bf16 v228, v96, v238
    v_dot2c_f32_bf16 v229, v96, v239
    v_dot2c_f32_bf16 v230, v97, v238
    v_dot2c_f32_bf16 v231, v97, v239
    v_dot2c_f32_bf16 v232, v98, v238
    v_dot2c_f32_bf16 v233, v98, v239
    v_dot2c_f32_bf16 v234, v99, v238
    v_dot2c_f32_bf16 v235, v99, v239
    s_waitcnt vmcnt(1)
    v_dot2c_f32_bf16 v228, v100, v238
    v_dot2c_f32_bf16 v229, v100, v239
    v_dot2c_f32_bf16 v230, v101, v238
    v_dot2c_f32_bf16 v231, v101, v239
    v_dot2c_f32_bf16 v232, v102, v238
    v_dot2c_f32_bf16 v233, v102, v239
    v_dot2c_f32_bf16 v234, v103, v238
    v_dot2c_f32_bf16 v235, v103, v239
    s_waitcnt vmcnt(0)
    v_dot2c_f32_bf16 v228, v124, v238
    v_dot2c_f32_bf16 v229, v124, v239
    v_dot2c_f32_bf16 v230, v125, v238
    v_dot2c_f32_bf16 v231, v125, v239
    v_dot2c_f32_bf16 v232, v126, v238
    v_dot2c_f32_bf16 v233, v126, v239
    v_dot2c_f32_bf16 v234, v127, v238
    v_dot2c_f32_bf16 v235, v127, v239
    v_mul_u32_u24 v167, 2731, v174
    v_lshrrev_b32 v167, 16, v167
    v_mul_u32_u24 v167, 24, v167
    v_sub_u32 v167, v174, v167
    v_add_f32 v168, v228, v230
    v_add_f32 v169, v232, v234
    v_add_f32 v168, v168, v169
    v_cmp_gt_u32 s[90:91], 21, v167
    v_cmp_u_f32 vcc, v168, v168
    s_nop 0
    s_and_b64 vcc, vcc, s[90:91]
    s_cbranch_vccz L_ok_27
    s_add_u32 s51, s51, 1
    s_cmp_gt_u32 s51, 200000
    s_cbranch_scc1 L_ok_27
    s_waitcnt vmcnt(0) lgkmcnt(0)
    s_sleep 1
    s_branch L_glp_26
L_ok_27:
L_gok_25:
    v_cvt_pk_bf16_f32 v236, v228, v229
    v_cvt_pk_bf16_f32 v237, v230, v231
    v_cvt_pk_bf16_f32 v238, v232, v233
    v_cvt_pk_bf16_f32 v239, v234, v235
    v_lshlrev_b32 v166, 4, v174
    v_add_u32 v166, 157696, v166
    ds_write_b128 v166, v[236:239]
    v_mov_b32 v24, 0
    v_mov_b32 v25, 0
    v_mov_b32 v26, 0
    v_mov_b32 v27, 0
    v_mov_b32 v28, 0
    v_mov_b32 v29, 0
    v_mov_b32 v30, 0
    v_mov_b32 v31, 0
    v_mov_b32 v32, 0
    v_mov_b32 v33, 0
    v_mov_b32 v34, 0
    v_mov_b32 v35, 0
    v_mov_b32 v36, 0
    v_mov_b32 v37, 0
    v_mov_b32 v38, 0
    v_mov_b32 v39, 0
    v_mov_b32 v40, 0
    v_mov_b32 v41, 0
    v_mov_b32 v42, 0
    v_mov_b32 v43, 0
    v_mov_b32 v44, 0
    v_mov_b32 v45, 0
    v_mov_b32 v46, 0
    v_mov_b32 v47, 0
    v_mov_b32 v48, 0
    v_mov_b32 v49, 0
    v_mov_b32 v50, 0
    v_mov_b32 v51, 0
    v_mov_b32 v52, 0
    v_mov_b32 v53, 0
    v_mov_b32 v54, 0
    v_mov_b32 v55, 0
    v_mov_b32 v128, 0
    v_mov_b32 v129, 0
    v_mov_b32 v130, 0
    v_mov_b32 v131, 0
    v_mov_b32 v132, 0
    v_mov_b32 v133, 0
    v_mov_b32 v134, 0
    v_mov_b32 v135, 0
    v_bfe_u32 v164, v21, 3, 2
    v_and_b32 v165, 3, v21
    v_lshl_add_u32 v164, v164, 2, v165
    v_lshlrev_b32 v164, 4, v164
    v_lshrrev_b32 v165, 5, v21
    v_mul_u32_u24 v165, 1920, v165
    v_add3_u32 v164, v164, v165, v165
    v_sub_u32 v164, v164, v165
    v_add_u32 v164, 157696, v164
    s_waitcnt lgkmcnt(0)
    s_barrier
    s_mov_b32 exec_lo, 0x0f0f0f0f
    s_mov_b32 exec_hi, 0xf0f0f0f0
    ds_read_b128 v[24:27], v164 offset:0
    ds_read_b128 v[28:31], v164 offset:256
    ds_read_b128 v[32:35], v164 offset:384
    ds_read_b128 v[36:39], v164 offset:640
    ds_read_b128 v[40:43], v164 offset:768
    ds_read_b128 v[44:47], v164 offset:1024
    ds_read_b128 v[48:51], v164 offset:1152
    ds_read_b128 v[52:55], v164 offset:1408
    ds_read_b128 v[128:131], v164 offset:1536
    ds_read_b128 v[132:135], v164 offset:1792
    s_mov_b64 exec, -1
    s_waitcnt lgkmcnt(8)
    v_mfma_f32_32x32x16_bf16 v[80:95], v[24:27], v[104:107], 0
    v_mfma_f32_32x32x16_bf16 v[64:79], v[28:31], v[104:107], 0
    s_waitcnt lgkmcnt(6)
    v_mfma_f32_32x32x16_bf16 v[80:95], v[32:35], v[108:111], v[80:95]
    v_mfma_f32_32x32x16_bf16 v[64:79], v[36:39], v[108:111], v[64:79]
    s_waitcnt lgkmcnt(4)
    v_mfma_f32_32x32x16_bf16 v[80:95], v[40:43], v[112:115], v[80:95]
    v_mfma_f32_32x32x16_bf16 v[64:79], v[44:47], v[112:115], v[64:79]
    s_waitcnt lgkmcnt(2)
    v_mfma_f32_32x32x16_bf16 v[80:95], v[48:51], v[116:119], v[80:95]
    v_mfma_f32_32x32x16_bf16 v[64:79], v[52:55], v[116:119], v[64:79]
    s_waitcnt lgkmcnt(0)
    v_mfma_f32_32x32x16_bf16 v[80:95], v[128:131], v[120:123], v[80:95]
    v_mfma_f32_32x32x16_bf16 v[64:79], v[132:135], v[120:123], v[64:79]
    s_nop 11
    v_add_f32 v164, 0x358637bd, v68
    v_rcp_f32 v164, v164
    s_nop 0
    v_pk_mul_f32 v[80:81], v[80:81], v[164:165] op_sel_hi:[1,0]
    v_pk_mul_f32 v[82:83], v[82:83], v[164:165] op_sel_hi:[1,0]
    v_pk_mul_f32 v[84:85], v[84:85], v[164:165] op_sel_hi:[1,0]
    v_pk_mul_f32 v[86:87], v[86:87], v[164:165] op_sel_hi:[1,0]
    v_pk_mul_f32 v[88:89], v[88:89], v[164:165] op_sel_hi:[1,0]
    v_pk_mul_f32 v[90:91], v[90:91], v[164:165] op_sel_hi:[1,0]
    v_pk_mul_f32 v[92:93], v[92:93], v[164:165] op_sel_hi:[1,0]
    v_pk_mul_f32 v[94:95], v[94:95], v[164:165] op_sel_hi:[1,0]
    v_pk_mul_f32 v[64:65], v[64:65], v[164:165] op_sel_hi:[1,0]
    v_pk_mul_f32 v[66:67], v[66:67], v[164:165] op_sel_hi:[1,0]
    v_cvt_pk_bf16_f32 v80, v80, v81
    v_cvt_pk_bf16_f32 v81, v82, v83
    v_cvt_pk_bf16_f32 v82, v84, v85
    v_cvt_pk_bf16_f32 v83, v86, v87
    v_cvt_pk_bf16_f32 v84, v88, v89
    v_cvt_pk_bf16_f32 v85, v90, v91
    v_cvt_pk_bf16_f32 v86, v92, v93
    v_cvt_pk_bf16_f32 v87, v94, v95
    v_cvt_pk_bf16_f32 v88, v64, v65
    v_cvt_pk_bf16_f32 v89, v66, v67
    s_nop 0
    v_permlane32_swap_b32 v88, v90
    v_permlane32_swap_b32 v89, v91
    s_mul_i32 s52, s49, 40960
    s_lshl_b32 s53, s46, 10
    s_add_u32 s52, s52, 10485760
    s_add_u32 s53, s53, s52
    s_lshl_b32 s54, s46, 8
    s_add_u32 s54, s54, s52
    s_add_u32 s54, s54, 16384
    buffer_store_dwordx4 v[80:83], v14, s[8:11], s53 offen sc1
    buffer_store_dwordx4 v[84:87], v14, s[8:11], s53 offen offset:256 sc1
    s_mov_b64 exec, 0xffffffff
    buffer_store_dwordx4 v[88:91], v14, s[8:11], s54 offen sc1
    s_mov_b64 exec, -1
    s_waitcnt vmcnt(3)
    s_barrier
    s_mul_i32 s59, s50, 20480
    s_add_u32 s59, s59, 10485760
    s_add_u32 s60, s59, 16384
    v_add_u32 v166, s89, v1
    v_add_u32 v167, 0x10000, v166
    ds_write_b128 v166, a[160:163] offset:0
    ds_write_b128 v166, a[164:167] offset:4096
    ds_write_b128 v166, a[168:171] offset:8192
    ds_write_b128 v166, a[172:175] offset:12288
    ds_write_b128 v166, a[176:179] offset:16384
    ds_write_b128 v166, a[180:183] offset:20480
    ds_write_b128 v166, a[184:187] offset:24576
    ds_write_b128 v166, a[188:191] offset:28672
    ds_write_b128 v166, a[192:195] offset:32768
    ds_write_b128 v166, a[196:199] offset:36864
    ds_write_b128 v166, a[200:203] offset:40960
    ds_write_b128 v166, a[204:207] offset:45056
    v_add_u32 v175, 0x10000, v10
L_wo_28:
    buffer_load_dwordx4 v[24:27], v1, s[8:11], s60 offen offset:0 sc1
    buffer_load_dwordx4 v[28:31], v1, s[8:11], s60 offen offset:1024 sc1
    buffer_load_dwordx4 v[32:35], v1, s[8:11], s60 offen offset:2048 sc1
    buffer_load_dwordx4 v[36:39], v1, s[8:11], s60 offen offset:3072 sc1
    v_lshlrev_b32 v64, 16, v200
    v_and_b32 v65, 0xffff0000, v200
    v_lshlrev_b32 v66, 16, v201
    v_and_b32 v67, 0xffff0000, v201
    v_lshlrev_b32 v68, 16, v202
    v_and_b32 v69, 0xffff0000, v202
    v_lshlrev_b32 v70, 16, v203
    v_and_b32 v71, 0xffff0000, v203
    v_lshlrev_b32 v72, 16, v204
    v_and_b32 v73, 0xffff0000, v204
    v_lshlrev_b32 v74, 16, v205
    v_and_b32 v75, 0xffff0000, v205
    v_lshlrev_b32 v76, 16, v206
    v_and_b32 v77, 0xffff0000, v206
    v_lshlrev_b32 v78, 16, v207
    v_and_b32 v79, 0xffff0000, v207
    v_lshlrev_b32 v80, 16, v208
    v_and_b32 v81, 0xffff0000, v208
    v_lshlrev_b32 v82, 16, v209
    v_and_b32 v83, 0xffff0000, v209
    s_waitcnt vmcnt(0)
    v_max3_u32 v164, v24, v25, v26
    v_max3_u32 v164, v164, v27, v28
    v_max3_u32 v164, v164, v29, v30
    v_max3_u32 v164, v164, v31, v32
    v_max3_u32 v164, v164, v33, v34
    v_max3_u32 v164, v164, v35, v36
    v_max3_u32 v164, v164, v37, v38
    v_max_u32 v164, v164, v39
    v_cmp_eq_u32 vcc, -1, v164
    s_cbranch_vccz L_ok_29
    s_add_u32 s51, s51, 1
    s_cmp_gt_u32 s51, 200000
    s_cbranch_scc1 L_ok_29
    s_waitcnt vmcnt(0) lgkmcnt(0)
    s_sleep 2
    s_branch L_wo_28
L_ok_29:
    s_add_u32 s61, s59, 0
    buffer_load_dwordx4 a[0:3], v1, s[8:11], s61 offen offset:0 sc1
    buffer_load_dwordx4 a[4:7], v1, s[8:11], s61 offen offset:1024 sc1
    buffer_load_dwordx4 a[8:11], v1, s[8:11], s61 offen offset:2048 sc1
    buffer_load_dwordx4 a[12:15], v1, s[8:11], s61 offen offset:3072 sc1
    s_add_u32 s61, s59, 4096
    buffer_load_dwordx4 a[16:19], v1, s[8:11], s61 offen offset:0 sc1
    buffer_load_dwordx4 a[20:23], v1, s[8:11], s61 offen offset:1024 sc1
    buffer_load_dwordx4 a[24:27], v1, s[8:11], s61 offen offset:2048 sc1
    buffer_load_dwordx4 a[28:31], v1, s[8:11], s61 offen offset:3072 sc1
    s_add_u32 s61, s59, 8192
    buffer_load_dwordx4 a[32:35], v1, s[8:11], s61 offen offset:0 sc1
    buffer_load_dwordx4 a[36:39], v1, s[8:11], s61 offen offset:1024 sc1
    ds_read_b128 v[84:87], v175 offset:16384
    ds_read_b128 v[88:91], v175 offset:17408
    ds_read_b128 v[92:95], v175 offset:18432
    ds_read_b128 v[96:99], v175 offset:19456
    ds_read_b128 v[100:103], v175 offset:20480
    ds_read_b128 v[104:107], v175 offset:21504
    ds_read_b128 v[108:111], v175 offset:22528
    s_waitcnt lgkmcnt(6)
    v_mfma_f32_16x16x32_bf16 v[64:67], v[84:87], v[24:27], v[64:67]
    ds_read_b128 v[112:115], v175 offset:23552
    buffer_load_dwordx4 a[40:43], v1, s[8:11], s61 offen offset:2048 sc1
    s_waitcnt lgkmcnt(6)
    v_mfma_f32_16x16x32_bf16 v[68:71], v[88:91], v[24:27], v[68:71]
    ds_read_b128 v[116:119], v175 offset:24576
    s_waitcnt lgkmcnt(6)
    v_mfma_f32_16x16x32_bf16 v[72:75], v[92:95], v[24:27], v[72:75]
    ds_read_b128 v[84:87], v175 offset:25600
    s_waitcnt lgkmcnt(6)
    v_mfma_f32_16x16x32_bf16 v[76:79], v[96:99], v[24:27], v[76:79]
    ds_read_b128 v[88:91], v175 offset:26624
    s_waitcnt lgkmcnt(6)
    v_mfma_f32_16x16x32_bf16 v[80:83], v[100:103], v[24:27], v[80:83]
    ds_read_b128 v[92:95], v175 offset:27648
    buffer_load_dwordx4 a[44:47], v1, s[8:11], s61 offen offset:3072 sc1
    s_waitcnt lgkmcnt(6)
    v_mfma_f32_16x16x32_bf16 v[64:67], v[104:107], v[28:31], v[64:67]
    ds_read_b128 v[96:99], v175 offset:28672
    s_waitcnt lgkmcnt(6)
    v_mfma_f32_16x16x32_bf16 v[68:71], v[108:111], v[28:31], v[68:71]
    ds_read_b128 v[100:103], v175 offset:29696
    s_waitcnt lgkmcnt(6)
    v_mfma_f32_16x16x32_bf16 v[72:75], v[112:115], v[28:31], v[72:75]
    ds_read_b128 v[104:107], v175 offset:30720
    s_waitcnt lgkmcnt(6)
    v_mfma_f32_16x16x32_bf16 v[76:79], v[116:119], v[28:31], v[76:79]
    ds_read_b128 v[108:111], v175 offset:31744
    s_add_u32 s61, s59, 12288
    buffer_load_dwordx4 a[48:51], v1, s[8:11], s61 offen offset:0 sc1
    s_waitcnt lgkmcnt(6)
    v_mfma_f32_16x16x32_bf16 v[80:83], v[84:87], v[28:31], v[80:83]
    ds_read_b128 v[112:115], v175 offset:32768
    s_waitcnt lgkmcnt(6)
    v_mfma_f32_16x16x32_bf16 v[64:67], v[88:91], v[32:35], v[64:67]
    ds_read_b128 v[116:119], v175 offset:33792
    s_waitcnt lgkmcnt(6)
    v_mfma_f32_16x16x32_bf16 v[68:71], v[92:95], v[32:35], v[68:71]
    ds_read_b128 v[84:87], v175 offset:34816
    s_waitcnt lgkmcnt(6)
    v_mfma_f32_16x16x32_bf16 v[72:75], v[96:99], v[32:35], v[72:75]
    ds_read_b128 v[88:91], v175 offset:35840
    buffer_load_dwordx4 a[52:55], v1, s[8:11], s61 offen offset:1024 sc1
    s_waitcnt lgkmcnt(6)
    v_mfma_f32_16x16x32_bf16 v[76:79], v[100:103], v[32:35], v[76:79]
    ds_read_b128 v[92:95], v10 offset:0
    s_waitcnt lgkmcnt(6)
    v_mfma_f32_16x16x32_bf16 v[80:83], v[104:107], v[32:35], v[80:83]
    ds_read_b128 v[96:99], v10 offset:1024
    s_waitcnt lgkmcnt(6)
    v_mfma_f32_16x16x32_bf16 v[64:67], v[108:111], v[36:39], v[64:67]
    ds_read_b128 v[100:103], v10 offset:2048
    s_waitcnt lgkmcnt(6)
    v_mfma_f32_16x16x32_bf16 v[68:71], v[112:115], v[36:39], v[68:71]
    ds_read_b128 v[104:107], v10 offset:3072
    buffer_load_dwordx4 a[56:59], v1, s[8:11], s61 offen offset:2048 sc1
    s_waitcnt lgkmcnt(6)
    v_mfma_f32_16x16x32_bf16 v[72:75], v[116:119], v[36:39], v[72:75]
    ds_read_b128 v[108:111], v10 offset:4096
    s_waitcnt lgkmcnt(6)
    v_mfma_f32_16x16x32_bf16 v[76:79], v[84:87], v[36:39], v[76:79]
    ds_read_b128 v[112:115], v10 offset:5120
    s_waitcnt lgkmcnt(6)
    v_mfma_f32_16x16x32_bf16 v[80:83], v[88:91], v[36:39], v[80:83]
    ds_read_b128 v[116:119], v10 offset:6144
    s_waitcnt vmcnt(14) lgkmcnt(6)
    v_mfma_f32_16x16x32_bf16 v[64:67], v[92:95], a[0:3], v[64:67]
    ds_read_b128 v[84:87], v10 offset:7168
    buffer_load_dwordx4 a[60:63], v1, s[8:11], s61 offen offset:3072 sc1
    s_waitcnt lgkmcnt(6)
    v_mfma_f32_16x16x32_bf16 v[68:71], v[96:99], a[0:3], v[68:71]
    ds_read_b128 v[88:91], v10 offset:8192
    s_waitcnt lgkmcnt(6)
    v_mfma_f32_16x16x32_bf16 v[72:75], v[100:103], a[0:3], v[72:75]
    ds_read_b128 v[92:95], v10 offset:9216
    s_waitcnt lgkmcnt(6)
    v_mfma_f32_16x16x32_bf16 v[76:79], v[104:107], a[0:3], v[76:79]
    ds_read_b128 v[96:99], v10 offset:10240
    s_waitcnt lgkmcnt(6)
    v_mfma_f32_16x16x32_bf16 v[80:83], v[108:111], a[0:3], v[80:83]
    ds_read_b128 v[100:103], v10 offset:11264
    s_waitcnt vmcnt(14) lgkmcnt(6)
    v_mfma_f32_16x16x32_bf16 v[64:67], v[112:115], a[4:7], v[64:67]
    ds_read_b128 v[104:107], v10 offset:12288
    s_waitcnt lgkmcnt(6)
    v_mfma_f32_16x16x32_bf16 v[68:71], v[116:119], a[4:7], v[68:71]
    ds_read_b128 v[108:111], v10 offset:13312
    s_waitcnt lgkmcnt(6)
    v_mfma_f32_16x16x32_bf16 v[72:75], v[84:87], a[4:7], v[72:75]
    ds_read_b128 v[112:115], v10 offset:14336
    s_waitcnt lgkmcnt(6)
    v_mfma_f32_16x16x32_bf16 v[76:79], v[88:91], a[4:7], v[76:79]
    ds_read_b128 v[116:119], v10 offset:15360
    s_waitcnt lgkmcnt(6)
    v_mfma_f32_16x16x32_bf16 v[80:83], v[92:95], a[4:7], v[80:83]
    ds_read_b128 v[84:87], v10 offset:16384
    s_waitcnt vmcnt(13) lgkmcnt(6)
    v_mfma_f32_16x16x32_bf16 v[64:67], v[96:99], a[8:11], v[64:67]
    ds_read_b128 v[88:91], v10 offset:17408
    s_waitcnt lgkmcnt(6)
    v_mfma_f32_16x16x32_bf16 v[68:71], v[100:103], a[8:11], v[68:71]
    ds_read_b128 v[92:95], v10 offset:18432
    s_waitcnt lgkmcnt(6)
    v_mfma_f32_16x16x32_bf16 v[72:75], v[104:107], a[8:11], v[72:75]
    ds_read_b128 v[96:99], v10 offset:19456
    s_waitcnt lgkmcnt(6)
    v_mfma_f32_16x16x32_bf16 v[76:79], v[108:111], a[8:11], v[76:79]
    ds_read_b128 v[100:103], v10 offset:20480
    s_waitcnt lgkmcnt(6)
    v_mfma_f32_16x16x32_bf16 v[80:83], v[112:115], a[8:11], v[80:83]
    ds_read_b128 v[104:107], v10 offset:21504
    s_waitcnt vmcnt(12) lgkmcnt(6)
    v_mfma_f32_16x16x32_bf16 v[64:67], v[116:119], a[12:15], v[64:67]
    ds_read_b128 v[108:111], v10 offset:22528
    s_waitcnt lgkmcnt(6)
    v_mfma_f32_16x16x32_bf16 v[68:71], v[84:87], a[12:15], v[68:71]
    ds_read_b128 v[112:115], v10 offset:23552
    s_waitcnt lgkmcnt(6)
    v_mfma_f32_16x16x32_bf16 v[72:75], v[88:91], a[12:15], v[72:75]
    ds_read_b128 v[116:119], v10 offset:24576
    s_waitcnt lgkmcnt(6)
    v_mfma_f32_16x16x32_bf16 v[76:79], v[92:95], a[12:15], v[76:79]
    ds_read_b128 v[84:87], v10 offset:25600
    s_waitcnt lgkmcnt(6)
    v_mfma_f32_16x16x32_bf16 v[80:83], v[96:99], a[12:15], v[80:83]
    ds_read_b128 v[88:91], v10 offset:26624
    s_waitcnt vmcnt(11) lgkmcnt(6)
    v_mfma_f32_16x16x32_bf16 v[64:67], v[100:103], a[16:19], v[64:67]
    ds_read_b128 v[92:95], v10 offset:27648
    s_waitcnt lgkmcnt(6)
    v_mfma_f32_16x16x32_bf16 v[68:71], v[104:107], a[16:19], v[68:71]
    ds_read_b128 v[96:99], v10 offset:28672
    s_waitcnt lgkmcnt(6)
    v_mfma_f32_16x16x32_bf16 v[72:75], v[108:111], a[16:19], v[72:75]
    ds_read_b128 v[100:103], v10 offset:29696
    s_waitcnt lgkmcnt(6)
    v_mfma_f32_16x16x32_bf16 v[76:79], v[112:115], a[16:19], v[76:79]
    ds_read_b128 v[104:107], v10 offset:30720
    s_waitcnt lgkmcnt(6)
    v_mfma_f32_16x16x32_bf16 v[80:83], v[116:119], a[16:19], v[80:83]
    ds_read_b128 v[108:111], v10 offset:31744
    s_waitcnt vmcnt(10) lgkmcnt(6)
    v_mfma_f32_16x16x32_bf16 v[64:67], v[84:87], a[20:23], v[64:67]
    ds_read_b128 v[112:115], v10 offset:32768
    s_waitcnt lgkmcnt(6)
    v_mfma_f32_16x16x32_bf16 v[68:71], v[88:91], a[20:23], v[68:71]
    ds_read_b128 v[116:119], v10 offset:33792
    s_waitcnt lgkmcnt(6)
    v_mfma_f32_16x16x32_bf16 v[72:75], v[92:95], a[20:23], v[72:75]
    ds_read_b128 v[84:87], v10 offset:34816
    s_waitcnt lgkmcnt(6)
    v_mfma_f32_16x16x32_bf16 v[76:79], v[96:99], a[20:23], v[76:79]
    ds_read_b128 v[88:91], v10 offset:35840
    s_waitcnt lgkmcnt(6)
    v_mfma_f32_16x16x32_bf16 v[80:83], v[100:103], a[20:23], v[80:83]
    ds_read_b128 v[92:95], v10 offset:36864
    s_waitcnt vmcnt(9) lgkmcnt(6)
    v_mfma_f32_16x16x32_bf16 v[64:67], v[104:107], a[24:27], v[64:67]
    ds_read_b128 v[96:99], v10 offset:37888
    s_waitcnt lgkmcnt(6)
    v_mfma_f32_16x16x32_bf16 v[68:71], v[108:111], a[24:27], v[68:71]
    ds_read_b128 v[100:103], v10 offset:38912
    s_waitcnt lgkmcnt(6)
    v_mfma_f32_16x16x32_bf16 v[72:75], v[112:115], a[24:27], v[72:75]
    ds_read_b128 v[104:107], v10 offset:39936
    s_waitcnt lgkmcnt(6)
    v_mfma_f32_16x16x32_bf16 v[76:79], v[116:119], a[24:27], v[76:79]
    ds_read_b128 v[108:111], v10 offset:40960
    s_waitcnt lgkmcnt(6)
    v_mfma_f32_16x16x32_bf16 v[80:83], v[84:87], a[24:27], v[80:83]
    ds_read_b128 v[112:115], v10 offset:41984
    s_waitcnt vmcnt(8) lgkmcnt(6)
    v_mfma_f32_16x16x32_bf16 v[64:67], v[88:91], a[28:31], v[64:67]
    ds_read_b128 v[116:119], v10 offset:43008
    s_waitcnt lgkmcnt(6)
    v_mfma_f32_16x16x32_bf16 v[68:71], v[92:95], a[28:31], v[68:71]
    ds_read_b128 v[84:87], v10 offset:44032
    s_waitcnt lgkmcnt(6)
    v_mfma_f32_16x16x32_bf16 v[72:75], v[96:99], a[28:31], v[72:75]
    ds_read_b128 v[88:91], v10 offset:45056
    s_waitcnt lgkmcnt(6)
    v_mfma_f32_16x16x32_bf16 v[76:79], v[100:103], a[28:31], v[76:79]
    ds_read_b128 v[92:95], v10 offset:46080
    s_waitcnt lgkmcnt(6)
    v_mfma_f32_16x16x32_bf16 v[80:83], v[104:107], a[28:31], v[80:83]
    ds_read_b128 v[96:99], v10 offset:47104
    s_waitcnt vmcnt(7) lgkmcnt(6)
    v_mfma_f32_16x16x32_bf16 v[64:67], v[108:111], a[32:35], v[64:67]
    ds_read_b128 v[100:103], v10 offset:48128
    s_waitcnt lgkmcnt(6)
    v_mfma_f32_16x16x32_bf16 v[68:71], v[112:115], a[32:35], v[68:71]
    ds_read_b128 v[104:107], v10 offset:49152
    s_waitcnt lgkmcnt(6)
    v_mfma_f32_16x16x32_bf16 v[72:75], v[116:119], a[32:35], v[72:75]
    ds_read_b128 v[108:111], v10 offset:50176
    s_waitcnt lgkmcnt(6)
    v_mfma_f32_16x16x32_bf16 v[76:79], v[84:87], a[32:35], v[76:79]
    ds_read_b128 v[112:115], v10 offset:51200
    s_waitcnt lgkmcnt(6)
    v_mfma_f32_16x16x32_bf16 v[80:83], v[88:91], a[32:35], v[80:83]
    ds_read_b128 v[116:119], v10 offset:52224
    s_waitcnt vmcnt(6) lgkmcnt(6)
    v_mfma_f32_16x16x32_bf16 v[64:67], v[92:95], a[36:39], v[64:67]
    ds_read_b128 v[84:87], v10 offset:53248
    s_waitcnt lgkmcnt(6)
    v_mfma_f32_16x16x32_bf16 v[68:71], v[96:99], a[36:39], v[68:71]
    ds_read_b128 v[88:91], v10 offset:54272
    s_waitcnt lgkmcnt(6)
    v_mfma_f32_16x16x32_bf16 v[72:75], v[100:103], a[36:39], v[72:75]
    ds_read_b128 v[92:95], v10 offset:55296
    s_waitcnt lgkmcnt(6)
    v_mfma_f32_16x16x32_bf16 v[76:79], v[104:107], a[36:39], v[76:79]
    ds_read_b128 v[96:99], v10 offset:56320
    s_waitcnt lgkmcnt(6)
    v_mfma_f32_16x16x32_bf16 v[80:83], v[108:111], a[36:39], v[80:83]
    ds_read_b128 v[100:103], v10 offset:57344
    s_waitcnt vmcnt(5) lgkmcnt(6)
    v_mfma_f32_16x16x32_bf16 v[64:67], v[112:115], a[40:43], v[64:67]
    ds_read_b128 v[104:107], v10 offset:58368
    s_waitcnt lgkmcnt(6)
    v_mfma_f32_16x16x32_bf16 v[68:71], v[116:119], a[40:43], v[68:71]
    ds_read_b128 v[108:111], v10 offset:59392
    s_waitcnt lgkmcnt(6)
    v_mfma_f32_16x16x32_bf16 v[72:75], v[84:87], a[40:43], v[72:75]
    ds_read_b128 v[112:115], v10 offset:60416
    s_waitcnt lgkmcnt(6)
    v_mfma_f32_16x16x32_bf16 v[76:79], v[88:91], a[40:43], v[76:79]
    ds_read_b128 v[116:119], v10 offset:61440
    s_waitcnt lgkmcnt(6)
    v_mfma_f32_16x16x32_bf16 v[80:83], v[92:95], a[40:43], v[80:83]
    ds_read_b128 v[84:87], v10 offset:62464
    s_waitcnt vmcnt(4) lgkmcnt(6)
    v_mfma_f32_16x16x32_bf16 v[64:67], v[96:99], a[44:47], v[64:67]
    ds_read_b128 v[88:91], v10 offset:63488
    s_waitcnt lgkmcnt(6)
    v_mfma_f32_16x16x32_bf16 v[68:71], v[100:103], a[44:47], v[68:71]
    ds_read_b128 v[92:95], v10 offset:64512
    s_waitcnt lgkmcnt(6)
    v_mfma_f32_16x16x32_bf16 v[72:75], v[104:107], a[44:47], v[72:75]
    ds_read_b128 v[96:99], v175 offset:0
    s_waitcnt lgkmcnt(6)
    v_mfma_f32_16x16x32_bf16 v[76:79], v[108:111], a[44:47], v[76:79]
    ds_read_b128 v[100:103], v175 offset:1024
    s_waitcnt lgkmcnt(6)
    v_mfma_f32_16x16x32_bf16 v[80:83], v[112:115], a[44:47], v[80:83]
    ds_read_b128 v[104:107], v175 offset:2048
    s_waitcnt vmcnt(3) lgkmcnt(6)
    v_mfma_f32_16x16x32_bf16 v[64:67], v[116:119], a[48:51], v[64:67]
    ds_read_b128 v[108:111], v175 offset:3072
    s_waitcnt lgkmcnt(6)
    v_mfma_f32_16x16x32_bf16 v[68:71], v[84:87], a[48:51], v[68:71]
    ds_read_b128 v[112:115], v175 offset:4096
    s_waitcnt lgkmcnt(6)
    v_mfma_f32_16x16x32_bf16 v[72:75], v[88:91], a[48:51], v[72:75]
    ds_read_b128 v[116:119], v175 offset:5120
    s_waitcnt lgkmcnt(6)
    v_mfma_f32_16x16x32_bf16 v[76:79], v[92:95], a[48:51], v[76:79]
    ds_read_b128 v[84:87], v175 offset:6144
    s_waitcnt lgkmcnt(6)
    v_mfma_f32_16x16x32_bf16 v[80:83], v[96:99], a[48:51], v[80:83]
    ds_read_b128 v[88:91], v175 offset:7168
    s_waitcnt vmcnt(2) lgkmcnt(6)
    v_mfma_f32_16x16x32_bf16 v[64:67], v[100:103], a[52:55], v[64:67]
    ds_read_b128 v[92:95], v175 offset:8192
    s_waitcnt lgkmcnt(6)
    v_mfma_f32_16x16x32_bf16 v[68:71], v[104:107], a[52:55], v[68:71]
    ds_read_b128 v[96:99], v175 offset:9216
    s_waitcnt lgkmcnt(6)
    v_mfma_f32_16x16x32_bf16 v[72:75], v[108:111], a[52:55], v[72:75]
    ds_read_b128 v[100:103], v175 offset:10240
    s_waitcnt lgkmcnt(6)
    v_mfma_f32_16x16x32_bf16 v[76:79], v[112:115], a[52:55], v[76:79]
    ds_read_b128 v[104:107], v175 offset:11264
    s_waitcnt lgkmcnt(6)
    v_mfma_f32_16x16x32_bf16 v[80:83], v[116:119], a[52:55], v[80:83]
    ds_read_b128 v[108:111], v175 offset:12288
    s_waitcnt vmcnt(1) lgkmcnt(6)
    v_mfma_f32_16x16x32_bf16 v[64:67], v[84:87], a[56:59], v[64:67]
    ds_read_b128 v[112:115], v175 offset:13312
    s_waitcnt lgkmcnt(6)
    v_mfma_f32_16x16x32_bf16 v[68:71], v[88:91], a[56:59], v[68:71]
    ds_read_b128 v[116:119], v175 offset:14336
    s_waitcnt lgkmcnt(6)
    v_mfma_f32_16x16x32_bf16 v[72:75], v[92:95], a[56:59], v[72:75]
    ds_read_b128 v[84:87], v175 offset:15360
    s_waitcnt lgkmcnt(6)
    v_mfma_f32_16x16x32_bf16 v[76:79], v[96:99], a[56:59], v[76:79]
    s_waitcnt lgkmcnt(5)
    v_mfma_f32_16x16x32_bf16 v[80:83], v[100:103], a[56:59], v[80:83]
    s_waitcnt vmcnt(0) lgkmcnt(4)
    v_mfma_f32_16x16x32_bf16 v[64:67], v[104:107], a[60:63], v[64:67]
    s_waitcnt lgkmcnt(3)
    v_mfma_f32_16x16x32_bf16 v[68:71], v[108:111], a[60:63], v[68:71]
    s_waitcnt lgkmcnt(2)
    v_mfma_f32_16x16x32_bf16 v[72:75], v[112:115], a[60:63], v[72:75]
    s_waitcnt lgkmcnt(1)
    v_mfma_f32_16x16x32_bf16 v[76:79], v[116:119], a[60:63], v[76:79]
    s_waitcnt lgkmcnt(0)
    v_mfma_f32_16x16x32_bf16 v[80:83], v[84:87], a[60:63], v[80:83]
    s_nop 7
    v_cmp_u_f32 vcc, v80, v80
    s_cbranch_vccz L_ok_30
    s_add_u32 s51, s51, 1
    s_cmp_gt_u32 s51, 200000
    s_cbranch_scc1 L_ok_30
    s_waitcnt vmcnt(0) lgkmcnt(0)
    s_sleep 2
    s_branch L_wo_28
L_ok_30:
    v_cvt_pk_bf16_f32 v40, v64, v65
    v_cvt_pk_bf16_f32 v41, v66, v67
    v_cvt_pk_bf16_f32 v42, v68, v69
    v_cvt_pk_bf16_f32 v43, v70, v71
    v_cvt_pk_bf16_f32 v44, v72, v73
    v_cvt_pk_bf16_f32 v45, v74, v75
    v_cvt_pk_bf16_f32 v46, v76, v77
    v_cvt_pk_bf16_f32 v47, v78, v79
    v_cvt_pk_bf16_f32 v48, v80, v81
    v_cvt_pk_bf16_f32 v49, v82, v83
    v_mov_b32 v200, v40
    v_mov_b32 v201, v41
    v_mov_b32 v202, v42
    v_mov_b32 v203, v43
    v_mov_b32 v204, v44
    v_mov_b32 v205, v45
    v_mov_b32 v206, v46
    v_mov_b32 v207, v47
    v_mov_b32 v208, v48
    v_mov_b32 v209, v49
    v_permlane16_swap_b32 v40, v42
    v_permlane16_swap_b32 v41, v43
    v_permlane16_swap_b32 v44, v46
    v_permlane16_swap_b32 v45, v47
    v_permlane16_swap_b32 v48, v50
    v_permlane16_swap_b32 v49, v51
    s_lshr_b32 s52, s50, 1
    s_mul_i32 s52, s52, 40960
    s_mul_i32 s53, s47, 5120
    s_add_u32 s52, s52, s53
    s_add_u32 s52, s52, 2621440
    s_add_u32 s53, s52, 4096
    s_lshl_b32 s54, s50, 10
    s_lshl_b32 s55, s47, 7
    s_add_u32 s54, s54, s55
    s_add_u32 s54, s54, 18481152
    buffer_store_dwordx4 v[40:43], v11, s[8:11], s52 offen sc1
    buffer_store_dwordx4 v[44:47], v11, s[8:11], s52 offen offset:2048 sc1
    s_mov_b32 exec_lo, 0xffff
    s_mov_b32 exec_hi, 0xffff
    buffer_store_dwordx4 v[48:51], v11, s[8:11], s53 offen sc1
    s_mov_b64 exec, -1
    v_mov_b32 v164, 0
    v_mov_b32 v165, 0
    v_dot2c_f32_bf16 v164, v200, v22
    v_dot2c_f32_bf16 v165, v200, v200
    v_dot2c_f32_bf16 v164, v201, v22
    v_dot2c_f32_bf16 v165, v201, v201
    v_dot2c_f32_bf16 v164, v202, v22
    v_dot2c_f32_bf16 v165, v202, v202
    v_dot2c_f32_bf16 v164, v203, v22
    v_dot2c_f32_bf16 v165, v203, v203
    v_dot2c_f32_bf16 v164, v204, v22
    v_dot2c_f32_bf16 v165, v204, v204
    v_dot2c_f32_bf16 v164, v205, v22
    v_dot2c_f32_bf16 v165, v205, v205
    v_dot2c_f32_bf16 v164, v206, v22
    v_dot2c_f32_bf16 v165, v206, v206
    v_dot2c_f32_bf16 v164, v207, v22
    v_dot2c_f32_bf16 v165, v207, v207
    v_dot2c_f32_bf16 v164, v208, v22
    v_dot2c_f32_bf16 v165, v208, v208
    v_dot2c_f32_bf16 v164, v209, v22
    v_dot2c_f32_bf16 v165, v209, v209
    s_nop 1
    v_mov_b32 v166, v164
    v_mov_b32 v167, v165
    s_nop 0
    v_permlane16_swap_b32 v164, v166
    v_permlane16_swap_b32 v165, v167
    v_pk_add_f32 v[164:165], v[164:165], v[166:167]
    v_mov_b32 v166, v164
    v_mov_b32 v167, v165
    s_nop 0
    v_permlane32_swap_b32 v164, v166
    v_permlane32_swap_b32 v165, v167
    v_pk_add_f32 v[164:165], v[164:165], v[166:167]
    s_mov_b64 exec, 0xffff
    buffer_store_dwordx2 v[164:165], v12, s[8:11], s54 offen sc1
    s_mov_b64 exec, -1
    s_barrier
    v_add_u32 v172, s89, v1
    v_add_u32 v173, 0x10000, v172
    ds_write_b128 v172, a[208:211] offset:49152
    ds_write_b128 v172, a[212:215] offset:53248
    ds_write_b128 v172, a[216:219] offset:57344
    ds_write_b128 v172, a[220:223] offset:61440
    ds_write_b128 v173, a[224:227] offset:0
    ds_write_b128 v173, a[228:231] offset:4096
    ds_write_b128 v173, a[232:235] offset:8192
    ds_write_b128 v173, a[236:239] offset:12288
    ds_write_b128 v173, a[240:243] offset:16384
    ds_write_b128 v173, a[244:247] offset:20480
    ds_write_b128 v173, a[248:251] offset:24576
    ds_write_b128 v173, a[252:255] offset:28672
    ds_write_b128 v173, v[240:243] offset:32768
    ds_write_b128 v173, v[244:247] offset:36864
    ds_write_b128 v173, v[248:251] offset:40960
    ds_write_b128 v173, v[252:255] offset:45056
    s_mov_b32 s98, s88
    s_mul_i32 s88, s46, 153600
    s_lshl_b32 s89, s44, 10
    s_add_u32 s88, s88, s89
    s_add_u32 s88, s88, 23461888
    s_lshl_b32 s59, s49, 11
    s_add_u32 s59, s59, 18481152
    s_mul_i32 s60, s49, 40960
    s_add_u32 s60, s60, 2621440
    s_mov_b32 s99, 0
L_qkv_31:
    buffer_load_dwordx2 v[164:165], v13, s[8:11], s59 offen offset:0 sc1
    buffer_load_dwordx2 v[166:167], v13, s[8:11], s59 offen offset:128 sc1
    buffer_load_dwordx2 v[168:169], v13, s[8:11], s59 offen offset:256 sc1
    buffer_load_dwordx2 v[170:171], v13, s[8:11], s59 offen offset:384 sc1
    ds_read_b128 v[64:67], v19 offset:0
    ds_read_b128 v[68:71], v19 offset:16
    ds_read_b128 v[72:75], v19 offset:32
    ds_read_b128 v[76:79], v19 offset:48
    ds_read_b128 v[80:83], v19 offset:64
    ds_read_b128 v[84:87], v19 offset:80
    ds_read_b128 v[88:91], v19 offset:96
    ds_read_b128 v[92:95], v19 offset:112
    ds_read_b128 v[96:99], v19 offset:128
    ds_read_b128 v[100:103], v19 offset:144
    ds_read_b128 v[104:107], v19 offset:160
    ds_read_b128 v[108:111], v19 offset:176
    ds_read_b128 v[112:115], v19 offset:192
    ds_read_b128 v[116:119], v19 offset:208
    ds_read_b128 v[120:123], v19 offset:224
    ds_read_b128 v[124:127], v19 offset:240
    s_waitcnt vmcnt(0)
    v_pk_add_f32 v[164:165], v[164:165], v[166:167]
    v_pk_add_f32 v[168:169], v[168:169], v[170:171]
    v_pk_add_f32 v[164:165], v[164:165], v[168:169]
    v_cmp_u_f32 vcc, v164, v164
    s_cbranch_vccz L_ok_32
    s_add_u32 s51, s51, 1
    s_cmp_gt_u32 s51, 200000
    s_cbranch_scc1 L_ok_32
    s_waitcnt vmcnt(0) lgkmcnt(0)
    s_sleep 2
    s_branch L_qkv_31
L_ok_32:
    s_add_u32 s61, s60, 0
    buffer_load_dwordx4 a[0:3], v1, s[8:11], s61 offen offset:0 sc1
    buffer_load_dwordx4 a[4:7], v1, s[8:11], s61 offen offset:1024 sc1
    buffer_load_dwordx4 a[8:11], v1, s[8:11], s61 offen offset:2048 sc1
    buffer_load_dwordx4 a[12:15], v1, s[8:11], s61 offen offset:3072 sc1
    s_add_u32 s61, s60, 4096
    buffer_load_dwordx4 a[16:19], v1, s[8:11], s61 offen offset:0 sc1
    buffer_load_dwordx4 a[20:23], v1, s[8:11], s61 offen offset:1024 sc1
    buffer_load_dwordx4 a[24:27], v1, s[8:11], s61 offen offset:2048 sc1
    buffer_load_dwordx4 a[28:31], v1, s[8:11], s61 offen offset:3072 sc1
    s_add_u32 s61, s60, 8192
    buffer_load_dwordx4 a[32:35], v1, s[8:11], s61 offen offset:0 sc1
    buffer_load_dwordx4 a[36:39], v1, s[8:11], s61 offen offset:1024 sc1
    v_mov_b32 v166, v164
    v_mov_b32 v167, v165
    s_nop 0
    v_permlane32_swap_b32 v164, v166
    v_permlane32_swap_b32 v165, v167
    v_pk_add_f32 v[164:165], v[164:165], v[166:167]
    s_mov_b32 s56, 0x3acccccd
    v_mul_f32 v210, s56, v164
    v_mul_f32 v0, s56, v165
    v_fma_f32 v0, -v210, v210, v0
    v_max_f32 v0, 0, v0
    v_add_f32 v0, 0x3727c5ac, v0
    v_rsq_f32 v0, v0
    v_sub_f32 v210, 0, v210
    s_waitcnt lgkmcnt(12)
    v_pk_mul_f32 v[64:65], v[64:65], v[210:211] op_sel_hi:[1,0]
    v_pk_mul_f32 v[66:67], v[66:67], v[210:211] op_sel_hi:[1,0]
    v_pk_mul_f32 v[68:69], v[68:69], v[210:211] op_sel_hi:[1,0]
    v_pk_mul_f32 v[70:71], v[70:71], v[210:211] op_sel_hi:[1,0]
    v_pk_mul_f32 v[72:73], v[72:73], v[210:211] op_sel_hi:[1,0]
    v_pk_mul_f32 v[74:75], v[74:75], v[210:211] op_sel_hi:[1,0]
    v_pk_mul_f32 v[76:77], v[76:77], v[210:211] op_sel_hi:[1,0]
    v_pk_mul_f32 v[78:79], v[78:79], v[210:211] op_sel_hi:[1,0]
    s_waitcnt lgkmcnt(8)
    v_pk_mul_f32 v[80:81], v[80:81], v[210:211] op_sel_hi:[1,0]
    v_pk_mul_f32 v[82:83], v[82:83], v[210:211] op_sel_hi:[1,0]
    v_pk_mul_f32 v[84:85], v[84:85], v[210:211] op_sel_hi:[1,0]
    v_pk_mul_f32 v[86:87], v[86:87], v[210:211] op_sel_hi:[1,0]
    v_pk_mul_f32 v[88:89], v[88:89], v[210:211] op_sel_hi:[1,0]
    v_pk_mul_f32 v[90:91], v[90:91], v[210:211] op_sel_hi:[1,0]
    v_pk_mul_f32 v[92:93], v[92:93], v[210:211] op_sel_hi:[1,0]
    v_pk_mul_f32 v[94:95], v[94:95], v[210:211] op_sel_hi:[1,0]
    s_waitcnt lgkmcnt(4)
    v_pk_mul_f32 v[96:97], v[96:97], v[210:211] op_sel_hi:[1,0]
    v_pk_mul_f32 v[98:99], v[98:99], v[210:211] op_sel_hi:[1,0]
    v_pk_mul_f32 v[100:101], v[100:101], v[210:211] op_sel_hi:[1,0]
    v_pk_mul_f32 v[102:103], v[102:103], v[210:211] op_sel_hi:[1,0]
    v_pk_mul_f32 v[104:105], v[104:105], v[210:211] op_sel_hi:[1,0]
    v_pk_mul_f32 v[106:107], v[106:107], v[210:211] op_sel_hi:[1,0]
    v_pk_mul_f32 v[108:109], v[108:109], v[210:211] op_sel_hi:[1,0]
    v_pk_mul_f32 v[110:111], v[110:111], v[210:211] op_sel_hi:[1,0]
    s_waitcnt lgkmcnt(0)
    v_pk_mul_f32 v[112:113], v[112:113], v[210:211] op_sel_hi:[1,0]
    v_pk_mul_f32 v[114:115], v[114:115], v[210:211] op_sel_hi:[1,0]
    v_pk_mul_f32 v[116:117], v[116:117], v[210:211] op_sel_hi:[1,0]
    v_pk_mul_f32 v[118:119], v[118:119], v[210:211] op_sel_hi:[1,0]
    v_pk_mul_f32 v[120:121], v[120:121], v[210:211] op_sel_hi:[1,0]
    v_pk_mul_f32 v[122:123], v[122:123], v[210:211] op_sel_hi:[1,0]
    v_pk_mul_f32 v[124:125], v[124:125], v[210:211] op_sel_hi:[1,0]
    v_pk_mul_f32 v[126:127], v[126:127], v[210:211] op_sel_hi:[1,0]
    s_waitcnt lgkmcnt(0)
    s_cmp_eq_u32 s99, 0
    s_cbranch_scc0 L_skb_33
    s_barrier
    s_mov_b32 s99, 1
L_skb_33:
    ds_read_b128 v[128:131], v2 offset:0
    ds_read_b128 v[132:135], v2 offset:1024
    ds_read_b128 v[136:139], v4 offset:2048
    ds_read_b128 v[140:143], v2 offset:2816
    ds_read_b128 v[144:147], v2 offset:3840
    ds_read_b128 v[148:151], v4 offset:4864
    s_waitcnt vmcnt(9) lgkmcnt(5)
    v_mfma_f32_32x32x16_bf16 v[64:79], v[128:131], a[0:3], v[64:79]
    ds_read_b128 v[152:155], v2 offset:5632
    s_waitcnt lgkmcnt(5)
    v_mfma_f32_32x32x16_bf16 v[80:95], v[132:135], a[0:3], v[80:95]
    ds_read_b128 v[156:159], v2 offset:6656
    buffer_load_dwordx4 a[40:43], v1, s[8:11], s61 offen offset:2048 sc1
    s_waitcnt lgkmcnt(5)
    v_mfma_f32_32x32x16_bf16 v[96:111], v[136:139], a[0:3], v[96:111]
    ds_read_b128 v[160:163], v4 offset:7680
    s_waitcnt vmcnt(9) lgkmcnt(5)
    v_mfma_f32_32x32x16_bf16 v[64:79], v[140:143], a[4:7], v[64:79]
    ds_read_b128 v[128:131], v2 offset:8448
    buffer_load_dwordx4 a[44:47], v1, s[8:11], s61 offen offset:3072 sc1
    s_waitcnt lgkmcnt(5)
    v_mfma_f32_32x32x16_bf16 v[80:95], v[144:147], a[4:7], v[80:95]
    ds_read_b128 v[132:135], v2 offset:9472
    s_waitcnt lgkmcnt(5)
    v_mfma_f32_32x32x16_bf16 v[96:111], v[148:151], a[4:7], v[96:111]
    ds_read_b128 v[136:139], v4 offset:10496
    s_add_u32 s61, s60, 12288
    buffer_load_dwordx4 a[48:51], v1, s[8:11], s61 offen offset:0 sc1
    s_waitcnt vmcnt(10) lgkmcnt(5)
    v_mfma_f32_32x32x16_bf16 v[64:79], v[152:155], a[8:11], v[64:79]
    ds_read_b128 v[140:143], v2 offset:11264
    s_waitcnt lgkmcnt(5)
    v_mfma_f32_32x32x16_bf16 v[80:95], v[156:159], a[8:11], v[80:95]
    ds_read_b128 v[144:147], v2 offset:12288
    buffer_load_dwordx4 a[52:55], v1, s[8:11], s61 offen offset:1024 sc1
    s_waitcnt lgkmcnt(5)
    v_mfma_f32_32x32x16_bf16 v[96:111], v[160:163], a[8:11], v[96:111]
    ds_read_b128 v[148:151], v4 offset:13312
    s_waitcnt vmcnt(10) lgkmcnt(5)
    v_mfma_f32_32x32x16_bf16 v[64:79], v[128:131], a[12:15], v[64:79]
    ds_read_b128 v[152:155], v2 offset:14080
    buffer_load_dwordx4 a[56:59], v1, s[8:11], s61 offen offset:2048 sc1
    s_waitcnt lgkmcnt(5)
    v_mfma_f32_32x32x16_bf16 v[80:95], v[132:135], a[12:15], v[80:95]
    ds_read_b128 v[156:159], v2 offset:15104
    s_waitcnt lgkmcnt(5)
    v_mfma_f32_32x32x16_bf16 v[96:111], v[136:139], a[12:15], v[96:111]
    ds_read_b128 v[160:163], v4 offset:16128
    buffer_load_dwordx4 a[60:63], v1, s[8:11], s61 offen offset:3072 sc1
    s_waitcnt vmcnt(11) lgkmcnt(5)
    v_mfma_f32_32x32x16_bf16 v[64:79], v[140:143], a[16:19], v[64:79]
    ds_read_b128 v[128:131], v2 offset:16896
    s_waitcnt lgkmcnt(5)
    v_mfma_f32_32x32x16_bf16 v[80:95], v[144:147], a[16:19], v[80:95]
    ds_read_b128 v[132:135], v2 offset:17920
    s_add_u32 s61, s60, 16384
    buffer_load_dwordx4 a[64:67], v1, s[8:11], s61 offen offset:0 sc1
    s_waitcnt lgkmcnt(5)
    v_mfma_f32_32x32x16_bf16 v[96:111], v[148:151], a[16:19], v[96:111]
    ds_read_b128 v[136:139], v4 offset:18944
    s_waitcnt vmcnt(11) lgkmcnt(5)
    v_mfma_f32_32x32x16_bf16 v[64:79], v[152:155], a[20:23], v[64:79]
    ds_read_b128 v[140:143], v2 offset:19712
    buffer_load_dwordx4 a[68:71], v1, s[8:11], s61 offen offset:1024 sc1
    s_waitcnt lgkmcnt(5)
    v_mfma_f32_32x32x16_bf16 v[80:95], v[156:159], a[20:23], v[80:95]
    ds_read_b128 v[144:147], v2 offset:20736
    s_waitcnt lgkmcnt(5)
    v_mfma_f32_32x32x16_bf16 v[96:111], v[160:163], a[20:23], v[96:111]
    ds_read_b128 v[148:151], v4 offset:21760
    buffer_load_dwordx4 a[72:75], v1, s[8:11], s61 offen offset:2048 sc1
    s_waitcnt vmcnt(12) lgkmcnt(5)
    v_mfma_f32_32x32x16_bf16 v[64:79], v[128:131], a[24:27], v[64:79]
    ds_read_b128 v[152:155], v2 offset:22528
    s_waitcnt lgkmcnt(5)
    v_mfma_f32_32x32x16_bf16 v[80:95], v[132:135], a[24:27], v[80:95]
    ds_read_b128 v[156:159], v2 offset:23552
    buffer_load_dwordx4 a[76:79], v1, s[8:11], s61 offen offset:3072 sc1
    s_waitcnt lgkmcnt(5)
    v_mfma_f32_32x32x16_bf16 v[96:111], v[136:139], a[24:27], v[96:111]
    ds_read_b128 v[160:163], v4 offset:24576
    s_waitcnt vmcnt(12) lgkmcnt(5)
    v_mfma_f32_32x32x16_bf16 v[64:79], v[140:143], a[28:31], v[64:79]
    ds_read_b128 v[128:131], v2 offset:25344
    s_add_u32 s61, s60, 20480
    buffer_load_dwordx4 a[80:83], v1, s[8:11], s61 offen offset:0 sc1
    s_waitcnt lgkmcnt(5)
    v_mfma_f32_32x32x16_bf16 v[80:95], v[144:147], a[28:31], v[80:95]
    ds_read_b128 v[132:135], v2 offset:26368
    s_waitcnt lgkmcnt(5)
    v_mfma_f32_32x32x16_bf16 v[96:111], v[148:151], a[28:31], v[96:111]
    ds_read_b128 v[136:139], v4 offset:27392
    buffer_load_dwordx4 a[84:87], v1, s[8:11], s61 offen offset:1024 sc1
    s_waitcnt vmcnt(13) lgkmcnt(5)
    v_mfma_f32_32x32x16_bf16 v[64:79], v[152:155], a[32:35], v[64:79]
    ds_read_b128 v[140:143], v2 offset:28160
    s_waitcnt lgkmcnt(5)
    v_mfma_f32_32x32x16_bf16 v[80:95], v[156:159], a[32:35], v[80:95]
    ds_read_b128 v[144:147], v2 offset:29184
    buffer_load_dwordx4 a[88:91], v1, s[8:11], s61 offen offset:2048 sc1
    s_waitcnt lgkmcnt(5)
    v_mfma_f32_32x32x16_bf16 v[96:111], v[160:163], a[32:35], v[96:111]
    ds_read_b128 v[148:151], v4 offset:30208
    s_waitcnt vmcnt(13) lgkmcnt(5)
    v_mfma_f32_32x32x16_bf16 v[64:79], v[128:131], a[36:39], v[64:79]
    ds_read_b128 v[152:155], v2 offset:30976
    buffer_load_dwordx4 a[92:95], v1, s[8:11], s61 offen offset:3072 sc1
    s_waitcnt lgkmcnt(5)
    v_mfma_f32_32x32x16_bf16 v[80:95], v[132:135], a[36:39], v[80:95]
    ds_read_b128 v[156:159], v2 offset:32000
    s_waitcnt lgkmcnt(5)
    v_mfma_f32_32x32x16_bf16 v[96:111], v[136:139], a[36:39], v[96:111]
    ds_read_b128 v[160:163], v4 offset:33024
    s_add_u32 s61, s60, 24576
    buffer_load_dwordx4 a[96:99], v1, s[8:11], s61 offen offset:0 sc1
    s_waitcnt vmcnt(14) lgkmcnt(5)
    v_mfma_f32_32x32x16_bf16 v[64:79], v[140:143], a[40:43], v[64:79]
    ds_read_b128 v[128:131], v2 offset:33792
    s_waitcnt lgkmcnt(5)
    v_mfma_f32_32x32x16_bf16 v[80:95], v[144:147], a[40:43], v[80:95]
    ds_read_b128 v[132:135], v2 offset:34816
    buffer_load_dwordx4 a[100:103], v1, s[8:11], s61 offen offset:1024 sc1
    s_waitcnt lgkmcnt(5)
    v_mfma_f32_32x32x16_bf16 v[96:111], v[148:151], a[40:43], v[96:111]
    ds_read_b128 v[136:139], v4 offset:35840
    s_waitcnt vmcnt(14) lgkmcnt(5)
    v_mfma_f32_32x32x16_bf16 v[64:79], v[152:155], a[44:47], v[64:79]
    ds_read_b128 v[140:143], v2 offset:36608
    buffer_load_dwordx4 a[104:107], v1, s[8:11], s61 offen offset:2048 sc1
    s_waitcnt lgkmcnt(5)
    v_mfma_f32_32x32x16_bf16 v[80:95], v[156:159], a[44:47], v[80:95]
    ds_read_b128 v[144:147], v2 offset:37632
    s_waitcnt lgkmcnt(5)
    v_mfma_f32_32x32x16_bf16 v[96:111], v[160:163], a[44:47], v[96:111]
    ds_read_b128 v[148:151], v4 offset:38656
    buffer_load_dwordx4 a[108:111], v1, s[8:11], s61 offen offset:3072 sc1
    s_waitcnt vmcnt(15) lgkmcnt(5)
    v_mfma_f32_32x32x16_bf16 v[64:79], v[128:131], a[48:51], v[64:79]
    ds_read_b128 v[152:155], v2 offset:39424
    s_waitcnt lgkmcnt(5)
    v_mfma_f32_32x32x16_bf16 v[80:95], v[132:135], a[48:51], v[80:95]
    ds_read_b128 v[156:159], v2 offset:40448
    s_add_u32 s61, s60, 28672
    buffer_load_dwordx4 a[112:115], v1, s[8:11], s61 offen offset:0 sc1
    s_waitcnt lgkmcnt(5)
    v_mfma_f32_32x32x16_bf16 v[96:111], v[136:139], a[48:51], v[96:111]
    ds_read_b128 v[160:163], v4 offset:41472
    s_waitcnt vmcnt(15) lgkmcnt(5)
    v_mfma_f32_32x32x16_bf16 v[64:79], v[140:143], a[52:55], v[64:79]
    ds_read_b128 v[128:131], v2 offset:42240
    buffer_load_dwordx4 a[116:119], v1, s[8:11], s61 offen offset:1024 sc1
    s_waitcnt lgkmcnt(5)
    v_mfma_f32_32x32x16_bf16 v[80:95], v[144:147], a[52:55], v[80:95]
    ds_read_b128 v[132:135], v2 offset:43264
    s_waitcnt lgkmcnt(5)
    v_mfma_f32_32x32x16_bf16 v[96:111], v[148:151], a[52:55], v[96:111]
    ds_read_b128 v[136:139], v4 offset:44288
    buffer_load_dwordx4 a[120:123], v1, s[8:11], s61 offen offset:2048 sc1
    s_waitcnt vmcnt(16) lgkmcnt(5)
    v_mfma_f32_32x32x16_bf16 v[64:79], v[152:155], a[56:59], v[64:79]
    ds_read_b128 v[140:143], v2 offset:45056
    s_waitcnt lgkmcnt(5)
    v_mfma_f32_32x32x16_bf16 v[80:95], v[156:159], a[56:59], v[80:95]
    ds_read_b128 v[144:147], v2 offset:46080
    buffer_load_dwordx4 a[124:127], v1, s[8:11], s61 offen offset:3072 sc1
    s_waitcnt lgkmcnt(5)
    v_mfma_f32_32x32x16_bf16 v[96:111], v[160:163], a[56:59], v[96:111]
    ds_read_b128 v[148:151], v4 offset:47104
    s_waitcnt vmcnt(16) lgkmcnt(5)
    v_mfma_f32_32x32x16_bf16 v[64:79], v[128:131], a[60:63], v[64:79]
    ds_read_b128 v[152:155], v2 offset:47872
    s_add_u32 s61, s60, 32768
    buffer_load_dwordx4 a[128:131], v1, s[8:11], s61 offen offset:0 sc1
    s_waitcnt lgkmcnt(5)
    v_mfma_f32_32x32x16_bf16 v[80:95], v[132:135], a[60:63], v[80:95]
    ds_read_b128 v[156:159], v2 offset:48896
    s_waitcnt lgkmcnt(5)
    v_mfma_f32_32x32x16_bf16 v[96:111], v[136:139], a[60:63], v[96:111]
    ds_read_b128 v[160:163], v4 offset:49920
    buffer_load_dwordx4 a[132:135], v1, s[8:11], s61 offen offset:1024 sc1
    s_waitcnt vmcnt(17) lgkmcnt(5)
    v_mfma_f32_32x32x16_bf16 v[64:79], v[140:143], a[64:67], v[64:79]
    ds_read_b128 v[128:131], v2 offset:50688
    s_waitcnt lgkmcnt(5)
    v_mfma_f32_32x32x16_bf16 v[80:95], v[144:147], a[64:67], v[80:95]
    ds_read_b128 v[132:135], v2 offset:51712
    buffer_load_dwordx4 a[136:139], v1, s[8:11], s61 offen offset:2048 sc1
    s_waitcnt lgkmcnt(5)
    v_mfma_f32_32x32x16_bf16 v[96:111], v[148:151], a[64:67], v[96:111]
    ds_read_b128 v[136:139], v4 offset:52736
    s_waitcnt vmcnt(17) lgkmcnt(5)
    v_mfma_f32_32x32x16_bf16 v[64:79], v[152:155], a[68:71], v[64:79]
    ds_read_b128 v[140:143], v2 offset:53504
    buffer_load_dwordx4 a[140:143], v1, s[8:11], s61 offen offset:3072 sc1
    s_waitcnt lgkmcnt(5)
    v_mfma_f32_32x32x16_bf16 v[80:95], v[156:159], a[68:71], v[80:95]
    ds_read_b128 v[144:147], v2 offset:54528
    s_waitcnt lgkmcnt(5)
    v_mfma_f32_32x32x16_bf16 v[96:111], v[160:163], a[68:71], v[96:111]
    ds_read_b128 v[148:151], v4 offset:55552
    s_add_u32 s61, s60, 36864
    buffer_load_dwordx4 a[144:147], v1, s[8:11], s61 offen offset:0 sc1
    s_waitcnt vmcnt(18) lgkmcnt(5)
    v_mfma_f32_32x32x16_bf16 v[64:79], v[128:131], a[72:75], v[64:79]
    ds_read_b128 v[152:155], v3 offset:0
    s_waitcnt lgkmcnt(5)
    v_mfma_f32_32x32x16_bf16 v[80:95], v[132:135], a[72:75], v[80:95]
    ds_read_b128 v[156:159], v3 offset:1024
    buffer_load_dwordx4 a[148:151], v1, s[8:11], s61 offen offset:1024 sc1
    s_waitcnt lgkmcnt(5)
    v_mfma_f32_32x32x16_bf16 v[96:111], v[136:139], a[72:75], v[96:111]
    ds_read_b128 v[160:163], v5 offset:2048
    s_waitcnt vmcnt(18) lgkmcnt(5)
    v_mfma_f32_32x32x16_bf16 v[64:79], v[140:143], a[76:79], v[64:79]
    ds_read_b128 v[128:131], v3 offset:2816
    buffer_load_dwordx4 a[152:155], v1, s[8:11], s61 offen offset:2048 sc1
    s_waitcnt lgkmcnt(5)
    v_mfma_f32_32x32x16_bf16 v[80:95], v[144:147], a[76:79], v[80:95]
    ds_read_b128 v[132:135], v3 offset:3840
    s_waitcnt lgkmcnt(5)
    v_mfma_f32_32x32x16_bf16 v[96:111], v[148:151], a[76:79], v[96:111]
    ds_read_b128 v[136:139], v5 offset:4864
    buffer_load_dwordx4 a[156:159], v1, s[8:11], s61 offen offset:3072 sc1
    s_waitcnt vmcnt(19) lgkmcnt(5)
    v_mfma_f32_32x32x16_bf16 v[64:79], v[152:155], a[80:83], v[64:79]
    ds_read_b128 v[140:143], v3 offset:5632
    s_waitcnt lgkmcnt(5)
    v_mfma_f32_32x32x16_bf16 v[80:95], v[156:159], a[80:83], v[80:95]
    ds_read_b128 v[144:147], v3 offset:6656
    s_add_u32 s94, s89, 114688
    s_mov_b32 m0, s94
    s_add_u32 s95, s98, 114688
    buffer_load_dwordx4 v1, s[8:11], s95 offen lds
    s_waitcnt lgkmcnt(5)
    v_mfma_f32_32x32x16_bf16 v[96:111], v[160:163], a[80:83], v[96:111]
    ds_read_b128 v[148:151], v5 offset:7680
    s_waitcnt vmcnt(19) lgkmcnt(5)
    v_mfma_f32_32x32x16_bf16 v[64:79], v[128:131], a[84:87], v[64:79]
    ds_read_b128 v[152:155], v3 offset:8448
    s_add_u32 s94, s89, 118784
    s_mov_b32 m0, s94
    s_add_u32 s95, s98, 118784
    buffer_load_dwordx4 v1, s[8:11], s95 offen lds
    s_waitcnt lgkmcnt(5)
    v_mfma_f32_32x32x16_bf16 v[80:95], v[132:135], a[84:87], v[80:95]
    ds_read_b128 v[156:159], v3 offset:9472
    s_waitcnt lgkmcnt(5)
    v_mfma_f32_32x32x16_bf16 v[96:111], v[136:139], a[84:87], v[96:111]
    ds_read_b128 v[160:163], v5 offset:10496
    s_add_u32 s94, s89, 122880
    s_mov_b32 m0, s94
    s_add_u32 s95, s98, 122880
    buffer_load_dwordx4 v1, s[8:11], s95 offen lds
    s_waitcnt vmcnt(20) lgkmcnt(5)
    v_mfma_f32_32x32x16_bf16 v[64:79], v[140:143], a[88:91], v[64:79]
    ds_read_b128 v[128:131], v3 offset:11264
    s_waitcnt lgkmcnt(5)
    v_mfma_f32_32x32x16_bf16 v[80:95], v[144:147], a[88:91], v[80:95]
    ds_read_b128 v[132:135], v3 offset:12288
    s_add_u32 s94, s89, 126976
    s_mov_b32 m0, s94
    s_add_u32 s95, s98, 126976
    buffer_load_dwordx4 v1, s[8:11], s95 offen lds
    s_waitcnt lgkmcnt(5)
    v_mfma_f32_32x32x16_bf16 v[96:111], v[148:151], a[88:91], v[96:111]
    ds_read_b128 v[136:139], v5 offset:13312
    s_waitcnt vmcnt(20) lgkmcnt(5)
    v_mfma_f32_32x32x16_bf16 v[64:79], v[152:155], a[92:95], v[64:79]
    ds_read_b128 v[140:143], v3 offset:14080
    s_add_u32 s94, s89, 131072
    s_mov_b32 m0, s94
    s_add_u32 s95, s98, 131072
    buffer_load_dwordx4 v1, s[8:11], s95 offen lds
    s_waitcnt lgkmcnt(5)
    v_mfma_f32_32x32x16_bf16 v[80:95], v[156:159], a[92:95], v[80:95]
    ds_read_b128 v[144:147], v3 offset:15104
    s_waitcnt lgkmcnt(5)
    v_mfma_f32_32x32x16_bf16 v[96:111], v[160:163], a[92:95], v[96:111]
    ds_read_b128 v[148:151], v5 offset:16128
    s_add_u32 s94, s89, 135168
    s_mov_b32 m0, s94
    s_add_u32 s95, s98, 135168
    buffer_load_dwordx4 v1, s[8:11], s95 offen lds
    s_waitcnt vmcnt(21) lgkmcnt(5)
    v_mfma_f32_32x32x16_bf16 v[64:79], v[128:131], a[96:99], v[64:79]
    ds_read_b128 v[152:155], v3 offset:16896
    s_waitcnt lgkmcnt(5)
    v_mfma_f32_32x32x16_bf16 v[80:95], v[132:135], a[96:99], v[80:95]
    ds_read_b128 v[156:159], v3 offset:17920
    s_add_u32 s94, s89, 139264
    s_mov_b32 m0, s94
    s_add_u32 s95, s98, 139264
    buffer_load_dwordx4 v1, s[8:11], s95 offen lds
    s_waitcnt lgkmcnt(5)
    v_mfma_f32_32x32x16_bf16 v[96:111], v[136:139], a[96:99], v[96:111]
    ds_read_b128 v[160:163], v5 offset:18944
    s_waitcnt vmcnt(21) lgkmcnt(5)
    v_mfma_f32_32x32x16_bf16 v[64:79], v[140:143], a[100:103], v[64:79]
    ds_read_b128 v[128:131], v3 offset:19712
    s_add_u32 s94, s89, 143360
    s_mov_b32 m0, s94
    s_add_u32 s95, s98, 143360
    buffer_load_dwordx4 v1, s[8:11], s95 offen lds
    s_waitcnt lgkmcnt(5)
    v_mfma_f32_32x32x16_bf16 v[80:95], v[144:147], a[100:103], v[80:95]
    ds_read_b128 v[132:135], v3 offset:20736
    s_waitcnt lgkmcnt(5)
    v_mfma_f32_32x32x16_bf16 v[96:111], v[148:151], a[100:103], v[96:111]
    ds_read_b128 v[136:139], v5 offset:21760
    s_add_u32 s94, s89, 147456
    s_mov_b32 m0, s94
    s_add_u32 s95, s98, 147456
    buffer_load_dwordx4 v1, s[8:11], s95 offen lds
    s_waitcnt vmcnt(22) lgkmcnt(5)
    v_mfma_f32_32x32x16_bf16 v[64:79], v[152:155], a[104:107], v[64:79]
    ds_read_b128 v[140:143], v3 offset:22528
    s_waitcnt lgkmcnt(5)
    v_mfma_f32_32x32x16_bf16 v[80:95], v[156:159], a[104:107], v[80:95]
    ds_read_b128 v[144:147], v3 offset:23552
    s_add_u32 s94, s89, 151552
    s_cmp_lt_u32 s44, 2
    s_cselect_b32 s94, s94, 0x30000
    s_mov_b32 m0, s94
    s_add_u32 s95, s98, 151552
    buffer_load_dwordx4 v1, s[8:11], s95 offen lds
    v_mov_b32 v228, -1
    v_mov_b32 v229, -1
    s_waitcnt lgkmcnt(5)
    v_mfma_f32_32x32x16_bf16 v[96:111], v[160:163], a[104:107], v[96:111]
    ds_read_b128 v[148:151], v5 offset:24576
    v_mov_b32 v230, -1
    v_mov_b32 v231, -1
    s_waitcnt vmcnt(22) lgkmcnt(5)
    v_mfma_f32_32x32x16_bf16 v[64:79], v[128:131], a[108:111], v[64:79]
    ds_read_b128 v[152:155], v3 offset:25344
    s_lshr_b32 s70, s50, 1
    s_mul_i32 s70, s70, 40960
    s_mul_i32 s71, s47, 5120
    s_add_u32 s70, s70, s71
    s_add_u32 s70, s70, 5242880
    s_add_u32 s71, s70, 4096
    s_lshl_b32 s72, s50, 10
    s_lshl_b32 s73, s47, 7
    s_add_u32 s72, s72, s73
    s_add_u32 s72, s72, 18612224
    buffer_store_dwordx4 v[228:231], v11, s[8:11], s70 offen sc1
    s_waitcnt lgkmcnt(5)
    v_mfma_f32_32x32x16_bf16 v[80:95], v[132:135], a[108:111], v[80:95]
    ds_read_b128 v[156:159], v3 offset:26368
    s_waitcnt lgkmcnt(5)
    v_mfma_f32_32x32x16_bf16 v[96:111], v[136:139], a[108:111], v[96:111]
    ds_read_b128 v[160:163], v5 offset:27392
    buffer_store_dwordx4 v[228:231], v11, s[8:11], s70 offen offset:2048 sc1
    s_waitcnt vmcnt(23) lgkmcnt(5)
    v_mfma_f32_32x32x16_bf16 v[64:79], v[140:143], a[112:115], v[64:79]
    ds_read_b128 v[128:131], v3 offset:28160
    s_waitcnt lgkmcnt(5)
    v_mfma_f32_32x32x16_bf16 v[80:95], v[144:147], a[112:115], v[80:95]
    ds_read_b128 v[132:135], v3 offset:29184
    s_mov_b32 exec_lo, 0xffff
    s_mov_b32 exec_hi, 0xffff
    buffer_store_dwordx4 v[228:231], v11, s[8:11], s71 offen sc1
    s_mov_b64 exec, 0xffff
    buffer_store_dwordx2 v[228:229], v12, s[8:11], s72 offen sc1
    s_mov_b64 exec, -1
    s_waitcnt lgkmcnt(5)
    v_mfma_f32_32x32x16_bf16 v[96:111], v[148:151], a[112:115], v[96:111]
    ds_read_b128 v[136:139], v5 offset:30208
    s_waitcnt vmcnt(24) lgkmcnt(5)
    v_mfma_f32_32x32x16_bf16 v[64:79], v[152:155], a[116:119], v[64:79]
    ds_read_b128 v[140:143], v3 offset:30976
    s_mul_i32 s70, s49, 40960
    s_lshl_b32 s71, s46, 10
    s_add_u32 s70, s70, 15728640
    s_add_u32 s71, s71, s70
    s_lshl_b32 s72, s46, 8
    s_add_u32 s72, s72, s70
    s_add_u32 s72, s72, 16384
    buffer_store_dwordx4 v[228:231], v14, s[8:11], s71 offen sc1
    s_waitcnt lgkmcnt(5)
    v_mfma_f32_32x32x16_bf16 v[80:95], v[156:159], a[116:119], v[80:95]
    ds_read_b128 v[144:147], v3 offset:32000
    s_waitcnt lgkmcnt(5)
    v_mfma_f32_32x32x16_bf16 v[96:111], v[160:163], a[116:119], v[96:111]
    ds_read_b128 v[148:151], v5 offset:33024
    buffer_store_dwordx4 v[228:231], v14, s[8:11], s71 offen offset:256 sc1
    s_waitcnt vmcnt(25) lgkmcnt(5)
    v_mfma_f32_32x32x16_bf16 v[64:79], v[128:131], a[120:123], v[64:79]
    ds_read_b128 v[152:155], v3 offset:33792
    s_waitcnt lgkmcnt(5)
    v_mfma_f32_32x32x16_bf16 v[80:95], v[132:135], a[120:123], v[80:95]
    ds_read_b128 v[156:159], v3 offset:34816
    s_mov_b64 exec, 0xffffffff
    buffer_store_dwordx4 v[228:231], v14, s[8:11], s72 offen sc1
    s_mov_b64 exec, -1
    s_waitcnt lgkmcnt(5)
    v_mfma_f32_32x32x16_bf16 v[96:111], v[136:139], a[120:123], v[96:111]
    ds_read_b128 v[160:163], v5 offset:35840
    s_waitcnt vmcnt(25) lgkmcnt(5)
    v_mfma_f32_32x32x16_bf16 v[64:79], v[140:143], a[124:127], v[64:79]
    ds_read_b128 v[128:131], v3 offset:36608
    s_add_u32 s95, s88, 0
    buffer_load_dwordx4 a[160:163], v1, s[8:11], s95 offen
    s_waitcnt lgkmcnt(5)
    v_mfma_f32_32x32x16_bf16 v[80:95], v[144:147], a[124:127], v[80:95]
    ds_read_b128 v[132:135], v3 offset:37632
    s_waitcnt lgkmcnt(5)
    v_mfma_f32_32x32x16_bf16 v[96:111], v[148:151], a[124:127], v[96:111]
    ds_read_b128 v[136:139], v5 offset:38656
    s_add_u32 s95, s88, 4096
    buffer_load_dwordx4 a[164:167], v1, s[8:11], s95 offen
    s_waitcnt vmcnt(26) lgkmcnt(5)
    v_mfma_f32_32x32x16_bf16 v[64:79], v[152:155], a[128:131], v[64:79]
    ds_read_b128 v[140:143], v3 offset:39424
    s_waitcnt lgkmcnt(5)
    v_mfma_f32_32x32x16_bf16 v[80:95], v[156:159], a[128:131], v[80:95]
    ds_read_b128 v[144:147], v3 offset:40448
    s_add_u32 s95, s88, 8192
    buffer_load_dwordx4 a[168:171], v1, s[8:11], s95 offen
    s_waitcnt lgkmcnt(5)
    v_mfma_f32_32x32x16_bf16 v[96:111], v[160:163], a[128:131], v[96:111]
    ds_read_b128 v[148:151], v5 offset:41472
    s_waitcnt vmcnt(26) lgkmcnt(5)
    v_mfma_f32_32x32x16_bf16 v[64:79], v[128:131], a[132:135], v[64:79]
    ds_read_b128 v[152:155], v3 offset:42240
    s_add_u32 s95, s88, 12288
    buffer_load_dwordx4 a[172:175], v1, s[8:11], s95 offen
    s_waitcnt lgkmcnt(5)
    v_mfma_f32_32x32x16_bf16 v[80:95], v[132:135], a[132:135], v[80:95]
    ds_read_b128 v[156:159], v3 offset:43264
    s_waitcnt lgkmcnt(5)
    v_mfma_f32_32x32x16_bf16 v[96:111], v[136:139], a[132:135], v[96:111]
    ds_read_b128 v[160:163], v5 offset:44288
    s_add_u32 s95, s88, 16384
    buffer_load_dwordx4 a[176:179], v1, s[8:11], s95 offen
    s_waitcnt vmcnt(27) lgkmcnt(5)
    v_mfma_f32_32x32x16_bf16 v[64:79], v[140:143], a[136:139], v[64:79]
    ds_read_b128 v[128:131], v3 offset:45056
    s_waitcnt lgkmcnt(5)
    v_mfma_f32_32x32x16_bf16 v[80:95], v[144:147], a[136:139], v[80:95]
    ds_read_b128 v[132:135], v3 offset:46080
    s_add_u32 s95, s88, 20480
    buffer_load_dwordx4 a[180:183], v1, s[8:11], s95 offen
    s_waitcnt lgkmcnt(5)
    v_mfma_f32_32x32x16_bf16 v[96:111], v[148:151], a[136:139], v[96:111]
    ds_read_b128 v[136:139], v5 offset:47104
    s_waitcnt vmcnt(27) lgkmcnt(5)
    v_mfma_f32_32x32x16_bf16 v[64:79], v[152:155], a[140:143], v[64:79]
    ds_read_b128 v[140:143], v3 offset:47872
    s_add_u32 s95, s88, 24576
    buffer_load_dwordx4 a[184:187], v1, s[8:11], s95 offen
    s_waitcnt lgkmcnt(5)
    v_mfma_f32_32x32x16_bf16 v[80:95], v[156:159], a[140:143], v[80:95]
    ds_read_b128 v[144:147], v3 offset:48896
    s_waitcnt lgkmcnt(5)
    v_mfma_f32_32x32x16_bf16 v[96:111], v[160:163], a[140:143], v[96:111]
    ds_read_b128 v[148:151], v5 offset:49920
    s_add_u32 s95, s88, 28672
    buffer_load_dwordx4 a[188:191], v1, s[8:11], s95 offen
    s_waitcnt vmcnt(28) lgkmcnt(5)
    v_mfma_f32_32x32x16_bf16 v[64:79], v[128:131], a[144:147], v[64:79]
    ds_read_b128 v[152:155], v3 offset:50688
    s_waitcnt lgkmcnt(5)
    v_mfma_f32_32x32x16_bf16 v[80:95], v[132:135], a[144:147], v[80:95]
    ds_read_b128 v[156:159], v3 offset:51712
    s_add_u32 s95, s88, 32768
    buffer_load_dwordx4 a[192:195], v1, s[8:11], s95 offen
    s_waitcnt lgkmcnt(5)
    v_mfma_f32_32x32x16_bf16 v[96:111], v[136:139], a[144:147], v[96:111]
    ds_read_b128 v[160:163], v5 offset:52736
    s_waitcnt vmcnt(28) lgkmcnt(5)
    v_mfma_f32_32x32x16_bf16 v[64:79], v[140:143], a[148:151], v[64:79]
    ds_read_b128 v[128:131], v3 offset:53504
    s_add_u32 s95, s88, 36864
    buffer_load_dwordx4 a[196:199], v1, s[8:11], s95 offen
    s_waitcnt lgkmcnt(5)
    v_mfma_f32_32x32x16_bf16 v[80:95], v[144:147], a[148:151], v[80:95]
    ds_read_b128 v[132:135], v3 offset:54528
    s_waitcnt lgkmcnt(5)
    v_mfma_f32_32x32x16_bf16 v[96:111], v[148:151], a[148:151], v[96:111]
    ds_read_b128 v[136:139], v5 offset:55552
    s_add_u32 s95, s88, 40960
    buffer_load_dwordx4 a[200:203], v1, s[8:11], s95 offen
    s_waitcnt vmcnt(29) lgkmcnt(5)
    v_mfma_f32_32x32x16_bf16 v[64:79], v[152:155], a[152:155], v[64:79]
    s_waitcnt lgkmcnt(4)
    v_mfma_f32_32x32x16_bf16 v[80:95], v[156:159], a[152:155], v[80:95]
    s_add_u32 s95, s88, 45056
    buffer_load_dwordx4 a[204:207], v1, s[8:11], s95 offen
    s_waitcnt lgkmcnt(3)
    v_mfma_f32_32x32x16_bf16 v[96:111], v[160:163], a[152:155], v[96:111]
    s_waitcnt vmcnt(29) lgkmcnt(2)
    v_mfma_f32_32x32x16_bf16 v[64:79], v[128:131], a[156:159], v[64:79]
    s_add_u32 s95, s88, 49152
    buffer_load_dwordx4 a[208:211], v1, s[8:11], s95 offen
    s_waitcnt lgkmcnt(1)
    v_mfma_f32_32x32x16_bf16 v[80:95], v[132:135], a[156:159], v[80:95]
    s_waitcnt lgkmcnt(0)
    v_mfma_f32_32x32x16_bf16 v[96:111], v[136:139], a[156:159], v[96:111]
    s_add_u32 s95, s88, 53248
    buffer_load_dwordx4 a[212:215], v1, s[8:11], s95 offen
    s_nop 9
    v_cmp_u_f32 vcc, v96, v96
    s_cbranch_vccz L_ok_34
    s_add_u32 s51, s51, 1
    s_cmp_gt_u32 s51, 200000
    s_cbranch_scc1 L_ok_34
    s_waitcnt vmcnt(0) lgkmcnt(0)
    s_sleep 2
    s_branch L_qkv_31
L_ok_34:
    v_pk_mul_f32 v[64:65], v[64:65], v[0:1] op_sel_hi:[1,0]
    v_pk_mul_f32 v[66:67], v[66:67], v[0:1] op_sel_hi:[1,0]
    v_pk_mul_f32 v[68:69], v[68:69], v[0:1] op_sel_hi:[1,0]
    v_pk_mul_f32 v[70:71], v[70:71], v[0:1] op_sel_hi:[1,0]
    v_pk_mul_f32 v[72:73], v[72:73], v[0:1] op_sel_hi:[1,0]
    v_pk_mul_f32 v[74:75], v[74:75], v[0:1] op_sel_hi:[1,0]
    v_pk_mul_f32 v[76:77], v[76:77], v[0:1] op_sel_hi:[1,0]
    v_pk_mul_f32 v[78:79], v[78:79], v[0:1] op_sel_hi:[1,0]
    v_pk_mul_f32 v[100:101], v[100:101], v[0:1] op_sel_hi:[1,0]
    v_pk_mul_f32 v[102:103], v[102:103], v[0:1] op_sel_hi:[1,0]
    v_pk_mul_f32 v[104:105], v[104:105], v[0:1] op_sel_hi:[1,0]
    v_pk_mul_f32 v[106:107], v[106:107], v[0:1] op_sel_hi:[1,0]
    v_pk_mul_f32 v[80:81], v[80:81], v[0:1] op_sel_hi:[1,0]
    v_pk_mul_f32 v[82:83], v[82:83], v[0:1] op_sel_hi:[1,0]
    v_pk_mul_f32 v[84:85], v[84:85], v[0:1] op_sel_hi:[1,0]
    v_pk_mul_f32 v[86:87], v[86:87], v[0:1] op_sel_hi:[1,0]
    v_pk_mul_f32 v[88:89], v[88:89], v[0:1] op_sel_hi:[1,0]
    v_pk_mul_f32 v[90:91], v[90:91], v[0:1] op_sel_hi:[1,0]
    v_pk_mul_f32 v[92:93], v[92:93], v[0:1] op_sel_hi:[1,0]
    v_pk_mul_f32 v[94:95], v[94:95], v[0:1] op_sel_hi:[1,0]
    v_cvt_pk_bf16_f32 v64, v64, v65
    v_cvt_pk_bf16_f32 v65, v66, v67
    v_cvt_pk_bf16_f32 v66, v68, v69
    v_cvt_pk_bf16_f32 v67, v70, v71
    v_cvt_pk_bf16_f32 v68, v72, v73
    v_cvt_pk_bf16_f32 v69, v74, v75
    v_cvt_pk_bf16_f32 v70, v76, v77
    v_cvt_pk_bf16_f32 v71, v78, v79
    v_cvt_pk_bf16_f32 v72, v100, v101
    v_cvt_pk_bf16_f32 v73, v102, v103
    s_waitcnt vmcnt(21)
    s_waitcnt lgkmcnt(0)
    s_barrier
    s_mul_i32 s96, s47, 102400
    s_lshl_b32 s97, s44, 10
    s_add_u32 s96, s96, s97
    s_add_u32 s96, s96, 26214400
    v_lshrrev_b32 v164, 5, v21
    v_lshlrev_b32 v165, 1, v12
    v_lshl_add_u32 v164, v164, 8, v165
    ds_read_b128 v[128:131], v6 offset:0
    ds_read_b128 v[132:135], v6 offset:1024
    ds_read_b128 v[136:139], v6 offset:2048
    ds_read_b128 v[140:143], v6 offset:3072
    ds_read_b128 v[144:147], v6 offset:4096
    s_waitcnt lgkmcnt(4)
    v_mfma_f32_32x32x16_bf16 v[112:127], v[128:131], a[0:3], v[112:127]
    ds_read_b128 v[148:151], v6 offset:5120
    s_lshl_b32 s52, s45, 4
    s_add_u32 s52, s52, s46
    s_lshl_b32 s52, s52, 12
    s_add_u32 s52, s52, 28966912
    s_cmp_eq_u32 s44, 3
    s_cselect_b32 s54, 0xffff0000, 0
    s_mov_b32 exec_lo, s54
    s_mov_b32 exec_hi, s54
    s_cbranch_scc0 L_hs_35
    buffer_store_dwordx4 v[64:67], v164, s[8:11], s52 offen offset:0 sc1
    buffer_store_dwordx4 v[68:71], v164, s[8:11], s52 offen offset:512 sc1
    buffer_store_dwordx4 v[72:75], v164, s[8:11], s52 offen offset:1024 sc1
    buffer_store_dwordx4 v[80:83], v164, s[8:11], s52 offen offset:1536 sc1
    buffer_store_dwordx4 v[84:87], v164, s[8:11], s52 offen offset:2048 sc1
    buffer_store_dwordx4 v[88:91], v164, s[8:11], s52 offen offset:2560 sc1
    buffer_store_dwordx4 v[92:95], v164, s[8:11], s52 offen offset:3072 sc1
    buffer_store_dwordx4 v[104:107], v164, s[8:11], s52 offen offset:3584 sc1
L_hs_35:
    s_mov_b64 exec, -1
    s_waitcnt lgkmcnt(4)
    v_mfma_f32_32x32x16_bf16 v[112:127], v[132:135], a[4:7], v[112:127]
    ds_read_b128 v[152:155], v6 offset:6144
    ds_write_b128 v17, v[64:67] offset:672
    s_waitcnt lgkmcnt(5)
    v_mfma_f32_32x32x16_bf16 v[112:127], v[136:139], a[8:11], v[112:127]
    ds_read_b128 v[128:131], v6 offset:7168
    s_waitcnt lgkmcnt(5)
    v_mfma_f32_32x32x16_bf16 v[112:127], v[140:143], a[12:15], v[112:127]
    ds_read_b128 v[132:135], v6 offset:8192
    ds_write_b128 v17, v[68:71] offset:688
    s_waitcnt lgkmcnt(6)
    v_mfma_f32_32x32x16_bf16 v[112:127], v[144:147], a[16:19], v[112:127]
    ds_read_b128 v[136:139], v6 offset:9216
    s_add_u32 s94, s97, 59392
    s_mov_b32 m0, s94
    s_add_u32 s95, s96, 8192
    buffer_load_dwordx4 v1, s[8:11], s95 offen lds
    s_waitcnt lgkmcnt(6)
    v_mfma_f32_32x32x16_bf16 v[112:127], v[148:151], a[20:23], v[112:127]
    ds_read_b128 v[140:143], v6 offset:10240
    ds_write_b64 v17, v[72:73] offset:704
    s_waitcnt lgkmcnt(7)
    v_mfma_f32_32x32x16_bf16 v[112:127], v[152:155], a[24:27], v[112:127]
    ds_read_b128 v[144:147], v6 offset:11264
    s_add_u32 s94, s97, 63488
    s_mov_b32 m0, s94
    s_add_u32 s95, s96, 12288
    buffer_load_dwordx4 v1, s[8:11], s95 offen lds
    s_waitcnt lgkmcnt(6)
    v_mfma_f32_32x32x16_bf16 v[112:127], v[128:131], a[28:31], v[112:127]
    ds_read_b128 v[148:151], v6 offset:12288
    ds_write_b128 v18, v[80:83] offset:1120
    s_waitcnt lgkmcnt(7)
    v_mfma_f32_32x32x16_bf16 v[112:127], v[132:135], a[32:35], v[112:127]
    ds_read_b128 v[152:155], v6 offset:13312
    s_add_u32 s94, s97, 67584
    s_mov_b32 m0, s94
    s_add_u32 s95, s96, 16384
    buffer_load_dwordx4 v1, s[8:11], s95 offen lds
    s_waitcnt lgkmcnt(6)
    v_mfma_f32_32x32x16_bf16 v[112:127], v[136:139], a[36:39], v[112:127]
    ds_read_b128 v[128:131], v6 offset:14336
    ds_write_b128 v18, v[84:87] offset:1136
    s_waitcnt lgkmcnt(7)
    v_mfma_f32_32x32x16_bf16 v[112:127], v[140:143], a[40:43], v[112:127]
    ds_read_b128 v[132:135], v6 offset:15360
    s_add_u32 s94, s97, 71680
    s_mov_b32 m0, s94
    s_add_u32 s95, s96, 20480
    buffer_load_dwordx4 v1, s[8:11], s95 offen lds
    s_waitcnt lgkmcnt(6)
    v_mfma_f32_32x32x16_bf16 v[112:127], v[144:147], a[44:47], v[112:127]
    ds_read_b128 v[136:139], v6 offset:16384
    ds_write_b128 v18, v[88:91] offset:1152
    s_waitcnt lgkmcnt(7)
    v_mfma_f32_32x32x16_bf16 v[112:127], v[148:151], a[48:51], v[112:127]
    ds_read_b128 v[140:143], v6 offset:17408
    s_add_u32 s94, s97, 75776
    s_mov_b32 m0, s94
    s_add_u32 s95, s96, 24576
    buffer_load_dwordx4 v1, s[8:11], s95 offen lds
    s_waitcnt lgkmcnt(6)
    v_mfma_f32_32x32x16_bf16 v[112:127], v[152:155], a[52:55], v[112:127]
    ds_read_b128 v[144:147], v6 offset:18432
    ds_write_b128 v18, v[92:95] offset:1168
    s_waitcnt lgkmcnt(7)
    v_mfma_f32_32x32x16_bf16 v[112:127], v[128:131], a[56:59], v[112:127]
    ds_read_b128 v[148:151], v6 offset:19456
    s_add_u32 s94, s97, 79872
    s_mov_b32 m0, s94
    s_add_u32 s95, s96, 28672
    buffer_load_dwordx4 v1, s[8:11], s95 offen lds
    s_waitcnt lgkmcnt(6)
    v_mfma_f32_32x32x16_bf16 v[112:127], v[132:135], a[60:63], v[112:127]
    ds_read_b128 v[152:155], v6 offset:20480
    ds_write_b128 v18, v[104:107] offset:1184
    s_waitcnt lgkmcnt(7)
    v_mfma_f32_32x32x16_bf16 v[112:127], v[136:139], a[64:67], v[112:127]
    ds_read_b128 v[128:131], v6 offset:21504
    s_add_u32 s94, s97, 83968
    s_mov_b32 m0, s94
    s_add_u32 s95, s96, 32768
    buffer_load_dwordx4 v1, s[8:11], s95 offen lds
    s_waitcnt lgkmcnt(6)
    v_mfma_f32_32x32x16_bf16 v[112:127], v[140:143], a[68:71], v[112:127]
    ds_read_b128 v[132:135], v6 offset:22528
    s_waitcnt lgkmcnt(6)
    v_mfma_f32_32x32x16_bf16 v[112:127], v[144:147], a[72:75], v[112:127]
    ds_read_b128 v[136:139], v6 offset:23552
    s_add_u32 s94, s97, 88064
    s_mov_b32 m0, s94
    s_add_u32 s95, s96, 36864
    buffer_load_dwordx4 v1, s[8:11], s95 offen lds
    s_waitcnt lgkmcnt(5)
    v_mfma_f32_32x32x16_bf16 v[112:127], v[148:151], a[76:79], v[112:127]
    ds_read_b128 v[140:143], v6 offset:24576
    s_waitcnt lgkmcnt(5)
    v_mfma_f32_32x32x16_bf16 v[112:127], v[152:155], a[80:83], v[112:127]
    ds_read_b128 v[144:147], v6 offset:25600
    s_add_u32 s94, s97, 92160
    s_mov_b32 m0, s94
    s_add_u32 s95, s96, 40960
    buffer_load_dwordx4 v1, s[8:11], s95 offen lds
    s_waitcnt lgkmcnt(4)
    v_mfma_f32_32x32x16_bf16 v[112:127], v[128:131], a[84:87], v[112:127]
    ds_read_b128 v[148:151], v6 offset:26624
    s_waitcnt lgkmcnt(4)
    v_mfma_f32_32x32x16_bf16 v[112:127], v[132:135], a[88:91], v[112:127]
    ds_read_b128 v[152:155], v6 offset:27648
    s_add_u32 s94, s97, 96256
    s_mov_b32 m0, s94
    s_add_u32 s95, s96, 45056
    buffer_load_dwordx4 v1, s[8:11], s95 offen lds
    s_waitcnt lgkmcnt(4)
    v_mfma_f32_32x32x16_bf16 v[112:127], v[136:139], a[92:95], v[112:127]
    ds_read_b128 v[128:131], v6 offset:28672
    s_waitcnt lgkmcnt(4)
    v_mfma_f32_32x32x16_bf16 v[112:127], v[140:143], a[96:99], v[112:127]
    ds_read_b128 v[132:135], v6 offset:29696
    s_add_u32 s94, s97, 100352
    s_mov_b32 m0, s94
    s_add_u32 s95, s96, 49152
    buffer_load_dwordx4 v1, s[8:11], s95 offen lds
    s_waitcnt lgkmcnt(4)
    v_mfma_f32_32x32x16_bf16 v[112:127], v[144:147], a[100:103], v[112:127]
    ds_read_b128 v[136:139], v6 offset:30720
    s_waitcnt lgkmcnt(4)
    v_mfma_f32_32x32x16_bf16 v[112:127], v[148:151], a[104:107], v[112:127]
    ds_read_b128 v[140:143], v6 offset:31744
    s_waitcnt lgkmcnt(4)
    v_mfma_f32_32x32x16_bf16 v[112:127], v[152:155], a[108:111], v[112:127]
    ds_read_b128 v[144:147], v6 offset:32768
    s_waitcnt lgkmcnt(4)
    v_mfma_f32_32x32x16_bf16 v[112:127], v[128:131], a[112:115], v[112:127]
    ds_read_b128 v[148:151], v6 offset:33792
    s_waitcnt lgkmcnt(4)
    v_mfma_f32_32x32x16_bf16 v[112:127], v[132:135], a[116:119], v[112:127]
    ds_read_b128 v[152:155], v6 offset:34816
    s_waitcnt lgkmcnt(4)
    v_mfma_f32_32x32x16_bf16 v[112:127], v[136:139], a[120:123], v[112:127]
    ds_read_b128 v[128:131], v6 offset:35840
    s_waitcnt lgkmcnt(4)
    v_mfma_f32_32x32x16_bf16 v[112:127], v[140:143], a[124:127], v[112:127]
    ds_read_b128 v[132:135], v6 offset:36864
    s_waitcnt lgkmcnt(4)
    v_mfma_f32_32x32x16_bf16 v[112:127], v[144:147], a[128:131], v[112:127]
    ds_read_b128 v[136:139], v6 offset:37888
    s_lshl_b32 s94, s45, 4
    s_add_u32 s94, s94, s46
    s_lshl_b32 s94, s94, 12
    s_add_u32 s94, s94, 28901376
    buffer_load_dwordx4 v[24:27], v15, s[8:11], s94 offen offset:0 sc1
    buffer_load_dwordx4 v[28:31], v15, s[8:11], s94 offen offset:1024 sc1
    buffer_load_dwordx4 v[32:35], v15, s[8:11], s94 offen offset:2048 sc1
    buffer_load_dwordx4 v[36:39], v15, s[8:11], s94 offen offset:3072 sc1
    s_waitcnt lgkmcnt(4)
    v_mfma_f32_32x32x16_bf16 v[112:127], v[148:151], a[132:135], v[112:127]
    ds_read_b128 v[140:143], v6 offset:38912
    s_waitcnt lgkmcnt(4)
    v_mfma_f32_32x32x16_bf16 v[112:127], v[152:155], a[136:139], v[112:127]
    ds_read_b128 v[144:147], v6 offset:39936
    s_add_u32 s94, s97, 104448
    s_mov_b32 m0, s94
    s_add_u32 s95, s96, 53248
    buffer_load_dwordx4 v1, s[8:11], s95 offen lds
    s_waitcnt lgkmcnt(4)
    v_mfma_f32_32x32x16_bf16 v[112:127], v[128:131], a[140:143], v[112:127]
    s_waitcnt lgkmcnt(3)
    v_mfma_f32_32x32x16_bf16 v[112:127], v[132:135], a[144:147], v[112:127]
    s_add_u32 s94, s97, 108544
    s_mov_b32 m0, s94
    s_add_u32 s95, s96, 57344
    buffer_load_dwordx4 v1, s[8:11], s95 offen lds
    s_waitcnt lgkmcnt(2)
    v_mfma_f32_32x32x16_bf16 v[112:127], v[136:139], a[148:151], v[112:127]
    s_waitcnt lgkmcnt(1)
    v_mfma_f32_32x32x16_bf16 v[112:127], v[140:143], a[152:155], v[112:127]
    s_add_u32 s95, s88, 57344
    buffer_load_dwordx4 a[216:219], v1, s[8:11], s95 offen
    s_waitcnt lgkmcnt(0)
    v_mfma_f32_32x32x16_bf16 v[112:127], v[144:147], a[156:159], v[112:127]
    s_waitcnt vmcnt(32)
    s_waitcnt lgkmcnt(0)
    s_barrier
    ds_read_b128 v[140:143], v17 offset:576
    ds_read_b128 v[144:147], v17 offset:592
    ds_read_b64 v[148:149], v17 offset:608
    ds_read_b128 v[152:155], v17 offset:480
    ds_read_b128 v[156:159], v17 offset:496
    ds_read_b64 v[160:161], v17 offset:512
    ds_read_b128 v[128:131], v17 offset:384
    ds_read_b128 v[132:135], v17 offset:400
    ds_read_b64 v[136:137], v17 offset:416
    v_pk_mul_f32 v[112:113], v[112:113], v[0:1] op_sel_hi:[1,0]
    v_pk_mul_f32 v[114:115], v[114:115], v[0:1] op_sel_hi:[1,0]
    v_pk_mul_f32 v[116:117], v[116:117], v[0:1] op_sel_hi:[1,0]
    s_add_u32 s94, s97, 51200
    s_mov_b32 m0, s94
    s_add_u32 s95, s96, 0
    buffer_load_dwordx4 v1, s[8:11], s95 offen lds
    v_pk_mul_f32 v[118:119], v[118:119], v[0:1] op_sel_hi:[1,0]
    v_pk_mul_f32 v[120:121], v[120:121], v[0:1] op_sel_hi:[1,0]
    v_pk_mul_f32 v[122:123], v[122:123], v[0:1] op_sel_hi:[1,0]
    v_pk_mul_f32 v[124:125], v[124:125], v[0:1] op_sel_hi:[1,0]
    v_pk_mul_f32 v[126:127], v[126:127], v[0:1] op_sel_hi:[1,0]
    v_pk_mul_f32 v[96:97], v[96:97], v[0:1] op_sel_hi:[1,0]
    v_pk_mul_f32 v[98:99], v[98:99], v[0:1] op_sel_hi:[1,0]
    v_cvt_pk_bf16_f32 v112, v112, v113
    v_cvt_pk_bf16_f32 v113, v114, v115
    v_cvt_pk_bf16_f32 v114, v116, v117
    v_cvt_pk_bf16_f32 v115, v118, v119
    v_cvt_pk_bf16_f32 v116, v120, v121
    s_add_u32 s94, s97, 55296
    s_mov_b32 m0, s94
    s_add_u32 s95, s96, 4096
    buffer_load_dwordx4 v1, s[8:11], s95 offen lds
    v_cvt_pk_bf16_f32 v117, v122, v123
    v_cvt_pk_bf16_f32 v118, v124, v125
    v_cvt_pk_bf16_f32 v119, v126, v127
    v_cvt_pk_bf16_f32 v120, v96, v97
    v_cvt_pk_bf16_f32 v121, v98, v99
    v_mov_b32 v164, 0
    v_mov_b32 v165, 0
    v_mov_b32 v166, 0
    v_mov_b32 v167, 0
    v_mov_b32 v168, 0
    v_mov_b32 v169, 0
    v_mov_b32 v170, 0
    s_add_u32 s94, s97, 112640
    s_mov_b32 m0, s94
    s_add_u32 s95, s96, 61440
    buffer_load_dwordx4 v1, s[8:11], s95 offen lds
    v_mov_b32 v171, 0
    v_dot2c_f32_bf16 v164, v112, v64
    v_dot2c_f32_bf16 v164, v113, v65
    v_dot2c_f32_bf16 v164, v114, v66
    v_dot2c_f32_bf16 v164, v115, v67
    v_dot2c_f32_bf16 v164, v116, v68
    v_dot2c_f32_bf16 v164, v117, v69
    v_dot2c_f32_bf16 v164, v118, v70
    v_dot2c_f32_bf16 v164, v119, v71
    v_dot2c_f32_bf16 v164, v120, v72
    v_dot2c_f32_bf16 v164, v121, v73
    s_cmp_lg_u32 s44, 0
    s_cbranch_scc1 L_hk_36
    s_waitcnt vmcnt(6)
    s_branch L_hc_37
L_hl_38:
    s_lshl_b32 s94, s45, 4
    s_add_u32 s94, s94, s46
    s_lshl_b32 s94, s94, 12
    s_add_u32 s94, s94, 28901376
    buffer_load_dwordx4 v[24:27], v15, s[8:11], s94 offen offset:0 sc1
    buffer_load_dwordx4 v[28:31], v15, s[8:11], s94 offen offset:1024 sc1
    buffer_load_dwordx4 v[32:35], v15, s[8:11], s94 offen offset:2048 sc1
    buffer_load_dwordx4 v[36:39], v15, s[8:11], s94 offen offset:3072 sc1
    s_waitcnt vmcnt(0)
L_hc_37:
    v_max3_u32 v40, v24, v25, v26
    v_max3_u32 v40, v40, v27, v28
    v_max3_u32 v40, v40, v29, v30
    v_max3_u32 v40, v40, v31, v32
    v_max3_u32 v40, v40, v33, v34
    v_max3_u32 v40, v40, v35, v36
    v_max3_u32 v40, v40, v37, v38
    v_max_u32 v40, v40, v39
    v_cmp_eq_u32 vcc, -1, v40
    s_cbranch_vccz L_ok_39
    s_add_u32 s51, s51, 1
    s_cmp_gt_u32 s51, 200000
    s_cbranch_scc1 L_ok_39
    s_waitcnt vmcnt(0) lgkmcnt(0)
    s_sleep 1
    s_branch L_hl_38
L_ok_39:
    ds_write_b128 v7, v[24:27]
    ds_write_b128 v8, v[28:31]
    ds_write_b128 v16, v[32:35]
    ds_write_b128 v20, v[36:39]
    s_waitcnt lgkmcnt(0)
    ds_read_b128 v[140:143], v17 offset:576
    ds_read_b128 v[144:147], v17 offset:592
    ds_read_b64 v[148:149], v17 offset:608
    ds_read_b128 v[152:155], v17 offset:480
    ds_read_b128 v[156:159], v17 offset:496
    ds_read_b64 v[160:161], v17 offset:512
    ds_read_b128 v[128:131], v17 offset:384
    ds_read_b128 v[132:135], v17 offset:400
    ds_read_b64 v[136:137], v17 offset:416
    s_waitcnt lgkmcnt(0)
L_hk_36:
    s_waitcnt lgkmcnt(6)
    v_dot2c_f32_bf16 v165, v112, v140
    s_add_u32 s94, s97, 116736
    s_mov_b32 m0, s94
    s_add_u32 s95, s96, 65536
    buffer_load_dwordx4 v1, s[8:11], s95 offen lds
    v_dot2c_f32_bf16 v165, v113, v141
    v_dot2c_f32_bf16 v165, v114, v142
    v_dot2c_f32_bf16 v165, v115, v143
    v_dot2c_f32_bf16 v165, v116, v144
    v_dot2c_f32_bf16 v165, v117, v145
    v_dot2c_f32_bf16 v165, v118, v146
    v_dot2c_f32_bf16 v165, v119, v147
    v_dot2c_f32_bf16 v165, v120, v148
    v_dot2c_f32_bf16 v165, v121, v149
    ds_read_b128 v[140:143], v17 offset:288
    ds_read_b128 v[144:147], v17 offset:304
    ds_read_b64 v[148:149], v17 offset:320
    s_add_u32 s94, s97, 120832
    s_mov_b32 m0, s94
    s_add_u32 s95, s96, 69632
    buffer_load_dwordx4 v1, s[8:11], s95 offen lds
    s_waitcnt lgkmcnt(6)
    v_dot2c_f32_bf16 v166, v112, v152
    v_dot2c_f32_bf16 v166, v113, v153
    v_dot2c_f32_bf16 v166, v114, v154
    v_dot2c_f32_bf16 v166, v115, v155
    v_dot2c_f32_bf16 v166, v116, v156
    v_dot2c_f32_bf16 v166, v117, v157
    v_dot2c_f32_bf16 v166, v118, v158
    v_dot2c_f32_bf16 v166, v119, v159
    v_dot2c_f32_bf16 v166, v120, v160
    v_dot2c_f32_bf16 v166, v121, v161
    ds_read_b128 v[152:155], v17 offset:192
    ds_read_b128 v[156:159], v17 offset:208
    s_add_u32 s94, s97, 124928
    s_mov_b32 m0, s94
    s_add_u32 s95, s96, 73728
    buffer_load_dwordx4 v1, s[8:11], s95 offen lds
    ds_read_b64 v[160:161], v17 offset:224
    s_waitcnt lgkmcnt(6)
    v_dot2c_f32_bf16 v167, v112, v128
    v_dot2c_f32_bf16 v167, v113, v129
    v_dot2c_f32_bf16 v167, v114, v130
    v_dot2c_f32_bf16 v167, v115, v131
    v_dot2c_f32_bf16 v167, v116, v132
    v_dot2c_f32_bf16 v167, v117, v133
    v_dot2c_f32_bf16 v167, v118, v134
    v_dot2c_f32_bf16 v167, v119, v135
    v_dot2c_f32_bf16 v167, v120, v136
    v_dot2c_f32_bf16 v167, v121, v137
    ds_read_b128 v[128:131], v17 offset:96
    s_add_u32 s94, s97, 129024
    s_mov_b32 m0, s94
    s_add_u32 s95, s96, 77824
    buffer_load_dwordx4 v1, s[8:11], s95 offen lds
    ds_read_b128 v[132:135], v17 offset:112
    ds_read_b64 v[136:137], v17 offset:128
    s_waitcnt lgkmcnt(6)
    v_dot2c_f32_bf16 v168, v112, v140
    v_dot2c_f32_bf16 v168, v113, v141
    v_dot2c_f32_bf16 v168, v114, v142
    v_dot2c_f32_bf16 v168, v115, v143
    v_dot2c_f32_bf16 v168, v116, v144
    v_dot2c_f32_bf16 v168, v117, v145
    v_dot2c_f32_bf16 v168, v118, v146
    v_dot2c_f32_bf16 v168, v119, v147
    v_dot2c_f32_bf16 v168, v120, v148
    v_dot2c_f32_bf16 v168, v121, v149
    s_add_u32 s94, s97, 133120
    s_mov_b32 m0, s94
    s_add_u32 s95, s96, 81920
    buffer_load_dwordx4 v1, s[8:11], s95 offen lds
    ds_read_b128 v[140:143], v17 offset:0
    ds_read_b128 v[144:147], v17 offset:16
    ds_read_b64 v[148:149], v17 offset:32
    s_waitcnt lgkmcnt(6)
    v_dot2c_f32_bf16 v169, v112, v152
    v_dot2c_f32_bf16 v169, v113, v153
    v_dot2c_f32_bf16 v169, v114, v154
    v_dot2c_f32_bf16 v169, v115, v155
    v_dot2c_f32_bf16 v169, v116, v156
    v_dot2c_f32_bf16 v169, v117, v157
    v_dot2c_f32_bf16 v169, v118, v158
    v_dot2c_f32_bf16 v169, v119, v159
    v_dot2c_f32_bf16 v169, v120, v160
    s_add_u32 s94, s97, 137216
    s_mov_b32 m0, s94
    s_add_u32 s95, s96, 86016
    buffer_load_dwordx4 v1, s[8:11], s95 offen lds
    v_dot2c_f32_bf16 v169, v121, v161
    ds_read_b128 v[44:47], v18 offset:960
    ds_read_b128 v[48:51], v18 offset:976
    ds_read_b128 v[52:55], v18 offset:992
    ds_read_b128 v[56:59], v18 offset:1008
    ds_read_b128 v[60:63], v18 offset:1024
    s_waitcnt lgkmcnt(8)
    v_dot2c_f32_bf16 v170, v112, v128
    v_dot2c_f32_bf16 v170, v113, v129
    v_dot2c_f32_bf16 v170, v114, v130
    v_dot2c_f32_bf16 v170, v115, v131
    v_dot2c_f32_bf16 v170, v116, v132
    v_dot2c_f32_bf16 v170, v117, v133
    s_add_u32 s94, s97, 141312
    s_mov_b32 m0, s94
    s_add_u32 s95, s96, 90112
    buffer_load_dwordx4 v1, s[8:11], s95 offen lds
    v_dot2c_f32_bf16 v170, v118, v134
    v_dot2c_f32_bf16 v170, v119, v135
    v_dot2c_f32_bf16 v170, v120, v136
    v_dot2c_f32_bf16 v170, v121, v137
    ds_read_b128 v[212:215], v18 offset:800
    ds_read_b128 v[216:219], v18 offset:816
    ds_read_b128 v[220:223], v18 offset:832
    ds_read_b128 v[224:227], v18 offset:848
    ds_read_b128 v[228:231], v18 offset:864
    s_waitcnt lgkmcnt(10)
    v_dot2c_f32_bf16 v171, v112, v140
    v_dot2c_f32_bf16 v171, v113, v141
    v_dot2c_f32_bf16 v171, v114, v142
    s_add_u32 s94, s97, 145408
    s_mov_b32 m0, s94
    s_add_u32 s95, s96, 94208
    buffer_load_dwordx4 v1, s[8:11], s95 offen lds
    v_dot2c_f32_bf16 v171, v115, v143
    v_dot2c_f32_bf16 v171, v116, v144
    v_dot2c_f32_bf16 v171, v117, v145
    v_dot2c_f32_bf16 v171, v118, v146
    v_dot2c_f32_bf16 v171, v119, v147
    v_dot2c_f32_bf16 v171, v120, v148
    v_dot2c_f32_bf16 v171, v121, v149
    s_waitcnt vmcnt(14)
    ds_read_b128 v[24:27], v18 offset:640
    ds_read_b128 v[28:31], v18 offset:656
    ds_read_b128 v[32:35], v18 offset:672
    ds_read_b128 v[36:39], v18 offset:688
    ds_read_b128 v[40:43], v18 offset:704
    s_add_u32 s94, s97, 149504
    s_mov_b32 m0, s94
    s_add_u32 s95, s96, 98304
    buffer_load_dwordx4 v1, s[8:11], s95 offen lds
    s_cmp_lg_u32 s49, 0
    s_cbranch_scc1 L_nomask_40
    v_and_b32 v172, 31, v21
    v_mov_b32 v173, 0xff800000
    v_cmp_le_u32 vcc, 2, v172
    s_nop 1
    v_cndmask_b32 v165, v173, v165, vcc
    v_cmp_le_u32 vcc, 4, v172
    s_nop 1
    v_cndmask_b32 v166, v173, v166, vcc
    v_cmp_le_u32 vcc, 6, v172
    s_nop 1
    v_cndmask_b32 v167, v173, v167, vcc
    v_cmp_le_u32 vcc, 8, v172
    s_nop 1
    v_cndmask_b32 v168, v173, v168, vcc
    v_cmp_le_u32 vcc, 10, v172
    s_nop 1
    v_cndmask_b32 v169, v173, v169, vcc
    v_cmp_le_u32 vcc, 12, v172
    s_nop 1
    v_cndmask_b32 v170, v173, v170, vcc
    v_cmp_le_u32 vcc, 14, v172
    s_nop 1
    v_cndmask_b32 v171, v173, v171, vcc
    s_nop 2
L_nomask_40:
    v_max3_f32 v172, v164, v165, v166
    v_max3_f32 v173, v167, v168, v169
    v_max3_f32 v172, v172, v170, v171
    v_max_f32 v172, v172, v173
    s_mov_b32 s56, 0x3ea52b5c
    v_mul_f32 v172, s56, v172
    v_fma_f32 v164, v164, s56, -v172
    v_fma_f32 v165, v165, s56, -v172
    v_fma_f32 v166, v166, s56, -v172
    v_fma_f32 v167, v167, s56, -v172
    v_fma_f32 v168, v168, s56, -v172
    v_fma_f32 v169, v169, s56, -v172
    v_fma_f32 v170, v170, s56, -v172
    v_fma_f32 v171, v171, s56, -v172
    v_exp_f32 v164, v164
    v_exp_f32 v165, v165
    v_exp_f32 v166, v166
    v_exp_f32 v167, v167
    v_exp_f32 v168, v168
    v_exp_f32 v169, v169
    s_add_u32 s95, s88, 61440
    buffer_load_dwordx4 a[220:223], v1, s[8:11], s95 offen
    v_exp_f32 v170, v170
    v_exp_f32 v171, v171
    v_pk_add_f32 v[172:173], v[164:165], v[166:167]
    v_pk_add_f32 v[174:175], v[168:169], v[170:171]
    v_pk_add_f32 v[172:173], v[172:173], v[174:175]
    v_add_f32 v172, v172, v173
    v_rcp_f32 v172, v172
    v_pk_mul_f32 v[80:81], v[80:81], v[164:165] op_sel_hi:[1,0]
    v_pk_mul_f32 v[82:83], v[82:83], v[164:165] op_sel_hi:[1,0]
    s_add_u32 s95, s88, 65536
    buffer_load_dwordx4 a[224:227], v1, s[8:11], s95 offen
    v_pk_mul_f32 v[84:85], v[84:85], v[164:165] op_sel_hi:[1,0]
    v_pk_mul_f32 v[86:87], v[86:87], v[164:165] op_sel_hi:[1,0]
    v_pk_mul_f32 v[88:89], v[88:89], v[164:165] op_sel_hi:[1,0]
    v_pk_mul_f32 v[90:91], v[90:91], v[164:165] op_sel_hi:[1,0]
    v_pk_mul_f32 v[92:93], v[92:93], v[164:165] op_sel_hi:[1,0]
    v_pk_mul_f32 v[94:95], v[94:95], v[164:165] op_sel_hi:[1,0]
    v_pk_mul_f32 v[104:105], v[104:105], v[164:165] op_sel_hi:[1,0]
    v_pk_mul_f32 v[106:107], v[106:107], v[164:165] op_sel_hi:[1,0]
    s_waitcnt lgkmcnt(10)
    v_pk_fma_f32 v[80:81], v[44:45], v[164:165], v[80:81] op_sel:[0,1,0] op_sel_hi:[1,1,1]
    v_pk_fma_f32 v[82:83], v[46:47], v[164:165], v[82:83] op_sel:[0,1,0] op_sel_hi:[1,1,1]
    v_pk_fma_f32 v[84:85], v[48:49], v[164:165], v[84:85] op_sel:[0,1,0] op_sel_hi:[1,1,1]
    v_pk_fma_f32 v[86:87], v[50:51], v[164:165], v[86:87] op_sel:[0,1,0] op_sel_hi:[1,1,1]
    s_add_u32 s95, s88, 69632
    buffer_load_dwordx4 a[228:231], v1, s[8:11], s95 offen
    v_pk_fma_f32 v[88:89], v[52:53], v[164:165], v[88:89] op_sel:[0,1,0] op_sel_hi:[1,1,1]
    v_pk_fma_f32 v[90:91], v[54:55], v[164:165], v[90:91] op_sel:[0,1,0] op_sel_hi:[1,1,1]
    v_pk_fma_f32 v[92:93], v[56:57], v[164:165], v[92:93] op_sel:[0,1,0] op_sel_hi:[1,1,1]
    v_pk_fma_f32 v[94:95], v[58:59], v[164:165], v[94:95] op_sel:[0,1,0] op_sel_hi:[1,1,1]
    v_pk_fma_f32 v[104:105], v[60:61], v[164:165], v[104:105] op_sel:[0,1,0] op_sel_hi:[1,1,1]
    v_pk_fma_f32 v[106:107], v[62:63], v[164:165], v[106:107] op_sel:[0,1,0] op_sel_hi:[1,1,1]
    ds_read_b128 v[44:47], v18 offset:480
    ds_read_b128 v[48:51], v18 offset:496
    ds_read_b128 v[52:55], v18 offset:512
    ds_read_b128 v[56:59], v18 offset:528
    ds_read_b128 v[60:63], v18 offset:544
    s_waitcnt lgkmcnt(10)
    v_pk_fma_f32 v[80:81], v[212:213], v[166:167], v[80:81] op_sel:[0,0,0] op_sel_hi:[1,0,1]
    s_add_u32 s95, s88, 73728
    buffer_load_dwordx4 a[232:235], v1, s[8:11], s95 offen
    v_pk_fma_f32 v[82:83], v[214:215], v[166:167], v[82:83] op_sel:[0,0,0] op_sel_hi:[1,0,1]
    v_pk_fma_f32 v[84:85], v[216:217], v[166:167], v[84:85] op_sel:[0,0,0] op_sel_hi:[1,0,1]
    v_pk_fma_f32 v[86:87], v[218:219], v[166:167], v[86:87] op_sel:[0,0,0] op_sel_hi:[1,0,1]
    v_pk_fma_f32 v[88:89], v[220:221], v[166:167], v[88:89] op_sel:[0,0,0] op_sel_hi:[1,0,1]
    v_pk_fma_f32 v[90:91], v[222:223], v[166:167], v[90:91] op_sel:[0,0,0] op_sel_hi:[1,0,1]
    v_pk_fma_f32 v[92:93], v[224:225], v[166:167], v[92:93] op_sel:[0,0,0] op_sel_hi:[1,0,1]
    v_pk_fma_f32 v[94:95], v[226:227], v[166:167], v[94:95] op_sel:[0,0,0] op_sel_hi:[1,0,1]
    v_pk_fma_f32 v[104:105], v[228:229], v[166:167], v[104:105] op_sel:[0,0,0] op_sel_hi:[1,0,1]
    v_pk_fma_f32 v[106:107], v[230:231], v[166:167], v[106:107] op_sel:[0,0,0] op_sel_hi:[1,0,1]
    ds_read_b128 v[212:215], v18 offset:320
    ds_read_b128 v[216:219], v18 offset:336
    ds_read_b128 v[220:223], v18 offset:352
    s_add_u32 s95, s88, 77824
    buffer_load_dwordx4 a[236:239], v1, s[8:11], s95 offen
    ds_read_b128 v[224:227], v18 offset:368
    ds_read_b128 v[228:231], v18 offset:384
    s_waitcnt lgkmcnt(10)
    v_pk_fma_f32 v[80:81], v[24:25], v[166:167], v[80:81] op_sel:[0,1,0] op_sel_hi:[1,1,1]
    v_pk_fma_f32 v[82:83], v[26:27], v[166:167], v[82:83] op_sel:[0,1,0] op_sel_hi:[1,1,1]
    v_pk_fma_f32 v[84:85], v[28:29], v[166:167], v[84:85] op_sel:[0,1,0] op_sel_hi:[1,1,1]
    v_pk_fma_f32 v[86:87], v[30:31], v[166:167], v[86:87] op_sel:[0,1,0] op_sel_hi:[1,1,1]
    v_pk_fma_f32 v[88:89], v[32:33], v[166:167], v[88:89] op_sel:[0,1,0] op_sel_hi:[1,1,1]
    v_pk_fma_f32 v[90:91], v[34:35], v[166:167], v[90:91] op_sel:[0,1,0] op_sel_hi:[1,1,1]
    v_pk_fma_f32 v[92:93], v[36:37], v[166:167], v[92:93] op_sel:[0,1,0] op_sel_hi:[1,1,1]
    v_pk_fma_f32 v[94:95], v[38:39], v[166:167], v[94:95] op_sel:[0,1,0] op_sel_hi:[1,1,1]
    v_pk_fma_f32 v[104:105], v[40:41], v[166:167], v[104:105] op_sel:[0,1,0] op_sel_hi:[1,1,1]
    v_pk_fma_f32 v[106:107], v[42:43], v[166:167], v[106:107] op_sel:[0,1,0] op_sel_hi:[1,1,1]
    s_add_u32 s95, s88, 81920
    buffer_load_dwordx4 a[240:243], v1, s[8:11], s95 offen
    ds_read_b128 v[24:27], v18 offset:160
    ds_read_b128 v[28:31], v18 offset:176
    ds_read_b128 v[32:35], v18 offset:192
    ds_read_b128 v[36:39], v18 offset:208
    ds_read_b128 v[40:43], v18 offset:224
    s_waitcnt lgkmcnt(10)
    v_pk_fma_f32 v[80:81], v[44:45], v[168:169], v[80:81] op_sel:[0,0,0] op_sel_hi:[1,0,1]
    v_pk_fma_f32 v[82:83], v[46:47], v[168:169], v[82:83] op_sel:[0,0,0] op_sel_hi:[1,0,1]
    v_pk_fma_f32 v[84:85], v[48:49], v[168:169], v[84:85] op_sel:[0,0,0] op_sel_hi:[1,0,1]
    v_pk_fma_f32 v[86:87], v[50:51], v[168:169], v[86:87] op_sel:[0,0,0] op_sel_hi:[1,0,1]
    v_pk_fma_f32 v[88:89], v[52:53], v[168:169], v[88:89] op_sel:[0,0,0] op_sel_hi:[1,0,1]
    v_pk_fma_f32 v[90:91], v[54:55], v[168:169], v[90:91] op_sel:[0,0,0] op_sel_hi:[1,0,1]
    v_pk_fma_f32 v[92:93], v[56:57], v[168:169], v[92:93] op_sel:[0,0,0] op_sel_hi:[1,0,1]
    s_add_u32 s95, s88, 86016
    buffer_load_dwordx4 a[244:247], v1, s[8:11], s95 offen
    v_pk_fma_f32 v[94:95], v[58:59], v[168:169], v[94:95] op_sel:[0,0,0] op_sel_hi:[1,0,1]
    v_pk_fma_f32 v[104:105], v[60:61], v[168:169], v[104:105] op_sel:[0,0,0] op_sel_hi:[1,0,1]
    v_pk_fma_f32 v[106:107], v[62:63], v[168:169], v[106:107] op_sel:[0,0,0] op_sel_hi:[1,0,1]
    ds_read_b128 v[44:47], v18 offset:0
    ds_read_b128 v[48:51], v18 offset:16
    ds_read_b128 v[52:55], v18 offset:32
    ds_read_b128 v[56:59], v18 offset:48
    ds_read_b128 v[60:63], v18 offset:64
    s_waitcnt lgkmcnt(10)
    v_pk_fma_f32 v[80:81], v[212:213], v[168:169], v[80:81] op_sel:[0,1,0] op_sel_hi:[1,1,1]
    v_pk_fma_f32 v[82:83], v[214:215], v[168:169], v[82:83] op_sel:[0,1,0] op_sel_hi:[1,1,1]
    v_pk_fma_f32 v[84:85], v[216:217], v[168:169], v[84:85] op_sel:[0,1,0] op_sel_hi:[1,1,1]
    v_pk_fma_f32 v[86:87], v[218:219], v[168:169], v[86:87] op_sel:[0,1,0] op_sel_hi:[1,1,1]
    s_add_u32 s95, s88, 90112
    buffer_load_dwordx4 a[248:251], v1, s[8:11], s95 offen
    v_pk_fma_f32 v[88:89], v[220:221], v[168:169], v[88:89] op_sel:[0,1,0] op_sel_hi:[1,1,1]
    v_pk_fma_f32 v[90:91], v[222:223], v[168:169], v[90:91] op_sel:[0,1,0] op_sel_hi:[1,1,1]
    v_pk_fma_f32 v[92:93], v[224:225], v[168:169], v[92:93] op_sel:[0,1,0] op_sel_hi:[1,1,1]
    v_pk_fma_f32 v[94:95], v[226:227], v[168:169], v[94:95] op_sel:[0,1,0] op_sel_hi:[1,1,1]
    v_pk_fma_f32 v[104:105], v[228:229], v[168:169], v[104:105] op_sel:[0,1,0] op_sel_hi:[1,1,1]
    v_pk_fma_f32 v[106:107], v[230:231], v[168:169], v[106:107] op_sel:[0,1,0] op_sel_hi:[1,1,1]
    s_waitcnt lgkmcnt(5)
    v_pk_fma_f32 v[80:81], v[24:25], v[170:171], v[80:81] op_sel:[0,0,0] op_sel_hi:[1,0,1]
    v_pk_fma_f32 v[82:83], v[26:27], v[170:171], v[82:83] op_sel:[0,0,0] op_sel_hi:[1,0,1]
    v_pk_fma_f32 v[84:85], v[28:29], v[170:171], v[84:85] op_sel:[0,0,0] op_sel_hi:[1,0,1]
    v_pk_fma_f32 v[86:87], v[30:31], v[170:171], v[86:87] op_sel:[0,0,0] op_sel_hi:[1,0,1]
    v_pk_fma_f32 v[88:89], v[32:33], v[170:171], v[88:89] op_sel:[0,0,0] op_sel_hi:[1,0,1]
    v_pk_fma_f32 v[90:91], v[34:35], v[170:171], v[90:91] op_sel:[0,0,0] op_sel_hi:[1,0,1]
    s_add_u32 s95, s88, 94208
    buffer_load_dwordx4 a[252:255], v1, s[8:11], s95 offen
    v_pk_fma_f32 v[92:93], v[36:37], v[170:171], v[92:93] op_sel:[0,0,0] op_sel_hi:[1,0,1]
    v_pk_fma_f32 v[94:95], v[38:39], v[170:171], v[94:95] op_sel:[0,0,0] op_sel_hi:[1,0,1]
    v_pk_fma_f32 v[104:105], v[40:41], v[170:171], v[104:105] op_sel:[0,0,0] op_sel_hi:[1,0,1]
    v_pk_fma_f32 v[106:107], v[42:43], v[170:171], v[106:107] op_sel:[0,0,0] op_sel_hi:[1,0,1]
    s_waitcnt lgkmcnt(0)
    v_pk_fma_f32 v[80:81], v[44:45], v[170:171], v[80:81] op_sel:[0,1,0] op_sel_hi:[1,1,1]
    v_pk_fma_f32 v[82:83], v[46:47], v[170:171], v[82:83] op_sel:[0,1,0] op_sel_hi:[1,1,1]
    v_pk_fma_f32 v[84:85], v[48:49], v[170:171], v[84:85] op_sel:[0,1,0] op_sel_hi:[1,1,1]
    v_pk_fma_f32 v[86:87], v[50:51], v[170:171], v[86:87] op_sel:[0,1,0] op_sel_hi:[1,1,1]
    v_pk_fma_f32 v[88:89], v[52:53], v[170:171], v[88:89] op_sel:[0,1,0] op_sel_hi:[1,1,1]
    v_pk_fma_f32 v[90:91], v[54:55], v[170:171], v[90:91] op_sel:[0,1,0] op_sel_hi:[1,1,1]
    v_pk_fma_f32 v[92:93], v[56:57], v[170:171], v[92:93] op_sel:[0,1,0] op_sel_hi:[1,1,1]
    v_pk_fma_f32 v[94:95], v[58:59], v[170:171], v[94:95] op_sel:[0,1,0] op_sel_hi:[1,1,1]
    s_add_u32 s95, s88, 98304
    buffer_load_dwordx4 v[240:243], v1, s[8:11], s95 offen
    v_pk_fma_f32 v[104:105], v[60:61], v[170:171], v[104:105] op_sel:[0,1,0] op_sel_hi:[1,1,1]
    v_pk_fma_f32 v[106:107], v[62:63], v[170:171], v[106:107] op_sel:[0,1,0] op_sel_hi:[1,1,1]
    v_pk_mul_f32 v[80:81], v[80:81], v[172:173] op_sel_hi:[1,0]
    v_pk_mul_f32 v[82:83], v[82:83], v[172:173] op_sel_hi:[1,0]
    v_pk_mul_f32 v[84:85], v[84:85], v[172:173] op_sel_hi:[1,0]
    v_pk_mul_f32 v[86:87], v[86:87], v[172:173] op_sel_hi:[1,0]
    v_pk_mul_f32 v[88:89], v[88:89], v[172:173] op_sel_hi:[1,0]
    v_pk_mul_f32 v[90:91], v[90:91], v[172:173] op_sel_hi:[1,0]
    v_pk_mul_f32 v[92:93], v[92:93], v[172:173] op_sel_hi:[1,0]
    v_pk_mul_f32 v[94:95], v[94:95], v[172:173] op_sel_hi:[1,0]
    v_pk_mul_f32 v[104:105], v[104:105], v[172:173] op_sel_hi:[1,0]
    v_pk_mul_f32 v[106:107], v[106:107], v[172:173] op_sel_hi:[1,0]
    s_add_u32 s95, s88, 102400
    buffer_load_dwordx4 v[244:247], v1, s[8:11], s95 offen
    v_cvt_pk_bf16_f32 v80, v80, v81
    v_cvt_pk_bf16_f32 v81, v82, v83
    v_cvt_pk_bf16_f32 v82, v84, v85
    v_cvt_pk_bf16_f32 v83, v86, v87
    v_cvt_pk_bf16_f32 v84, v88, v89
    v_cvt_pk_bf16_f32 v85, v90, v91
    v_cvt_pk_bf16_f32 v86, v92, v93
    v_cvt_pk_bf16_f32 v87, v94, v95
    v_cvt_pk_bf16_f32 v88, v104, v105
    v_cvt_pk_bf16_f32 v89, v106, v107
    s_nop 0
    v_permlane32_swap_b32 v88, v90
    v_permlane32_swap_b32 v89, v91
    s_add_u32 s95, s88, 106496
    buffer_load_dwordx4 v[248:251], v1, s[8:11], s95 offen
    s_mul_i32 s52, s49, 40960
    s_lshl_b32 s53, s46, 10
    s_add_u32 s52, s52, 13107200
    s_add_u32 s53, s53, s52
    s_lshl_b32 s54, s46, 8
    s_add_u32 s54, s54, s52
    s_add_u32 s54, s54, 16384
    buffer_store_dwordx4 v[80:83], v14, s[8:11], s53 offen sc1
    buffer_store_dwordx4 v[84:87], v14, s[8:11], s53 offen offset:256 sc1
    s_mov_b64 exec, 0xffffffff
    buffer_store_dwordx4 v[88:91], v14, s[8:11], s54 offen sc1
    s_mov_b64 exec, -1
    s_waitcnt vmcnt(15)
    s_barrier
    s_mul_i32 s59, s50, 20480
    s_add_u32 s59, s59, 13107200
    s_add_u32 s60, s59, 16384
    v_add_u32 v166, s89, v1
    v_add_u32 v167, 0x10000, v166
    ds_write_b128 v166, a[160:163] offset:0
    ds_write_b128 v166, a[164:167] offset:4096
    ds_write_b128 v166, a[168:171] offset:8192
    ds_write_b128 v166, a[172:175] offset:12288
    ds_write_b128 v166, a[176:179] offset:16384
    ds_write_b128 v166, a[180:183] offset:20480
    ds_write_b128 v166, a[184:187] offset:24576
    ds_write_b128 v166, a[188:191] offset:28672
    ds_write_b128 v166, a[192:195] offset:32768
    ds_write_b128 v166, a[196:199] offset:36864
    ds_write_b128 v166, a[200:203] offset:40960
    ds_write_b128 v166, a[204:207] offset:45056
    v_add_u32 v175, 0x10000, v10
L_wo_41:
    buffer_load_dwordx4 v[24:27], v1, s[8:11], s60 offen offset:0 sc1
    buffer_load_dwordx4 v[28:31], v1, s[8:11], s60 offen offset:1024 sc1
    buffer_load_dwordx4 v[32:35], v1, s[8:11], s60 offen offset:2048 sc1
    buffer_load_dwordx4 v[36:39], v1, s[8:11], s60 offen offset:3072 sc1
    v_lshlrev_b32 v64, 16, v200
    v_and_b32 v65, 0xffff0000, v200
    v_lshlrev_b32 v66, 16, v201
    v_and_b32 v67, 0xffff0000, v201
    v_lshlrev_b32 v68, 16, v202
    v_and_b32 v69, 0xffff0000, v202
    v_lshlrev_b32 v70, 16, v203
    v_and_b32 v71, 0xffff0000, v203
    v_lshlrev_b32 v72, 16, v204
    v_and_b32 v73, 0xffff0000, v204
    v_lshlrev_b32 v74, 16, v205
    v_and_b32 v75, 0xffff0000, v205
    v_lshlrev_b32 v76, 16, v206
    v_and_b32 v77, 0xffff0000, v206
    v_lshlrev_b32 v78, 16, v207
    v_and_b32 v79, 0xffff0000, v207
    v_lshlrev_b32 v80, 16, v208
    v_and_b32 v81, 0xffff0000, v208
    v_lshlrev_b32 v82, 16, v209
    v_and_b32 v83, 0xffff0000, v209
    s_waitcnt vmcnt(0)
    v_max3_u32 v164, v24, v25, v26
    v_max3_u32 v164, v164, v27, v28
    v_max3_u32 v164, v164, v29, v30
    v_max3_u32 v164, v164, v31, v32
    v_max3_u32 v164, v164, v33, v34
    v_max3_u32 v164, v164, v35, v36
    v_max3_u32 v164, v164, v37, v38
    v_max_u32 v164, v164, v39
    v_cmp_eq_u32 vcc, -1, v164
    s_cbranch_vccz L_ok_42
    s_add_u32 s51, s51, 1
    s_cmp_gt_u32 s51, 200000
    s_cbranch_scc1 L_ok_42
    s_waitcnt vmcnt(0) lgkmcnt(0)
    s_sleep 2
    s_branch L_wo_41
L_ok_42:
    s_add_u32 s61, s59, 0
    buffer_load_dwordx4 a[0:3], v1, s[8:11], s61 offen offset:0 sc1
    buffer_load_dwordx4 a[4:7], v1, s[8:11], s61 offen offset:1024 sc1
    buffer_load_dwordx4 a[8:11], v1, s[8:11], s61 offen offset:2048 sc1
    buffer_load_dwordx4 a[12:15], v1, s[8:11], s61 offen offset:3072 sc1
    s_add_u32 s61, s59, 4096
    buffer_load_dwordx4 a[16:19], v1, s[8:11], s61 offen offset:0 sc1
    buffer_load_dwordx4 a[20:23], v1, s[8:11], s61 offen offset:1024 sc1
    buffer_load_dwordx4 a[24:27], v1, s[8:11], s61 offen offset:2048 sc1
    buffer_load_dwordx4 a[28:31], v1, s[8:11], s61 offen offset:3072 sc1
    s_add_u32 s61, s59, 8192
    buffer_load_dwordx4 a[32:35], v1, s[8:11], s61 offen offset:0 sc1
    buffer_load_dwordx4 a[36:39], v1, s[8:11], s61 offen offset:1024 sc1
    ds_read_b128 v[84:87], v175 offset:16384
    ds_read_b128 v[88:91], v175 offset:17408
    ds_read_b128 v[92:95], v175 offset:18432
    ds_read_b128 v[96:99], v175 offset:19456
    ds_read_b128 v[100:103], v175 offset:20480
    ds_read_b128 v[104:107], v175 offset:21504
    ds_read_b128 v[108:111], v175 offset:22528
    s_waitcnt lgkmcnt(6)
    v_mfma_f32_16x16x32_bf16 v[64:67], v[84:87], v[24:27], v[64:67]
    ds_read_b128 v[112:115], v175 offset:23552
    buffer_load_dwordx4 a[40:43], v1, s[8:11], s61 offen offset:2048 sc1
    s_waitcnt lgkmcnt(6)
    v_mfma_f32_16x16x32_bf16 v[68:71], v[88:91], v[24:27], v[68:71]
    ds_read_b128 v[116:119], v175 offset:24576
    s_waitcnt lgkmcnt(6)
    v_mfma_f32_16x16x32_bf16 v[72:75], v[92:95], v[24:27], v[72:75]
    ds_read_b128 v[84:87], v175 offset:25600
    s_waitcnt lgkmcnt(6)
    v_mfma_f32_16x16x32_bf16 v[76:79], v[96:99], v[24:27], v[76:79]
    ds_read_b128 v[88:91], v175 offset:26624
    s_waitcnt lgkmcnt(6)
    v_mfma_f32_16x16x32_bf16 v[80:83], v[100:103], v[24:27], v[80:83]
    ds_read_b128 v[92:95], v175 offset:27648
    buffer_load_dwordx4 a[44:47], v1, s[8:11], s61 offen offset:3072 sc1
    s_waitcnt lgkmcnt(6)
    v_mfma_f32_16x16x32_bf16 v[64:67], v[104:107], v[28:31], v[64:67]
    ds_read_b128 v[96:99], v175 offset:28672
    s_waitcnt lgkmcnt(6)
    v_mfma_f32_16x16x32_bf16 v[68:71], v[108:111], v[28:31], v[68:71]
    ds_read_b128 v[100:103], v175 offset:29696
    s_waitcnt lgkmcnt(6)
    v_mfma_f32_16x16x32_bf16 v[72:75], v[112:115], v[28:31], v[72:75]
    ds_read_b128 v[104:107], v175 offset:30720
    s_waitcnt lgkmcnt(6)
    v_mfma_f32_16x16x32_bf16 v[76:79], v[116:119], v[28:31], v[76:79]
    ds_read_b128 v[108:111], v175 offset:31744
    s_add_u32 s61, s59, 12288
    buffer_load_dwordx4 a[48:51], v1, s[8:11], s61 offen offset:0 sc1
    s_waitcnt lgkmcnt(6)
    v_mfma_f32_16x16x32_bf16 v[80:83], v[84:87], v[28:31], v[80:83]
    ds_read_b128 v[112:115], v175 offset:32768
    s_waitcnt lgkmcnt(6)
    v_mfma_f32_16x16x32_bf16 v[64:67], v[88:91], v[32:35], v[64:67]
    ds_read_b128 v[116:119], v175 offset:33792
    s_waitcnt lgkmcnt(6)
    v_mfma_f32_16x16x32_bf16 v[68:71], v[92:95], v[32:35], v[68:71]
    ds_read_b128 v[84:87], v175 offset:34816
    s_waitcnt lgkmcnt(6)
    v_mfma_f32_16x16x32_bf16 v[72:75], v[96:99], v[32:35], v[72:75]
    ds_read_b128 v[88:91], v175 offset:35840
    buffer_load_dwordx4 a[52:55], v1, s[8:11], s61 offen offset:1024 sc1
    s_waitcnt lgkmcnt(6)
    v_mfma_f32_16x16x32_bf16 v[76:79], v[100:103], v[32:35], v[76:79]
    ds_read_b128 v[92:95], v10 offset:0
    s_waitcnt lgkmcnt(6)
    v_mfma_f32_16x16x32_bf16 v[80:83], v[104:107], v[32:35], v[80:83]
    ds_read_b128 v[96:99], v10 offset:1024
    s_waitcnt lgkmcnt(6)
    v_mfma_f32_16x16x32_bf16 v[64:67], v[108:111], v[36:39], v[64:67]
    ds_read_b128 v[100:103], v10 offset:2048
    s_waitcnt lgkmcnt(6)
    v_mfma_f32_16x16x32_bf16 v[68:71], v[112:115], v[36:39], v[68:71]
    ds_read_b128 v[104:107], v10 offset:3072
    buffer_load_dwordx4 a[56:59], v1, s[8:11], s61 offen offset:2048 sc1
    s_waitcnt lgkmcnt(6)
    v_mfma_f32_16x16x32_bf16 v[72:75], v[116:119], v[36:39], v[72:75]
    ds_read_b128 v[108:111], v10 offset:4096
    s_waitcnt lgkmcnt(6)
    v_mfma_f32_16x16x32_bf16 v[76:79], v[84:87], v[36:39], v[76:79]
    ds_read_b128 v[112:115], v10 offset:5120
    s_waitcnt lgkmcnt(6)
    v_mfma_f32_16x16x32_bf16 v[80:83], v[88:91], v[36:39], v[80:83]
    ds_read_b128 v[116:119], v10 offset:6144
    s_waitcnt vmcnt(14) lgkmcnt(6)
    v_mfma_f32_16x16x32_bf16 v[64:67], v[92:95], a[0:3], v[64:67]
    ds_read_b128 v[84:87], v10 offset:7168
    buffer_load_dwordx4 a[60:63], v1, s[8:11], s61 offen offset:3072 sc1
    s_waitcnt lgkmcnt(6)
    v_mfma_f32_16x16x32_bf16 v[68:71], v[96:99], a[0:3], v[68:71]
    ds_read_b128 v[88:91], v10 offset:8192
    s_waitcnt lgkmcnt(6)
    v_mfma_f32_16x16x32_bf16 v[72:75], v[100:103], a[0:3], v[72:75]
    ds_read_b128 v[92:95], v10 offset:9216
    s_waitcnt lgkmcnt(6)
    v_mfma_f32_16x16x32_bf16 v[76:79], v[104:107], a[0:3], v[76:79]
    ds_read_b128 v[96:99], v10 offset:10240
    s_waitcnt lgkmcnt(6)
    v_mfma_f32_16x16x32_bf16 v[80:83], v[108:111], a[0:3], v[80:83]
    ds_read_b128 v[100:103], v10 offset:11264
    s_add_u32 s95, s88, 110592
    buffer_load_dwordx4 v[252:255], v1, s[8:11], s95 offen
    s_waitcnt vmcnt(15) lgkmcnt(6)
    v_mfma_f32_16x16x32_bf16 v[64:67], v[112:115], a[4:7], v[64:67]
    ds_read_b128 v[104:107], v10 offset:12288
    s_waitcnt lgkmcnt(6)
    v_mfma_f32_16x16x32_bf16 v[68:71], v[116:119], a[4:7], v[68:71]
    ds_read_b128 v[108:111], v10 offset:13312
    s_waitcnt lgkmcnt(6)
    v_mfma_f32_16x16x32_bf16 v[72:75], v[84:87], a[4:7], v[72:75]
    ds_read_b128 v[112:115], v10 offset:14336
    s_waitcnt lgkmcnt(6)
    v_mfma_f32_16x16x32_bf16 v[76:79], v[88:91], a[4:7], v[76:79]
    ds_read_b128 v[116:119], v10 offset:15360
    s_waitcnt lgkmcnt(6)
    v_mfma_f32_16x16x32_bf16 v[80:83], v[92:95], a[4:7], v[80:83]
    ds_read_b128 v[84:87], v10 offset:16384
    s_waitcnt vmcnt(14) lgkmcnt(6)
    v_mfma_f32_16x16x32_bf16 v[64:67], v[96:99], a[8:11], v[64:67]
    ds_read_b128 v[88:91], v10 offset:17408
    s_waitcnt lgkmcnt(6)
    v_mfma_f32_16x16x32_bf16 v[68:71], v[100:103], a[8:11], v[68:71]
    ds_read_b128 v[92:95], v10 offset:18432
    s_waitcnt lgkmcnt(6)
    v_mfma_f32_16x16x32_bf16 v[72:75], v[104:107], a[8:11], v[72:75]
    ds_read_b128 v[96:99], v10 offset:19456
    s_waitcnt lgkmcnt(6)
    v_mfma_f32_16x16x32_bf16 v[76:79], v[108:111], a[8:11], v[76:79]
    ds_read_b128 v[100:103], v10 offset:20480
    s_waitcnt lgkmcnt(6)
    v_mfma_f32_16x16x32_bf16 v[80:83], v[112:115], a[8:11], v[80:83]
    ds_read_b128 v[104:107], v10 offset:21504
    s_waitcnt vmcnt(13) lgkmcnt(6)
    v_mfma_f32_16x16x32_bf16 v[64:67], v[116:119], a[12:15], v[64:67]
    ds_read_b128 v[108:111], v10 offset:22528
    s_waitcnt lgkmcnt(6)
    v_mfma_f32_16x16x32_bf16 v[68:71], v[84:87], a[12:15], v[68:71]
    ds_read_b128 v[112:115], v10 offset:23552
    s_waitcnt lgkmcnt(6)
    v_mfma_f32_16x16x32_bf16 v[72:75], v[88:91], a[12:15], v[72:75]
    ds_read_b128 v[116:119], v10 offset:24576
    s_waitcnt lgkmcnt(6)
    v_mfma_f32_16x16x32_bf16 v[76:79], v[92:95], a[12:15], v[76:79]
    ds_read_b128 v[84:87], v10 offset:25600
    s_waitcnt lgkmcnt(6)
    v_mfma_f32_16x16x32_bf16 v[80:83], v[96:99], a[12:15], v[80:83]
    ds_read_b128 v[88:91], v10 offset:26624
    s_waitcnt vmcnt(12) lgkmcnt(6)
    v_mfma_f32_16x16x32_bf16 v[64:67], v[100:103], a[16:19], v[64:67]
    ds_read_b128 v[92:95], v10 offset:27648
    s_waitcnt lgkmcnt(6)
    v_mfma_f32_16x16x32_bf16 v[68:71], v[104:107], a[16:19], v[68:71]
    ds_read_b128 v[96:99], v10 offset:28672
    s_waitcnt lgkmcnt(6)
    v_mfma_f32_16x16x32_bf16 v[72:75], v[108:111], a[16:19], v[72:75]
    ds_read_b128 v[100:103], v10 offset:29696
    s_waitcnt lgkmcnt(6)
    v_mfma_f32_16x16x32_bf16 v[76:79], v[112:115], a[16:19], v[76:79]
    ds_read_b128 v[104:107], v10 offset:30720
    s_waitcnt lgkmcnt(6)
    v_mfma_f32_16x16x32_bf16 v[80:83], v[116:119], a[16:19], v[80:83]
    ds_read_b128 v[108:111], v10 offset:31744
    s_waitcnt vmcnt(11) lgkmcnt(6)
    v_mfma_f32_16x16x32_bf16 v[64:67], v[84:87], a[20:23], v[64:67]
    ds_read_b128 v[112:115], v10 offset:32768
    s_waitcnt lgkmcnt(6)
    v_mfma_f32_16x16x32_bf16 v[68:71], v[88:91], a[20:23], v[68:71]
    ds_read_b128 v[116:119], v10 offset:33792
    s_waitcnt lgkmcnt(6)
    v_mfma_f32_16x16x32_bf16 v[72:75], v[92:95], a[20:23], v[72:75]
    ds_read_b128 v[84:87], v10 offset:34816
    s_waitcnt lgkmcnt(6)
    v_mfma_f32_16x16x32_bf16 v[76:79], v[96:99], a[20:23], v[76:79]
    ds_read_b128 v[88:91], v10 offset:35840
    s_waitcnt lgkmcnt(6)
    v_mfma_f32_16x16x32_bf16 v[80:83], v[100:103], a[20:23], v[80:83]
    ds_read_b128 v[92:95], v10 offset:36864
    s_waitcnt vmcnt(10) lgkmcnt(6)
    v_mfma_f32_16x16x32_bf16 v[64:67], v[104:107], a[24:27], v[64:67]
    ds_read_b128 v[96:99], v10 offset:37888
    s_waitcnt lgkmcnt(6)
    v_mfma_f32_16x16x32_bf16 v[68:71], v[108:111], a[24:27], v[68:71]
    ds_read_b128 v[100:103], v10 offset:38912
    s_waitcnt lgkmcnt(6)
    v_mfma_f32_16x16x32_bf16 v[72:75], v[112:115], a[24:27], v[72:75]
    ds_read_b128 v[104:107], v10 offset:39936
    s_waitcnt lgkmcnt(6)
    v_mfma_f32_16x16x32_bf16 v[76:79], v[116:119], a[24:27], v[76:79]
    ds_read_b128 v[108:111], v10 offset:40960
    s_waitcnt lgkmcnt(6)
    v_mfma_f32_16x16x32_bf16 v[80:83], v[84:87], a[24:27], v[80:83]
    ds_read_b128 v[112:115], v10 offset:41984
    s_waitcnt vmcnt(9) lgkmcnt(6)
    v_mfma_f32_16x16x32_bf16 v[64:67], v[88:91], a[28:31], v[64:67]
    ds_read_b128 v[116:119], v10 offset:43008
    s_waitcnt lgkmcnt(6)
    v_mfma_f32_16x16x32_bf16 v[68:71], v[92:95], a[28:31], v[68:71]
    ds_read_b128 v[84:87], v10 offset:44032
    s_waitcnt lgkmcnt(6)
    v_mfma_f32_16x16x32_bf16 v[72:75], v[96:99], a[28:31], v[72:75]
    ds_read_b128 v[88:91], v10 offset:45056
    s_waitcnt lgkmcnt(6)
    v_mfma_f32_16x16x32_bf16 v[76:79], v[100:103], a[28:31], v[76:79]
    ds_read_b128 v[92:95], v10 offset:46080
    s_waitcnt lgkmcnt(6)
    v_mfma_f32_16x16x32_bf16 v[80:83], v[104:107], a[28:31], v[80:83]
    ds_read_b128 v[96:99], v10 offset:47104
    s_waitcnt vmcnt(8) lgkmcnt(6)
    v_mfma_f32_16x16x32_bf16 v[64:67], v[108:111], a[32:35], v[64:67]
    ds_read_b128 v[100:103], v10 offset:48128
    s_waitcnt lgkmcnt(6)
    v_mfma_f32_16x16x32_bf16 v[68:71], v[112:115], a[32:35], v[68:71]
    ds_read_b128 v[104:107], v10 offset:49152
    s_waitcnt lgkmcnt(6)
    v_mfma_f32_16x16x32_bf16 v[72:75], v[116:119], a[32:35], v[72:75]
    ds_read_b128 v[108:111], v10 offset:50176
    s_waitcnt lgkmcnt(6)
    v_mfma_f32_16x16x32_bf16 v[76:79], v[84:87], a[32:35], v[76:79]
    ds_read_b128 v[112:115], v10 offset:51200
    s_waitcnt lgkmcnt(6)
    v_mfma_f32_16x16x32_bf16 v[80:83], v[88:91], a[32:35], v[80:83]
    ds_read_b128 v[116:119], v10 offset:52224
    s_waitcnt vmcnt(7) lgkmcnt(6)
    v_mfma_f32_16x16x32_bf16 v[64:67], v[92:95], a[36:39], v[64:67]
    ds_read_b128 v[84:87], v10 offset:53248
    s_waitcnt lgkmcnt(6)
    v_mfma_f32_16x16x32_bf16 v[68:71], v[96:99], a[36:39], v[68:71]
    ds_read_b128 v[88:91], v10 offset:54272
    s_waitcnt lgkmcnt(6)
    v_mfma_f32_16x16x32_bf16 v[72:75], v[100:103], a[36:39], v[72:75]
    ds_read_b128 v[92:95], v10 offset:55296
    s_waitcnt lgkmcnt(6)
    v_mfma_f32_16x16x32_bf16 v[76:79], v[104:107], a[36:39], v[76:79]
    ds_read_b128 v[96:99], v10 offset:56320
    s_waitcnt lgkmcnt(6)
    v_mfma_f32_16x16x32_bf16 v[80:83], v[108:111], a[36:39], v[80:83]
    ds_read_b128 v[100:103], v10 offset:57344
    s_waitcnt vmcnt(6) lgkmcnt(6)
    v_mfma_f32_16x16x32_bf16 v[64:67], v[112:115], a[40:43], v[64:67]
    ds_read_b128 v[104:107], v10 offset:58368
    s_waitcnt lgkmcnt(6)
    v_mfma_f32_16x16x32_bf16 v[68:71], v[116:119], a[40:43], v[68:71]
    ds_read_b128 v[108:111], v10 offset:59392
    s_waitcnt lgkmcnt(6)
    v_mfma_f32_16x16x32_bf16 v[72:75], v[84:87], a[40:43], v[72:75]
    ds_read_b128 v[112:115], v10 offset:60416
    s_waitcnt lgkmcnt(6)
    v_mfma_f32_16x16x32_bf16 v[76:79], v[88:91], a[40:43], v[76:79]
    ds_read_b128 v[116:119], v10 offset:61440
    s_waitcnt lgkmcnt(6)
    v_mfma_f32_16x16x32_bf16 v[80:83], v[92:95], a[40:43], v[80:83]
    ds_read_b128 v[84:87], v10 offset:62464
    s_waitcnt vmcnt(5) lgkmcnt(6)
    v_mfma_f32_16x16x32_bf16 v[64:67], v[96:99], a[44:47], v[64:67]
    ds_read_b128 v[88:91], v10 offset:63488
    s_waitcnt lgkmcnt(6)
    v_mfma_f32_16x16x32_bf16 v[68:71], v[100:103], a[44:47], v[68:71]
    ds_read_b128 v[92:95], v10 offset:64512
    s_waitcnt lgkmcnt(6)
    v_mfma_f32_16x16x32_bf16 v[72:75], v[104:107], a[44:47], v[72:75]
    ds_read_b128 v[96:99], v175 offset:0
    s_waitcnt lgkmcnt(6)
    v_mfma_f32_16x16x32_bf16 v[76:79], v[108:111], a[44:47], v[76:79]
    ds_read_b128 v[100:103], v175 offset:1024
    s_waitcnt lgkmcnt(6)
    v_mfma_f32_16x16x32_bf16 v[80:83], v[112:115], a[44:47], v[80:83]
    ds_read_b128 v[104:107], v175 offset:2048
    s_waitcnt vmcnt(4) lgkmcnt(6)
    v_mfma_f32_16x16x32_bf16 v[64:67], v[116:119], a[48:51], v[64:67]
    ds_read_b128 v[108:111], v175 offset:3072
    s_waitcnt lgkmcnt(6)
    v_mfma_f32_16x16x32_bf16 v[68:71], v[84:87], a[48:51], v[68:71]
    ds_read_b128 v[112:115], v175 offset:4096
    s_waitcnt lgkmcnt(6)
    v_mfma_f32_16x16x32_bf16 v[72:75], v[88:91], a[48:51], v[72:75]
    ds_read_b128 v[116:119], v175 offset:5120
    s_waitcnt lgkmcnt(6)
    v_mfma_f32_16x16x32_bf16 v[76:79], v[92:95], a[48:51], v[76:79]
    ds_read_b128 v[84:87], v175 offset:6144
    s_waitcnt lgkmcnt(6)
    v_mfma_f32_16x16x32_bf16 v[80:83], v[96:99], a[48:51], v[80:83]
    ds_read_b128 v[88:91], v175 offset:7168
    s_waitcnt vmcnt(3) lgkmcnt(6)
    v_mfma_f32_16x16x32_bf16 v[64:67], v[100:103], a[52:55], v[64:67]
    ds_read_b128 v[92:95], v175 offset:8192
    s_waitcnt lgkmcnt(6)
    v_mfma_f32_16x16x32_bf16 v[68:71], v[104:107], a[52:55], v[68:71]
    ds_read_b128 v[96:99], v175 offset:9216
    s_waitcnt lgkmcnt(6)
    v_mfma_f32_16x16x32_bf16 v[72:75], v[108:111], a[52:55], v[72:75]
    ds_read_b128 v[100:103], v175 offset:10240
    s_waitcnt lgkmcnt(6)
    v_mfma_f32_16x16x32_bf16 v[76:79], v[112:115], a[52:55], v[76:79]
    ds_read_b128 v[104:107], v175 offset:11264
    s_waitcnt lgkmcnt(6)
    v_mfma_f32_16x16x32_bf16 v[80:83], v[116:119], a[52:55], v[80:83]
    ds_read_b128 v[108:111], v175 offset:12288
    s_waitcnt vmcnt(2) lgkmcnt(6)
    v_mfma_f32_16x16x32_bf16 v[64:67], v[84:87], a[56:59], v[64:67]
    ds_read_b128 v[112:115], v175 offset:13312
    s_waitcnt lgkmcnt(6)
    v_mfma_f32_16x16x32_bf16 v[68:71], v[88:91], a[56:59], v[68:71]
    ds_read_b128 v[116:119], v175 offset:14336
    s_waitcnt lgkmcnt(6)
    v_mfma_f32_16x16x32_bf16 v[72:75], v[92:95], a[56:59], v[72:75]
    ds_read_b128 v[84:87], v175 offset:15360
    s_waitcnt lgkmcnt(6)
    v_mfma_f32_16x16x32_bf16 v[76:79], v[96:99], a[56:59], v[76:79]
    s_waitcnt lgkmcnt(5)
    v_mfma_f32_16x16x32_bf16 v[80:83], v[100:103], a[56:59], v[80:83]
    s_waitcnt vmcnt(1) lgkmcnt(4)
    v_mfma_f32_16x16x32_bf16 v[64:67], v[104:107], a[60:63], v[64:67]
    s_waitcnt lgkmcnt(3)
    v_mfma_f32_16x16x32_bf16 v[68:71], v[108:111], a[60:63], v[68:71]
    s_waitcnt lgkmcnt(2)
    v_mfma_f32_16x16x32_bf16 v[72:75], v[112:115], a[60:63], v[72:75]
    s_waitcnt lgkmcnt(1)
    v_mfma_f32_16x16x32_bf16 v[76:79], v[116:119], a[60:63], v[76:79]
    s_waitcnt lgkmcnt(0)
    v_mfma_f32_16x16x32_bf16 v[80:83], v[84:87], a[60:63], v[80:83]
    s_nop 7
    v_cmp_u_f32 vcc, v80, v80
    s_cbranch_vccz L_ok_43
    s_add_u32 s51, s51, 1
    s_cmp_gt_u32 s51, 200000
    s_cbranch_scc1 L_ok_43
    s_waitcnt vmcnt(0) lgkmcnt(0)
    s_sleep 2
    s_branch L_wo_41
L_ok_43:
    v_cvt_pk_bf16_f32 v40, v64, v65
    v_cvt_pk_bf16_f32 v41, v66, v67
    v_cvt_pk_bf16_f32 v42, v68, v69
    v_cvt_pk_bf16_f32 v43, v70, v71
    v_cvt_pk_bf16_f32 v44, v72, v73
    v_cvt_pk_bf16_f32 v45, v74, v75
    v_cvt_pk_bf16_f32 v46, v76, v77
    v_cvt_pk_bf16_f32 v47, v78, v79
    v_cvt_pk_bf16_f32 v48, v80, v81
    v_cvt_pk_bf16_f32 v49, v82, v83
    v_mov_b32 v200, v40
    v_mov_b32 v201, v41
    v_mov_b32 v202, v42
    v_mov_b32 v203, v43
    v_mov_b32 v204, v44
    v_mov_b32 v205, v45
    v_mov_b32 v206, v46
    v_mov_b32 v207, v47
    v_mov_b32 v208, v48
    v_mov_b32 v209, v49
    v_permlane16_swap_b32 v40, v42
    v_permlane16_swap_b32 v41, v43
    v_permlane16_swap_b32 v44, v46
    v_permlane16_swap_b32 v45, v47
    v_permlane16_swap_b32 v48, v50
    v_permlane16_swap_b32 v49, v51
    s_lshr_b32 s52, s50, 1
    s_mul_i32 s52, s52, 40960
    s_mul_i32 s53, s47, 5120
    s_add_u32 s52, s52, s53
    s_add_u32 s52, s52, 5242880
    s_add_u32 s53, s52, 4096
    s_lshl_b32 s54, s50, 10
    s_lshl_b32 s55, s47, 7
    s_add_u32 s54, s54, s55
    s_add_u32 s54, s54, 18612224
    buffer_store_dwordx4 v[40:43], v11, s[8:11], s52 offen sc1
    buffer_store_dwordx4 v[44:47], v11, s[8:11], s52 offen offset:2048 sc1
    s_mov_b32 exec_lo, 0xffff
    s_mov_b32 exec_hi, 0xffff
    buffer_store_dwordx4 v[48:51], v11, s[8:11], s53 offen sc1
    s_mov_b64 exec, -1
    v_mov_b32 v164, 0
    v_mov_b32 v165, 0
    v_dot2c_f32_bf16 v164, v200, v22
    v_dot2c_f32_bf16 v165, v200, v200
    v_dot2c_f32_bf16 v164, v201, v22
    v_dot2c_f32_bf16 v165, v201, v201
    v_dot2c_f32_bf16 v164, v202, v22
    v_dot2c_f32_bf16 v165, v202, v202
    v_dot2c_f32_bf16 v164, v203, v22
    v_dot2c_f32_bf16 v165, v203, v203
    v_dot2c_f32_bf16 v164, v204, v22
    v_dot2c_f32_bf16 v165, v204, v204
    v_dot2c_f32_bf16 v164, v205, v22
    v_dot2c_f32_bf16 v165, v205, v205
    v_dot2c_f32_bf16 v164, v206, v22
    v_dot2c_f32_bf16 v165, v206, v206
    v_dot2c_f32_bf16 v164, v207, v22
    v_dot2c_f32_bf16 v165, v207, v207
    v_dot2c_f32_bf16 v164, v208, v22
    v_dot2c_f32_bf16 v165, v208, v208
    v_dot2c_f32_bf16 v164, v209, v22
    v_dot2c_f32_bf16 v165, v209, v209
    s_nop 1
    v_mov_b32 v166, v164
    v_mov_b32 v167, v165
    s_nop 0
    v_permlane16_swap_b32 v164, v166
    v_permlane16_swap_b32 v165, v167
    v_pk_add_f32 v[164:165], v[164:165], v[166:167]
    v_mov_b32 v166, v164
    v_mov_b32 v167, v165
    s_nop 0
    v_permlane32_swap_b32 v164, v166
    v_permlane32_swap_b32 v165, v167
    v_pk_add_f32 v[164:165], v[164:165], v[166:167]
    s_mov_b64 exec, 0xffff
    buffer_store_dwordx2 v[164:165], v12, s[8:11], s54 offen sc1
    s_mov_b64 exec, -1
    s_barrier
    v_add_u32 v172, s89, v1
    v_add_u32 v173, 0x10000, v172
    ds_write_b128 v172, a[208:211] offset:49152
    ds_write_b128 v172, a[212:215] offset:53248
    ds_write_b128 v172, a[216:219] offset:57344
    ds_write_b128 v172, a[220:223] offset:61440
    ds_write_b128 v173, a[224:227] offset:0
    ds_write_b128 v173, a[228:231] offset:4096
    ds_write_b128 v173, a[232:235] offset:8192
    ds_write_b128 v173, a[236:239] offset:12288
    ds_write_b128 v173, a[240:243] offset:16384
    ds_write_b128 v173, a[244:247] offset:20480
    ds_write_b128 v173, a[248:251] offset:24576
    ds_write_b128 v173, a[252:255] offset:28672
    ds_write_b128 v173, v[240:243] offset:32768
    ds_write_b128 v173, v[244:247] offset:36864
    ds_write_b128 v173, v[248:251] offset:40960
    s_waitcnt vmcnt(4)
    ds_write_b128 v173, v[252:255] offset:45056
    s_mov_b32 s98, s88
    s_lshl_b32 s59, s49, 11
    s_add_u32 s59, s59, 18612224
    s_mul_i32 s60, s49, 40960
    s_add_u32 s60, s60, 5242880
    s_mov_b32 s99, 0
L_qkv_44:
    buffer_load_dwordx2 v[164:165], v13, s[8:11], s59 offen offset:0 sc1
    buffer_load_dwordx2 v[166:167], v13, s[8:11], s59 offen offset:128 sc1
    buffer_load_dwordx2 v[168:169], v13, s[8:11], s59 offen offset:256 sc1
    buffer_load_dwordx2 v[170:171], v13, s[8:11], s59 offen offset:384 sc1
    ds_read_b128 v[64:67], v19 offset:512
    ds_read_b128 v[68:71], v19 offset:528
    ds_read_b128 v[72:75], v19 offset:544
    ds_read_b128 v[76:79], v19 offset:560
    ds_read_b128 v[80:83], v19 offset:576
    ds_read_b128 v[84:87], v19 offset:592
    ds_read_b128 v[88:91], v19 offset:608
    ds_read_b128 v[92:95], v19 offset:624
    ds_read_b128 v[96:99], v19 offset:640
    ds_read_b128 v[100:103], v19 offset:656
    ds_read_b128 v[104:107], v19 offset:672
    ds_read_b128 v[108:111], v19 offset:688
    ds_read_b128 v[112:115], v19 offset:704
    ds_read_b128 v[116:119], v19 offset:720
    ds_read_b128 v[120:123], v19 offset:736
    ds_read_b128 v[124:127], v19 offset:752
    s_waitcnt vmcnt(0)
    v_pk_add_f32 v[164:165], v[164:165], v[166:167]
    v_pk_add_f32 v[168:169], v[168:169], v[170:171]
    v_pk_add_f32 v[164:165], v[164:165], v[168:169]
    v_cmp_u_f32 vcc, v164, v164
    s_cbranch_vccz L_ok_45
    s_add_u32 s51, s51, 1
    s_cmp_gt_u32 s51, 200000
    s_cbranch_scc1 L_ok_45
    s_waitcnt vmcnt(0) lgkmcnt(0)
    s_sleep 2
    s_branch L_qkv_44
L_ok_45:
    s_add_u32 s61, s60, 0
    buffer_load_dwordx4 a[0:3], v1, s[8:11], s61 offen offset:0 sc1
    buffer_load_dwordx4 a[4:7], v1, s[8:11], s61 offen offset:1024 sc1
    buffer_load_dwordx4 a[8:11], v1, s[8:11], s61 offen offset:2048 sc1
    buffer_load_dwordx4 a[12:15], v1, s[8:11], s61 offen offset:3072 sc1
    s_add_u32 s61, s60, 4096
    buffer_load_dwordx4 a[16:19], v1, s[8:11], s61 offen offset:0 sc1
    buffer_load_dwordx4 a[20:23], v1, s[8:11], s61 offen offset:1024 sc1
    buffer_load_dwordx4 a[24:27], v1, s[8:11], s61 offen offset:2048 sc1
    buffer_load_dwordx4 a[28:31], v1, s[8:11], s61 offen offset:3072 sc1
    s_add_u32 s61, s60, 8192
    buffer_load_dwordx4 a[32:35], v1, s[8:11], s61 offen offset:0 sc1
    buffer_load_dwordx4 a[36:39], v1, s[8:11], s61 offen offset:1024 sc1
    v_mov_b32 v166, v164
    v_mov_b32 v167, v165
    s_nop 0
    v_permlane32_swap_b32 v164, v166
    v_permlane32_swap_b32 v165, v167
    v_pk_add_f32 v[164:165], v[164:165], v[166:167]
    s_mov_b32 s56, 0x3acccccd
    v_mul_f32 v210, s56, v164
    v_mul_f32 v0, s56, v165
    v_fma_f32 v0, -v210, v210, v0
    v_max_f32 v0, 0, v0
    v_add_f32 v0, 0x3727c5ac, v0
    v_rsq_f32 v0, v0
    v_sub_f32 v210, 0, v210
    s_waitcnt lgkmcnt(12)
    v_pk_mul_f32 v[64:65], v[64:65], v[210:211] op_sel_hi:[1,0]
    v_pk_mul_f32 v[66:67], v[66:67], v[210:211] op_sel_hi:[1,0]
    v_pk_mul_f32 v[68:69], v[68:69], v[210:211] op_sel_hi:[1,0]
    v_pk_mul_f32 v[70:71], v[70:71], v[210:211] op_sel_hi:[1,0]
    v_pk_mul_f32 v[72:73], v[72:73], v[210:211] op_sel_hi:[1,0]
    v_pk_mul_f32 v[74:75], v[74:75], v[210:211] op_sel_hi:[1,0]
    v_pk_mul_f32 v[76:77], v[76:77], v[210:211] op_sel_hi:[1,0]
    v_pk_mul_f32 v[78:79], v[78:79], v[210:211] op_sel_hi:[1,0]
    s_waitcnt lgkmcnt(8)
    v_pk_mul_f32 v[80:81], v[80:81], v[210:211] op_sel_hi:[1,0]
    v_pk_mul_f32 v[82:83], v[82:83], v[210:211] op_sel_hi:[1,0]
    v_pk_mul_f32 v[84:85], v[84:85], v[210:211] op_sel_hi:[1,0]
    v_pk_mul_f32 v[86:87], v[86:87], v[210:211] op_sel_hi:[1,0]
    v_pk_mul_f32 v[88:89], v[88:89], v[210:211] op_sel_hi:[1,0]
    v_pk_mul_f32 v[90:91], v[90:91], v[210:211] op_sel_hi:[1,0]
    v_pk_mul_f32 v[92:93], v[92:93], v[210:211] op_sel_hi:[1,0]
    v_pk_mul_f32 v[94:95], v[94:95], v[210:211] op_sel_hi:[1,0]
    s_waitcnt lgkmcnt(4)
    v_pk_mul_f32 v[96:97], v[96:97], v[210:211] op_sel_hi:[1,0]
    v_pk_mul_f32 v[98:99], v[98:99], v[210:211] op_sel_hi:[1,0]
    v_pk_mul_f32 v[100:101], v[100:101], v[210:211] op_sel_hi:[1,0]
    v_pk_mul_f32 v[102:103], v[102:103], v[210:211] op_sel_hi:[1,0]
    v_pk_mul_f32 v[104:105], v[104:105], v[210:211] op_sel_hi:[1,0]
    v_pk_mul_f32 v[106:107], v[106:107], v[210:211] op_sel_hi:[1,0]
    v_pk_mul_f32 v[108:109], v[108:109], v[210:211] op_sel_hi:[1,0]
    v_pk_mul_f32 v[110:111], v[110:111], v[210:211] op_sel_hi:[1,0]
    s_waitcnt lgkmcnt(0)
    v_pk_mul_f32 v[112:113], v[112:113], v[210:211] op_sel_hi:[1,0]
    v_pk_mul_f32 v[114:115], v[114:115], v[210:211] op_sel_hi:[1,0]
    v_pk_mul_f32 v[116:117], v[116:117], v[210:211] op_sel_hi:[1,0]
    v_pk_mul_f32 v[118:119], v[118:119], v[210:211] op_sel_hi:[1,0]
    v_pk_mul_f32 v[120:121], v[120:121], v[210:211] op_sel_hi:[1,0]
    v_pk_mul_f32 v[122:123], v[122:123], v[210:211] op_sel_hi:[1,0]
    v_pk_mul_f32 v[124:125], v[124:125], v[210:211] op_sel_hi:[1,0]
    v_pk_mul_f32 v[126:127], v[126:127], v[210:211] op_sel_hi:[1,0]
    s_waitcnt lgkmcnt(0)
    s_cmp_eq_u32 s99, 0
    s_cbranch_scc0 L_skb_46
    s_barrier
    s_mov_b32 s99, 1
L_skb_46:
    ds_read_b128 v[128:131], v2 offset:0
    ds_read_b128 v[132:135], v2 offset:1024
    ds_read_b128 v[136:139], v4 offset:2048
    ds_read_b128 v[140:143], v2 offset:2816
    ds_read_b128 v[144:147], v2 offset:3840
    ds_read_b128 v[148:151], v4 offset:4864
    s_waitcnt vmcnt(9) lgkmcnt(5)
    v_mfma_f32_32x32x16_bf16 v[64:79], v[128:131], a[0:3], v[64:79]
    ds_read_b128 v[152:155], v2 offset:5632
    s_waitcnt lgkmcnt(5)
    v_mfma_f32_32x32x16_bf16 v[80:95], v[132:135], a[0:3], v[80:95]
    ds_read_b128 v[156:159], v2 offset:6656
    buffer_load_dwordx4 a[40:43], v1, s[8:11], s61 offen offset:2048 sc1
    s_waitcnt lgkmcnt(5)
    v_mfma_f32_32x32x16_bf16 v[96:111], v[136:139], a[0:3], v[96:111]
    ds_read_b128 v[160:163], v4 offset:7680
    s_waitcnt vmcnt(9) lgkmcnt(5)
    v_mfma_f32_32x32x16_bf16 v[64:79], v[140:143], a[4:7], v[64:79]
    ds_read_b128 v[128:131], v2 offset:8448
    buffer_load_dwordx4 a[44:47], v1, s[8:11], s61 offen offset:3072 sc1
    s_waitcnt lgkmcnt(5)
    v_mfma_f32_32x32x16_bf16 v[80:95], v[144:147], a[4:7], v[80:95]
    ds_read_b128 v[132:135], v2 offset:9472
    s_waitcnt lgkmcnt(5)
    v_mfma_f32_32x32x16_bf16 v[96:111], v[148:151], a[4:7], v[96:111]
    ds_read_b128 v[136:139], v4 offset:10496
    s_add_u32 s61, s60, 12288
    buffer_load_dwordx4 a[48:51], v1, s[8:11], s61 offen offset:0 sc1
    s_waitcnt vmcnt(10) lgkmcnt(5)
    v_mfma_f32_32x32x16_bf16 v[64:79], v[152:155], a[8:11], v[64:79]
    ds_read_b128 v[140:143], v2 offset:11264
    s_waitcnt lgkmcnt(5)
    v_mfma_f32_32x32x16_bf16 v[80:95], v[156:159], a[8:11], v[80:95]
    ds_read_b128 v[144:147], v2 offset:12288
    buffer_load_dwordx4 a[52:55], v1, s[8:11], s61 offen offset:1024 sc1
    s_waitcnt lgkmcnt(5)
    v_mfma_f32_32x32x16_bf16 v[96:111], v[160:163], a[8:11], v[96:111]
    ds_read_b128 v[148:151], v4 offset:13312
    s_waitcnt vmcnt(10) lgkmcnt(5)
    v_mfma_f32_32x32x16_bf16 v[64:79], v[128:131], a[12:15], v[64:79]
    ds_read_b128 v[152:155], v2 offset:14080
    buffer_load_dwordx4 a[56:59], v1, s[8:11], s61 offen offset:2048 sc1
    s_waitcnt lgkmcnt(5)
    v_mfma_f32_32x32x16_bf16 v[80:95], v[132:135], a[12:15], v[80:95]
    ds_read_b128 v[156:159], v2 offset:15104
    s_waitcnt lgkmcnt(5)
    v_mfma_f32_32x32x16_bf16 v[96:111], v[136:139], a[12:15], v[96:111]
    ds_read_b128 v[160:163], v4 offset:16128
    buffer_load_dwordx4 a[60:63], v1, s[8:11], s61 offen offset:3072 sc1
    s_waitcnt vmcnt(11) lgkmcnt(5)
    v_mfma_f32_32x32x16_bf16 v[64:79], v[140:143], a[16:19], v[64:79]
    ds_read_b128 v[128:131], v2 offset:16896
    s_waitcnt lgkmcnt(5)
    v_mfma_f32_32x32x16_bf16 v[80:95], v[144:147], a[16:19], v[80:95]
    ds_read_b128 v[132:135], v2 offset:17920
    s_add_u32 s61, s60, 16384
    buffer_load_dwordx4 a[64:67], v1, s[8:11], s61 offen offset:0 sc1
    s_waitcnt lgkmcnt(5)
    v_mfma_f32_32x32x16_bf16 v[96:111], v[148:151], a[16:19], v[96:111]
    ds_read_b128 v[136:139], v4 offset:18944
    s_waitcnt vmcnt(11) lgkmcnt(5)
    v_mfma_f32_32x32x16_bf16 v[64:79], v[152:155], a[20:23], v[64:79]
    ds_read_b128 v[140:143], v2 offset:19712
    buffer_load_dwordx4 a[68:71], v1, s[8:11], s61 offen offset:1024 sc1
    s_waitcnt lgkmcnt(5)
    v_mfma_f32_32x32x16_bf16 v[80:95], v[156:159], a[20:23], v[80:95]
    ds_read_b128 v[144:147], v2 offset:20736
    s_waitcnt lgkmcnt(5)
    v_mfma_f32_32x32x16_bf16 v[96:111], v[160:163], a[20:23], v[96:111]
    ds_read_b128 v[148:151], v4 offset:21760
    buffer_load_dwordx4 a[72:75], v1, s[8:11], s61 offen offset:2048 sc1
    s_waitcnt vmcnt(12) lgkmcnt(5)
    v_mfma_f32_32x32x16_bf16 v[64:79], v[128:131], a[24:27], v[64:79]
    ds_read_b128 v[152:155], v2 offset:22528
    s_waitcnt lgkmcnt(5)
    v_mfma_f32_32x32x16_bf16 v[80:95], v[132:135], a[24:27], v[80:95]
    ds_read_b128 v[156:159], v2 offset:23552
    buffer_load_dwordx4 a[76:79], v1, s[8:11], s61 offen offset:3072 sc1
    s_waitcnt lgkmcnt(5)
    v_mfma_f32_32x32x16_bf16 v[96:111], v[136:139], a[24:27], v[96:111]
    ds_read_b128 v[160:163], v4 offset:24576
    s_waitcnt vmcnt(12) lgkmcnt(5)
    v_mfma_f32_32x32x16_bf16 v[64:79], v[140:143], a[28:31], v[64:79]
    ds_read_b128 v[128:131], v2 offset:25344
    s_add_u32 s61, s60, 20480
    buffer_load_dwordx4 a[80:83], v1, s[8:11], s61 offen offset:0 sc1
    s_waitcnt lgkmcnt(5)
    v_mfma_f32_32x32x16_bf16 v[80:95], v[144:147], a[28:31], v[80:95]
    ds_read_b128 v[132:135], v2 offset:26368
    s_waitcnt lgkmcnt(5)
    v_mfma_f32_32x32x16_bf16 v[96:111], v[148:151], a[28:31], v[96:111]
    ds_read_b128 v[136:139], v4 offset:27392
    buffer_load_dwordx4 a[84:87], v1, s[8:11], s61 offen offset:1024 sc1
    s_waitcnt vmcnt(13) lgkmcnt(5)
    v_mfma_f32_32x32x16_bf16 v[64:79], v[152:155], a[32:35], v[64:79]
    ds_read_b128 v[140:143], v2 offset:28160
    s_waitcnt lgkmcnt(5)
    v_mfma_f32_32x32x16_bf16 v[80:95], v[156:159], a[32:35], v[80:95]
    ds_read_b128 v[144:147], v2 offset:29184
    buffer_load_dwordx4 a[88:91], v1, s[8:11], s61 offen offset:2048 sc1
    s_waitcnt lgkmcnt(5)
    v_mfma_f32_32x32x16_bf16 v[96:111], v[160:163], a[32:35], v[96:111]
    ds_read_b128 v[148:151], v4 offset:30208
    s_waitcnt vmcnt(13) lgkmcnt(5)
    v_mfma_f32_32x32x16_bf16 v[64:79], v[128:131], a[36:39], v[64:79]
    ds_read_b128 v[152:155], v2 offset:30976
    buffer_load_dwordx4 a[92:95], v1, s[8:11], s61 offen offset:3072 sc1
    s_waitcnt lgkmcnt(5)
    v_mfma_f32_32x32x16_bf16 v[80:95], v[132:135], a[36:39], v[80:95]
    ds_read_b128 v[156:159], v2 offset:32000
    s_waitcnt lgkmcnt(5)
    v_mfma_f32_32x32x16_bf16 v[96:111], v[136:139], a[36:39], v[96:111]
    ds_read_b128 v[160:163], v4 offset:33024
    s_add_u32 s61, s60, 24576
    buffer_load_dwordx4 a[96:99], v1, s[8:11], s61 offen offset:0 sc1
    s_waitcnt vmcnt(14) lgkmcnt(5)
    v_mfma_f32_32x32x16_bf16 v[64:79], v[140:143], a[40:43], v[64:79]
    ds_read_b128 v[128:131], v2 offset:33792
    s_waitcnt lgkmcnt(5)
    v_mfma_f32_32x32x16_bf16 v[80:95], v[144:147], a[40:43], v[80:95]
    ds_read_b128 v[132:135], v2 offset:34816
    buffer_load_dwordx4 a[100:103], v1, s[8:11], s61 offen offset:1024 sc1
    s_waitcnt lgkmcnt(5)
    v_mfma_f32_32x32x16_bf16 v[96:111], v[148:151], a[40:43], v[96:111]
    ds_read_b128 v[136:139], v4 offset:35840
    s_waitcnt vmcnt(14) lgkmcnt(5)
    v_mfma_f32_32x32x16_bf16 v[64:79], v[152:155], a[44:47], v[64:79]
    ds_read_b128 v[140:143], v2 offset:36608
    buffer_load_dwordx4 a[104:107], v1, s[8:11], s61 offen offset:2048 sc1
    s_waitcnt lgkmcnt(5)
    v_mfma_f32_32x32x16_bf16 v[80:95], v[156:159], a[44:47], v[80:95]
    ds_read_b128 v[144:147], v2 offset:37632
    s_waitcnt lgkmcnt(5)
    v_mfma_f32_32x32x16_bf16 v[96:111], v[160:163], a[44:47], v[96:111]
    ds_read_b128 v[148:151], v4 offset:38656
    buffer_load_dwordx4 a[108:111], v1, s[8:11], s61 offen offset:3072 sc1
    s_waitcnt vmcnt(15) lgkmcnt(5)
    v_mfma_f32_32x32x16_bf16 v[64:79], v[128:131], a[48:51], v[64:79]
    ds_read_b128 v[152:155], v2 offset:39424
    s_waitcnt lgkmcnt(5)
    v_mfma_f32_32x32x16_bf16 v[80:95], v[132:135], a[48:51], v[80:95]
    ds_read_b128 v[156:159], v2 offset:40448
    s_add_u32 s61, s60, 28672
    buffer_load_dwordx4 a[112:115], v1, s[8:11], s61 offen offset:0 sc1
    s_waitcnt lgkmcnt(5)
    v_mfma_f32_32x32x16_bf16 v[96:111], v[136:139], a[48:51], v[96:111]
    ds_read_b128 v[160:163], v4 offset:41472
    s_waitcnt vmcnt(15) lgkmcnt(5)
    v_mfma_f32_32x32x16_bf16 v[64:79], v[140:143], a[52:55], v[64:79]
    ds_read_b128 v[128:131], v2 offset:42240
    buffer_load_dwordx4 a[116:119], v1, s[8:11], s61 offen offset:1024 sc1
    s_waitcnt lgkmcnt(5)
    v_mfma_f32_32x32x16_bf16 v[80:95], v[144:147], a[52:55], v[80:95]
    ds_read_b128 v[132:135], v2 offset:43264
    s_waitcnt lgkmcnt(5)
    v_mfma_f32_32x32x16_bf16 v[96:111], v[148:151], a[52:55], v[96:111]
    ds_read_b128 v[136:139], v4 offset:44288
    buffer_load_dwordx4 a[120:123], v1, s[8:11], s61 offen offset:2048 sc1
    s_waitcnt vmcnt(16) lgkmcnt(5)
    v_mfma_f32_32x32x16_bf16 v[64:79], v[152:155], a[56:59], v[64:79]
    ds_read_b128 v[140:143], v2 offset:45056
    s_waitcnt lgkmcnt(5)
    v_mfma_f32_32x32x16_bf16 v[80:95], v[156:159], a[56:59], v[80:95]
    ds_read_b128 v[144:147], v2 offset:46080
    buffer_load_dwordx4 a[124:127], v1, s[8:11], s61 offen offset:3072 sc1
    s_waitcnt lgkmcnt(5)
    v_mfma_f32_32x32x16_bf16 v[96:111], v[160:163], a[56:59], v[96:111]
    ds_read_b128 v[148:151], v4 offset:47104
    s_waitcnt vmcnt(16) lgkmcnt(5)
    v_mfma_f32_32x32x16_bf16 v[64:79], v[128:131], a[60:63], v[64:79]
    ds_read_b128 v[152:155], v2 offset:47872
    s_add_u32 s61, s60, 32768
    buffer_load_dwordx4 a[128:131], v1, s[8:11], s61 offen offset:0 sc1
    s_waitcnt lgkmcnt(5)
    v_mfma_f32_32x32x16_bf16 v[80:95], v[132:135], a[60:63], v[80:95]
    ds_read_b128 v[156:159], v2 offset:48896
    s_waitcnt lgkmcnt(5)
    v_mfma_f32_32x32x16_bf16 v[96:111], v[136:139], a[60:63], v[96:111]
    ds_read_b128 v[160:163], v4 offset:49920
    buffer_load_dwordx4 a[132:135], v1, s[8:11], s61 offen offset:1024 sc1
    s_waitcnt vmcnt(17) lgkmcnt(5)
    v_mfma_f32_32x32x16_bf16 v[64:79], v[140:143], a[64:67], v[64:79]
    ds_read_b128 v[128:131], v2 offset:50688
    s_waitcnt lgkmcnt(5)
    v_mfma_f32_32x32x16_bf16 v[80:95], v[144:147], a[64:67], v[80:95]
    ds_read_b128 v[132:135], v2 offset:51712
    buffer_load_dwordx4 a[136:139], v1, s[8:11], s61 offen offset:2048 sc1
    s_waitcnt lgkmcnt(5)
    v_mfma_f32_32x32x16_bf16 v[96:111], v[148:151], a[64:67], v[96:111]
    ds_read_b128 v[136:139], v4 offset:52736
    s_waitcnt vmcnt(17) lgkmcnt(5)
    v_mfma_f32_32x32x16_bf16 v[64:79], v[152:155], a[68:71], v[64:79]
    ds_read_b128 v[140:143], v2 offset:53504
    buffer_load_dwordx4 a[140:143], v1, s[8:11], s61 offen offset:3072 sc1
    s_waitcnt lgkmcnt(5)
    v_mfma_f32_32x32x16_bf16 v[80:95], v[156:159], a[68:71], v[80:95]
    ds_read_b128 v[144:147], v2 offset:54528
    s_waitcnt lgkmcnt(5)
    v_mfma_f32_32x32x16_bf16 v[96:111], v[160:163], a[68:71], v[96:111]
    ds_read_b128 v[148:151], v4 offset:55552
    s_add_u32 s61, s60, 36864
    buffer_load_dwordx4 a[144:147], v1, s[8:11], s61 offen offset:0 sc1
    s_waitcnt vmcnt(18) lgkmcnt(5)
    v_mfma_f32_32x32x16_bf16 v[64:79], v[128:131], a[72:75], v[64:79]
    ds_read_b128 v[152:155], v3 offset:0
    s_waitcnt lgkmcnt(5)
    v_mfma_f32_32x32x16_bf16 v[80:95], v[132:135], a[72:75], v[80:95]
    ds_read_b128 v[156:159], v3 offset:1024
    buffer_load_dwordx4 a[148:151], v1, s[8:11], s61 offen offset:1024 sc1
    s_waitcnt lgkmcnt(5)
    v_mfma_f32_32x32x16_bf16 v[96:111], v[136:139], a[72:75], v[96:111]
    ds_read_b128 v[160:163], v5 offset:2048
    s_waitcnt vmcnt(18) lgkmcnt(5)
    v_mfma_f32_32x32x16_bf16 v[64:79], v[140:143], a[76:79], v[64:79]
    ds_read_b128 v[128:131], v3 offset:2816
    buffer_load_dwordx4 a[152:155], v1, s[8:11], s61 offen offset:2048 sc1
    s_waitcnt lgkmcnt(5)
    v_mfma_f32_32x32x16_bf16 v[80:95], v[144:147], a[76:79], v[80:95]
    ds_read_b128 v[132:135], v3 offset:3840
    s_waitcnt lgkmcnt(5)
    v_mfma_f32_32x32x16_bf16 v[96:111], v[148:151], a[76:79], v[96:111]
    ds_read_b128 v[136:139], v5 offset:4864
    buffer_load_dwordx4 a[156:159], v1, s[8:11], s61 offen offset:3072 sc1
    s_waitcnt vmcnt(19) lgkmcnt(5)
    v_mfma_f32_32x32x16_bf16 v[64:79], v[152:155], a[80:83], v[64:79]
    ds_read_b128 v[140:143], v3 offset:5632
    s_waitcnt lgkmcnt(5)
    v_mfma_f32_32x32x16_bf16 v[80:95], v[156:159], a[80:83], v[80:95]
    ds_read_b128 v[144:147], v3 offset:6656
    s_add_u32 s94, s89, 114688
    s_mov_b32 m0, s94
    s_add_u32 s95, s98, 114688
    buffer_load_dwordx4 v1, s[8:11], s95 offen lds
    s_waitcnt lgkmcnt(5)
    v_mfma_f32_32x32x16_bf16 v[96:111], v[160:163], a[80:83], v[96:111]
    ds_read_b128 v[148:151], v5 offset:7680
    s_waitcnt vmcnt(19) lgkmcnt(5)
    v_mfma_f32_32x32x16_bf16 v[64:79], v[128:131], a[84:87], v[64:79]
    ds_read_b128 v[152:155], v3 offset:8448
    s_add_u32 s94, s89, 118784
    s_mov_b32 m0, s94
    s_add_u32 s95, s98, 118784
    buffer_load_dwordx4 v1, s[8:11], s95 offen lds
    s_waitcnt lgkmcnt(5)
    v_mfma_f32_32x32x16_bf16 v[80:95], v[132:135], a[84:87], v[80:95]
    ds_read_b128 v[156:159], v3 offset:9472
    s_waitcnt lgkmcnt(5)
    v_mfma_f32_32x32x16_bf16 v[96:111], v[136:139], a[84:87], v[96:111]
    ds_read_b128 v[160:163], v5 offset:10496
    s_add_u32 s94, s89, 122880
    s_mov_b32 m0, s94
    s_add_u32 s95, s98, 122880
    buffer_load_dwordx4 v1, s[8:11], s95 offen lds
    s_waitcnt vmcnt(20) lgkmcnt(5)
    v_mfma_f32_32x32x16_bf16 v[64:79], v[140:143], a[88:91], v[64:79]
    ds_read_b128 v[128:131], v3 offset:11264
    s_waitcnt lgkmcnt(5)
    v_mfma_f32_32x32x16_bf16 v[80:95], v[144:147], a[88:91], v[80:95]
    ds_read_b128 v[132:135], v3 offset:12288
    s_add_u32 s94, s89, 126976
    s_mov_b32 m0, s94
    s_add_u32 s95, s98, 126976
    buffer_load_dwordx4 v1, s[8:11], s95 offen lds
    s_waitcnt lgkmcnt(5)
    v_mfma_f32_32x32x16_bf16 v[96:111], v[148:151], a[88:91], v[96:111]
    ds_read_b128 v[136:139], v5 offset:13312
    s_waitcnt vmcnt(20) lgkmcnt(5)
    v_mfma_f32_32x32x16_bf16 v[64:79], v[152:155], a[92:95], v[64:79]
    ds_read_b128 v[140:143], v3 offset:14080
    s_add_u32 s94, s89, 131072
    s_mov_b32 m0, s94
    s_add_u32 s95, s98, 131072
    buffer_load_dwordx4 v1, s[8:11], s95 offen lds
    s_waitcnt lgkmcnt(5)
    v_mfma_f32_32x32x16_bf16 v[80:95], v[156:159], a[92:95], v[80:95]
    ds_read_b128 v[144:147], v3 offset:15104
    s_waitcnt lgkmcnt(5)
    v_mfma_f32_32x32x16_bf16 v[96:111], v[160:163], a[92:95], v[96:111]
    ds_read_b128 v[148:151], v5 offset:16128
    s_add_u32 s94, s89, 135168
    s_mov_b32 m0, s94
    s_add_u32 s95, s98, 135168
    buffer_load_dwordx4 v1, s[8:11], s95 offen lds
    s_waitcnt vmcnt(21) lgkmcnt(5)
    v_mfma_f32_32x32x16_bf16 v[64:79], v[128:131], a[96:99], v[64:79]
    ds_read_b128 v[152:155], v3 offset:16896
    s_waitcnt lgkmcnt(5)
    v_mfma_f32_32x32x16_bf16 v[80:95], v[132:135], a[96:99], v[80:95]
    ds_read_b128 v[156:159], v3 offset:17920
    s_add_u32 s94, s89, 139264
    s_mov_b32 m0, s94
    s_add_u32 s95, s98, 139264
    buffer_load_dwordx4 v1, s[8:11], s95 offen lds
    s_waitcnt lgkmcnt(5)
    v_mfma_f32_32x32x16_bf16 v[96:111], v[136:139], a[96:99], v[96:111]
    ds_read_b128 v[160:163], v5 offset:18944
    s_waitcnt vmcnt(21) lgkmcnt(5)
    v_mfma_f32_32x32x16_bf16 v[64:79], v[140:143], a[100:103], v[64:79]
    ds_read_b128 v[128:131], v3 offset:19712
    s_add_u32 s94, s89, 143360
    s_mov_b32 m0, s94
    s_add_u32 s95, s98, 143360
    buffer_load_dwordx4 v1, s[8:11], s95 offen lds
    s_waitcnt lgkmcnt(5)
    v_mfma_f32_32x32x16_bf16 v[80:95], v[144:147], a[100:103], v[80:95]
    ds_read_b128 v[132:135], v3 offset:20736
    s_waitcnt lgkmcnt(5)
    v_mfma_f32_32x32x16_bf16 v[96:111], v[148:151], a[100:103], v[96:111]
    ds_read_b128 v[136:139], v5 offset:21760
    s_add_u32 s94, s89, 147456
    s_mov_b32 m0, s94
    s_add_u32 s95, s98, 147456
    buffer_load_dwordx4 v1, s[8:11], s95 offen lds
    s_waitcnt vmcnt(22) lgkmcnt(5)
    v_mfma_f32_32x32x16_bf16 v[64:79], v[152:155], a[104:107], v[64:79]
    ds_read_b128 v[140:143], v3 offset:22528
    s_waitcnt lgkmcnt(5)
    v_mfma_f32_32x32x16_bf16 v[80:95], v[156:159], a[104:107], v[80:95]
    ds_read_b128 v[144:147], v3 offset:23552
    s_add_u32 s94, s89, 151552
    s_cmp_lt_u32 s44, 2
    s_cselect_b32 s94, s94, 0x30000
    s_mov_b32 m0, s94
    s_add_u32 s95, s98, 151552
    buffer_load_dwordx4 v1, s[8:11], s95 offen lds
    s_waitcnt lgkmcnt(5)
    v_mfma_f32_32x32x16_bf16 v[96:111], v[160:163], a[104:107], v[96:111]
    ds_read_b128 v[148:151], v5 offset:24576
    s_waitcnt vmcnt(22) lgkmcnt(5)
    v_mfma_f32_32x32x16_bf16 v[64:79], v[128:131], a[108:111], v[64:79]
    ds_read_b128 v[152:155], v3 offset:25344
    s_waitcnt lgkmcnt(5)
    v_mfma_f32_32x32x16_bf16 v[80:95], v[132:135], a[108:111], v[80:95]
    ds_read_b128 v[156:159], v3 offset:26368
    s_waitcnt lgkmcnt(5)
    v_mfma_f32_32x32x16_bf16 v[96:111], v[136:139], a[108:111], v[96:111]
    ds_read_b128 v[160:163], v5 offset:27392
    s_waitcnt vmcnt(21) lgkmcnt(5)
    v_mfma_f32_32x32x16_bf16 v[64:79], v[140:143], a[112:115], v[64:79]
    ds_read_b128 v[128:131], v3 offset:28160
    s_waitcnt lgkmcnt(5)
    v_mfma_f32_32x32x16_bf16 v[80:95], v[144:147], a[112:115], v[80:95]
    ds_read_b128 v[132:135], v3 offset:29184
    s_waitcnt lgkmcnt(5)
    v_mfma_f32_32x32x16_bf16 v[96:111], v[148:151], a[112:115], v[96:111]
    ds_read_b128 v[136:139], v5 offset:30208
    s_waitcnt vmcnt(20) lgkmcnt(5)
    v_mfma_f32_32x32x16_bf16 v[64:79], v[152:155], a[116:119], v[64:79]
    ds_read_b128 v[140:143], v3 offset:30976
    s_waitcnt lgkmcnt(5)
    v_mfma_f32_32x32x16_bf16 v[80:95], v[156:159], a[116:119], v[80:95]
    ds_read_b128 v[144:147], v3 offset:32000
    s_waitcnt lgkmcnt(5)
    v_mfma_f32_32x32x16_bf16 v[96:111], v[160:163], a[116:119], v[96:111]
    ds_read_b128 v[148:151], v5 offset:33024
    s_waitcnt vmcnt(19) lgkmcnt(5)
    v_mfma_f32_32x32x16_bf16 v[64:79], v[128:131], a[120:123], v[64:79]
    ds_read_b128 v[152:155], v3 offset:33792
    s_waitcnt lgkmcnt(5)
    v_mfma_f32_32x32x16_bf16 v[80:95], v[132:135], a[120:123], v[80:95]
    ds_read_b128 v[156:159], v3 offset:34816
    s_waitcnt lgkmcnt(5)
    v_mfma_f32_32x32x16_bf16 v[96:111], v[136:139], a[120:123], v[96:111]
    ds_read_b128 v[160:163], v5 offset:35840
    s_waitcnt vmcnt(18) lgkmcnt(5)
    v_mfma_f32_32x32x16_bf16 v[64:79], v[140:143], a[124:127], v[64:79]
    ds_read_b128 v[128:131], v3 offset:36608
    s_waitcnt lgkmcnt(5)
    v_mfma_f32_32x32x16_bf16 v[80:95], v[144:147], a[124:127], v[80:95]
    ds_read_b128 v[132:135], v3 offset:37632
    s_waitcnt lgkmcnt(5)
    v_mfma_f32_32x32x16_bf16 v[96:111], v[148:151], a[124:127], v[96:111]
    ds_read_b128 v[136:139], v5 offset:38656
    s_waitcnt vmcnt(17) lgkmcnt(5)
    v_mfma_f32_32x32x16_bf16 v[64:79], v[152:155], a[128:131], v[64:79]
    ds_read_b128 v[140:143], v3 offset:39424
    s_waitcnt lgkmcnt(5)
    v_mfma_f32_32x32x16_bf16 v[80:95], v[156:159], a[128:131], v[80:95]
    ds_read_b128 v[144:147], v3 offset:40448
    s_waitcnt lgkmcnt(5)
    v_mfma_f32_32x32x16_bf16 v[96:111], v[160:163], a[128:131], v[96:111]
    ds_read_b128 v[148:151], v5 offset:41472
    s_waitcnt vmcnt(16) lgkmcnt(5)
    v_mfma_f32_32x32x16_bf16 v[64:79], v[128:131], a[132:135], v[64:79]
    ds_read_b128 v[152:155], v3 offset:42240
    s_waitcnt lgkmcnt(5)
    v_mfma_f32_32x32x16_bf16 v[80:95], v[132:135], a[132:135], v[80:95]
    ds_read_b128 v[156:159], v3 offset:43264
    s_waitcnt lgkmcnt(5)
    v_mfma_f32_32x32x16_bf16 v[96:111], v[136:139], a[132:135], v[96:111]
    ds_read_b128 v[160:163], v5 offset:44288
    s_waitcnt vmcnt(15) lgkmcnt(5)
    v_mfma_f32_32x32x16_bf16 v[64:79], v[140:143], a[136:139], v[64:79]
    ds_read_b128 v[128:131], v3 offset:45056
    s_waitcnt lgkmcnt(5)
    v_mfma_f32_32x32x16_bf16 v[80:95], v[144:147], a[136:139], v[80:95]
    ds_read_b128 v[132:135], v3 offset:46080
    s_waitcnt lgkmcnt(5)
    v_mfma_f32_32x32x16_bf16 v[96:111], v[148:151], a[136:139], v[96:111]
    ds_read_b128 v[136:139], v5 offset:47104
    s_waitcnt vmcnt(14) lgkmcnt(5)
    v_mfma_f32_32x32x16_bf16 v[64:79], v[152:155], a[140:143], v[64:79]
    ds_read_b128 v[140:143], v3 offset:47872
    s_waitcnt lgkmcnt(5)
    v_mfma_f32_32x32x16_bf16 v[80:95], v[156:159], a[140:143], v[80:95]
    ds_read_b128 v[144:147], v3 offset:48896
    s_waitcnt lgkmcnt(5)
    v_mfma_f32_32x32x16_bf16 v[96:111], v[160:163], a[140:143], v[96:111]
    ds_read_b128 v[148:151], v5 offset:49920
    s_waitcnt vmcnt(13) lgkmcnt(5)
    v_mfma_f32_32x32x16_bf16 v[64:79], v[128:131], a[144:147], v[64:79]
    ds_read_b128 v[152:155], v3 offset:50688
    s_waitcnt lgkmcnt(5)
    v_mfma_f32_32x32x16_bf16 v[80:95], v[132:135], a[144:147], v[80:95]
    ds_read_b128 v[156:159], v3 offset:51712
    s_waitcnt lgkmcnt(5)
    v_mfma_f32_32x32x16_bf16 v[96:111], v[136:139], a[144:147], v[96:111]
    ds_read_b128 v[160:163], v5 offset:52736
    s_waitcnt vmcnt(12) lgkmcnt(5)
    v_mfma_f32_32x32x16_bf16 v[64:79], v[140:143], a[148:151], v[64:79]
    ds_read_b128 v[128:131], v3 offset:53504
    s_waitcnt lgkmcnt(5)
    v_mfma_f32_32x32x16_bf16 v[80:95], v[144:147], a[148:151], v[80:95]
    ds_read_b128 v[132:135], v3 offset:54528
    s_waitcnt lgkmcnt(5)
    v_mfma_f32_32x32x16_bf16 v[96:111], v[148:151], a[148:151], v[96:111]
    ds_read_b128 v[136:139], v5 offset:55552
    s_waitcnt vmcnt(11) lgkmcnt(5)
    v_mfma_f32_32x32x16_bf16 v[64:79], v[152:155], a[152:155], v[64:79]
    s_waitcnt lgkmcnt(4)
    v_mfma_f32_32x32x16_bf16 v[80:95], v[156:159], a[152:155], v[80:95]
    s_waitcnt lgkmcnt(3)
    v_mfma_f32_32x32x16_bf16 v[96:111], v[160:163], a[152:155], v[96:111]
    s_waitcnt vmcnt(10) lgkmcnt(2)
    v_mfma_f32_32x32x16_bf16 v[64:79], v[128:131], a[156:159], v[64:79]
    s_waitcnt lgkmcnt(1)
    v_mfma_f32_32x32x16_bf16 v[80:95], v[132:135], a[156:159], v[80:95]
    s_waitcnt lgkmcnt(0)
    v_mfma_f32_32x32x16_bf16 v[96:111], v[136:139], a[156:159], v[96:111]
    s_nop 11
    v_cmp_u_f32 vcc, v96, v96
    s_cbranch_vccz L_ok_47
    s_add_u32 s51, s51, 1
    s_cmp_gt_u32 s51, 200000
    s_cbranch_scc1 L_ok_47
    s_waitcnt vmcnt(0) lgkmcnt(0)
    s_sleep 2
    s_branch L_qkv_44
L_ok_47:
    s_waitcnt vmcnt(0)
    s_waitcnt lgkmcnt(0)
    s_barrier
    s_mul_i32 s96, s47, 102400
    s_lshl_b32 s97, s44, 10
    s_add_u32 s96, s96, s97
    s_add_u32 s96, s96, 27066368
    v_pk_mul_f32 v[64:65], v[64:65], v[0:1] op_sel_hi:[1,0]
    v_pk_mul_f32 v[66:67], v[66:67], v[0:1] op_sel_hi:[1,0]
    v_pk_mul_f32 v[68:69], v[68:69], v[0:1] op_sel_hi:[1,0]
    v_pk_mul_f32 v[70:71], v[70:71], v[0:1] op_sel_hi:[1,0]
    v_pk_mul_f32 v[72:73], v[72:73], v[0:1] op_sel_hi:[1,0]
    v_pk_mul_f32 v[74:75], v[74:75], v[0:1] op_sel_hi:[1,0]
    v_pk_mul_f32 v[76:77], v[76:77], v[0:1] op_sel_hi:[1,0]
    v_pk_mul_f32 v[78:79], v[78:79], v[0:1] op_sel_hi:[1,0]
    v_pk_mul_f32 v[100:101], v[100:101], v[0:1] op_sel_hi:[1,0]
    v_pk_mul_f32 v[102:103], v[102:103], v[0:1] op_sel_hi:[1,0]
    v_pk_mul_f32 v[104:105], v[104:105], v[0:1] op_sel_hi:[1,0]
    v_pk_mul_f32 v[106:107], v[106:107], v[0:1] op_sel_hi:[1,0]
    v_pk_mul_f32 v[80:81], v[80:81], v[0:1] op_sel_hi:[1,0]
    v_pk_mul_f32 v[82:83], v[82:83], v[0:1] op_sel_hi:[1,0]
    v_pk_mul_f32 v[84:85], v[84:85], v[0:1] op_sel_hi:[1,0]
    v_pk_mul_f32 v[86:87], v[86:87], v[0:1] op_sel_hi:[1,0]
    s_add_u32 s94, s97, 59392
    s_mov_b32 m0, s94
    s_add_u32 s95, s96, 8192
    buffer_load_dwordx4 v1, s[8:11], s95 offen lds
    v_pk_mul_f32 v[88:89], v[88:89], v[0:1] op_sel_hi:[1,0]
    v_pk_mul_f32 v[90:91], v[90:91], v[0:1] op_sel_hi:[1,0]
    v_pk_mul_f32 v[92:93], v[92:93], v[0:1] op_sel_hi:[1,0]
    v_pk_mul_f32 v[94:95], v[94:95], v[0:1] op_sel_hi:[1,0]
    v_cvt_pk_bf16_f32 v80, v80, v81
    v_cvt_pk_bf16_f32 v81, v82, v83
    v_cvt_pk_bf16_f32 v82, v84, v85
    v_cvt_pk_bf16_f32 v83, v86, v87
    v_cvt_pk_bf16_f32 v84, v88, v89
    v_cvt_pk_bf16_f32 v85, v90, v91
    v_cvt_pk_bf16_f32 v86, v92, v93
    v_cvt_pk_bf16_f32 v87, v94, v95
    v_cvt_pk_bf16_f32 v88, v104, v105
    v_cvt_pk_bf16_f32 v89, v106, v107
    v_mov_b32 v90, 0x3f80
    v_mov_b32 v91, 0
    v_lshrrev_b32 v172, 5, v21
    v_lshlrev_b32 v172, 7, v172
    v_and_b32 v173, 31, v21
    v_add_u32 v172, v172, v173
    s_lshl_b32 s52, s44, 5
    v_add_u32 v172, s52, v172
    v_mul_u32_u24 v172, 160, v172
    ds_write_b128 v172, v[80:83] offset:80
    ds_write_b128 v172, v[84:87] offset:96
    ds_write_b128 v172, v[88:91] offset:112
    v_cvt_pk_bf16_f32 v64, v64, v65
    v_cvt_pk_bf16_f32 v65, v66, v67
    s_add_u32 s94, s97, 63488
    s_mov_b32 m0, s94
    s_add_u32 s95, s96, 12288
    buffer_load_dwordx4 v1, s[8:11], s95 offen lds
    v_cvt_pk_bf16_f32 v66, v68, v69
    v_cvt_pk_bf16_f32 v67, v70, v71
    v_cvt_pk_bf16_f32 v68, v72, v73
    v_cvt_pk_bf16_f32 v69, v74, v75
    v_cvt_pk_bf16_f32 v70, v76, v77
    v_cvt_pk_bf16_f32 v71, v78, v79
    v_cvt_pk_bf16_f32 v72, v100, v101
    v_cvt_pk_bf16_f32 v73, v102, v103
    v_mov_b32 v74, 0
    v_mov_b32 v75, 0
    v_mfma_f32_32x32x16_bf16 v[212:227], v[176:179], v[64:67], 0
    s_add_u32 s94, s97, 67584
    s_mov_b32 m0, s94
    s_add_u32 s95, s96, 16384
    buffer_load_dwordx4 v1, s[8:11], s95 offen lds
    v_mfma_f32_32x32x16_bf16 v[24:39], v[188:191], v[64:67], 0
    v_mfma_f32_32x32x16_bf16 v[212:227], v[180:183], v[68:71], v[212:227]
    v_mfma_f32_32x32x16_bf16 v[24:39], v[192:195], v[68:71], v[24:39]
    s_add_u32 s94, s97, 71680
    s_mov_b32 m0, s94
    s_add_u32 s95, s96, 20480
    buffer_load_dwordx4 v1, s[8:11], s95 offen lds
    v_mfma_f32_32x32x16_bf16 v[212:227], v[184:187], v[72:75], v[212:227]
    v_mfma_f32_32x32x16_bf16 v[24:39], v[196:199], v[72:75], v[24:39]
    s_nop 10
    v_max3_f32 v164, v212, v213, v214
    v_max3_f32 v164, v164, v215, v216
    v_max3_f32 v164, v164, v217, v218
    v_max3_f32 v164, v164, v219, v220
    s_add_u32 s94, s97, 75776
    s_mov_b32 m0, s94
    s_add_u32 s95, s96, 24576
    buffer_load_dwordx4 v1, s[8:11], s95 offen lds
    v_max3_f32 v164, v164, v221, v222
    v_max3_f32 v164, v164, v223, v224
    v_max3_f32 v164, v164, v225, v226
    v_max3_f32 v164, v164, v227, v24
    v_max3_f32 v164, v164, v25, v26
    v_max_f32 v164, v164, v27
    v_min3_f32 v166, v212, v213, v214
    v_min3_f32 v166, v166, v215, v216
    v_min3_f32 v166, v166, v217, v218
    v_min3_f32 v166, v166, v219, v220
    v_min3_f32 v166, v166, v221, v222
    v_min3_f32 v166, v166, v223, v224
    v_min3_f32 v166, v166, v225, v226
    v_min3_f32 v166, v166, v227, v24
    v_min3_f32 v166, v166, v25, v26
    v_min_f32 v166, v166, v27
    s_add_u32 s94, s97, 79872
    s_mov_b32 m0, s94
    s_add_u32 s95, s96, 28672
    buffer_load_dwordx4 v1, s[8:11], s95 offen lds
    s_mov_b32 s56, 0x3fb8aa3b
    s_mov_b32 s57, 0xbfb8aa3b
    v_mul_f32 v164, s57, v164
    v_mul_f32 v166, s56, v166
    v_mov_b32 v168, s56
    v_mov_b32 v170, s57
    v_pk_fma_f32 v[128:129], v[212:213], v[168:169], v[164:165] op_sel_hi:[1,0,0]
    v_pk_fma_f32 v[130:131], v[214:215], v[168:169], v[164:165] op_sel_hi:[1,0,0]
    v_pk_fma_f32 v[132:133], v[216:217], v[168:169], v[164:165] op_sel_hi:[1,0,0]
    v_pk_fma_f32 v[134:135], v[218:219], v[168:169], v[164:165] op_sel_hi:[1,0,0]
    v_pk_fma_f32 v[136:137], v[220:221], v[168:169], v[164:165] op_sel_hi:[1,0,0]
    v_pk_fma_f32 v[138:139], v[222:223], v[168:169], v[164:165] op_sel_hi:[1,0,0]
    v_pk_fma_f32 v[140:141], v[224:225], v[168:169], v[164:165] op_sel_hi:[1,0,0]
    v_pk_fma_f32 v[142:143], v[226:227], v[168:169], v[164:165] op_sel_hi:[1,0,0]
    v_pk_fma_f32 v[144:145], v[24:25], v[168:169], v[164:165] op_sel_hi:[1,0,0]
    v_pk_fma_f32 v[146:147], v[26:27], v[168:169], v[164:165] op_sel_hi:[1,0,0]
    v_exp_f32 v128, v128
    s_add_u32 s94, s97, 83968
    s_mov_b32 m0, s94
    s_add_u32 s95, s96, 32768
    buffer_load_dwordx4 v1, s[8:11], s95 offen lds
    v_exp_f32 v129, v129
    v_exp_f32 v130, v130
    v_exp_f32 v131, v131
    v_exp_f32 v132, v132
    v_exp_f32 v133, v133
    v_exp_f32 v134, v134
    v_exp_f32 v135, v135
    v_exp_f32 v136, v136
    s_add_u32 s94, s97, 88064
    s_mov_b32 m0, s94
    s_add_u32 s95, s96, 36864
    buffer_load_dwordx4 v1, s[8:11], s95 offen lds
    v_exp_f32 v137, v137
    v_exp_f32 v138, v138
    v_exp_f32 v139, v139
    v_exp_f32 v140, v140
    v_exp_f32 v141, v141
    v_exp_f32 v142, v142
    v_exp_f32 v143, v143
    v_exp_f32 v144, v144
    s_add_u32 s94, s97, 92160
    s_mov_b32 m0, s94
    s_add_u32 s95, s96, 40960
    buffer_load_dwordx4 v1, s[8:11], s95 offen lds
    v_exp_f32 v145, v145
    v_exp_f32 v146, v146
    v_exp_f32 v147, v147
    v_pk_fma_f32 v[40:41], v[212:213], v[170:171], v[166:167] op_sel_hi:[1,0,0]
    v_pk_fma_f32 v[42:43], v[214:215], v[170:171], v[166:167] op_sel_hi:[1,0,0]
    v_pk_fma_f32 v[44:45], v[216:217], v[170:171], v[166:167] op_sel_hi:[1,0,0]
    v_pk_fma_f32 v[46:47], v[218:219], v[170:171], v[166:167] op_sel_hi:[1,0,0]
    v_pk_fma_f32 v[48:49], v[220:221], v[170:171], v[166:167] op_sel_hi:[1,0,0]
    v_pk_fma_f32 v[50:51], v[222:223], v[170:171], v[166:167] op_sel_hi:[1,0,0]
    v_pk_fma_f32 v[52:53], v[224:225], v[170:171], v[166:167] op_sel_hi:[1,0,0]
    v_pk_fma_f32 v[54:55], v[226:227], v[170:171], v[166:167] op_sel_hi:[1,0,0]
    v_pk_fma_f32 v[56:57], v[24:25], v[170:171], v[166:167] op_sel_hi:[1,0,0]
    v_pk_fma_f32 v[58:59], v[26:27], v[170:171], v[166:167] op_sel_hi:[1,0,0]
    s_add_u32 s94, s97, 96256
    s_mov_b32 m0, s94
    s_add_u32 s95, s96, 45056
    buffer_load_dwordx4 v1, s[8:11], s95 offen lds
    v_exp_f32 v40, v40
    v_exp_f32 v41, v41
    v_exp_f32 v42, v42
    v_exp_f32 v43, v43
    v_exp_f32 v44, v44
    v_exp_f32 v45, v45
    v_exp_f32 v46, v46
    v_exp_f32 v47, v47
    s_add_u32 s94, s97, 100352
    s_mov_b32 m0, s94
    s_add_u32 s95, s96, 49152
    buffer_load_dwordx4 v1, s[8:11], s95 offen lds
    v_exp_f32 v48, v48
    v_exp_f32 v49, v49
    v_exp_f32 v50, v50
    v_exp_f32 v51, v51
    v_exp_f32 v52, v52
    v_exp_f32 v53, v53
    v_exp_f32 v54, v54
    v_exp_f32 v55, v55
    s_add_u32 s94, s97, 104448
    s_mov_b32 m0, s94
    s_add_u32 s95, s96, 53248
    buffer_load_dwordx4 v1, s[8:11], s95 offen lds
    v_exp_f32 v56, v56
    v_exp_f32 v57, v57
    v_exp_f32 v58, v58
    v_exp_f32 v59, v59
    v_pk_add_f32 v[164:165], v[128:129], v[130:131]
    v_pk_add_f32 v[164:165], v[164:165], v[132:133]
    v_pk_add_f32 v[164:165], v[164:165], v[134:135]
    v_pk_add_f32 v[164:165], v[164:165], v[136:137]
    v_pk_add_f32 v[164:165], v[164:165], v[138:139]
    v_pk_add_f32 v[164:165], v[164:165], v[140:141]
    v_pk_add_f32 v[164:165], v[164:165], v[142:143]
    v_pk_add_f32 v[164:165], v[164:165], v[144:145]
    s_add_u32 s94, s97, 108544
    s_mov_b32 m0, s94
    s_add_u32 s95, s96, 57344
    buffer_load_dwordx4 v1, s[8:11], s95 offen lds
    v_pk_add_f32 v[164:165], v[164:165], v[146:147]
    v_add_f32 v164, v164, v165
    v_rcp_f32 v164, v164
    v_pk_add_f32 v[166:167], v[40:41], v[42:43]
    v_pk_add_f32 v[166:167], v[166:167], v[44:45]
    v_pk_add_f32 v[166:167], v[166:167], v[46:47]
    v_pk_add_f32 v[166:167], v[166:167], v[48:49]
    v_pk_add_f32 v[166:167], v[166:167], v[50:51]
    v_pk_add_f32 v[166:167], v[166:167], v[52:53]
    v_pk_add_f32 v[166:167], v[166:167], v[54:55]
    v_pk_add_f32 v[166:167], v[166:167], v[56:57]
    v_pk_add_f32 v[166:167], v[166:167], v[58:59]
    v_add_f32 v166, v166, v167
    v_rcp_f32 v166, v166
    v_pk_mul_f32 v[128:129], v[128:129], v[164:165] op_sel_hi:[1,0]
    v_pk_mul_f32 v[130:131], v[130:131], v[164:165] op_sel_hi:[1,0]
    v_pk_mul_f32 v[132:133], v[132:133], v[164:165] op_sel_hi:[1,0]
    v_pk_mul_f32 v[134:135], v[134:135], v[164:165] op_sel_hi:[1,0]
    v_pk_mul_f32 v[136:137], v[136:137], v[164:165] op_sel_hi:[1,0]
    v_pk_mul_f32 v[138:139], v[138:139], v[164:165] op_sel_hi:[1,0]
    v_pk_mul_f32 v[140:141], v[140:141], v[164:165] op_sel_hi:[1,0]
    v_pk_mul_f32 v[142:143], v[142:143], v[164:165] op_sel_hi:[1,0]
    v_pk_mul_f32 v[144:145], v[144:145], v[164:165] op_sel_hi:[1,0]
    v_pk_mul_f32 v[146:147], v[146:147], v[164:165] op_sel_hi:[1,0]
    v_pk_mul_f32 v[40:41], v[40:41], v[166:167] op_sel_hi:[1,0]
    v_pk_mul_f32 v[42:43], v[42:43], v[166:167] op_sel_hi:[1,0]
    v_pk_mul_f32 v[44:45], v[44:45], v[166:167] op_sel_hi:[1,0]
    v_pk_mul_f32 v[46:47], v[46:47], v[166:167] op_sel_hi:[1,0]
    v_pk_mul_f32 v[48:49], v[48:49], v[166:167] op_sel_hi:[1,0]
    v_pk_mul_f32 v[50:51], v[50:51], v[166:167] op_sel_hi:[1,0]
    v_pk_mul_f32 v[52:53], v[52:53], v[166:167] op_sel_hi:[1,0]
    v_pk_mul_f32 v[54:55], v[54:55], v[166:167] op_sel_hi:[1,0]
    v_pk_mul_f32 v[56:57], v[56:57], v[166:167] op_sel_hi:[1,0]
    v_pk_mul_f32 v[58:59], v[58:59], v[166:167] op_sel_hi:[1,0]
    v_cvt_pk_bf16_f32 v128, v128, v129
    v_cvt_pk_bf16_f32 v129, v130, v131
    v_cvt_pk_bf16_f32 v130, v132, v133
    v_cvt_pk_bf16_f32 v131, v134, v135
    v_cvt_pk_bf16_f32 v132, v136, v137
    v_cvt_pk_bf16_f32 v133, v138, v139
    v_cvt_pk_bf16_f32 v134, v140, v141
    v_cvt_pk_bf16_f32 v135, v142, v143
    v_cvt_pk_bf16_f32 v136, v144, v145
    v_cvt_pk_bf16_f32 v137, v146, v147
    v_cvt_pk_bf16_f32 v138, v40, v41
    v_cvt_pk_bf16_f32 v139, v42, v43
    v_cvt_pk_bf16_f32 v140, v44, v45
    v_cvt_pk_bf16_f32 v141, v46, v47
    v_cvt_pk_bf16_f32 v142, v48, v49
    v_cvt_pk_bf16_f32 v143, v50, v51
    v_cvt_pk_bf16_f32 v144, v52, v53
    v_cvt_pk_bf16_f32 v145, v54, v55
    v_cvt_pk_bf16_f32 v146, v56, v57
    v_cvt_pk_bf16_f32 v147, v58, v59
    ds_write_b128 v172, v[128:131] offset:0
    ds_write_b128 v172, v[132:135] offset:16
    ds_write_b128 v172, v[136:139] offset:32
    ds_write_b128 v172, v[140:143] offset:48
    ds_write_b128 v172, v[144:147] offset:64
    s_lshr_b32 s52, s44, 1
    s_mul_i32 s52, s52, 20480
    s_sub_u32 s52, s52, 51200
    s_and_b32 s53, s44, 1
    s_lshl_b32 s53, s53, 5
    v_add_u32 v166, s52, v9
    v_add_u32 v167, s53, v166
    s_waitcnt lgkmcnt(0)
    s_barrier
    ds_read_b64_tr_b16 v[24:25], v167 offset:80
    ds_read_b64_tr_b16 v[26:27], v167 offset:2640
    ds_read_b64_tr_b16 v[28:29], v167 offset:5200
    ds_read_b64_tr_b16 v[30:31], v167 offset:7760
    ds_read_b64_tr_b16 v[32:33], v167 offset:10320
    ds_read_b64_tr_b16 v[34:35], v167 offset:12880
    ds_read_b64_tr_b16 v[36:37], v167 offset:15440
    ds_read_b64_tr_b16 v[38:39], v167 offset:18000
    ds_read_b64_tr_b16 v[128:129], v166 offset:0
    ds_read_b64_tr_b16 v[130:131], v166 offset:2560
    ds_read_b64_tr_b16 v[132:133], v166 offset:32
    ds_read_b64_tr_b16 v[134:135], v166 offset:2592
    ds_read_b64_tr_b16 v[136:137], v166 offset:64
    ds_read_b64_tr_b16 v[138:139], v166 offset:2624
    s_waitcnt lgkmcnt(4)
    v_mfma_f32_16x16x32_bf16 v[40:43], v[128:131], v[24:27], 0
    ds_read_b64_tr_b16 v[140:141], v166 offset:5120
    ds_read_b64_tr_b16 v[142:143], v166 offset:7680
    s_waitcnt lgkmcnt(4)
    v_mfma_f32_16x16x32_bf16 v[44:47], v[132:135], v[24:27], 0
    ds_read_b64_tr_b16 v[144:145], v166 offset:5152
    ds_read_b64_tr_b16 v[146:147], v166 offset:7712
    s_waitcnt lgkmcnt(4)
    v_mfma_f32_16x16x32_bf16 v[48:51], v[136:139], v[24:27], 0
    ds_read_b64_tr_b16 v[148:149], v166 offset:5184
    ds_read_b64_tr_b16 v[150:151], v166 offset:7744
    s_waitcnt lgkmcnt(4)
    v_mfma_f32_16x16x32_bf16 v[40:43], v[140:143], v[28:31], v[40:43]
    ds_read_b64_tr_b16 v[152:153], v166 offset:10240
    ds_read_b64_tr_b16 v[154:155], v166 offset:12800
    s_waitcnt lgkmcnt(4)
    v_mfma_f32_16x16x32_bf16 v[44:47], v[144:147], v[28:31], v[44:47]
    ds_read_b64_tr_b16 v[128:129], v166 offset:10272
    ds_read_b64_tr_b16 v[130:131], v166 offset:12832
    s_waitcnt lgkmcnt(4)
    v_mfma_f32_16x16x32_bf16 v[48:51], v[148:151], v[28:31], v[48:51]
    ds_read_b64_tr_b16 v[132:133], v166 offset:10304
    ds_read_b64_tr_b16 v[134:135], v166 offset:12864
    s_waitcnt lgkmcnt(4)
    v_mfma_f32_16x16x32_bf16 v[40:43], v[152:155], v[32:35], v[40:43]
    ds_read_b64_tr_b16 v[136:137], v166 offset:15360
    ds_read_b64_tr_b16 v[138:139], v166 offset:17920
    s_waitcnt lgkmcnt(4)
    v_mfma_f32_16x16x32_bf16 v[44:47], v[128:131], v[32:35], v[44:47]
    ds_read_b64_tr_b16 v[140:141], v166 offset:15392
    ds_read_b64_tr_b16 v[142:143], v166 offset:17952
    s_waitcnt lgkmcnt(4)
    v_mfma_f32_16x16x32_bf16 v[48:51], v[132:135], v[32:35], v[48:51]
    ds_read_b64_tr_b16 v[144:145], v166 offset:15424
    ds_read_b64_tr_b16 v[146:147], v166 offset:17984
    s_waitcnt lgkmcnt(4)
    v_mfma_f32_16x16x32_bf16 v[40:43], v[136:139], v[36:39], v[40:43]
    s_waitcnt lgkmcnt(2)
    v_mfma_f32_16x16x32_bf16 v[44:47], v[140:143], v[36:39], v[44:47]
    s_waitcnt lgkmcnt(0)
    v_mfma_f32_16x16x32_bf16 v[48:51], v[144:147], v[36:39], v[48:51]
    s_nop 3
    v_cvt_pk_bf16_f32 v52, v40, v41
    v_cvt_pk_bf16_f32 v53, v42, v43
    v_cvt_pk_bf16_f32 v54, v44, v45
    v_cvt_pk_bf16_f32 v55, v46, v47
    v_cvt_pk_bf16_f32 v56, v48, v49
    v_cvt_pk_bf16_f32 v57, v50, v51
    s_nop 0
    v_permlane16_swap_b32 v56, v58
    v_permlane16_swap_b32 v57, v59
    v_lshrrev_b32 v164, 4, v21
    v_mul_u32_u24 v164, 384, v164
    v_and_b32 v165, 15, v21
    v_lshl_add_u32 v164, v165, 4, v164
    s_lshl_b32 s52, s46, 4
    s_add_u32 s52, s52, s45
    s_lshl_b32 s52, s52, 12
    s_add_u32 s52, s52, 19791872
    s_lshr_b32 s53, s44, 1
    s_mul_i32 s53, s53, 1920
    s_add_u32 s52, s52, s53
    s_and_b32 s53, s44, 1
    s_lshl_b32 s54, s53, 8
    s_add_u32 s52, s52, s54
    s_cmp_eq_u32 s53, 0
    s_cselect_b32 s54, -1, 0x00ff00ff
    s_and_b32 s55, s54, 0xffff
    s_mov_b32 exec_lo, s54
    s_mov_b32 exec_hi, s54
    buffer_store_dwordx4 v[52:55], v164, s[8:11], s52 offen sc1
    s_mov_b32 exec_lo, s55
    s_mov_b32 exec_hi, 0
    buffer_store_dwordx4 v[56:59], v164, s[8:11], s52 offen offset:1536 sc1
    s_mov_b64 exec, -1
    s_lshl_b32 s59, s46, 16
    s_lshl_b32 s52, s44, 10
    s_add_u32 s59, s59, s52
    s_add_u32 s59, s59, 19791872
    v_lshlrev_b32 v236, 12, v21
    v_mov_b32 v238, 0x3f80
    v_mov_b32 v239, 1.0
    v_cmp_gt_u32 vcc, 16, v21
    v_mov_b32 v237, 0x80000000
    s_nop 0
    v_cndmask_b32 v236, v237, v236, vcc
    s_lshl_b32 s52, s44, 6
    v_add_u32 v174, s52, v21
    v_cmp_gt_u32 vcc, 240, v174
    s_nop 1
    v_cndmask_b32 v175, v237, v1, vcc
    ds_read_b128 v[128:131], v6 offset:0
    ds_read_b128 v[132:135], v6 offset:1024
    ds_read_b128 v[136:139], v6 offset:2048
    ds_read_b128 v[140:143], v6 offset:3072
    ds_read_b128 v[144:147], v6 offset:4096
    s_waitcnt lgkmcnt(4)
    v_mfma_f32_32x32x16_bf16 v[112:127], v[128:131], a[0:3], v[112:127]
    ds_read_b128 v[148:151], v6 offset:5120
    s_waitcnt lgkmcnt(4)
    v_mfma_f32_32x32x16_bf16 v[112:127], v[132:135], a[4:7], v[112:127]
    ds_read_b128 v[152:155], v6 offset:6144
    s_waitcnt lgkmcnt(4)
    v_mfma_f32_32x32x16_bf16 v[112:127], v[136:139], a[8:11], v[112:127]
    ds_read_b128 v[128:131], v6 offset:7168
    s_waitcnt lgkmcnt(4)
    v_mfma_f32_32x32x16_bf16 v[112:127], v[140:143], a[12:15], v[112:127]
    ds_read_b128 v[132:135], v6 offset:8192
    s_waitcnt lgkmcnt(4)
    v_mfma_f32_32x32x16_bf16 v[112:127], v[144:147], a[16:19], v[112:127]
    ds_read_b128 v[136:139], v6 offset:9216
    s_waitcnt lgkmcnt(4)
    v_mfma_f32_32x32x16_bf16 v[112:127], v[148:151], a[20:23], v[112:127]
    ds_read_b128 v[140:143], v6 offset:10240
    s_waitcnt lgkmcnt(4)
    v_mfma_f32_32x32x16_bf16 v[112:127], v[152:155], a[24:27], v[112:127]
    ds_read_b128 v[144:147], v6 offset:11264
    s_waitcnt lgkmcnt(4)
    v_mfma_f32_32x32x16_bf16 v[112:127], v[128:131], a[28:31], v[112:127]
    ds_read_b128 v[148:151], v6 offset:12288
    s_waitcnt lgkmcnt(4)
    v_mfma_f32_32x32x16_bf16 v[112:127], v[132:135], a[32:35], v[112:127]
    ds_read_b128 v[152:155], v6 offset:13312
    s_waitcnt lgkmcnt(4)
    v_mfma_f32_32x32x16_bf16 v[112:127], v[136:139], a[36:39], v[112:127]
    ds_read_b128 v[128:131], v6 offset:14336
    s_waitcnt lgkmcnt(4)
    v_mfma_f32_32x32x16_bf16 v[112:127], v[140:143], a[40:43], v[112:127]
    ds_read_b128 v[132:135], v6 offset:15360
    s_waitcnt lgkmcnt(4)
    v_mfma_f32_32x32x16_bf16 v[112:127], v[144:147], a[44:47], v[112:127]
    ds_read_b128 v[136:139], v6 offset:16384
    s_waitcnt lgkmcnt(4)
    v_mfma_f32_32x32x16_bf16 v[112:127], v[148:151], a[48:51], v[112:127]
    ds_read_b128 v[140:143], v6 offset:17408
    s_waitcnt lgkmcnt(4)
    v_mfma_f32_32x32x16_bf16 v[112:127], v[152:155], a[52:55], v[112:127]
    ds_read_b128 v[144:147], v6 offset:18432
    s_waitcnt lgkmcnt(4)
    v_mfma_f32_32x32x16_bf16 v[112:127], v[128:131], a[56:59], v[112:127]
    ds_read_b128 v[148:151], v6 offset:19456
    s_waitcnt lgkmcnt(4)
    v_mfma_f32_32x32x16_bf16 v[112:127], v[132:135], a[60:63], v[112:127]
    ds_read_b128 v[152:155], v6 offset:20480
    s_waitcnt lgkmcnt(4)
    v_mfma_f32_32x32x16_bf16 v[112:127], v[136:139], a[64:67], v[112:127]
    ds_read_b128 v[128:131], v6 offset:21504
    s_waitcnt lgkmcnt(4)
    v_mfma_f32_32x32x16_bf16 v[112:127], v[140:143], a[68:71], v[112:127]
    ds_read_b128 v[132:135], v6 offset:22528
    s_waitcnt lgkmcnt(4)
    v_mfma_f32_32x32x16_bf16 v[112:127], v[144:147], a[72:75], v[112:127]
    ds_read_b128 v[136:139], v6 offset:23552
    s_waitcnt lgkmcnt(4)
    v_mfma_f32_32x32x16_bf16 v[112:127], v[148:151], a[76:79], v[112:127]
    ds_read_b128 v[140:143], v6 offset:24576
    s_waitcnt lgkmcnt(4)
    v_mfma_f32_32x32x16_bf16 v[112:127], v[152:155], a[80:83], v[112:127]
    ds_read_b128 v[144:147], v6 offset:25600
    s_waitcnt lgkmcnt(4)
    v_mfma_f32_32x32x16_bf16 v[112:127], v[128:131], a[84:87], v[112:127]
    ds_read_b128 v[148:151], v6 offset:26624
    s_waitcnt lgkmcnt(4)
    v_mfma_f32_32x32x16_bf16 v[112:127], v[132:135], a[88:91], v[112:127]
    ds_read_b128 v[152:155], v6 offset:27648
    s_waitcnt lgkmcnt(4)
    v_mfma_f32_32x32x16_bf16 v[112:127], v[136:139], a[92:95], v[112:127]
    ds_read_b128 v[128:131], v6 offset:28672
    s_waitcnt lgkmcnt(4)
    v_mfma_f32_32x32x16_bf16 v[112:127], v[140:143], a[96:99], v[112:127]
    ds_read_b128 v[132:135], v6 offset:29696
    buffer_load_dword v237, v236, s[8:11], s59 offen offset:752 sc1
    s_waitcnt lgkmcnt(4)
    v_mfma_f32_32x32x16_bf16 v[112:127], v[144:147], a[100:103], v[112:127]
    ds_read_b128 v[136:139], v6 offset:30720
    s_waitcnt lgkmcnt(4)
    v_mfma_f32_32x32x16_bf16 v[112:127], v[148:151], a[104:107], v[112:127]
    ds_read_b128 v[140:143], v6 offset:31744
    s_waitcnt lgkmcnt(4)
    v_mfma_f32_32x32x16_bf16 v[112:127], v[152:155], a[108:111], v[112:127]
    ds_read_b128 v[144:147], v6 offset:32768
    s_waitcnt lgkmcnt(4)
    v_mfma_f32_32x32x16_bf16 v[112:127], v[128:131], a[112:115], v[112:127]
    ds_read_b128 v[148:151], v6 offset:33792
    s_waitcnt lgkmcnt(4)
    v_mfma_f32_32x32x16_bf16 v[112:127], v[132:135], a[116:119], v[112:127]
    ds_read_b128 v[152:155], v6 offset:34816
    s_waitcnt lgkmcnt(4)
    v_mfma_f32_32x32x16_bf16 v[112:127], v[136:139], a[120:123], v[112:127]
    ds_read_b128 v[128:131], v6 offset:35840
    s_waitcnt lgkmcnt(4)
    v_mfma_f32_32x32x16_bf16 v[112:127], v[140:143], a[124:127], v[112:127]
    ds_read_b128 v[132:135], v6 offset:36864
    s_waitcnt lgkmcnt(4)
    v_mfma_f32_32x32x16_bf16 v[112:127], v[144:147], a[128:131], v[112:127]
    ds_read_b128 v[136:139], v6 offset:37888
    s_waitcnt lgkmcnt(4)
    v_mfma_f32_32x32x16_bf16 v[112:127], v[148:151], a[132:135], v[112:127]
    ds_read_b128 v[140:143], v6 offset:38912
    s_waitcnt lgkmcnt(4)
    v_mfma_f32_32x32x16_bf16 v[112:127], v[152:155], a[136:139], v[112:127]
    ds_read_b128 v[144:147], v6 offset:39936
    s_waitcnt lgkmcnt(4)
    v_mfma_f32_32x32x16_bf16 v[112:127], v[128:131], a[140:143], v[112:127]
    s_waitcnt lgkmcnt(3)
    v_mfma_f32_32x32x16_bf16 v[112:127], v[132:135], a[144:147], v[112:127]
    s_waitcnt lgkmcnt(2)
    v_mfma_f32_32x32x16_bf16 v[112:127], v[136:139], a[148:151], v[112:127]
    s_waitcnt lgkmcnt(1)
    v_mfma_f32_32x32x16_bf16 v[112:127], v[140:143], a[152:155], v[112:127]
    s_waitcnt lgkmcnt(0)
    v_mfma_f32_32x32x16_bf16 v[112:127], v[144:147], a[156:159], v[112:127]
    s_waitcnt lgkmcnt(0)
    s_barrier
    s_nop 9
    v_pk_mul_f32 v[112:113], v[112:113], v[0:1] op_sel_hi:[1,0]
    v_pk_mul_f32 v[114:115], v[114:115], v[0:1] op_sel_hi:[1,0]
    v_pk_mul_f32 v[116:117], v[116:117], v[0:1] op_sel_hi:[1,0]
    v_pk_mul_f32 v[118:119], v[118:119], v[0:1] op_sel_hi:[1,0]
    v_pk_mul_f32 v[120:121], v[120:121], v[0:1] op_sel_hi:[1,0]
    v_pk_mul_f32 v[122:123], v[122:123], v[0:1] op_sel_hi:[1,0]
    v_pk_mul_f32 v[124:125], v[124:125], v[0:1] op_sel_hi:[1,0]
    v_pk_mul_f32 v[126:127], v[126:127], v[0:1] op_sel_hi:[1,0]
    v_pk_mul_f32 v[96:97], v[96:97], v[0:1] op_sel_hi:[1,0]
    v_pk_mul_f32 v[98:99], v[98:99], v[0:1] op_sel_hi:[1,0]
    v_cvt_pk_bf16_f32 v112, v112, v113
    v_cvt_pk_bf16_f32 v113, v114, v115
    v_cvt_pk_bf16_f32 v114, v116, v117
    v_cvt_pk_bf16_f32 v115, v118, v119
    v_cvt_pk_bf16_f32 v116, v120, v121
    v_cvt_pk_bf16_f32 v117, v122, v123
    v_cvt_pk_bf16_f32 v118, v124, v125
    v_cvt_pk_bf16_f32 v119, v126, v127
    v_cvt_pk_bf16_f32 v120, v96, v97
    v_cvt_pk_bf16_f32 v121, v98, v99
    s_waitcnt vmcnt(0)
    v_cmp_eq_u32 vcc, -1, v237
    s_cbranch_vccz L_kvok_49
L_kvp_48:
    buffer_load_dword v237, v236, s[8:11], s59 offen offset:752 sc1
    s_waitcnt vmcnt(0)
    v_cmp_eq_u32 vcc, -1, v237
    s_cbranch_vccz L_ok_50
    s_add_u32 s51, s51, 1
    s_cmp_gt_u32 s51, 200000
    s_cbranch_scc1 L_ok_50
    s_waitcnt vmcnt(0) lgkmcnt(0)
    s_sleep 1
    s_branch L_kvp_48
L_ok_50:
L_kvok_49:
    s_add_u32 s95, s59, 0
    buffer_load_dwordx4 v[64:67], v175, s[8:11], s95 offen sc1
    s_add_u32 s95, s59, 4096
    buffer_load_dwordx4 v[68:71], v175, s[8:11], s95 offen sc1
    s_add_u32 s95, s59, 8192
    buffer_load_dwordx4 v[72:75], v175, s[8:11], s95 offen sc1
    s_add_u32 s95, s59, 12288
    buffer_load_dwordx4 v[76:79], v175, s[8:11], s95 offen sc1
    s_add_u32 s95, s59, 16384
    buffer_load_dwordx4 v[80:83], v175, s[8:11], s95 offen sc1
    s_add_u32 s95, s59, 20480
    buffer_load_dwordx4 v[84:87], v175, s[8:11], s95 offen sc1
    v_mov_b32 v122, 0
    v_mov_b32 v123, 0
    v_mfma_f32_32x32x16_bf16 v[212:227], v[176:179], v[112:115], 0
    s_add_u32 s95, s59, 24576
    buffer_load_dwordx4 v[88:91], v175, s[8:11], s95 offen sc1
    v_mfma_f32_32x32x16_bf16 v[24:39], v[188:191], v[112:115], 0
    v_mfma_f32_32x32x16_bf16 v[212:227], v[180:183], v[116:119], v[212:227]
    s_add_u32 s95, s59, 28672
    buffer_load_dwordx4 v[92:95], v175, s[8:11], s95 offen sc1
    v_mfma_f32_32x32x16_bf16 v[24:39], v[192:195], v[116:119], v[24:39]
    v_mfma_f32_32x32x16_bf16 v[212:227], v[184:187], v[120:123], v[212:227]
    s_add_u32 s95, s59, 32768
    buffer_load_dwordx4 v[148:151], v175, s[8:11], s95 offen sc1
    v_mfma_f32_32x32x16_bf16 v[24:39], v[196:199], v[120:123], v[24:39]
    s_nop 8
    v_max3_f32 v164, v212, v213, v214
    v_max3_f32 v164, v164, v215, v216
    s_add_u32 s95, s59, 36864
    buffer_load_dwordx4 v[152:155], v175, s[8:11], s95 offen sc1
    v_max3_f32 v164, v164, v217, v218
    v_max3_f32 v164, v164, v219, v220
    v_max3_f32 v164, v164, v221, v222
    v_max3_f32 v164, v164, v223, v224
    v_max3_f32 v164, v164, v225, v226
    v_max3_f32 v164, v164, v227, v24
    v_max3_f32 v164, v164, v25, v26
    v_max_f32 v164, v164, v27
    s_add_u32 s95, s59, 40960
    buffer_load_dwordx4 v[156:159], v175, s[8:11], s95 offen sc1
    v_min3_f32 v166, v212, v213, v214
    v_min3_f32 v166, v166, v215, v216
    v_min3_f32 v166, v166, v217, v218
    v_min3_f32 v166, v166, v219, v220
    v_min3_f32 v166, v166, v221, v222
    v_min3_f32 v166, v166, v223, v224
    v_min3_f32 v166, v166, v225, v226
    v_min3_f32 v166, v166, v227, v24
    s_add_u32 s95, s59, 45056
    buffer_load_dwordx4 v[160:163], v175, s[8:11], s95 offen sc1
    v_min3_f32 v166, v166, v25, v26
    v_min_f32 v166, v166, v27
    s_mov_b32 s56, 0x3fb8aa3b
    s_mov_b32 s57, 0xbfb8aa3b
    v_mul_f32 v164, s57, v164
    v_mul_f32 v166, s56, v166
    v_mov_b32 v168, s56
    v_mov_b32 v170, s57
    v_pk_fma_f32 v[128:129], v[212:213], v[168:169], v[164:165] op_sel_hi:[1,0,0]
    v_pk_fma_f32 v[130:131], v[214:215], v[168:169], v[164:165] op_sel_hi:[1,0,0]
    s_add_u32 s95, s59, 49152
    buffer_load_dwordx4 v[60:63], v175, s[8:11], s95 offen sc1
    v_pk_fma_f32 v[132:133], v[216:217], v[168:169], v[164:165] op_sel_hi:[1,0,0]
    v_pk_fma_f32 v[134:135], v[218:219], v[168:169], v[164:165] op_sel_hi:[1,0,0]
    v_pk_fma_f32 v[136:137], v[220:221], v[168:169], v[164:165] op_sel_hi:[1,0,0]
    v_pk_fma_f32 v[138:139], v[222:223], v[168:169], v[164:165] op_sel_hi:[1,0,0]
    v_pk_fma_f32 v[140:141], v[224:225], v[168:169], v[164:165] op_sel_hi:[1,0,0]
    v_pk_fma_f32 v[142:143], v[226:227], v[168:169], v[164:165] op_sel_hi:[1,0,0]
    v_pk_fma_f32 v[144:145], v[24:25], v[168:169], v[164:165] op_sel_hi:[1,0,0]
    v_pk_fma_f32 v[146:147], v[26:27], v[168:169], v[164:165] op_sel_hi:[1,0,0]
    s_add_u32 s95, s59, 53248
    buffer_load_dwordx4 v[96:99], v175, s[8:11], s95 offen sc1
    v_exp_f32 v128, v128
    v_exp_f32 v129, v129
    v_exp_f32 v130, v130
    v_exp_f32 v131, v131
    s_add_u32 s95, s59, 57344
    buffer_load_dwordx4 v[100:103], v175, s[8:11], s95 offen sc1
    v_exp_f32 v132, v132
    v_exp_f32 v133, v133
    v_exp_f32 v134, v134
    v_exp_f32 v135, v135
    s_add_u32 s95, s59, 61440
    buffer_load_dwordx4 v[124:127], v175, s[8:11], s95 offen sc1
    v_exp_f32 v136, v136
    v_exp_f32 v137, v137
    v_exp_f32 v138, v138
    v_exp_f32 v139, v139
    s_add_u32 s94, s97, 51200
    s_mov_b32 m0, s94
    s_add_u32 s95, s96, 0
    buffer_load_dwordx4 v1, s[8:11], s95 offen lds
    v_exp_f32 v140, v140
    v_exp_f32 v141, v141
    v_exp_f32 v142, v142
    v_exp_f32 v143, v143
    s_add_u32 s94, s97, 55296
    s_mov_b32 m0, s94
    s_add_u32 s95, s96, 4096
    buffer_load_dwordx4 v1, s[8:11], s95 offen lds
    v_exp_f32 v144, v144
    v_exp_f32 v145, v145
    v_exp_f32 v146, v146
    v_exp_f32 v147, v147
    s_add_u32 s94, s97, 112640
    s_mov_b32 m0, s94
    s_add_u32 s95, s96, 61440
    buffer_load_dwordx4 v1, s[8:11], s95 offen lds
    v_pk_fma_f32 v[40:41], v[212:213], v[170:171], v[166:167] op_sel_hi:[1,0,0]
    v_pk_fma_f32 v[42:43], v[214:215], v[170:171], v[166:167] op_sel_hi:[1,0,0]
    v_pk_fma_f32 v[44:45], v[216:217], v[170:171], v[166:167] op_sel_hi:[1,0,0]
    v_pk_fma_f32 v[46:47], v[218:219], v[170:171], v[166:167] op_sel_hi:[1,0,0]
    v_pk_fma_f32 v[48:49], v[220:221], v[170:171], v[166:167] op_sel_hi:[1,0,0]
    v_pk_fma_f32 v[50:51], v[222:223], v[170:171], v[166:167] op_sel_hi:[1,0,0]
    v_pk_fma_f32 v[52:53], v[224:225], v[170:171], v[166:167] op_sel_hi:[1,0,0]
    v_pk_fma_f32 v[54:55], v[226:227], v[170:171], v[166:167] op_sel_hi:[1,0,0]
    s_add_u32 s94, s97, 116736
    s_mov_b32 m0, s94
    s_add_u32 s95, s96, 65536
    buffer_load_dwordx4 v1, s[8:11], s95 offen lds
    v_pk_fma_f32 v[56:57], v[24:25], v[170:171], v[166:167] op_sel_hi:[1,0,0]
    v_pk_fma_f32 v[58:59], v[26:27], v[170:171], v[166:167] op_sel_hi:[1,0,0]
    v_exp_f32 v40, v40
    v_exp_f32 v41, v41
    v_exp_f32 v42, v42
    s_add_u32 s94, s97, 120832
    s_mov_b32 m0, s94
    s_add_u32 s95, s96, 69632
    buffer_load_dwordx4 v1, s[8:11], s95 offen lds
    v_exp_f32 v43, v43
    v_exp_f32 v44, v44
    v_exp_f32 v45, v45
    v_exp_f32 v46, v46
    s_add_u32 s94, s97, 124928
    s_mov_b32 m0, s94
    s_add_u32 s95, s96, 73728
    buffer_load_dwordx4 v1, s[8:11], s95 offen lds
    v_exp_f32 v47, v47
    v_exp_f32 v48, v48
    v_exp_f32 v49, v49
    v_exp_f32 v50, v50
    s_add_u32 s94, s97, 129024
    s_mov_b32 m0, s94
    s_add_u32 s95, s96, 77824
    buffer_load_dwordx4 v1, s[8:11], s95 offen lds
    v_exp_f32 v51, v51
    v_exp_f32 v52, v52
    v_exp_f32 v53, v53
    v_exp_f32 v54, v54
    s_add_u32 s94, s97, 133120
    s_mov_b32 m0, s94
    s_add_u32 s95, s96, 81920
    buffer_load_dwordx4 v1, s[8:11], s95 offen lds
    v_exp_f32 v55, v55
    v_exp_f32 v56, v56
    v_exp_f32 v57, v57
    v_exp_f32 v58, v58
    s_add_u32 s94, s97, 137216
    s_mov_b32 m0, s94
    s_add_u32 s95, s96, 86016
    buffer_load_dwordx4 v1, s[8:11], s95 offen lds
    v_exp_f32 v59, v59
    v_pk_add_f32 v[164:165], v[128:129], v[130:131]
    v_pk_add_f32 v[164:165], v[164:165], v[132:133]
    v_pk_add_f32 v[164:165], v[164:165], v[134:135]
    v_pk_add_f32 v[164:165], v[164:165], v[136:137]
    v_pk_add_f32 v[164:165], v[164:165], v[138:139]
    v_pk_add_f32 v[164:165], v[164:165], v[140:141]
    s_add_u32 s94, s97, 141312
    s_mov_b32 m0, s94
    s_add_u32 s95, s96, 90112
    buffer_load_dwordx4 v1, s[8:11], s95 offen lds
    v_pk_add_f32 v[164:165], v[164:165], v[142:143]
    v_pk_add_f32 v[164:165], v[164:165], v[144:145]
    v_pk_add_f32 v[164:165], v[164:165], v[146:147]
    v_add_f32 v164, v164, v165
    v_rcp_f32 v164, v164
    v_pk_add_f32 v[166:167], v[40:41], v[42:43]
    v_pk_add_f32 v[166:167], v[166:167], v[44:45]
    s_add_u32 s94, s97, 145408
    s_mov_b32 m0, s94
    s_add_u32 s95, s96, 94208
    buffer_load_dwordx4 v1, s[8:11], s95 offen lds
    v_pk_add_f32 v[166:167], v[166:167], v[46:47]
    v_pk_add_f32 v[166:167], v[166:167], v[48:49]
    v_pk_add_f32 v[166:167], v[166:167], v[50:51]
    v_pk_add_f32 v[166:167], v[166:167], v[52:53]
    v_pk_add_f32 v[166:167], v[166:167], v[54:55]
    v_pk_add_f32 v[166:167], v[166:167], v[56:57]
    v_pk_add_f32 v[166:167], v[166:167], v[58:59]
    v_add_f32 v166, v166, v167
    s_add_u32 s94, s97, 149504
    s_mov_b32 m0, s94
    s_add_u32 s95, s96, 98304
    buffer_load_dwordx4 v1, s[8:11], s95 offen lds
    v_rcp_f32 v166, v166
    v_pk_mul_f32 v[128:129], v[128:129], v[164:165] op_sel_hi:[1,0]
    v_pk_mul_f32 v[130:131], v[130:131], v[164:165] op_sel_hi:[1,0]
    v_pk_mul_f32 v[132:133], v[132:133], v[164:165] op_sel_hi:[1,0]
    v_pk_mul_f32 v[134:135], v[134:135], v[164:165] op_sel_hi:[1,0]
    v_pk_mul_f32 v[136:137], v[136:137], v[164:165] op_sel_hi:[1,0]
    v_pk_mul_f32 v[138:139], v[138:139], v[164:165] op_sel_hi:[1,0]
    v_pk_mul_f32 v[140:141], v[140:141], v[164:165] op_sel_hi:[1,0]
    v_pk_mul_f32 v[142:143], v[142:143], v[164:165] op_sel_hi:[1,0]
    v_pk_mul_f32 v[144:145], v[144:145], v[164:165] op_sel_hi:[1,0]
    v_pk_mul_f32 v[146:147], v[146:147], v[164:165] op_sel_hi:[1,0]
    v_pk_mul_f32 v[40:41], v[40:41], v[166:167] op_sel_hi:[1,0]
    v_pk_mul_f32 v[42:43], v[42:43], v[166:167] op_sel_hi:[1,0]
    v_pk_mul_f32 v[44:45], v[44:45], v[166:167] op_sel_hi:[1,0]
    v_pk_mul_f32 v[46:47], v[46:47], v[166:167] op_sel_hi:[1,0]
    v_pk_mul_f32 v[48:49], v[48:49], v[166:167] op_sel_hi:[1,0]
    v_pk_mul_f32 v[50:51], v[50:51], v[166:167] op_sel_hi:[1,0]
    v_pk_mul_f32 v[52:53], v[52:53], v[166:167] op_sel_hi:[1,0]
    v_pk_mul_f32 v[54:55], v[54:55], v[166:167] op_sel_hi:[1,0]
    v_pk_mul_f32 v[56:57], v[56:57], v[166:167] op_sel_hi:[1,0]
    v_pk_mul_f32 v[58:59], v[58:59], v[166:167] op_sel_hi:[1,0]
    v_cvt_pk_bf16_f32 v104, v128, v129
    v_cvt_pk_bf16_f32 v105, v130, v131
    v_cvt_pk_bf16_f32 v106, v144, v145
    v_cvt_pk_bf16_f32 v107, v146, v147
    v_cvt_pk_bf16_f32 v108, v132, v133
    v_cvt_pk_bf16_f32 v109, v134, v135
    v_cvt_pk_bf16_f32 v110, v40, v41
    v_cvt_pk_bf16_f32 v111, v42, v43
    v_cvt_pk_bf16_f32 v112, v136, v137
    v_cvt_pk_bf16_f32 v113, v138, v139
    v_cvt_pk_bf16_f32 v114, v44, v45
    v_cvt_pk_bf16_f32 v115, v46, v47
    v_cvt_pk_bf16_f32 v116, v140, v141
    v_cvt_pk_bf16_f32 v117, v142, v143
    v_cvt_pk_bf16_f32 v118, v48, v49
    v_cvt_pk_bf16_f32 v119, v50, v51
    v_cvt_pk_bf16_f32 v120, v52, v53
    v_cvt_pk_bf16_f32 v121, v54, v55
    v_cvt_pk_bf16_f32 v122, v56, v57
    v_cvt_pk_bf16_f32 v123, v58, v59
    v_mov_b32 v228, 0
    v_mov_b32 v229, 0
    v_mov_b32 v230, 0
    v_mov_b32 v231, 0
    v_mov_b32 v232, 0
    v_mov_b32 v233, 0
    v_mov_b32 v234, 0
    v_mov_b32 v235, 0
    s_waitcnt vmcnt(27)
    v_dot2c_f32_bf16 v228, v64, v238
    v_dot2c_f32_bf16 v229, v64, v239
    v_dot2c_f32_bf16 v230, v65, v238
    v_dot2c_f32_bf16 v231, v65, v239
    v_dot2c_f32_bf16 v232, v66, v238
    v_dot2c_f32_bf16 v233, v66, v239
    v_dot2c_f32_bf16 v234, v67, v238
    v_dot2c_f32_bf16 v235, v67, v239
    s_waitcnt vmcnt(26)
    v_dot2c_f32_bf16 v228, v68, v238
    v_dot2c_f32_bf16 v229, v68, v239
    v_dot2c_f32_bf16 v230, v69, v238
    v_dot2c_f32_bf16 v231, v69, v239
    v_dot2c_f32_bf16 v232, v70, v238
    v_dot2c_f32_bf16 v233, v70, v239
    v_dot2c_f32_bf16 v234, v71, v238
    v_dot2c_f32_bf16 v235, v71, v239
    s_waitcnt vmcnt(25)
    v_dot2c_f32_bf16 v228, v72, v238
    v_dot2c_f32_bf16 v229, v72, v239
    v_dot2c_f32_bf16 v230, v73, v238
    v_dot2c_f32_bf16 v231, v73, v239
    v_dot2c_f32_bf16 v232, v74, v238
    v_dot2c_f32_bf16 v233, v74, v239
    v_dot2c_f32_bf16 v234, v75, v238
    v_dot2c_f32_bf16 v235, v75, v239
    s_waitcnt vmcnt(24)
    v_dot2c_f32_bf16 v228, v76, v238
    v_dot2c_f32_bf16 v229, v76, v239
    v_dot2c_f32_bf16 v230, v77, v238
    v_dot2c_f32_bf16 v231, v77, v239
    v_dot2c_f32_bf16 v232, v78, v238
    v_dot2c_f32_bf16 v233, v78, v239
    v_dot2c_f32_bf16 v234, v79, v238
    v_dot2c_f32_bf16 v235, v79, v239
    s_waitcnt vmcnt(23)
    v_dot2c_f32_bf16 v228, v80, v238
    v_dot2c_f32_bf16 v229, v80, v239
    v_dot2c_f32_bf16 v230, v81, v238
    v_dot2c_f32_bf16 v231, v81, v239
    v_dot2c_f32_bf16 v232, v82, v238
    v_dot2c_f32_bf16 v233, v82, v239
    v_dot2c_f32_bf16 v234, v83, v238
    v_dot2c_f32_bf16 v235, v83, v239
    s_waitcnt vmcnt(22)
    v_dot2c_f32_bf16 v228, v84, v238
    v_dot2c_f32_bf16 v229, v84, v239
    v_dot2c_f32_bf16 v230, v85, v238
    v_dot2c_f32_bf16 v231, v85, v239
    v_dot2c_f32_bf16 v232, v86, v238
    v_dot2c_f32_bf16 v233, v86, v239
    v_dot2c_f32_bf16 v234, v87, v238
    v_dot2c_f32_bf16 v235, v87, v239
    s_waitcnt vmcnt(21)
    v_dot2c_f32_bf16 v228, v88, v238
    v_dot2c_f32_bf16 v229, v88, v239
    v_dot2c_f32_bf16 v230, v89, v238
    v_dot2c_f32_bf16 v231, v89, v239
    v_dot2c_f32_bf16 v232, v90, v238
    v_dot2c_f32_bf16 v233, v90, v239
    v_dot2c_f32_bf16 v234, v91, v238
    v_dot2c_f32_bf16 v235, v91, v239
    s_waitcnt vmcnt(20)
    v_dot2c_f32_bf16 v228, v92, v238
    v_dot2c_f32_bf16 v229, v92, v239
    v_dot2c_f32_bf16 v230, v93, v238
    v_dot2c_f32_bf16 v231, v93, v239
    v_dot2c_f32_bf16 v232, v94, v238
    v_dot2c_f32_bf16 v233, v94, v239
    v_dot2c_f32_bf16 v234, v95, v238
    v_dot2c_f32_bf16 v235, v95, v239
    s_waitcnt vmcnt(19)
    v_dot2c_f32_bf16 v228, v148, v238
    v_dot2c_f32_bf16 v229, v148, v239
    v_dot2c_f32_bf16 v230, v149, v238
    v_dot2c_f32_bf16 v231, v149, v239
    v_dot2c_f32_bf16 v232, v150, v238
    v_dot2c_f32_bf16 v233, v150, v239
    v_dot2c_f32_bf16 v234, v151, v238
    v_dot2c_f32_bf16 v235, v151, v239
    s_waitcnt vmcnt(18)
    v_dot2c_f32_bf16 v228, v152, v238
    v_dot2c_f32_bf16 v229, v152, v239
    v_dot2c_f32_bf16 v230, v153, v238
    v_dot2c_f32_bf16 v231, v153, v239
    v_dot2c_f32_bf16 v232, v154, v238
    v_dot2c_f32_bf16 v233, v154, v239
    v_dot2c_f32_bf16 v234, v155, v238
    v_dot2c_f32_bf16 v235, v155, v239
    s_waitcnt vmcnt(17)
    v_dot2c_f32_bf16 v228, v156, v238
    v_dot2c_f32_bf16 v229, v156, v239
    v_dot2c_f32_bf16 v230, v157, v238
    v_dot2c_f32_bf16 v231, v157, v239
    v_dot2c_f32_bf16 v232, v158, v238
    v_dot2c_f32_bf16 v233, v158, v239
    v_dot2c_f32_bf16 v234, v159, v238
    v_dot2c_f32_bf16 v235, v159, v239
    s_waitcnt vmcnt(16)
    v_dot2c_f32_bf16 v228, v160, v238
    v_dot2c_f32_bf16 v229, v160, v239
    v_dot2c_f32_bf16 v230, v161, v238
    v_dot2c_f32_bf16 v231, v161, v239
    v_dot2c_f32_bf16 v232, v162, v238
    v_dot2c_f32_bf16 v233, v162, v239
    v_dot2c_f32_bf16 v234, v163, v238
    v_dot2c_f32_bf16 v235, v163, v239
    s_waitcnt vmcnt(15)
    v_dot2c_f32_bf16 v228, v60, v238
    v_dot2c_f32_bf16 v229, v60, v239
    v_dot2c_f32_bf16 v230, v61, v238
    v_dot2c_f32_bf16 v231, v61, v239
    v_dot2c_f32_bf16 v232, v62, v238
    v_dot2c_f32_bf16 v233, v62, v239
    v_dot2c_f32_bf16 v234, v63, v238
    v_dot2c_f32_bf16 v235, v63, v239
    s_waitcnt vmcnt(14)
    v_dot2c_f32_bf16 v228, v96, v238
    v_dot2c_f32_bf16 v229, v96, v239
    v_dot2c_f32_bf16 v230, v97, v238
    v_dot2c_f32_bf16 v231, v97, v239
    v_dot2c_f32_bf16 v232, v98, v238
    v_dot2c_f32_bf16 v233, v98, v239
    v_dot2c_f32_bf16 v234, v99, v238
    v_dot2c_f32_bf16 v235, v99, v239
    s_waitcnt vmcnt(13)
    v_dot2c_f32_bf16 v228, v100, v238
    v_dot2c_f32_bf16 v229, v100, v239
    v_dot2c_f32_bf16 v230, v101, v238
    v_dot2c_f32_bf16 v231, v101, v239
    v_dot2c_f32_bf16 v232, v102, v238
    v_dot2c_f32_bf16 v233, v102, v239
    v_dot2c_f32_bf16 v234, v103, v238
    v_dot2c_f32_bf16 v235, v103, v239
    s_waitcnt vmcnt(12)
    v_dot2c_f32_bf16 v228, v124, v238
    v_dot2c_f32_bf16 v229, v124, v239
    v_dot2c_f32_bf16 v230, v125, v238
    v_dot2c_f32_bf16 v231, v125, v239
    v_dot2c_f32_bf16 v232, v126, v238
    v_dot2c_f32_bf16 v233, v126, v239
    v_dot2c_f32_bf16 v234, v127, v238
    v_dot2c_f32_bf16 v235, v127, v239
    v_mul_u32_u24 v167, 2731, v174
    v_lshrrev_b32 v167, 16, v167
    v_mul_u32_u24 v167, 24, v167
    v_sub_u32 v167, v174, v167
    v_add_f32 v168, v228, v230
    v_add_f32 v169, v232, v234
    v_add_f32 v168, v168, v169
    v_cmp_gt_u32 s[90:91], 21, v167
    v_cmp_u_f32 vcc, v168, v168
    s_nop 0
    s_and_b64 vcc, vcc, s[90:91]
    s_cbranch_vccz L_gok_51
L_glp_52:
    s_waitcnt vmcnt(0)
    s_add_u32 s95, s59, 0
    buffer_load_dwordx4 v[64:67], v175, s[8:11], s95 offen sc1
    s_add_u32 s95, s59, 4096
    buffer_load_dwordx4 v[68:71], v175, s[8:11], s95 offen sc1
    s_add_u32 s95, s59, 8192
    buffer_load_dwordx4 v[72:75], v175, s[8:11], s95 offen sc1
    s_add_u32 s95, s59, 12288
    buffer_load_dwordx4 v[76:79], v175, s[8:11], s95 offen sc1
    s_add_u32 s95, s59, 16384
    buffer_load_dwordx4 v[80:83], v175, s[8:11], s95 offen sc1
    s_add_u32 s95, s59, 20480
    buffer_load_dwordx4 v[84:87], v175, s[8:11], s95 offen sc1
    s_add_u32 s95, s59, 24576
    buffer_load_dwordx4 v[88:91], v175, s[8:11], s95 offen sc1
    s_add_u32 s95, s59, 28672
    buffer_load_dwordx4 v[92:95], v175, s[8:11], s95 offen sc1
    s_add_u32 s95, s59, 32768
    buffer_load_dwordx4 v[148:151], v175, s[8:11], s95 offen sc1
    s_add_u32 s95, s59, 36864
    buffer_load_dwordx4 v[152:155], v175, s[8:11], s95 offen sc1
    s_add_u32 s95, s59, 40960
    buffer_load_dwordx4 v[156:159], v175, s[8:11], s95 offen sc1
    s_add_u32 s95, s59, 45056
    buffer_load_dwordx4 v[160:163], v175, s[8:11], s95 offen sc1
    s_add_u32 s95, s59, 49152
    buffer_load_dwordx4 v[60:63], v175, s[8:11], s95 offen sc1
    s_add_u32 s95, s59, 53248
    buffer_load_dwordx4 v[96:99], v175, s[8:11], s95 offen sc1
    s_add_u32 s95, s59, 57344
    buffer_load_dwordx4 v[100:103], v175, s[8:11], s95 offen sc1
    s_add_u32 s95, s59, 61440
    buffer_load_dwordx4 v[124:127], v175, s[8:11], s95 offen sc1
    v_mov_b32 v228, 0
    v_mov_b32 v229, 0
    v_mov_b32 v230, 0
    v_mov_b32 v231, 0
    v_mov_b32 v232, 0
    v_mov_b32 v233, 0
    v_mov_b32 v234, 0
    v_mov_b32 v235, 0
    s_waitcnt vmcnt(15)
    v_dot2c_f32_bf16 v228, v64, v238
    v_dot2c_f32_bf16 v229, v64, v239
    v_dot2c_f32_bf16 v230, v65, v238
    v_dot2c_f32_bf16 v231, v65, v239
    v_dot2c_f32_bf16 v232, v66, v238
    v_dot2c_f32_bf16 v233, v66, v239
    v_dot2c_f32_bf16 v234, v67, v238
    v_dot2c_f32_bf16 v235, v67, v239
    s_waitcnt vmcnt(14)
    v_dot2c_f32_bf16 v228, v68, v238
    v_dot2c_f32_bf16 v229, v68, v239
    v_dot2c_f32_bf16 v230, v69, v238
    v_dot2c_f32_bf16 v231, v69, v239
    v_dot2c_f32_bf16 v232, v70, v238
    v_dot2c_f32_bf16 v233, v70, v239
    v_dot2c_f32_bf16 v234, v71, v238
    v_dot2c_f32_bf16 v235, v71, v239
    s_waitcnt vmcnt(13)
    v_dot2c_f32_bf16 v228, v72, v238
    v_dot2c_f32_bf16 v229, v72, v239
    v_dot2c_f32_bf16 v230, v73, v238
    v_dot2c_f32_bf16 v231, v73, v239
    v_dot2c_f32_bf16 v232, v74, v238
    v_dot2c_f32_bf16 v233, v74, v239
    v_dot2c_f32_bf16 v234, v75, v238
    v_dot2c_f32_bf16 v235, v75, v239
    s_waitcnt vmcnt(12)
    v_dot2c_f32_bf16 v228, v76, v238
    v_dot2c_f32_bf16 v229, v76, v239
    v_dot2c_f32_bf16 v230, v77, v238
    v_dot2c_f32_bf16 v231, v77, v239
    v_dot2c_f32_bf16 v232, v78, v238
    v_dot2c_f32_bf16 v233, v78, v239
    v_dot2c_f32_bf16 v234, v79, v238
    v_dot2c_f32_bf16 v235, v79, v239
    s_waitcnt vmcnt(11)
    v_dot2c_f32_bf16 v228, v80, v238
    v_dot2c_f32_bf16 v229, v80, v239
    v_dot2c_f32_bf16 v230, v81, v238
    v_dot2c_f32_bf16 v231, v81, v239
    v_dot2c_f32_bf16 v232, v82, v238
    v_dot2c_f32_bf16 v233, v82, v239
    v_dot2c_f32_bf16 v234, v83, v238
    v_dot2c_f32_bf16 v235, v83, v239
    s_waitcnt vmcnt(10)
    v_dot2c_f32_bf16 v228, v84, v238
    v_dot2c_f32_bf16 v229, v84, v239
    v_dot2c_f32_bf16 v230, v85, v238
    v_dot2c_f32_bf16 v231, v85, v239
    v_dot2c_f32_bf16 v232, v86, v238
    v_dot2c_f32_bf16 v233, v86, v239
    v_dot2c_f32_bf16 v234, v87, v238
    v_dot2c_f32_bf16 v235, v87, v239
    s_waitcnt vmcnt(9)
    v_dot2c_f32_bf16 v228, v88, v238
    v_dot2c_f32_bf16 v229, v88, v239
    v_dot2c_f32_bf16 v230, v89, v238
    v_dot2c_f32_bf16 v231, v89, v239
    v_dot2c_f32_bf16 v232, v90, v238
    v_dot2c_f32_bf16 v233, v90, v239
    v_dot2c_f32_bf16 v234, v91, v238
    v_dot2c_f32_bf16 v235, v91, v239
    s_waitcnt vmcnt(8)
    v_dot2c_f32_bf16 v228, v92, v238
    v_dot2c_f32_bf16 v229, v92, v239
    v_dot2c_f32_bf16 v230, v93, v238
    v_dot2c_f32_bf16 v231, v93, v239
    v_dot2c_f32_bf16 v232, v94, v238
    v_dot2c_f32_bf16 v233, v94, v239
    v_dot2c_f32_bf16 v234, v95, v238
    v_dot2c_f32_bf16 v235, v95, v239
    s_waitcnt vmcnt(7)
    v_dot2c_f32_bf16 v228, v148, v238
    v_dot2c_f32_bf16 v229, v148, v239
    v_dot2c_f32_bf16 v230, v149, v238
    v_dot2c_f32_bf16 v231, v149, v239
    v_dot2c_f32_bf16 v232, v150, v238
    v_dot2c_f32_bf16 v233, v150, v239
    v_dot2c_f32_bf16 v234, v151, v238
    v_dot2c_f32_bf16 v235, v151, v239
    s_waitcnt vmcnt(6)
    v_dot2c_f32_bf16 v228, v152, v238
    v_dot2c_f32_bf16 v229, v152, v239
    v_dot2c_f32_bf16 v230, v153, v238
    v_dot2c_f32_bf16 v231, v153, v239
    v_dot2c_f32_bf16 v232, v154, v238
    v_dot2c_f32_bf16 v233, v154, v239
    v_dot2c_f32_bf16 v234, v155, v238
    v_dot2c_f32_bf16 v235, v155, v239
    s_waitcnt vmcnt(5)
    v_dot2c_f32_bf16 v228, v156, v238
    v_dot2c_f32_bf16 v229, v156, v239
    v_dot2c_f32_bf16 v230, v157, v238
    v_dot2c_f32_bf16 v231, v157, v239
    v_dot2c_f32_bf16 v232, v158, v238
    v_dot2c_f32_bf16 v233, v158, v239
    v_dot2c_f32_bf16 v234, v159, v238
    v_dot2c_f32_bf16 v235, v159, v239
    s_waitcnt vmcnt(4)
    v_dot2c_f32_bf16 v228, v160, v238
    v_dot2c_f32_bf16 v229, v160, v239
    v_dot2c_f32_bf16 v230, v161, v238
    v_dot2c_f32_bf16 v231, v161, v239
    v_dot2c_f32_bf16 v232, v162, v238
    v_dot2c_f32_bf16 v233, v162, v239
    v_dot2c_f32_bf16 v234, v163, v238
    v_dot2c_f32_bf16 v235, v163, v239
    s_waitcnt vmcnt(3)
    v_dot2c_f32_bf16 v228, v60, v238
    v_dot2c_f32_bf16 v229, v60, v239
    v_dot2c_f32_bf16 v230, v61, v238
    v_dot2c_f32_bf16 v231, v61, v239
    v_dot2c_f32_bf16 v232, v62, v238
    v_dot2c_f32_bf16 v233, v62, v239
    v_dot2c_f32_bf16 v234, v63, v238
    v_dot2c_f32_bf16 v235, v63, v239
    s_waitcnt vmcnt(2)
    v_dot2c_f32_bf16 v228, v96, v238
    v_dot2c_f32_bf16 v229, v96, v239
    v_dot2c_f32_bf16 v230, v97, v238
    v_dot2c_f32_bf16 v231, v97, v239
    v_dot2c_f32_bf16 v232, v98, v238
    v_dot2c_f32_bf16 v233, v98, v239
    v_dot2c_f32_bf16 v234, v99, v238
    v_dot2c_f32_bf16 v235, v99, v239
    s_waitcnt vmcnt(1)
    v_dot2c_f32_bf16 v228, v100, v238
    v_dot2c_f32_bf16 v229, v100, v239
    v_dot2c_f32_bf16 v230, v101, v238
    v_dot2c_f32_bf16 v231, v101, v239
    v_dot2c_f32_bf16 v232, v102, v238
    v_dot2c_f32_bf16 v233, v102, v239
    v_dot2c_f32_bf16 v234, v103, v238
    v_dot2c_f32_bf16 v235, v103, v239
    s_waitcnt vmcnt(0)
    v_dot2c_f32_bf16 v228, v124, v238
    v_dot2c_f32_bf16 v229, v124, v239
    v_dot2c_f32_bf16 v230, v125, v238
    v_dot2c_f32_bf16 v231, v125, v239
    v_dot2c_f32_bf16 v232, v126, v238
    v_dot2c_f32_bf16 v233, v126, v239
    v_dot2c_f32_bf16 v234, v127, v238
    v_dot2c_f32_bf16 v235, v127, v239
    v_mul_u32_u24 v167, 2731, v174
    v_lshrrev_b32 v167, 16, v167
    v_mul_u32_u24 v167, 24, v167
    v_sub_u32 v167, v174, v167
    v_add_f32 v168, v228, v230
    v_add_f32 v169, v232, v234
    v_add_f32 v168, v168, v169
    v_cmp_gt_u32 s[90:91], 21, v167
    v_cmp_u_f32 vcc, v168, v168
    s_nop 0
    s_and_b64 vcc, vcc, s[90:91]
    s_cbranch_vccz L_ok_53
    s_add_u32 s51, s51, 1
    s_cmp_gt_u32 s51, 200000
    s_cbranch_scc1 L_ok_53
    s_waitcnt vmcnt(0) lgkmcnt(0)
    s_sleep 1
    s_branch L_glp_52
L_ok_53:
L_gok_51:
    v_cvt_pk_bf16_f32 v236, v228, v229
    v_cvt_pk_bf16_f32 v237, v230, v231
    v_cvt_pk_bf16_f32 v238, v232, v233
    v_cvt_pk_bf16_f32 v239, v234, v235
    v_lshlrev_b32 v166, 4, v174
    v_add_u32 v166, 157696, v166
    ds_write_b128 v166, v[236:239]
    v_mov_b32 v24, 0
    v_mov_b32 v25, 0
    v_mov_b32 v26, 0
    v_mov_b32 v27, 0
    v_mov_b32 v28, 0
    v_mov_b32 v29, 0
    v_mov_b32 v30, 0
    v_mov_b32 v31, 0
    v_mov_b32 v32, 0
    v_mov_b32 v33, 0
    v_mov_b32 v34, 0
    v_mov_b32 v35, 0
    v_mov_b32 v36, 0
    v_mov_b32 v37, 0
    v_mov_b32 v38, 0
    v_mov_b32 v39, 0
    v_mov_b32 v40, 0
    v_mov_b32 v41, 0
    v_mov_b32 v42, 0
    v_mov_b32 v43, 0
    v_mov_b32 v44, 0
    v_mov_b32 v45, 0
    v_mov_b32 v46, 0
    v_mov_b32 v47, 0
    v_mov_b32 v48, 0
    v_mov_b32 v49, 0
    v_mov_b32 v50, 0
    v_mov_b32 v51, 0
    v_mov_b32 v52, 0
    v_mov_b32 v53, 0
    v_mov_b32 v54, 0
    v_mov_b32 v55, 0
    v_mov_b32 v128, 0
    v_mov_b32 v129, 0
    v_mov_b32 v130, 0
    v_mov_b32 v131, 0
    v_mov_b32 v132, 0
    v_mov_b32 v133, 0
    v_mov_b32 v134, 0
    v_mov_b32 v135, 0
    v_bfe_u32 v164, v21, 3, 2
    v_and_b32 v165, 3, v21
    v_lshl_add_u32 v164, v164, 2, v165
    v_lshlrev_b32 v164, 4, v164
    v_lshrrev_b32 v165, 5, v21
    v_mul_u32_u24 v165, 1920, v165
    v_add3_u32 v164, v164, v165, v165
    v_sub_u32 v164, v164, v165
    v_add_u32 v164, 157696, v164
    s_waitcnt lgkmcnt(0)
    s_barrier
    s_mov_b32 exec_lo, 0x0f0f0f0f
    s_mov_b32 exec_hi, 0xf0f0f0f0
    ds_read_b128 v[24:27], v164 offset:0
    ds_read_b128 v[28:31], v164 offset:256
    ds_read_b128 v[32:35], v164 offset:384
    ds_read_b128 v[36:39], v164 offset:640
    ds_read_b128 v[40:43], v164 offset:768
    ds_read_b128 v[44:47], v164 offset:1024
    ds_read_b128 v[48:51], v164 offset:1152
    ds_read_b128 v[52:55], v164 offset:1408
    ds_read_b128 v[128:131], v164 offset:1536
    ds_read_b128 v[132:135], v164 offset:1792
    s_mov_b64 exec, -1
    s_waitcnt lgkmcnt(8)
    v_mfma_f32_32x32x16_bf16 v[80:95], v[24:27], v[104:107], 0
    v_mfma_f32_32x32x16_bf16 v[64:79], v[28:31], v[104:107], 0
    s_waitcnt lgkmcnt(6)
    v_mfma_f32_32x32x16_bf16 v[80:95], v[32:35], v[108:111], v[80:95]
    v_mfma_f32_32x32x16_bf16 v[64:79], v[36:39], v[108:111], v[64:79]
    s_waitcnt lgkmcnt(4)
    v_mfma_f32_32x32x16_bf16 v[80:95], v[40:43], v[112:115], v[80:95]
    v_mfma_f32_32x32x16_bf16 v[64:79], v[44:47], v[112:115], v[64:79]
    s_waitcnt lgkmcnt(2)
    v_mfma_f32_32x32x16_bf16 v[80:95], v[48:51], v[116:119], v[80:95]
    v_mfma_f32_32x32x16_bf16 v[64:79], v[52:55], v[116:119], v[64:79]
    s_waitcnt lgkmcnt(0)
    v_mfma_f32_32x32x16_bf16 v[80:95], v[128:131], v[120:123], v[80:95]
    v_mfma_f32_32x32x16_bf16 v[64:79], v[132:135], v[120:123], v[64:79]
    s_nop 11
    v_add_f32 v164, 0x358637bd, v68
    v_rcp_f32 v164, v164
    s_nop 0
    v_pk_mul_f32 v[80:81], v[80:81], v[164:165] op_sel_hi:[1,0]
    v_pk_mul_f32 v[82:83], v[82:83], v[164:165] op_sel_hi:[1,0]
    v_pk_mul_f32 v[84:85], v[84:85], v[164:165] op_sel_hi:[1,0]
    v_pk_mul_f32 v[86:87], v[86:87], v[164:165] op_sel_hi:[1,0]
    v_pk_mul_f32 v[88:89], v[88:89], v[164:165] op_sel_hi:[1,0]
    v_pk_mul_f32 v[90:91], v[90:91], v[164:165] op_sel_hi:[1,0]
    v_pk_mul_f32 v[92:93], v[92:93], v[164:165] op_sel_hi:[1,0]
    v_pk_mul_f32 v[94:95], v[94:95], v[164:165] op_sel_hi:[1,0]
    v_pk_mul_f32 v[64:65], v[64:65], v[164:165] op_sel_hi:[1,0]
    v_pk_mul_f32 v[66:67], v[66:67], v[164:165] op_sel_hi:[1,0]
    v_cvt_pk_bf16_f32 v80, v80, v81
    v_cvt_pk_bf16_f32 v81, v82, v83
    v_cvt_pk_bf16_f32 v82, v84, v85
    v_cvt_pk_bf16_f32 v83, v86, v87
    v_cvt_pk_bf16_f32 v84, v88, v89
    v_cvt_pk_bf16_f32 v85, v90, v91
    v_cvt_pk_bf16_f32 v86, v92, v93
    v_cvt_pk_bf16_f32 v87, v94, v95
    v_cvt_pk_bf16_f32 v88, v64, v65
    v_cvt_pk_bf16_f32 v89, v66, v67
    s_nop 0
    v_permlane32_swap_b32 v88, v90
    v_permlane32_swap_b32 v89, v91
    s_mul_i32 s52, s49, 40960
    s_lshl_b32 s53, s46, 10
    s_add_u32 s52, s52, 15728640
    s_add_u32 s53, s53, s52
    s_lshl_b32 s54, s46, 8
    s_add_u32 s54, s54, s52
    s_add_u32 s54, s54, 16384
    buffer_store_dwordx4 v[80:83], v14, s[8:11], s53 offen sc1
    buffer_store_dwordx4 v[84:87], v14, s[8:11], s53 offen offset:256 sc1
    s_mov_b64 exec, 0xffffffff
    buffer_store_dwordx4 v[88:91], v14, s[8:11], s54 offen sc1
    s_mov_b64 exec, -1
    s_waitcnt vmcnt(3)
    s_barrier
    s_mul_i32 s59, s50, 20480
    s_add_u32 s59, s59, 15728640
    s_add_u32 s60, s59, 16384
    s_sleep 6
    v_add_u32 v175, 0x10000, v10
L_wo_54:
    buffer_load_dwordx4 v[24:27], v1, s[8:11], s60 offen offset:0 sc1
    buffer_load_dwordx4 v[28:31], v1, s[8:11], s60 offen offset:1024 sc1
    buffer_load_dwordx4 v[32:35], v1, s[8:11], s60 offen offset:2048 sc1
    buffer_load_dwordx4 v[36:39], v1, s[8:11], s60 offen offset:3072 sc1
    v_lshlrev_b32 v64, 16, v200
    v_and_b32 v65, 0xffff0000, v200
    v_lshlrev_b32 v66, 16, v201
    v_and_b32 v67, 0xffff0000, v201
    v_lshlrev_b32 v68, 16, v202
    v_and_b32 v69, 0xffff0000, v202
    v_lshlrev_b32 v70, 16, v203
    v_and_b32 v71, 0xffff0000, v203
    v_lshlrev_b32 v72, 16, v204
    v_and_b32 v73, 0xffff0000, v204
    v_lshlrev_b32 v74, 16, v205
    v_and_b32 v75, 0xffff0000, v205
    v_lshlrev_b32 v76, 16, v206
    v_and_b32 v77, 0xffff0000, v206
    v_lshlrev_b32 v78, 16, v207
    v_and_b32 v79, 0xffff0000, v207
    v_lshlrev_b32 v80, 16, v208
    v_and_b32 v81, 0xffff0000, v208
    v_lshlrev_b32 v82, 16, v209
    v_and_b32 v83, 0xffff0000, v209
    s_waitcnt vmcnt(0)
    v_max3_u32 v164, v24, v25, v26
    v_max3_u32 v164, v164, v27, v28
    v_max3_u32 v164, v164, v29, v30
    v_max3_u32 v164, v164, v31, v32
    v_max3_u32 v164, v164, v33, v34
    v_max3_u32 v164, v164, v35, v36
    v_max3_u32 v164, v164, v37, v38
    v_max_u32 v164, v164, v39
    v_cmp_eq_u32 vcc, -1, v164
    s_cbranch_vccz L_ok_55
    s_add_u32 s51, s51, 1
    s_cmp_gt_u32 s51, 200000
    s_cbranch_scc1 L_ok_55
    s_waitcnt vmcnt(0) lgkmcnt(0)
    s_sleep 2
    s_branch L_wo_54
L_ok_55:
    s_add_u32 s61, s59, 0
    buffer_load_dwordx4 a[0:3], v1, s[8:11], s61 offen offset:0 sc1
    buffer_load_dwordx4 a[4:7], v1, s[8:11], s61 offen offset:1024 sc1
    buffer_load_dwordx4 a[8:11], v1, s[8:11], s61 offen offset:2048 sc1
    buffer_load_dwordx4 a[12:15], v1, s[8:11], s61 offen offset:3072 sc1
    s_add_u32 s61, s59, 4096
    buffer_load_dwordx4 a[16:19], v1, s[8:11], s61 offen offset:0 sc1
    buffer_load_dwordx4 a[20:23], v1, s[8:11], s61 offen offset:1024 sc1
    buffer_load_dwordx4 a[24:27], v1, s[8:11], s61 offen offset:2048 sc1
    buffer_load_dwordx4 a[28:31], v1, s[8:11], s61 offen offset:3072 sc1
    s_add_u32 s61, s59, 8192
    buffer_load_dwordx4 a[32:35], v1, s[8:11], s61 offen offset:0 sc1
    buffer_load_dwordx4 a[36:39], v1, s[8:11], s61 offen offset:1024 sc1
    ds_read_b128 v[84:87], v175 offset:16384
    ds_read_b128 v[88:91], v175 offset:17408
    ds_read_b128 v[92:95], v175 offset:18432
    ds_read_b128 v[96:99], v175 offset:19456
    ds_read_b128 v[100:103], v175 offset:20480
    ds_read_b128 v[104:107], v175 offset:21504
    ds_read_b128 v[108:111], v175 offset:22528
    s_waitcnt lgkmcnt(6)
    v_mfma_f32_16x16x32_bf16 v[64:67], v[84:87], v[24:27], v[64:67]
    ds_read_b128 v[112:115], v175 offset:23552
    buffer_load_dwordx4 a[40:43], v1, s[8:11], s61 offen offset:2048 sc1
    s_waitcnt lgkmcnt(6)
    v_mfma_f32_16x16x32_bf16 v[68:71], v[88:91], v[24:27], v[68:71]
    ds_read_b128 v[116:119], v175 offset:24576
    s_waitcnt lgkmcnt(6)
    v_mfma_f32_16x16x32_bf16 v[72:75], v[92:95], v[24:27], v[72:75]
    ds_read_b128 v[84:87], v175 offset:25600
    s_waitcnt lgkmcnt(6)
    v_mfma_f32_16x16x32_bf16 v[76:79], v[96:99], v[24:27], v[76:79]
    ds_read_b128 v[88:91], v175 offset:26624
    s_waitcnt lgkmcnt(6)
    v_mfma_f32_16x16x32_bf16 v[80:83], v[100:103], v[24:27], v[80:83]
    ds_read_b128 v[92:95], v175 offset:27648
    buffer_load_dwordx4 a[44:47], v1, s[8:11], s61 offen offset:3072 sc1
    s_waitcnt lgkmcnt(6)
    v_mfma_f32_16x16x32_bf16 v[64:67], v[104:107], v[28:31], v[64:67]
    ds_read_b128 v[96:99], v175 offset:28672
    s_waitcnt lgkmcnt(6)
    v_mfma_f32_16x16x32_bf16 v[68:71], v[108:111], v[28:31], v[68:71]
    ds_read_b128 v[100:103], v175 offset:29696
    s_waitcnt lgkmcnt(6)
    v_mfma_f32_16x16x32_bf16 v[72:75], v[112:115], v[28:31], v[72:75]
    ds_read_b128 v[104:107], v175 offset:30720
    s_waitcnt lgkmcnt(6)
    v_mfma_f32_16x16x32_bf16 v[76:79], v[116:119], v[28:31], v[76:79]
    ds_read_b128 v[108:111], v175 offset:31744
    s_add_u32 s61, s59, 12288
    buffer_load_dwordx4 a[48:51], v1, s[8:11], s61 offen offset:0 sc1
    s_waitcnt lgkmcnt(6)
    v_mfma_f32_16x16x32_bf16 v[80:83], v[84:87], v[28:31], v[80:83]
    ds_read_b128 v[112:115], v175 offset:32768
    s_waitcnt lgkmcnt(6)
    v_mfma_f32_16x16x32_bf16 v[64:67], v[88:91], v[32:35], v[64:67]
    ds_read_b128 v[116:119], v175 offset:33792
    s_waitcnt lgkmcnt(6)
    v_mfma_f32_16x16x32_bf16 v[68:71], v[92:95], v[32:35], v[68:71]
    ds_read_b128 v[84:87], v175 offset:34816
    s_waitcnt lgkmcnt(6)
    v_mfma_f32_16x16x32_bf16 v[72:75], v[96:99], v[32:35], v[72:75]
    ds_read_b128 v[88:91], v175 offset:35840
    buffer_load_dwordx4 a[52:55], v1, s[8:11], s61 offen offset:1024 sc1
    s_waitcnt lgkmcnt(6)
    v_mfma_f32_16x16x32_bf16 v[76:79], v[100:103], v[32:35], v[76:79]
    ds_read_b128 v[92:95], v10 offset:0
    s_waitcnt lgkmcnt(6)
    v_mfma_f32_16x16x32_bf16 v[80:83], v[104:107], v[32:35], v[80:83]
    ds_read_b128 v[96:99], v10 offset:1024
    s_waitcnt lgkmcnt(6)
    v_mfma_f32_16x16x32_bf16 v[64:67], v[108:111], v[36:39], v[64:67]
    ds_read_b128 v[100:103], v10 offset:2048
    s_waitcnt lgkmcnt(6)
    v_mfma_f32_16x16x32_bf16 v[68:71], v[112:115], v[36:39], v[68:71]
    ds_read_b128 v[104:107], v10 offset:3072
    buffer_load_dwordx4 a[56:59], v1, s[8:11], s61 offen offset:2048 sc1
    s_waitcnt lgkmcnt(6)
    v_mfma_f32_16x16x32_bf16 v[72:75], v[116:119], v[36:39], v[72:75]
    ds_read_b128 v[108:111], v10 offset:4096
    s_waitcnt lgkmcnt(6)
    v_mfma_f32_16x16x32_bf16 v[76:79], v[84:87], v[36:39], v[76:79]
    ds_read_b128 v[112:115], v10 offset:5120
    s_waitcnt lgkmcnt(6)
    v_mfma_f32_16x16x32_bf16 v[80:83], v[88:91], v[36:39], v[80:83]
    ds_read_b128 v[116:119], v10 offset:6144
    s_waitcnt vmcnt(14) lgkmcnt(6)
    v_mfma_f32_16x16x32_bf16 v[64:67], v[92:95], a[0:3], v[64:67]
    ds_read_b128 v[84:87], v10 offset:7168
    buffer_load_dwordx4 a[60:63], v1, s[8:11], s61 offen offset:3072 sc1
    s_waitcnt lgkmcnt(6)
    v_mfma_f32_16x16x32_bf16 v[68:71], v[96:99], a[0:3], v[68:71]
    ds_read_b128 v[88:91], v10 offset:8192
    s_waitcnt lgkmcnt(6)
    v_mfma_f32_16x16x32_bf16 v[72:75], v[100:103], a[0:3], v[72:75]
    ds_read_b128 v[92:95], v10 offset:9216
    s_waitcnt lgkmcnt(6)
    v_mfma_f32_16x16x32_bf16 v[76:79], v[104:107], a[0:3], v[76:79]
    ds_read_b128 v[96:99], v10 offset:10240
    s_waitcnt lgkmcnt(6)
    v_mfma_f32_16x16x32_bf16 v[80:83], v[108:111], a[0:3], v[80:83]
    ds_read_b128 v[100:103], v10 offset:11264
    s_waitcnt vmcnt(14) lgkmcnt(6)
    v_mfma_f32_16x16x32_bf16 v[64:67], v[112:115], a[4:7], v[64:67]
    ds_read_b128 v[104:107], v10 offset:12288
    s_waitcnt lgkmcnt(6)
    v_mfma_f32_16x16x32_bf16 v[68:71], v[116:119], a[4:7], v[68:71]
    ds_read_b128 v[108:111], v10 offset:13312
    s_waitcnt lgkmcnt(6)
    v_mfma_f32_16x16x32_bf16 v[72:75], v[84:87], a[4:7], v[72:75]
    ds_read_b128 v[112:115], v10 offset:14336
    s_waitcnt lgkmcnt(6)
    v_mfma_f32_16x16x32_bf16 v[76:79], v[88:91], a[4:7], v[76:79]
    ds_read_b128 v[116:119], v10 offset:15360
    s_waitcnt lgkmcnt(6)
    v_mfma_f32_16x16x32_bf16 v[80:83], v[92:95], a[4:7], v[80:83]
    ds_read_b128 v[84:87], v10 offset:16384
    s_waitcnt vmcnt(13) lgkmcnt(6)
    v_mfma_f32_16x16x32_bf16 v[64:67], v[96:99], a[8:11], v[64:67]
    ds_read_b128 v[88:91], v10 offset:17408
    s_waitcnt lgkmcnt(6)
    v_mfma_f32_16x16x32_bf16 v[68:71], v[100:103], a[8:11], v[68:71]
    ds_read_b128 v[92:95], v10 offset:18432
    s_waitcnt lgkmcnt(6)
    v_mfma_f32_16x16x32_bf16 v[72:75], v[104:107], a[8:11], v[72:75]
    ds_read_b128 v[96:99], v10 offset:19456
    s_waitcnt lgkmcnt(6)
    v_mfma_f32_16x16x32_bf16 v[76:79], v[108:111], a[8:11], v[76:79]
    ds_read_b128 v[100:103], v10 offset:20480
    s_waitcnt lgkmcnt(6)
    v_mfma_f32_16x16x32_bf16 v[80:83], v[112:115], a[8:11], v[80:83]
    ds_read_b128 v[104:107], v10 offset:21504
    s_waitcnt vmcnt(12) lgkmcnt(6)
    v_mfma_f32_16x16x32_bf16 v[64:67], v[116:119], a[12:15], v[64:67]
    ds_read_b128 v[108:111], v10 offset:22528
    s_waitcnt lgkmcnt(6)
    v_mfma_f32_16x16x32_bf16 v[68:71], v[84:87], a[12:15], v[68:71]
    ds_read_b128 v[112:115], v10 offset:23552
    s_waitcnt lgkmcnt(6)
    v_mfma_f32_16x16x32_bf16 v[72:75], v[88:91], a[12:15], v[72:75]
    ds_read_b128 v[116:119], v10 offset:24576
    s_waitcnt lgkmcnt(6)
    v_mfma_f32_16x16x32_bf16 v[76:79], v[92:95], a[12:15], v[76:79]
    ds_read_b128 v[84:87], v10 offset:25600
    s_waitcnt lgkmcnt(6)
    v_mfma_f32_16x16x32_bf16 v[80:83], v[96:99], a[12:15], v[80:83]
    ds_read_b128 v[88:91], v10 offset:26624
    s_waitcnt vmcnt(11) lgkmcnt(6)
    v_mfma_f32_16x16x32_bf16 v[64:67], v[100:103], a[16:19], v[64:67]
    ds_read_b128 v[92:95], v10 offset:27648
    s_waitcnt lgkmcnt(6)
    v_mfma_f32_16x16x32_bf16 v[68:71], v[104:107], a[16:19], v[68:71]
    ds_read_b128 v[96:99], v10 offset:28672
    s_waitcnt lgkmcnt(6)
    v_mfma_f32_16x16x32_bf16 v[72:75], v[108:111], a[16:19], v[72:75]
    ds_read_b128 v[100:103], v10 offset:29696
    s_waitcnt lgkmcnt(6)
    v_mfma_f32_16x16x32_bf16 v[76:79], v[112:115], a[16:19], v[76:79]
    ds_read_b128 v[104:107], v10 offset:30720
    s_waitcnt lgkmcnt(6)
    v_mfma_f32_16x16x32_bf16 v[80:83], v[116:119], a[16:19], v[80:83]
    ds_read_b128 v[108:111], v10 offset:31744
    s_waitcnt vmcnt(10) lgkmcnt(6)
    v_mfma_f32_16x16x32_bf16 v[64:67], v[84:87], a[20:23], v[64:67]
    ds_read_b128 v[112:115], v10 offset:32768
    s_waitcnt lgkmcnt(6)
    v_mfma_f32_16x16x32_bf16 v[68:71], v[88:91], a[20:23], v[68:71]
    ds_read_b128 v[116:119], v10 offset:33792
    s_waitcnt lgkmcnt(6)
    v_mfma_f32_16x16x32_bf16 v[72:75], v[92:95], a[20:23], v[72:75]
    ds_read_b128 v[84:87], v10 offset:34816
    s_waitcnt lgkmcnt(6)
    v_mfma_f32_16x16x32_bf16 v[76:79], v[96:99], a[20:23], v[76:79]
    ds_read_b128 v[88:91], v10 offset:35840
    s_waitcnt lgkmcnt(6)
    v_mfma_f32_16x16x32_bf16 v[80:83], v[100:103], a[20:23], v[80:83]
    ds_read_b128 v[92:95], v10 offset:36864
    s_waitcnt vmcnt(9) lgkmcnt(6)
    v_mfma_f32_16x16x32_bf16 v[64:67], v[104:107], a[24:27], v[64:67]
    ds_read_b128 v[96:99], v10 offset:37888
    s_waitcnt lgkmcnt(6)
    v_mfma_f32_16x16x32_bf16 v[68:71], v[108:111], a[24:27], v[68:71]
    ds_read_b128 v[100:103], v10 offset:38912
    s_waitcnt lgkmcnt(6)
    v_mfma_f32_16x16x32_bf16 v[72:75], v[112:115], a[24:27], v[72:75]
    ds_read_b128 v[104:107], v10 offset:39936
    s_waitcnt lgkmcnt(6)
    v_mfma_f32_16x16x32_bf16 v[76:79], v[116:119], a[24:27], v[76:79]
    ds_read_b128 v[108:111], v10 offset:40960
    s_waitcnt lgkmcnt(6)
    v_mfma_f32_16x16x32_bf16 v[80:83], v[84:87], a[24:27], v[80:83]
    ds_read_b128 v[112:115], v10 offset:41984
    s_waitcnt vmcnt(8) lgkmcnt(6)
    v_mfma_f32_16x16x32_bf16 v[64:67], v[88:91], a[28:31], v[64:67]
    ds_read_b128 v[116:119], v10 offset:43008
    s_waitcnt lgkmcnt(6)
    v_mfma_f32_16x16x32_bf16 v[68:71], v[92:95], a[28:31], v[68:71]
    ds_read_b128 v[84:87], v10 offset:44032
    s_waitcnt lgkmcnt(6)
    v_mfma_f32_16x16x32_bf16 v[72:75], v[96:99], a[28:31], v[72:75]
    ds_read_b128 v[88:91], v10 offset:45056
    s_waitcnt lgkmcnt(6)
    v_mfma_f32_16x16x32_bf16 v[76:79], v[100:103], a[28:31], v[76:79]
    ds_read_b128 v[92:95], v10 offset:46080
    s_waitcnt lgkmcnt(6)
    v_mfma_f32_16x16x32_bf16 v[80:83], v[104:107], a[28:31], v[80:83]
    ds_read_b128 v[96:99], v10 offset:47104
    s_waitcnt vmcnt(7) lgkmcnt(6)
    v_mfma_f32_16x16x32_bf16 v[64:67], v[108:111], a[32:35], v[64:67]
    ds_read_b128 v[100:103], v10 offset:48128
    s_waitcnt lgkmcnt(6)
    v_mfma_f32_16x16x32_bf16 v[68:71], v[112:115], a[32:35], v[68:71]
    ds_read_b128 v[104:107], v10 offset:49152
    s_waitcnt lgkmcnt(6)
    v_mfma_f32_16x16x32_bf16 v[72:75], v[116:119], a[32:35], v[72:75]
    ds_read_b128 v[108:111], v10 offset:50176
    s_waitcnt lgkmcnt(6)
    v_mfma_f32_16x16x32_bf16 v[76:79], v[84:87], a[32:35], v[76:79]
    ds_read_b128 v[112:115], v10 offset:51200
    s_waitcnt lgkmcnt(6)
    v_mfma_f32_16x16x32_bf16 v[80:83], v[88:91], a[32:35], v[80:83]
    ds_read_b128 v[116:119], v10 offset:52224
    s_waitcnt vmcnt(6) lgkmcnt(6)
    v_mfma_f32_16x16x32_bf16 v[64:67], v[92:95], a[36:39], v[64:67]
    ds_read_b128 v[84:87], v10 offset:53248
    s_waitcnt lgkmcnt(6)
    v_mfma_f32_16x16x32_bf16 v[68:71], v[96:99], a[36:39], v[68:71]
    ds_read_b128 v[88:91], v10 offset:54272
    s_waitcnt lgkmcnt(6)
    v_mfma_f32_16x16x32_bf16 v[72:75], v[100:103], a[36:39], v[72:75]
    ds_read_b128 v[92:95], v10 offset:55296
    s_waitcnt lgkmcnt(6)
    v_mfma_f32_16x16x32_bf16 v[76:79], v[104:107], a[36:39], v[76:79]
    ds_read_b128 v[96:99], v10 offset:56320
    s_waitcnt lgkmcnt(6)
    v_mfma_f32_16x16x32_bf16 v[80:83], v[108:111], a[36:39], v[80:83]
    ds_read_b128 v[100:103], v10 offset:57344
    s_waitcnt vmcnt(5) lgkmcnt(6)
    v_mfma_f32_16x16x32_bf16 v[64:67], v[112:115], a[40:43], v[64:67]
    ds_read_b128 v[104:107], v10 offset:58368
    s_waitcnt lgkmcnt(6)
    v_mfma_f32_16x16x32_bf16 v[68:71], v[116:119], a[40:43], v[68:71]
    ds_read_b128 v[108:111], v10 offset:59392
    s_waitcnt lgkmcnt(6)
    v_mfma_f32_16x16x32_bf16 v[72:75], v[84:87], a[40:43], v[72:75]
    ds_read_b128 v[112:115], v10 offset:60416
    s_waitcnt lgkmcnt(6)
    v_mfma_f32_16x16x32_bf16 v[76:79], v[88:91], a[40:43], v[76:79]
    ds_read_b128 v[116:119], v10 offset:61440
    s_waitcnt lgkmcnt(6)
    v_mfma_f32_16x16x32_bf16 v[80:83], v[92:95], a[40:43], v[80:83]
    ds_read_b128 v[84:87], v10 offset:62464
    s_waitcnt vmcnt(4) lgkmcnt(6)
    v_mfma_f32_16x16x32_bf16 v[64:67], v[96:99], a[44:47], v[64:67]
    ds_read_b128 v[88:91], v10 offset:63488
    s_waitcnt lgkmcnt(6)
    v_mfma_f32_16x16x32_bf16 v[68:71], v[100:103], a[44:47], v[68:71]
    ds_read_b128 v[92:95], v10 offset:64512
    s_waitcnt lgkmcnt(6)
    v_mfma_f32_16x16x32_bf16 v[72:75], v[104:107], a[44:47], v[72:75]
    ds_read_b128 v[96:99], v175 offset:0
    s_waitcnt lgkmcnt(6)
    v_mfma_f32_16x16x32_bf16 v[76:79], v[108:111], a[44:47], v[76:79]
    ds_read_b128 v[100:103], v175 offset:1024
    s_waitcnt lgkmcnt(6)
    v_mfma_f32_16x16x32_bf16 v[80:83], v[112:115], a[44:47], v[80:83]
    ds_read_b128 v[104:107], v175 offset:2048
    s_waitcnt vmcnt(3) lgkmcnt(6)
    v_mfma_f32_16x16x32_bf16 v[64:67], v[116:119], a[48:51], v[64:67]
    ds_read_b128 v[108:111], v175 offset:3072
    s_waitcnt lgkmcnt(6)
    v_mfma_f32_16x16x32_bf16 v[68:71], v[84:87], a[48:51], v[68:71]
    ds_read_b128 v[112:115], v175 offset:4096
    s_waitcnt lgkmcnt(6)
    v_mfma_f32_16x16x32_bf16 v[72:75], v[88:91], a[48:51], v[72:75]
    ds_read_b128 v[116:119], v175 offset:5120
    s_waitcnt lgkmcnt(6)
    v_mfma_f32_16x16x32_bf16 v[76:79], v[92:95], a[48:51], v[76:79]
    ds_read_b128 v[84:87], v175 offset:6144
    s_waitcnt lgkmcnt(6)
    v_mfma_f32_16x16x32_bf16 v[80:83], v[96:99], a[48:51], v[80:83]
    ds_read_b128 v[88:91], v175 offset:7168
    s_waitcnt vmcnt(2) lgkmcnt(6)
    v_mfma_f32_16x16x32_bf16 v[64:67], v[100:103], a[52:55], v[64:67]
    ds_read_b128 v[92:95], v175 offset:8192
    s_waitcnt lgkmcnt(6)
    v_mfma_f32_16x16x32_bf16 v[68:71], v[104:107], a[52:55], v[68:71]
    ds_read_b128 v[96:99], v175 offset:9216
    s_waitcnt lgkmcnt(6)
    v_mfma_f32_16x16x32_bf16 v[72:75], v[108:111], a[52:55], v[72:75]
    ds_read_b128 v[100:103], v175 offset:10240
    s_waitcnt lgkmcnt(6)
    v_mfma_f32_16x16x32_bf16 v[76:79], v[112:115], a[52:55], v[76:79]
    ds_read_b128 v[104:107], v175 offset:11264
    s_waitcnt lgkmcnt(6)
    v_mfma_f32_16x16x32_bf16 v[80:83], v[116:119], a[52:55], v[80:83]
    ds_read_b128 v[108:111], v175 offset:12288
    s_waitcnt vmcnt(1) lgkmcnt(6)
    v_mfma_f32_16x16x32_bf16 v[64:67], v[84:87], a[56:59], v[64:67]
    ds_read_b128 v[112:115], v175 offset:13312
    s_waitcnt lgkmcnt(6)
    v_mfma_f32_16x16x32_bf16 v[68:71], v[88:91], a[56:59], v[68:71]
    ds_read_b128 v[116:119], v175 offset:14336
    s_waitcnt lgkmcnt(6)
    v_mfma_f32_16x16x32_bf16 v[72:75], v[92:95], a[56:59], v[72:75]
    ds_read_b128 v[84:87], v175 offset:15360
    s_waitcnt lgkmcnt(6)
    v_mfma_f32_16x16x32_bf16 v[76:79], v[96:99], a[56:59], v[76:79]
    s_waitcnt lgkmcnt(5)
    v_mfma_f32_16x16x32_bf16 v[80:83], v[100:103], a[56:59], v[80:83]
    s_waitcnt vmcnt(0) lgkmcnt(4)
    v_mfma_f32_16x16x32_bf16 v[64:67], v[104:107], a[60:63], v[64:67]
    s_waitcnt lgkmcnt(3)
    v_mfma_f32_16x16x32_bf16 v[68:71], v[108:111], a[60:63], v[68:71]
    s_waitcnt lgkmcnt(2)
    v_mfma_f32_16x16x32_bf16 v[72:75], v[112:115], a[60:63], v[72:75]
    s_waitcnt lgkmcnt(1)
    v_mfma_f32_16x16x32_bf16 v[76:79], v[116:119], a[60:63], v[76:79]
    s_waitcnt lgkmcnt(0)
    v_mfma_f32_16x16x32_bf16 v[80:83], v[84:87], a[60:63], v[80:83]
    s_nop 7
    v_cmp_u_f32 vcc, v80, v80
    s_cbranch_vccz L_ok_56
    s_add_u32 s51, s51, 1
    s_cmp_gt_u32 s51, 200000
    s_cbranch_scc1 L_ok_56
    s_waitcnt vmcnt(0) lgkmcnt(0)
    s_sleep 2
    s_branch L_wo_54
L_ok_56:
    v_cvt_pk_bf16_f32 v40, v64, v65
    v_cvt_pk_bf16_f32 v41, v66, v67
    v_cvt_pk_bf16_f32 v42, v68, v69
    v_cvt_pk_bf16_f32 v43, v70, v71
    v_cvt_pk_bf16_f32 v44, v72, v73
    v_cvt_pk_bf16_f32 v45, v74, v75
    v_cvt_pk_bf16_f32 v46, v76, v77
    v_cvt_pk_bf16_f32 v47, v78, v79
    v_cvt_pk_bf16_f32 v48, v80, v81
    v_cvt_pk_bf16_f32 v49, v82, v83
    v_permlane16_swap_b32 v40, v42
    v_permlane16_swap_b32 v41, v43
    v_permlane16_swap_b32 v44, v46
    v_permlane16_swap_b32 v45, v47
    v_permlane16_swap_b32 v48, v50
    v_permlane16_swap_b32 v49, v51
    v_and_b32 v164, 15, v21
    v_mul_u32_u24 v164, 1280, v164
    v_lshrrev_b32 v165, 9, v11
    v_lshl_add_u32 v164, v165, 4, v164
    s_mul_i32 s52, s50, 20480
    s_mul_i32 s53, s47, 160
    s_add_u32 s52, s52, s53
    buffer_store_dwordx4 v[40:43], v164, s[36:39], s52 offen
    buffer_store_dwordx4 v[44:47], v164, s[36:39], s52 offen offset:64
    s_mov_b32 exec_lo, 0xffff
    s_mov_b32 exec_hi, 0xffff
    buffer_store_dwordx4 v[48:51], v164, s[36:39], s52 offen offset:128
    s_mov_b64 exec, -1
    s_waitcnt vmcnt(0)
L_end:
    s_endpgm
.section .rodata,"a"
.p2align 6
.amdhsa_kernel interleave_layers__sliding_local_dilated__linear_kernel_hedgehog__prompt_kernel
  .amdhsa_next_free_vgpr 512
  .amdhsa_next_free_sgpr 102
  .amdhsa_accum_offset 256
  .amdhsa_group_segment_fixed_size 0
  .amdhsa_kernarg_size 80
  .amdhsa_user_sgpr_count 2
  .amdhsa_user_sgpr_kernarg_segment_ptr 1
  .amdhsa_system_sgpr_workgroup_id_x 1
  .amdhsa_float_denorm_mode_32 3
.end_amdhsa_kernel
```
